```python
import torch

def _softmax(x, axis=-1):
    return torch.softmax(x, dim=axis)
def _gelu(x):
    return torch.nn.functional.gelu(x, approximate="tanh")
def _silu(x):
    return torch.nn.functional.silu(x)
def _sigmoid(x):
    return torch.sigmoid(x)
def _layernorm(x, axis=-1, eps=1e-5):
    m = x.mean(dim=axis, keepdim=True)
    v = x.var(dim=axis, keepdim=True, unbiased=False)
    return (x - m) / torch.sqrt(v + eps)
def _scatter_add(tgt, idx, src, axis=0):
    return tgt.clone().index_add_(axis, idx, src)
def _segment_sum(src, seg, n):
    out = torch.zeros((n,) + src.shape[1:], dtype=src.dtype)
    return out.index_add_(0, seg, src)
def _pad(x, pw):
    flat = tuple(v for pair in reversed(pw) for v in pair)
    return torch.nn.functional.pad(x, flat)

kernel_name = 'standalone__mha_softmax__near_ridge'

def setup_inputs():

    _w = (lambda a: (lambda t: t.to(torch.bfloat16) if t.is_floating_point() else t)(torch.as_tensor(a)))
    B, H, Sq, Sk, D = 8, 16, 304, 1024, 256
    return {
        "q": _w((lambda *s: torch.randn(*s, dtype=torch.bfloat16) * 0.8)(B, H, Sq, D)),
        "k": _w((lambda *s: torch.randn(*s, dtype=torch.bfloat16) * 0.8)(B, H, Sk, D)),
        "v": _w((lambda *s: torch.randn(*s, dtype=torch.bfloat16) * 0.05)(B, H, Sk, D)),
    }

def reference(q, k, v):
    scale = q.shape[-1] ** -0.5
    scores = torch.einsum("bhqd,bhkd->bhqk", q, k) * scale
    p = _softmax(scores, axis=-1)
    return torch.einsum("bhqk,bhkd->bhqd", p, v)
```

```asm
; @launch grid=(256,1,1) block=(256,1,1) lds=152576
.amdgcn_target "amdgcn-amd-amdhsa--gfx950"
.text
.globl standalone__mha_softmax__near_ridge_kernel
.p2align 8
.type standalone__mha_softmax__near_ridge_kernel,@function
standalone__mha_softmax__near_ridge_kernel:
  s_cmp_ge_u32 s2, 256
  s_cbranch_scc1 L_done
  s_load_dwordx4 s[4:7], s[0:1], 0
  s_load_dwordx4 s[8:11], s[0:1], 16
  s_and_b32 s14, s2, 7
  s_lshr_b32 s15, s2, 4
  s_lshl_b32 s15, s15, 3
  s_add_u32 s14, s14, s15
  s_lshr_b32 s15, s2, 3
  s_and_b32 s15, s15, 1
  v_lshrrev_b32 v242, 6, v0
  v_and_b32 v250, 63, v0
  v_readfirstlane_b32 s16, v242
  v_and_b32 v251, 31, v250
  v_lshrrev_b32 v252, 5, v250
  v_and_b32 v253, 15, v250
  v_lshrrev_b32 v254, 4, v250
  s_lshl_b32 s38, s16, 12
  s_lshl_b32 s49, s16, 3
  v_add_u32 v242, s49, v252
  v_lshlrev_b32 v243, 9, v242
  v_add_u32 v244, 0, v242
  v_and_b32 v244, 15, v244
  v_xor_b32 v244, v244, v251
  v_lshl_add_u32 v232, v244, 4, v243
  v_add_u32 v244, 2, v242
  v_and_b32 v244, 15, v244
  v_xor_b32 v244, v244, v251
  v_lshl_add_u32 v233, v244, 4, v243
  v_add_u32 v244, 4, v242
  v_and_b32 v244, 15, v244
  v_xor_b32 v244, v244, v251
  v_lshl_add_u32 v234, v244, 4, v243
  v_add_u32 v244, 6, v242
  v_and_b32 v244, 15, v244
  v_xor_b32 v244, v244, v251
  v_lshl_add_u32 v235, v244, 4, v243
  s_waitcnt lgkmcnt(0)
  s_lshl_b32 s48, s14, 19
  s_add_u32 s20, s6, s48
  s_addc_u32 s21, s7, 0
  s_and_b32 s21, s21, 0xffff
  s_mov_b32 s22, 524288
  s_mov_b32 s23, 0x20000
  s_add_u32 s24, s8, s48
  s_addc_u32 s25, s9, 0
  s_sub_u32 s24, s24, 16384
  s_subb_u32 s25, s25, 0
  s_and_b32 s25, s25, 0xffff
  s_mov_b32 s26, 540672
  s_mov_b32 s27, 0x20000
  s_mul_i32 s48, s14, 155648
  s_mul_i32 s49, s15, 81920
  s_add_u32 s48, s48, s49
  s_mul_i32 s49, s15, 8192
  s_sub_u32 s49, 81920, s49
  s_add_u32 s28, s4, s48
  s_addc_u32 s29, s5, 0
  s_and_b32 s29, s29, 0xffff
  s_mov_b32 s30, s49
  s_mov_b32 s31, 0x20000
  s_add_u32 s32, s10, s48
  s_addc_u32 s33, s11, 0
  s_and_b32 s33, s33, 0xffff
  s_mov_b32 s34, s49
  s_mov_b32 s35, 0x20000
  s_mov_b32 s36, 0
  s_add_u32 m0, s38, 0
  s_nop 0
  buffer_load_dwordx4 v232, s[20:23], s36 offen offset:0 nt lds
  buffer_load_dwordx4 v233, s[20:23], s36 offen offset:1024 nt lds
  buffer_load_dwordx4 v234, s[20:23], s36 offen offset:2048 nt lds
  buffer_load_dwordx4 v235, s[20:23], s36 offen offset:3072 nt lds
  s_mov_b32 s50, 0
  s_add_u32 m0, s38, 32768
  s_nop 0
  buffer_load_dwordx4 v232, s[28:31], s50 offen offset:0 nt lds
  buffer_load_dwordx4 v233, s[28:31], s50 offen offset:1024 nt lds
  buffer_load_dwordx4 v234, s[28:31], s50 offen offset:2048 nt lds
  buffer_load_dwordx4 v235, s[28:31], s50 offen offset:3072 nt lds
  s_mov_b32 s50, 16384
  s_add_u32 m0, s38, 49152
  s_nop 0
  buffer_load_dwordx4 v232, s[28:31], s50 offen offset:0 nt lds
  buffer_load_dwordx4 v233, s[28:31], s50 offen offset:1024 nt lds
  buffer_load_dwordx4 v234, s[28:31], s50 offen offset:2048 nt lds
  buffer_load_dwordx4 v235, s[28:31], s50 offen offset:3072 nt lds
  s_mov_b32 s50, 32768
  s_add_u32 m0, s38, 98304
  s_nop 0
  buffer_load_dwordx4 v232, s[28:31], s50 offen offset:0 nt lds
  buffer_load_dwordx4 v233, s[28:31], s50 offen offset:1024 nt lds
  buffer_load_dwordx4 v234, s[28:31], s50 offen offset:2048 nt lds
  buffer_load_dwordx4 v235, s[28:31], s50 offen offset:3072 nt lds
  s_mov_b32 s50, 49152
  s_add_u32 m0, s38, 114688
  s_nop 0
  buffer_load_dwordx4 v232, s[28:31], s50 offen offset:0 nt lds
  buffer_load_dwordx4 v233, s[28:31], s50 offen offset:1024 nt lds
  buffer_load_dwordx4 v234, s[28:31], s50 offen offset:2048 nt lds
  buffer_load_dwordx4 v235, s[28:31], s50 offen offset:3072 nt lds
  s_mov_b32 s50, 65536
  s_add_u32 m0, s38, 136192
  s_nop 0
  buffer_load_dwordx4 v232, s[28:31], s50 offen offset:0 nt lds
  buffer_load_dwordx4 v233, s[28:31], s50 offen offset:1024 nt lds
  buffer_load_dwordx4 v234, s[28:31], s50 offen offset:2048 nt lds
  buffer_load_dwordx4 v235, s[28:31], s50 offen offset:3072 nt lds
  v_lshlrev_b32 v245, 9, v253
  v_add_u32 v244, 0, v254
  v_xor_b32 v244, v244, v253
  v_lshl_add_u32 v220, v244, 4, v245
  v_add_u32 v244, 4, v254
  v_xor_b32 v244, v244, v253
  v_lshl_add_u32 v221, v244, 4, v245
  v_add_u32 v244, 8, v254
  v_xor_b32 v244, v244, v253
  v_lshl_add_u32 v222, v244, 4, v245
  v_add_u32 v244, 12, v254
  v_xor_b32 v244, v244, v253
  v_lshl_add_u32 v223, v244, 4, v245
  v_add_u32 v244, 0, v252
  v_lshlrev_b32 v244, 1, v244
  v_xor_b32 v244, v244, v251
  v_lshl_add_u32 v236, v244, 4, v243
  v_add_u32 v244, 2, v252
  v_lshlrev_b32 v244, 1, v244
  v_xor_b32 v244, v244, v251
  v_lshl_add_u32 v237, v244, 4, v243
  v_add_u32 v244, 4, v252
  v_lshlrev_b32 v244, 1, v244
  v_xor_b32 v244, v244, v251
  v_lshl_add_u32 v238, v244, 4, v243
  v_add_u32 v244, 6, v252
  v_lshlrev_b32 v244, 1, v244
  v_xor_b32 v244, v244, v251
  v_lshl_add_u32 v239, v244, 4, v243
  s_mov_b32 s36, 16384
  s_add_u32 m0, s38, 16384
  s_nop 0
  buffer_load_dwordx4 v232, s[20:23], s36 offen offset:0 nt lds
  buffer_load_dwordx4 v233, s[20:23], s36 offen offset:1024 nt lds
  buffer_load_dwordx4 v234, s[20:23], s36 offen offset:2048 nt lds
  buffer_load_dwordx4 v235, s[20:23], s36 offen offset:3072 nt lds
  s_mov_b32 s37, 16384
  s_add_u32 m0, s38, 65536
  s_nop 0
  buffer_load_dwordx4 v236, s[24:27], s37 offen offset:0 nt lds
  buffer_load_dwordx4 v237, s[24:27], s37 offen offset:1024 nt lds
  buffer_load_dwordx4 v238, s[24:27], s37 offen offset:2048 nt lds
  buffer_load_dwordx4 v239, s[24:27], s37 offen offset:3072 nt lds
  s_mov_b32 s41, 0
  s_mov_b32 s39, 0x3db8aa3b
  s_mov_b32 s42, 0x4e800000
  v_lshrrev_b32 v242, 2, v250
  v_lshlrev_b32 v243, 9, v242
  v_and_b32 v244, 3, v250
  v_lshl_add_u32 v243, v244, 3, v243
  v_add_u32 v243, 65536, v243
  v_and_b32 v242, 7, v242
  v_xor_b32 v242, s16, v242
  v_xor_b32 v244, 0, v242
  v_lshl_add_u32 v224, v244, 5, v243
  v_xor_b32 v244, 1, v242
  v_lshl_add_u32 v225, v244, 5, v243
  v_xor_b32 v244, 2, v242
  v_lshl_add_u32 v226, v244, 5, v243
  v_xor_b32 v244, 3, v242
  v_lshl_add_u32 v227, v244, 5, v243
  v_xor_b32 v244, 4, v242
  v_lshl_add_u32 v228, v244, 5, v243
  v_xor_b32 v244, 5, v242
  v_lshl_add_u32 v229, v244, 5, v243
  v_xor_b32 v244, 6, v242
  v_lshl_add_u32 v230, v244, 5, v243
  v_xor_b32 v244, 7, v242
  v_lshl_add_u32 v231, v244, 5, v243
  v_lshlrev_b32 v242, 4, v250
  v_add_u32 v241, 131072, v242
  s_lshr_b32 s49, s16, 1
  s_lshl_b32 s49, s49, 10
  s_and_b32 s50, s16, 1
  s_lshl_b32 s50, s50, 3
  s_add_u32 s49, s49, s50
  v_add_u32 v240, s49, v241
  v_mov_b32 v0, 0
  v_mov_b32 v1, 0
  v_mov_b32 v2, 0
  v_mov_b32 v3, 0
  v_mov_b32 v4, 0
  v_mov_b32 v5, 0
  v_mov_b32 v6, 0
  v_mov_b32 v7, 0
  v_mov_b32 v8, 0
  v_mov_b32 v9, 0
  v_mov_b32 v10, 0
  v_mov_b32 v11, 0
  v_mov_b32 v12, 0
  v_mov_b32 v13, 0
  v_mov_b32 v14, 0
  v_mov_b32 v15, 0
  v_mov_b32 v16, 0
  v_mov_b32 v17, 0
  v_mov_b32 v18, 0
  v_mov_b32 v19, 0
  v_mov_b32 v20, 0
  v_mov_b32 v21, 0
  v_mov_b32 v22, 0
  v_mov_b32 v23, 0
  v_mov_b32 v24, 0
  v_mov_b32 v25, 0
  v_mov_b32 v26, 0
  v_mov_b32 v27, 0
  v_mov_b32 v28, 0
  v_mov_b32 v29, 0
  v_mov_b32 v30, 0
  v_mov_b32 v31, 0
  v_mov_b32 v32, 0
  v_mov_b32 v33, 0
  v_mov_b32 v34, 0
  v_mov_b32 v35, 0
  v_mov_b32 v36, 0
  v_mov_b32 v37, 0
  v_mov_b32 v38, 0
  v_mov_b32 v39, 0
  v_mov_b32 v40, 0
  v_mov_b32 v41, 0
  v_mov_b32 v42, 0
  v_mov_b32 v43, 0
  v_mov_b32 v44, 0
  v_mov_b32 v45, 0
  v_mov_b32 v46, 0
  v_mov_b32 v47, 0
  v_mov_b32 v48, 0
  v_mov_b32 v49, 0
  v_mov_b32 v50, 0
  v_mov_b32 v51, 0
  v_mov_b32 v52, 0
  v_mov_b32 v53, 0
  v_mov_b32 v54, 0
  v_mov_b32 v55, 0
  v_mov_b32 v56, 0
  v_mov_b32 v57, 0
  v_mov_b32 v58, 0
  v_mov_b32 v59, 0
  v_mov_b32 v60, 0
  v_mov_b32 v61, 0
  v_mov_b32 v62, 0
  v_mov_b32 v63, 0
  v_mov_b32 v64, 0
  v_mov_b32 v65, 0
  v_mov_b32 v66, 0
  v_mov_b32 v67, 0
  v_mov_b32 v68, 0
  v_mov_b32 v69, 0
  v_mov_b32 v70, 0
  v_mov_b32 v71, 0
  v_mov_b32 v72, 0
  v_mov_b32 v73, 0
  v_mov_b32 v74, 0
  v_mov_b32 v75, 0
  v_mov_b32 v76, 0
  v_mov_b32 v77, 0
  v_mov_b32 v78, 0
  v_mov_b32 v79, 0
  v_mov_b32 v80, 0
  v_mov_b32 v81, 0
  v_mov_b32 v82, 0
  v_mov_b32 v83, 0
  v_mov_b32 v84, 0
  v_mov_b32 v85, 0
  v_mov_b32 v86, 0
  v_mov_b32 v87, 0
  v_mov_b32 v88, 0
  v_mov_b32 v89, 0
  v_mov_b32 v90, 0
  v_mov_b32 v91, 0
  v_mov_b32 v92, 0
  v_mov_b32 v93, 0
  v_mov_b32 v94, 0
  v_mov_b32 v95, 0
  v_mov_b32 v96, 0
  v_mov_b32 v97, 0
  v_mov_b32 v98, 0
  v_mov_b32 v99, 0
  v_mov_b32 v100, 0
  v_mov_b32 v101, 0
  v_mov_b32 v102, 0
  v_mov_b32 v103, 0
  v_mov_b32 v104, 0
  v_mov_b32 v105, 0
  v_mov_b32 v106, 0
  v_mov_b32 v107, 0
  v_mov_b32 v108, 0
  v_mov_b32 v109, 0
  v_mov_b32 v110, 0
  v_mov_b32 v111, 0
  v_mov_b32 v112, 0
  v_mov_b32 v113, 0
  v_mov_b32 v114, 0
  v_mov_b32 v115, 0
  v_mov_b32 v116, 0
  v_mov_b32 v117, 0
  v_mov_b32 v118, 0
  v_mov_b32 v119, 0
  v_mov_b32 v120, 0
  v_mov_b32 v121, 0
  v_mov_b32 v122, 0
  v_mov_b32 v123, 0
  v_mov_b32 v124, 0
  v_mov_b32 v125, 0
  v_mov_b32 v126, 0
  v_mov_b32 v127, 0
  v_mov_b32 v128, 0
  v_mov_b32 v129, 0
  v_mov_b32 v130, 0
  v_mov_b32 v131, 0
  v_mov_b32 v132, 0
  v_mov_b32 v133, 0
  v_mov_b32 v134, 0
  v_mov_b32 v135, 0
  v_mov_b32 v136, 0
  v_mov_b32 v137, 0
  v_mov_b32 v138, 0
  v_mov_b32 v139, 0
  v_mov_b32 v140, 0
  v_mov_b32 v141, 0
  v_mov_b32 v142, 0
  v_mov_b32 v143, 0
  v_mov_b32 v144, 0
  v_mov_b32 v145, 0
  v_mov_b32 v146, 0
  v_mov_b32 v147, 0
  v_mov_b32 v148, 0
  v_mov_b32 v149, 0
  v_mov_b32 v150, 0
  v_mov_b32 v151, 0
  v_mov_b32 v152, 0
  v_mov_b32 v153, 0
  v_mov_b32 v154, 0
  v_mov_b32 v155, 0
  v_mov_b32 v156, 0
  v_mov_b32 v157, 0
  v_mov_b32 v158, 0
  v_mov_b32 v159, 0
  v_mov_b32 v214, 0
  v_mov_b32 v215, 0
  v_mov_b32 v216, 0
  s_lshl_b32 s49, s16, 14
  s_and_b32 s50, s16, 2
  s_lshl_b32 s50, s50, 14
  s_add_u32 s49, s49, s50
  s_add_u32 s49, s49, 32768
  v_add_u32 v242, s49, v220
  v_add_u32 v243, s49, v221
  v_add_u32 v244, s49, v222
  v_add_u32 v245, s49, v223
  s_lshr_b32 s49, s16, 1
  s_lshl_b32 s49, s49, 13
  s_add_u32 s49, s49, 136192
  v_add_u32 v246, s49, v220
  v_add_u32 v247, s49, v221
  v_add_u32 v248, s49, v222
  v_add_u32 v249, s49, v223
  s_waitcnt vmcnt(8)
  s_barrier
  ds_read_b128 a[64:67], v220 offset:0
  ds_read_b128 a[128:131], v242 offset:0
  ds_read_b128 a[160:163], v242 offset:8192
  ds_read_b128 a[192:195], v246 offset:0
  ds_read_b128 a[68:71], v221 offset:0
  ds_read_b128 a[132:135], v243 offset:0
  ds_read_b128 a[164:167], v243 offset:8192
  ds_read_b128 a[196:199], v247 offset:0
  ds_read_b128 a[72:75], v222 offset:0
  ds_read_b128 a[136:139], v244 offset:0
  ds_read_b128 a[168:171], v244 offset:8192
  ds_read_b128 a[200:203], v248 offset:0
  ds_read_b128 a[76:79], v223 offset:0
  ds_read_b128 a[140:143], v245 offset:0
  ds_read_b128 a[172:175], v245 offset:8192
  ds_read_b128 a[204:207], v249 offset:0
  s_waitcnt lgkmcnt(12)
  v_mfma_f32_16x16x32_bf16 v[160:163], a[64:67], a[128:131], 0
  v_mfma_f32_16x16x32_bf16 v[164:167], a[64:67], a[160:163], 0
  v_mfma_f32_16x16x32_bf16 v[192:195], a[64:67], a[192:195], 0
  ds_read_b128 a[80:83], v220 offset:256
  ds_read_b128 a[144:147], v242 offset:256
  ds_read_b128 a[176:179], v242 offset:8448
  ds_read_b128 a[208:211], v246 offset:256
  s_waitcnt lgkmcnt(12)
  v_mfma_f32_16x16x32_bf16 v[160:163], a[68:71], a[132:135], v[160:163]
  v_mfma_f32_16x16x32_bf16 v[164:167], a[68:71], a[164:167], v[164:167]
  v_mfma_f32_16x16x32_bf16 v[192:195], a[68:71], a[196:199], v[192:195]
  ds_read_b128 a[84:87], v221 offset:256
  ds_read_b128 a[148:151], v243 offset:256
  ds_read_b128 a[180:183], v243 offset:8448
  ds_read_b128 a[212:215], v247 offset:256
  s_waitcnt lgkmcnt(12)
  v_mfma_f32_16x16x32_bf16 v[160:163], a[72:75], a[136:139], v[160:163]
  v_mfma_f32_16x16x32_bf16 v[164:167], a[72:75], a[168:171], v[164:167]
  v_mfma_f32_16x16x32_bf16 v[192:195], a[72:75], a[200:203], v[192:195]
  ds_read_b128 a[88:91], v222 offset:256
  ds_read_b128 a[152:155], v244 offset:256
  ds_read_b128 a[184:187], v244 offset:8448
  ds_read_b128 a[216:219], v248 offset:256
  s_waitcnt lgkmcnt(12)
  v_mfma_f32_16x16x32_bf16 v[160:163], a[76:79], a[140:143], v[160:163]
  v_mfma_f32_16x16x32_bf16 v[164:167], a[76:79], a[172:175], v[164:167]
  v_mfma_f32_16x16x32_bf16 v[192:195], a[76:79], a[204:207], v[192:195]
  ds_read_b128 a[92:95], v223 offset:256
  ds_read_b128 a[156:159], v245 offset:256
  ds_read_b128 a[188:191], v245 offset:8448
  ds_read_b128 a[220:223], v249 offset:256
  s_waitcnt lgkmcnt(12)
  v_mfma_f32_16x16x32_bf16 v[160:163], a[80:83], a[144:147], v[160:163]
  v_mfma_f32_16x16x32_bf16 v[164:167], a[80:83], a[176:179], v[164:167]
  v_mfma_f32_16x16x32_bf16 v[192:195], a[80:83], a[208:211], v[192:195]
  ds_read_b128 a[96:99], v220 offset:8192
  ds_read_b128 a[100:103], v221 offset:8192
  ds_read_b128 a[104:107], v222 offset:8192
  s_waitcnt lgkmcnt(11)
  v_mfma_f32_16x16x32_bf16 v[160:163], a[84:87], a[148:151], v[160:163]
  v_mfma_f32_16x16x32_bf16 v[164:167], a[84:87], a[180:183], v[164:167]
  v_mfma_f32_16x16x32_bf16 v[192:195], a[84:87], a[212:215], v[192:195]
  ds_read_b128 a[108:111], v223 offset:8192
  ds_read_b128 a[112:115], v220 offset:8448
  ds_read_b128 a[116:119], v221 offset:8448
  s_waitcnt lgkmcnt(10)
  v_mfma_f32_16x16x32_bf16 v[160:163], a[88:91], a[152:155], v[160:163]
  v_mfma_f32_16x16x32_bf16 v[164:167], a[88:91], a[184:187], v[164:167]
  v_mfma_f32_16x16x32_bf16 v[192:195], a[88:91], a[216:219], v[192:195]
  ds_read_b128 a[120:123], v222 offset:8448
  ds_read_b128 a[124:127], v223 offset:8448
  s_waitcnt lgkmcnt(8)
  v_mfma_f32_16x16x32_bf16 v[160:163], a[92:95], a[156:159], v[160:163]
  v_mfma_f32_16x16x32_bf16 v[164:167], a[92:95], a[188:191], v[164:167]
  v_mfma_f32_16x16x32_bf16 v[192:195], a[92:95], a[220:223], v[192:195]
  s_waitcnt lgkmcnt(0)
  s_barrier
  v_mfma_f32_16x16x32_bf16 v[168:171], a[96:99], a[128:131], 0
  v_mfma_f32_16x16x32_bf16 v[172:175], a[96:99], a[160:163], 0
  v_mfma_f32_16x16x32_bf16 v[196:199], a[96:99], a[192:195], 0
  s_mov_b32 s53, 32768
  s_add_u32 m0, s38, 81920
  v_mfma_f32_16x16x32_bf16 v[168:171], a[100:103], a[132:135], v[168:171]
  v_mfma_f32_16x16x32_bf16 v[172:175], a[100:103], a[164:167], v[172:175]
  v_mfma_f32_16x16x32_bf16 v[196:199], a[100:103], a[196:199], v[196:199]
  s_nop 0
  buffer_load_dwordx4 v236, s[24:27], s53 offen offset:0 nt lds
  v_mfma_f32_16x16x32_bf16 v[168:171], a[104:107], a[136:139], v[168:171]
  v_mfma_f32_16x16x32_bf16 v[172:175], a[104:107], a[168:171], v[172:175]
  v_mfma_f32_16x16x32_bf16 v[196:199], a[104:107], a[200:203], v[196:199]
  buffer_load_dwordx4 v237, s[24:27], s53 offen offset:1024 nt lds
  buffer_load_dwordx4 v238, s[24:27], s53 offen offset:2048 nt lds
  v_max3_f32 v217, v160, v161, v162
  v_max3_f32 v218, v164, v165, v166
  v_max3_f32 v219, v192, v193, v194
  v_max_f32 v217, v217, v163
  v_mfma_f32_16x16x32_bf16 v[168:171], a[108:111], a[140:143], v[168:171]
  v_mfma_f32_16x16x32_bf16 v[172:175], a[108:111], a[172:175], v[172:175]
  v_mfma_f32_16x16x32_bf16 v[196:199], a[108:111], a[204:207], v[196:199]
  buffer_load_dwordx4 v239, s[24:27], s53 offen offset:3072 nt lds
  s_mov_b32 s36, 32768
  v_max_f32 v218, v218, v167
  v_max_f32 v219, v219, v195
  v_mov_b32 v176, v217
  v_mov_b32 v177, v218
  v_mfma_f32_16x16x32_bf16 v[168:171], a[112:115], a[144:147], v[168:171]
  v_mfma_f32_16x16x32_bf16 v[172:175], a[112:115], a[176:179], v[172:175]
  v_mfma_f32_16x16x32_bf16 v[196:199], a[112:115], a[208:211], v[196:199]
  s_add_u32 m0, s38, 32768
  s_nop 0
  v_mov_b32 v178, v219
  v_permlane32_swap_b32 v217, v176
  v_permlane32_swap_b32 v218, v177
  v_permlane32_swap_b32 v219, v178
  v_mfma_f32_16x16x32_bf16 v[168:171], a[116:119], a[148:151], v[168:171]
  v_mfma_f32_16x16x32_bf16 v[172:175], a[116:119], a[180:183], v[172:175]
  v_mfma_f32_16x16x32_bf16 v[196:199], a[116:119], a[212:215], v[196:199]
  buffer_load_dwordx4 v232, s[20:23], s36 offen offset:0 nt lds
  buffer_load_dwordx4 v233, s[20:23], s36 offen offset:1024 nt lds
  v_max_f32 v217, v217, v176
  v_max_f32 v218, v218, v177
  v_max_f32 v219, v219, v178
  v_mov_b32 v176, v217
  v_mfma_f32_16x16x32_bf16 v[168:171], a[120:123], a[152:155], v[168:171]
  v_mfma_f32_16x16x32_bf16 v[172:175], a[120:123], a[184:187], v[172:175]
  v_mfma_f32_16x16x32_bf16 v[196:199], a[120:123], a[216:219], v[196:199]
  buffer_load_dwordx4 v234, s[20:23], s36 offen offset:2048 nt lds
  buffer_load_dwordx4 v235, s[20:23], s36 offen offset:3072 nt lds
  v_mov_b32 v177, v218
  v_mov_b32 v178, v219
  v_permlane16_swap_b32 v217, v176
  v_permlane16_swap_b32 v218, v177
  v_mfma_f32_16x16x32_bf16 v[168:171], a[124:127], a[156:159], v[168:171]
  v_mfma_f32_16x16x32_bf16 v[172:175], a[124:127], a[188:191], v[172:175]
  v_mfma_f32_16x16x32_bf16 v[196:199], a[124:127], a[220:223], v[196:199]
  v_permlane16_swap_b32 v219, v178
  v_max_f32 v217, v217, v176
  v_max_f32 v218, v218, v177
  v_max_f32 v219, v219, v178
  s_nop 7
  s_branch L_qk0done
L_restart:
  s_mov_b32 s36, 0
  s_add_u32 m0, s38, 0
  s_nop 0
  buffer_load_dwordx4 v232, s[20:23], s36 offen offset:0 nt lds
  buffer_load_dwordx4 v233, s[20:23], s36 offen offset:1024 nt lds
  buffer_load_dwordx4 v234, s[20:23], s36 offen offset:2048 nt lds
  buffer_load_dwordx4 v235, s[20:23], s36 offen offset:3072 nt lds
  s_mov_b32 s36, 16384
  s_add_u32 m0, s38, 16384
  s_nop 0
  buffer_load_dwordx4 v232, s[20:23], s36 offen offset:0 nt lds
  buffer_load_dwordx4 v233, s[20:23], s36 offen offset:1024 nt lds
  buffer_load_dwordx4 v234, s[20:23], s36 offen offset:2048 nt lds
  buffer_load_dwordx4 v235, s[20:23], s36 offen offset:3072 nt lds
  s_mov_b32 s37, 16384
  s_add_u32 m0, s38, 65536
  s_nop 0
  buffer_load_dwordx4 v236, s[24:27], s37 offen offset:0 nt lds
  buffer_load_dwordx4 v237, s[24:27], s37 offen offset:1024 nt lds
  buffer_load_dwordx4 v238, s[24:27], s37 offen offset:2048 nt lds
  buffer_load_dwordx4 v239, s[24:27], s37 offen offset:3072 nt lds
  s_mov_b32 s37, 32768
  s_add_u32 m0, s38, 81920
  s_nop 0
  buffer_load_dwordx4 v236, s[24:27], s37 offen offset:0 nt lds
  buffer_load_dwordx4 v237, s[24:27], s37 offen offset:1024 nt lds
  buffer_load_dwordx4 v238, s[24:27], s37 offen offset:2048 nt lds
  buffer_load_dwordx4 v239, s[24:27], s37 offen offset:3072 nt lds
  s_mov_b32 s36, 32768
  s_add_u32 m0, s38, 32768
  s_nop 0
  buffer_load_dwordx4 v232, s[20:23], s36 offen offset:0 nt lds
  buffer_load_dwordx4 v233, s[20:23], s36 offen offset:1024 nt lds
  buffer_load_dwordx4 v234, s[20:23], s36 offen offset:2048 nt lds
  buffer_load_dwordx4 v235, s[20:23], s36 offen offset:3072 nt lds
  v_mov_b32 v0, 0
  v_mov_b32 v1, 0
  v_mov_b32 v2, 0
  v_mov_b32 v3, 0
  v_mov_b32 v4, 0
  v_mov_b32 v5, 0
  v_mov_b32 v6, 0
  v_mov_b32 v7, 0
  v_mov_b32 v8, 0
  v_mov_b32 v9, 0
  v_mov_b32 v10, 0
  v_mov_b32 v11, 0
  v_mov_b32 v12, 0
  v_mov_b32 v13, 0
  v_mov_b32 v14, 0
  v_mov_b32 v15, 0
  v_mov_b32 v16, 0
  v_mov_b32 v17, 0
  v_mov_b32 v18, 0
  v_mov_b32 v19, 0
  v_mov_b32 v20, 0
  v_mov_b32 v21, 0
  v_mov_b32 v22, 0
  v_mov_b32 v23, 0
  v_mov_b32 v24, 0
  v_mov_b32 v25, 0
  v_mov_b32 v26, 0
  v_mov_b32 v27, 0
  v_mov_b32 v28, 0
  v_mov_b32 v29, 0
  v_mov_b32 v30, 0
  v_mov_b32 v31, 0
  v_mov_b32 v32, 0
  v_mov_b32 v33, 0
  v_mov_b32 v34, 0
  v_mov_b32 v35, 0
  v_mov_b32 v36, 0
  v_mov_b32 v37, 0
  v_mov_b32 v38, 0
  v_mov_b32 v39, 0
  v_mov_b32 v40, 0
  v_mov_b32 v41, 0
  v_mov_b32 v42, 0
  v_mov_b32 v43, 0
  v_mov_b32 v44, 0
  v_mov_b32 v45, 0
  v_mov_b32 v46, 0
  v_mov_b32 v47, 0
  v_mov_b32 v48, 0
  v_mov_b32 v49, 0
  v_mov_b32 v50, 0
  v_mov_b32 v51, 0
  v_mov_b32 v52, 0
  v_mov_b32 v53, 0
  v_mov_b32 v54, 0
  v_mov_b32 v55, 0
  v_mov_b32 v56, 0
  v_mov_b32 v57, 0
  v_mov_b32 v58, 0
  v_mov_b32 v59, 0
  v_mov_b32 v60, 0
  v_mov_b32 v61, 0
  v_mov_b32 v62, 0
  v_mov_b32 v63, 0
  v_mov_b32 v64, 0
  v_mov_b32 v65, 0
  v_mov_b32 v66, 0
  v_mov_b32 v67, 0
  v_mov_b32 v68, 0
  v_mov_b32 v69, 0
  v_mov_b32 v70, 0
  v_mov_b32 v71, 0
  v_mov_b32 v72, 0
  v_mov_b32 v73, 0
  v_mov_b32 v74, 0
  v_mov_b32 v75, 0
  v_mov_b32 v76, 0
  v_mov_b32 v77, 0
  v_mov_b32 v78, 0
  v_mov_b32 v79, 0
  v_mov_b32 v80, 0
  v_mov_b32 v81, 0
  v_mov_b32 v82, 0
  v_mov_b32 v83, 0
  v_mov_b32 v84, 0
  v_mov_b32 v85, 0
  v_mov_b32 v86, 0
  v_mov_b32 v87, 0
  v_mov_b32 v88, 0
  v_mov_b32 v89, 0
  v_mov_b32 v90, 0
  v_mov_b32 v91, 0
  v_mov_b32 v92, 0
  v_mov_b32 v93, 0
  v_mov_b32 v94, 0
  v_mov_b32 v95, 0
  v_mov_b32 v96, 0
  v_mov_b32 v97, 0
  v_mov_b32 v98, 0
  v_mov_b32 v99, 0
  v_mov_b32 v100, 0
  v_mov_b32 v101, 0
  v_mov_b32 v102, 0
  v_mov_b32 v103, 0
  v_mov_b32 v104, 0
  v_mov_b32 v105, 0
  v_mov_b32 v106, 0
  v_mov_b32 v107, 0
  v_mov_b32 v108, 0
  v_mov_b32 v109, 0
  v_mov_b32 v110, 0
  v_mov_b32 v111, 0
  v_mov_b32 v112, 0
  v_mov_b32 v113, 0
  v_mov_b32 v114, 0
  v_mov_b32 v115, 0
  v_mov_b32 v116, 0
  v_mov_b32 v117, 0
  v_mov_b32 v118, 0
  v_mov_b32 v119, 0
  v_mov_b32 v120, 0
  v_mov_b32 v121, 0
  v_mov_b32 v122, 0
  v_mov_b32 v123, 0
  v_mov_b32 v124, 0
  v_mov_b32 v125, 0
  v_mov_b32 v126, 0
  v_mov_b32 v127, 0
  v_mov_b32 v128, 0
  v_mov_b32 v129, 0
  v_mov_b32 v130, 0
  v_mov_b32 v131, 0
  v_mov_b32 v132, 0
  v_mov_b32 v133, 0
  v_mov_b32 v134, 0
  v_mov_b32 v135, 0
  v_mov_b32 v136, 0
  v_mov_b32 v137, 0
  v_mov_b32 v138, 0
  v_mov_b32 v139, 0
  v_mov_b32 v140, 0
  v_mov_b32 v141, 0
  v_mov_b32 v142, 0
  v_mov_b32 v143, 0
  v_mov_b32 v144, 0
  v_mov_b32 v145, 0
  v_mov_b32 v146, 0
  v_mov_b32 v147, 0
  v_mov_b32 v148, 0
  v_mov_b32 v149, 0
  v_mov_b32 v150, 0
  v_mov_b32 v151, 0
  v_mov_b32 v152, 0
  v_mov_b32 v153, 0
  v_mov_b32 v154, 0
  v_mov_b32 v155, 0
  v_mov_b32 v156, 0
  v_mov_b32 v157, 0
  v_mov_b32 v158, 0
  v_mov_b32 v159, 0
  v_mov_b32 v214, 0
  v_mov_b32 v215, 0
  v_mov_b32 v216, 0
  s_waitcnt vmcnt(16)
  s_barrier
  ds_read_b128 a[64:67], v220 offset:0
  ds_read_b128 a[68:71], v221 offset:0
  ds_read_b128 a[72:75], v222 offset:0
  ds_read_b128 a[76:79], v223 offset:0
  ds_read_b128 a[80:83], v220 offset:256
  ds_read_b128 a[84:87], v221 offset:256
  ds_read_b128 a[88:91], v222 offset:256
  ds_read_b128 a[92:95], v223 offset:256
  ds_read_b128 a[96:99], v220 offset:8192
  ds_read_b128 a[100:103], v221 offset:8192
  ds_read_b128 a[104:107], v222 offset:8192
  ds_read_b128 a[108:111], v223 offset:8192
  ds_read_b128 a[112:115], v220 offset:8448
  ds_read_b128 a[116:119], v221 offset:8448
  ds_read_b128 a[120:123], v222 offset:8448
  ds_read_b128 a[124:127], v223 offset:8448
  s_waitcnt lgkmcnt(0)
  v_mfma_f32_16x16x32_bf16 v[160:163], a[64:67], a[128:131], 0
  v_mfma_f32_16x16x32_bf16 v[164:167], a[64:67], a[160:163], 0
  v_mfma_f32_16x16x32_bf16 v[192:195], a[64:67], a[192:195], 0
  v_mfma_f32_16x16x32_bf16 v[160:163], a[68:71], a[132:135], v[160:163]
  v_mfma_f32_16x16x32_bf16 v[164:167], a[68:71], a[164:167], v[164:167]
  v_mfma_f32_16x16x32_bf16 v[192:195], a[68:71], a[196:199], v[192:195]
  v_mfma_f32_16x16x32_bf16 v[160:163], a[72:75], a[136:139], v[160:163]
  v_mfma_f32_16x16x32_bf16 v[164:167], a[72:75], a[168:171], v[164:167]
  v_mfma_f32_16x16x32_bf16 v[192:195], a[72:75], a[200:203], v[192:195]
  v_mfma_f32_16x16x32_bf16 v[160:163], a[76:79], a[140:143], v[160:163]
  v_mfma_f32_16x16x32_bf16 v[164:167], a[76:79], a[172:175], v[164:167]
  v_mfma_f32_16x16x32_bf16 v[192:195], a[76:79], a[204:207], v[192:195]
  v_mfma_f32_16x16x32_bf16 v[160:163], a[80:83], a[144:147], v[160:163]
  v_mfma_f32_16x16x32_bf16 v[164:167], a[80:83], a[176:179], v[164:167]
  v_mfma_f32_16x16x32_bf16 v[192:195], a[80:83], a[208:211], v[192:195]
  v_mfma_f32_16x16x32_bf16 v[160:163], a[84:87], a[148:151], v[160:163]
  v_mfma_f32_16x16x32_bf16 v[164:167], a[84:87], a[180:183], v[164:167]
  v_mfma_f32_16x16x32_bf16 v[192:195], a[84:87], a[212:215], v[192:195]
  v_mfma_f32_16x16x32_bf16 v[160:163], a[88:91], a[152:155], v[160:163]
  v_mfma_f32_16x16x32_bf16 v[164:167], a[88:91], a[184:187], v[164:167]
  v_mfma_f32_16x16x32_bf16 v[192:195], a[88:91], a[216:219], v[192:195]
  v_mfma_f32_16x16x32_bf16 v[160:163], a[92:95], a[156:159], v[160:163]
  v_mfma_f32_16x16x32_bf16 v[164:167], a[92:95], a[188:191], v[164:167]
  v_mfma_f32_16x16x32_bf16 v[192:195], a[92:95], a[220:223], v[192:195]
  v_mfma_f32_16x16x32_bf16 v[168:171], a[96:99], a[128:131], 0
  v_mfma_f32_16x16x32_bf16 v[172:175], a[96:99], a[160:163], 0
  v_mfma_f32_16x16x32_bf16 v[196:199], a[96:99], a[192:195], 0
  v_mfma_f32_16x16x32_bf16 v[168:171], a[100:103], a[132:135], v[168:171]
  v_mfma_f32_16x16x32_bf16 v[172:175], a[100:103], a[164:167], v[172:175]
  v_mfma_f32_16x16x32_bf16 v[196:199], a[100:103], a[196:199], v[196:199]
  v_mfma_f32_16x16x32_bf16 v[168:171], a[104:107], a[136:139], v[168:171]
  v_mfma_f32_16x16x32_bf16 v[172:175], a[104:107], a[168:171], v[172:175]
  v_mfma_f32_16x16x32_bf16 v[196:199], a[104:107], a[200:203], v[196:199]
  v_mfma_f32_16x16x32_bf16 v[168:171], a[108:111], a[140:143], v[168:171]
  v_mfma_f32_16x16x32_bf16 v[172:175], a[108:111], a[172:175], v[172:175]
  v_mfma_f32_16x16x32_bf16 v[196:199], a[108:111], a[204:207], v[196:199]
  v_mfma_f32_16x16x32_bf16 v[168:171], a[112:115], a[144:147], v[168:171]
  v_mfma_f32_16x16x32_bf16 v[172:175], a[112:115], a[176:179], v[172:175]
  v_mfma_f32_16x16x32_bf16 v[196:199], a[112:115], a[208:211], v[196:199]
  v_mfma_f32_16x16x32_bf16 v[168:171], a[116:119], a[148:151], v[168:171]
  v_mfma_f32_16x16x32_bf16 v[172:175], a[116:119], a[180:183], v[172:175]
  v_mfma_f32_16x16x32_bf16 v[196:199], a[116:119], a[212:215], v[196:199]
  v_mfma_f32_16x16x32_bf16 v[168:171], a[120:123], a[152:155], v[168:171]
  v_mfma_f32_16x16x32_bf16 v[172:175], a[120:123], a[184:187], v[172:175]
  v_mfma_f32_16x16x32_bf16 v[196:199], a[120:123], a[216:219], v[196:199]
  v_mfma_f32_16x16x32_bf16 v[168:171], a[124:127], a[156:159], v[168:171]
  v_mfma_f32_16x16x32_bf16 v[172:175], a[124:127], a[188:191], v[172:175]
  v_mfma_f32_16x16x32_bf16 v[196:199], a[124:127], a[220:223], v[196:199]
  s_nop 7
  s_nop 1
L_qk0done:
  s_waitcnt vmcnt(8)
  s_barrier
  s_and_b32 s48, s16, 1
  s_cmp_eq_u32 s15, 0
  s_cbranch_scc1 L_disp_full
  s_cmp_ge_u32 s16, 2
  s_cbranch_scc1 L_var_k0q0p0
  s_cmp_eq_u32 s48, 0
  s_cbranch_scc1 L_var_k0q1p0
  s_branch L_var_k1q1p0
L_disp_full:
  s_cmp_eq_u32 s48, 1
  s_cbranch_scc1 L_var_k1q1p1
L_var_k0q1p1:
  ds_read_b128 a[64:67], v220 offset:16384
  ds_read_b128 a[68:71], v221 offset:16384
  ds_read_b128 a[72:75], v222 offset:16384
  ds_read_b128 a[76:79], v223 offset:16384
  ds_read_b128 a[80:83], v220 offset:16640
  ds_read_b128 a[84:87], v221 offset:16640
  ds_read_b128 a[88:91], v222 offset:16640
  ds_read_b128 a[92:95], v223 offset:16640
  ds_read_b64_tr_b16 a[4:5], v225 offset:0
  ds_read_b128 a[96:99], v220 offset:24576
  ds_read_b128 a[100:103], v221 offset:24576
  ds_read_b128 a[104:107], v222 offset:24576
  ds_read_b64_tr_b16 a[6:7], v225 offset:8192
  ds_read_b128 a[108:111], v223 offset:24576
  ds_read_b128 a[112:115], v220 offset:24832
  ds_read_b128 a[116:119], v221 offset:24832
  ds_read_b128 a[120:123], v222 offset:24832
  ds_read_b64_tr_b16 a[8:9], v226 offset:0
  ds_read_b128 a[124:127], v223 offset:24832
  ds_read_b64_tr_b16 a[10:11], v226 offset:8192
  ds_read_b64_tr_b16 a[12:13], v227 offset:0
  ds_read_b64_tr_b16 a[14:15], v227 offset:8192
  ds_read_b64_tr_b16 a[20:21], v229 offset:0
  ds_read_b64_tr_b16 a[22:23], v229 offset:8192
  ds_read_b64_tr_b16 a[24:25], v230 offset:0
  v_sub_f32 v242, 0, v217
  v_sub_f32 v243, 0, v217
  v_sub_f32 v244, 0, v217
  v_sub_f32 v245, 0, v217
  v_sub_f32 v246, 0, v218
  v_sub_f32 v247, 0, v218
  v_sub_f32 v248, 0, v218
  v_sub_f32 v249, 0, v218
  v_sub_f32 v250, 0, v219
  v_sub_f32 v251, 0, v219
  v_sub_f32 v252, 0, v219
  v_sub_f32 v253, 0, v219
  v_mul_f32 v217, s39, v217
  v_mul_f32 v218, s39, v218
  v_mul_f32 v219, s39, v219
  v_fma_f32 v192, v192, s39, -v219
  v_fma_f32 v193, v193, s39, -v219
  v_fma_f32 v194, v194, s39, -v219
  v_fma_f32 v195, v195, s39, -v219
  v_exp_f32 v192, v192
  v_exp_f32 v193, v193
  v_exp_f32 v194, v194
  v_exp_f32 v195, v195
  s_nop 0
  v_add_f32 v216, v216, v192
  v_add_f32 v216, v216, v193
  v_add_f32 v216, v216, v194
  v_add_f32 v216, v216, v195
  v_cvt_pk_bf16_f32 v212, v192, v193
  v_cvt_pk_bf16_f32 v213, v194, v195
  ds_write_b64 v240, v[212:213] offset:0
  v_fma_f32 v160, v160, s39, -v217
  v_fma_f32 v161, v161, s39, -v217
  v_fma_f32 v162, v162, s39, -v217
  v_fma_f32 v163, v163, s39, -v217
  v_fma_f32 v168, v168, s39, -v217
  v_fma_f32 v169, v169, s39, -v217
  v_fma_f32 v170, v170, s39, -v217
  v_fma_f32 v171, v171, s39, -v217
  v_fma_f32 v164, v164, s39, -v218
  v_fma_f32 v165, v165, s39, -v218
  v_fma_f32 v166, v166, s39, -v218
  v_fma_f32 v167, v167, s39, -v218
  v_fma_f32 v172, v172, s39, -v218
  v_fma_f32 v173, v173, s39, -v218
  v_fma_f32 v174, v174, s39, -v218
  v_fma_f32 v175, v175, s39, -v218
  v_exp_f32 v160, v160
  v_exp_f32 v161, v161
  v_exp_f32 v162, v162
  v_exp_f32 v163, v163
  v_exp_f32 v168, v168
  v_exp_f32 v169, v169
  v_exp_f32 v170, v170
  v_exp_f32 v171, v171
  v_exp_f32 v164, v164
  v_cvt_pk_bf16_f32 v196, v160, v161
  v_cvt_pk_bf16_f32 v197, v162, v163
  v_cvt_pk_bf16_f32 v198, v168, v169
  v_add_f32 v214, v214, v160
  v_cvt_pk_bf16_f32 v199, v170, v171
  v_add_f32 v214, v214, v161
  v_add_f32 v214, v214, v162
  s_waitcnt lgkmcnt(0)
  v_mfma_f32_16x16x32_bf16 v[192:195], a[64:67], a[192:195], v[250:253]
  s_add_u32 s36, s36, 16384
  ds_read_b64_tr_b16 a[26:27], v230 offset:8192
  v_add_f32 v214, v214, v163
  v_mfma_f32_16x16x32_bf16 v[192:195], a[68:71], a[196:199], v[192:195]
  v_exp_f32 v165, v165
  v_mfma_f32_16x16x32_bf16 v[192:195], a[72:75], a[200:203], v[192:195]
  s_add_u32 m0, s38, 49152
  ds_read_b64_tr_b16 a[28:29], v231 offset:0
  v_cvt_pk_bf16_f32 v200, v164, v165
  v_mfma_f32_16x16x32_bf16 v[192:195], a[76:79], a[204:207], v[192:195]
  ds_read_b64_tr_b16 a[30:31], v231 offset:8192
  v_add_f32 v214, v214, v168
  v_mfma_f32_16x16x32_bf16 v[192:195], a[80:83], a[208:211], v[192:195]
  buffer_load_dwordx4 v232, s[20:23], s36 offen offset:0 nt lds
  v_mfma_f32_16x16x32_bf16 v[192:195], a[84:87], a[212:215], v[192:195]
  ds_read_b64_tr_b16 a[36:37], v225 offset:256
  v_add_f32 v214, v214, v169
  v_mfma_f32_16x16x32_bf16 v[192:195], a[88:91], a[216:219], v[192:195]
  v_exp_f32 v166, v166
  v_mfma_f32_16x16x32_bf16 v[192:195], a[92:95], a[220:223], v[192:195]
  buffer_load_dwordx4 v233, s[20:23], s36 offen offset:1024 nt lds
  ds_read_b64_tr_b16 a[38:39], v225 offset:8448
  v_add_f32 v214, v214, v170
  v_mfma_f32_16x16x32_bf16 v[176:179], a[64:67], a[128:131], v[242:245]
  ds_read_b64_tr_b16 a[40:41], v226 offset:256
  v_add_f32 v214, v214, v171
  v_mfma_f32_16x16x32_bf16 v[180:183], a[64:67], a[160:163], v[246:249]
  buffer_load_dwordx4 v234, s[20:23], s36 offen offset:2048 nt lds
  ds_read_b64_tr_b16 a[42:43], v226 offset:8448
  v_add_f32 v215, v215, v164
  v_mfma_f32_16x16x32_bf16 v[176:179], a[68:71], a[132:135], v[176:179]
  v_exp_f32 v167, v167
  v_mfma_f32_16x16x32_bf16 v[180:183], a[68:71], a[164:167], v[180:183]
  buffer_load_dwordx4 v235, s[20:23], s36 offen offset:3072 nt lds
  ds_read_b64_tr_b16 a[44:45], v227 offset:256
  v_mul_f32 v192, s39, v192
  v_mfma_f32_16x16x32_bf16 v[176:179], a[72:75], a[136:139], v[176:179]
  ds_read_b64_tr_b16 a[46:47], v227 offset:8448
  v_mul_f32 v193, s39, v193
  v_mfma_f32_16x16x32_bf16 v[180:183], a[72:75], a[168:171], v[180:183]
  v_exp_f32 v192, v192
  v_mfma_f32_16x16x32_bf16 v[176:179], a[76:79], a[140:143], v[176:179]
  s_add_u32 m0, s38, 98304
  ds_read_b64_tr_b16 a[52:53], v229 offset:256
  v_mul_f32 v194, s39, v194
  v_mfma_f32_16x16x32_bf16 v[180:183], a[76:79], a[172:175], v[180:183]
  v_exp_f32 v193, v193
  v_mfma_f32_16x16x32_bf16 v[176:179], a[80:83], a[144:147], v[176:179]
  buffer_load_dwordx4 v236, s[24:27], s36 offen offset:0 nt lds
  ds_read_b64_tr_b16 a[54:55], v229 offset:8448
  v_mul_f32 v195, s39, v195
  v_mfma_f32_16x16x32_bf16 v[180:183], a[80:83], a[176:179], v[180:183]
  v_mfma_f32_16x16x32_bf16 v[176:179], a[84:87], a[148:151], v[176:179]
  v_exp_f32 v194, v194
  v_mfma_f32_16x16x32_bf16 v[180:183], a[84:87], a[180:183], v[180:183]
  buffer_load_dwordx4 v237, s[24:27], s36 offen offset:1024 nt lds
  ds_read_b64_tr_b16 a[56:57], v230 offset:256
  v_cvt_pk_bf16_f32 v212, v192, v193
  v_mfma_f32_16x16x32_bf16 v[176:179], a[88:91], a[152:155], v[176:179]
  v_exp_f32 v195, v195
  v_mfma_f32_16x16x32_bf16 v[180:183], a[88:91], a[184:187], v[180:183]
  buffer_load_dwordx4 v238, s[24:27], s36 offen offset:2048 nt lds
  ds_read_b64_tr_b16 a[58:59], v230 offset:8448
  v_cvt_pk_bf16_f32 v213, v194, v195
  v_mfma_f32_16x16x32_bf16 v[176:179], a[92:95], a[156:159], v[176:179]
  ds_read_b64_tr_b16 a[60:61], v231 offset:256
  v_cvt_pk_bf16_f32 v201, v166, v167
  v_mfma_f32_16x16x32_bf16 v[180:183], a[92:95], a[188:191], v[180:183]
  buffer_load_dwordx4 v239, s[24:27], s36 offen offset:3072 nt lds
  ds_write_b64 v240, v[212:213] offset:2048
  v_add_f32 v215, v215, v165
  v_mfma_f32_16x16x32_bf16 v[184:187], a[96:99], a[128:131], v[242:245]
  v_exp_f32 v172, v172
  v_mfma_f32_16x16x32_bf16 v[188:191], a[96:99], a[160:163], v[246:249]
  ds_read_b64_tr_b16 a[62:63], v231 offset:8448
  v_add_f32 v215, v215, v166
  v_mfma_f32_16x16x32_bf16 v[184:187], a[100:103], a[132:135], v[184:187]
  s_add_u32 s36, s36, 16384
  ds_read_b64_tr_b16 a[0:1], v224 offset:0
  v_add_f32 v215, v215, v167
  v_mfma_f32_16x16x32_bf16 v[188:191], a[100:103], a[164:167], v[188:191]
  ds_read_b64_tr_b16 a[2:3], v224 offset:8192
  v_add_f32 v215, v215, v172
  v_mfma_f32_16x16x32_bf16 v[184:187], a[104:107], a[136:139], v[184:187]
  s_add_u32 m0, s38, 0
  v_exp_f32 v173, v173
  v_mfma_f32_16x16x32_bf16 v[188:191], a[104:107], a[168:171], v[188:191]
  ds_read_b64_tr_b16 a[16:17], v228 offset:0
  v_cvt_pk_bf16_f32 v202, v172, v173
  v_mfma_f32_16x16x32_bf16 v[184:187], a[108:111], a[140:143], v[184:187]
  buffer_load_dwordx4 v232, s[20:23], s36 offen offset:0 nt lds
  ds_read_b64_tr_b16 a[18:19], v228 offset:8192
  v_add_f32 v215, v215, v173
  v_mfma_f32_16x16x32_bf16 v[188:191], a[108:111], a[172:175], v[188:191]
  ds_read_b64_tr_b16 a[32:33], v224 offset:256
  v_add_f32 v216, v216, v192
  v_mfma_f32_16x16x32_bf16 v[184:187], a[112:115], a[144:147], v[184:187]
  ds_read_b64_tr_b16 a[34:35], v224 offset:8448
  v_add_f32 v216, v216, v193
  v_mfma_f32_16x16x32_bf16 v[188:191], a[112:115], a[176:179], v[188:191]
  buffer_load_dwordx4 v233, s[20:23], s36 offen offset:1024 nt lds
  ds_read_b64_tr_b16 a[48:49], v228 offset:256
  v_add_f32 v216, v216, v194
  v_mfma_f32_16x16x32_bf16 v[184:187], a[116:119], a[148:151], v[184:187]
  ds_read_b64_tr_b16 a[50:51], v228 offset:8448
  v_add_f32 v216, v216, v195
  v_mfma_f32_16x16x32_bf16 v[188:191], a[116:119], a[180:183], v[188:191]
  buffer_load_dwordx4 v234, s[20:23], s36 offen offset:2048 nt lds
  v_exp_f32 v174, v174
  v_mfma_f32_16x16x32_bf16 v[184:187], a[120:123], a[152:155], v[184:187]
  v_mfma_f32_16x16x32_bf16 v[188:191], a[120:123], a[184:187], v[188:191]
  v_exp_f32 v175, v175
  v_mfma_f32_16x16x32_bf16 v[184:187], a[124:127], a[156:159], v[184:187]
  buffer_load_dwordx4 v235, s[20:23], s36 offen offset:3072 nt lds
  v_cvt_pk_bf16_f32 v203, v174, v175
  v_mfma_f32_16x16x32_bf16 v[188:191], a[124:127], a[188:191], v[188:191]
  v_add_f32 v215, v215, v174
  v_add_f32 v215, v215, v175
  s_waitcnt vmcnt(12) lgkmcnt(0)
  s_barrier
  ds_read_b128 a[224:227], v241 offset:0
  ds_read_b128 a[228:231], v241 offset:1024
  v_mfma_f32_16x16x32_bf16 v[8:11], a[4:7], v[196:199], v[8:11]
  ds_read_b128 a[64:67], v220 offset:32768
  v_mul_f32 v176, s39, v176
  v_mfma_f32_16x16x32_bf16 v[12:15], a[4:7], v[200:203], v[12:15]
  s_add_u32 m0, s38, 114688
  v_exp_f32 v176, v176
  v_mfma_f32_16x16x32_bf16 v[16:19], a[8:11], v[196:199], v[16:19]
  ds_read_b128 a[68:71], v221 offset:32768
  v_mul_f32 v177, s39, v177
  v_mfma_f32_16x16x32_bf16 v[20:23], a[8:11], v[200:203], v[20:23]
  ds_read_b128 a[72:75], v222 offset:32768
  v_mfma_f32_16x16x32_bf16 v[24:27], a[12:15], v[196:199], v[24:27]
  buffer_load_dwordx4 v236, s[24:27], s36 offen offset:0 nt lds
  ds_read_b128 a[76:79], v223 offset:32768
  v_mfma_f32_16x16x32_bf16 v[28:31], a[12:15], v[200:203], v[28:31]
  v_exp_f32 v177, v177
  v_mfma_f32_16x16x32_bf16 v[40:43], a[20:23], v[196:199], v[40:43]
  ds_read_b128 a[80:83], v220 offset:33024
  v_mul_f32 v178, s39, v178
  v_mfma_f32_16x16x32_bf16 v[44:47], a[20:23], v[200:203], v[44:47]
  buffer_load_dwordx4 v237, s[24:27], s36 offen offset:1024 nt lds
  v_mfma_f32_16x16x32_bf16 v[48:51], a[24:27], v[196:199], v[48:51]
  ds_read_b128 a[84:87], v221 offset:33024
  v_mul_f32 v179, s39, v179
  v_mfma_f32_16x16x32_bf16 v[52:55], a[24:27], v[200:203], v[52:55]
  v_exp_f32 v178, v178
  v_mfma_f32_16x16x32_bf16 v[56:59], a[28:31], v[196:199], v[56:59]
  ds_read_b128 a[88:91], v222 offset:33024
  v_mul_f32 v184, s39, v184
  v_mfma_f32_16x16x32_bf16 v[60:63], a[28:31], v[200:203], v[60:63]
  buffer_load_dwordx4 v238, s[24:27], s36 offen offset:2048 nt lds
  ds_read_b128 a[92:95], v223 offset:33024
  v_mul_f32 v185, s39, v185
  v_mfma_f32_16x16x32_bf16 v[72:75], a[36:39], v[196:199], v[72:75]
  ds_read_b64_tr_b16 a[4:5], v225 offset:16384
  v_mul_f32 v186, s39, v186
  v_mfma_f32_16x16x32_bf16 v[76:79], a[36:39], v[200:203], v[76:79]
  ds_read_b128 a[232:235], v241 offset:2048
  v_mul_f32 v187, s39, v187
  v_mfma_f32_16x16x32_bf16 v[80:83], a[40:43], v[196:199], v[80:83]
  buffer_load_dwordx4 v239, s[24:27], s36 offen offset:3072 nt lds
  v_exp_f32 v179, v179
  v_mfma_f32_16x16x32_bf16 v[84:87], a[40:43], v[200:203], v[84:87]
  ds_read_b128 a[96:99], v220 offset:40960
  v_mul_f32 v180, s39, v180
  v_mfma_f32_16x16x32_bf16 v[88:91], a[44:47], v[196:199], v[88:91]
  v_mfma_f32_16x16x32_bf16 v[92:95], a[44:47], v[200:203], v[92:95]
  s_add_u32 s36, s36, 16384
  ds_read_b128 a[100:103], v221 offset:40960
  v_mul_f32 v181, s39, v181
  v_mfma_f32_16x16x32_bf16 v[104:107], a[52:55], v[196:199], v[104:107]
  v_exp_f32 v184, v184
  v_mfma_f32_16x16x32_bf16 v[108:111], a[52:55], v[200:203], v[108:111]
  ds_read_b128 a[104:107], v222 offset:40960
  v_mul_f32 v182, s39, v182
  v_mfma_f32_16x16x32_bf16 v[112:115], a[56:59], v[196:199], v[112:115]
  ds_read_b64_tr_b16 a[6:7], v225 offset:24576
  v_mul_f32 v183, s39, v183
  v_mfma_f32_16x16x32_bf16 v[116:119], a[56:59], v[200:203], v[116:119]
  s_add_u32 m0, s38, 16384
  ds_read_b128 a[108:111], v223 offset:40960
  v_mul_f32 v188, s39, v188
  v_mfma_f32_16x16x32_bf16 v[120:123], a[60:63], v[196:199], v[120:123]
  ds_read_b128 a[236:239], v241 offset:3072
  v_mul_f32 v189, s39, v189
  v_mfma_f32_16x16x32_bf16 v[124:127], a[60:63], v[200:203], v[124:127]
  v_exp_f32 v185, v185
  v_mfma_f32_16x16x32_bf16 v[0:3], a[0:3], v[196:199], v[0:3]
  buffer_load_dwordx4 v232, s[20:23], s36 offen offset:0 nt lds
  ds_read_b128 a[112:115], v220 offset:41216
  v_mul_f32 v190, s39, v190
  v_mfma_f32_16x16x32_bf16 v[4:7], a[0:3], v[200:203], v[4:7]
  s_waitcnt lgkmcnt(15)
  v_mfma_f32_16x16x32_bf16 v[128:131], a[0:3], a[224:227], v[128:131]
  ds_read_b128 a[116:119], v221 offset:41216
  v_mul_f32 v191, s39, v191
  v_mfma_f32_16x16x32_bf16 v[132:135], a[0:3], a[228:231], v[132:135]
  buffer_load_dwordx4 v233, s[20:23], s36 offen offset:1024 nt lds
  v_exp_f32 v186, v186
  v_mfma_f32_16x16x32_bf16 v[32:35], a[16:19], v[196:199], v[32:35]
  ds_read_b128 a[120:123], v222 offset:41216
  v_cvt_pk_bf16_f32 v204, v176, v177
  v_mfma_f32_16x16x32_bf16 v[36:39], a[16:19], v[200:203], v[36:39]
  ds_read_b64_tr_b16 a[8:9], v226 offset:16384
  v_cvt_pk_bf16_f32 v205, v178, v179
  v_mfma_f32_16x16x32_bf16 v[136:139], a[16:19], a[224:227], v[136:139]
  ds_read_b128 a[124:127], v223 offset:41216
  v_cvt_pk_bf16_f32 v206, v184, v185
  v_mfma_f32_16x16x32_bf16 v[140:143], a[16:19], a[228:231], v[140:143]
  buffer_load_dwordx4 v234, s[20:23], s36 offen offset:2048 nt lds
  ds_read_b64_tr_b16 a[10:11], v226 offset:24576
  v_add_f32 v214, v214, v176
  v_mfma_f32_16x16x32_bf16 v[64:67], a[32:35], v[196:199], v[64:67]
  v_exp_f32 v187, v187
  v_mfma_f32_16x16x32_bf16 v[68:71], a[32:35], v[200:203], v[68:71]
  ds_read_b64_tr_b16 a[12:13], v227 offset:16384
  v_cvt_pk_bf16_f32 v207, v186, v187
  v_mfma_f32_16x16x32_bf16 v[144:147], a[32:35], a[224:227], v[144:147]
  buffer_load_dwordx4 v235, s[20:23], s36 offen offset:3072 nt lds
  v_mfma_f32_16x16x32_bf16 v[148:151], a[32:35], a[228:231], v[148:151]
  ds_read_b64_tr_b16 a[14:15], v227 offset:24576
  v_mfma_f32_16x16x32_bf16 v[96:99], a[48:51], v[196:199], v[96:99]
  v_exp_f32 v180, v180
  v_mfma_f32_16x16x32_bf16 v[100:103], a[48:51], v[200:203], v[100:103]
  ds_read_b64_tr_b16 a[20:21], v229 offset:16384
  v_add_f32 v214, v214, v177
  v_mfma_f32_16x16x32_bf16 v[152:155], a[48:51], a[224:227], v[152:155]
  s_add_u32 m0, s38, 65536
  ds_read_b64_tr_b16 a[22:23], v229 offset:24576
  v_add_f32 v214, v214, v178
  v_mfma_f32_16x16x32_bf16 v[156:159], a[48:51], a[228:231], v[156:159]
  ds_read_b64_tr_b16 a[24:25], v230 offset:16384
  s_waitcnt lgkmcnt(6)
  s_mov_b32 s40, 0
.p2align 6
L_loop_k0q1p1:
  v_mfma_f32_16x16x32_bf16 v[192:195], a[64:67], a[192:195], v[250:253]
  ds_read_b64_tr_b16 a[26:27], v230 offset:24576
  v_add_f32 v214, v214, v179
  v_mfma_f32_16x16x32_bf16 v[192:195], a[68:71], a[196:199], v[192:195]
  v_exp_f32 v181, v181
  v_mfma_f32_16x16x32_bf16 v[192:195], a[72:75], a[200:203], v[192:195]
  ds_read_b64_tr_b16 a[28:29], v231 offset:16384
  v_cvt_pk_bf16_f32 v208, v180, v181
  v_mfma_f32_16x16x32_bf16 v[192:195], a[76:79], a[204:207], v[192:195]
  ds_read_b64_tr_b16 a[30:31], v231 offset:24576
  v_add_f32 v214, v214, v184
  v_mfma_f32_16x16x32_bf16 v[192:195], a[80:83], a[208:211], v[192:195]
  buffer_load_dwordx4 v236, s[24:27], s36 offen offset:0 nt lds
  v_mfma_f32_16x16x32_bf16 v[192:195], a[84:87], a[212:215], v[192:195]
  ds_read_b64_tr_b16 a[36:37], v225 offset:16640
  v_add_f32 v214, v214, v185
  v_mfma_f32_16x16x32_bf16 v[192:195], a[88:91], a[216:219], v[192:195]
  v_exp_f32 v182, v182
  v_mfma_f32_16x16x32_bf16 v[192:195], a[92:95], a[220:223], v[192:195]
  ds_read_b64_tr_b16 a[38:39], v225 offset:24832
  v_add_f32 v214, v214, v186
  v_mfma_f32_16x16x32_bf16 v[160:163], a[64:67], a[128:131], v[242:245]
  ds_read_b64_tr_b16 a[40:41], v226 offset:16640
  v_add_f32 v214, v214, v187
  v_mfma_f32_16x16x32_bf16 v[164:167], a[64:67], a[160:163], v[246:249]
  ds_read_b64_tr_b16 a[42:43], v226 offset:24832
  v_add_f32 v215, v215, v180
  v_mfma_f32_16x16x32_bf16 v[160:163], a[68:71], a[132:135], v[160:163]
  v_exp_f32 v183, v183
  v_mfma_f32_16x16x32_bf16 v[164:167], a[68:71], a[164:167], v[164:167]
  ds_read_b64_tr_b16 a[44:45], v227 offset:16640
  v_mul_f32 v192, s39, v192
  v_mfma_f32_16x16x32_bf16 v[160:163], a[72:75], a[136:139], v[160:163]
  ds_read_b64_tr_b16 a[46:47], v227 offset:24832
  v_mul_f32 v193, s39, v193
  v_mfma_f32_16x16x32_bf16 v[164:167], a[72:75], a[168:171], v[164:167]
  v_exp_f32 v192, v192
  v_mfma_f32_16x16x32_bf16 v[160:163], a[76:79], a[140:143], v[160:163]
  ds_read_b64_tr_b16 a[52:53], v229 offset:16640
  v_mul_f32 v194, s39, v194
  v_mfma_f32_16x16x32_bf16 v[164:167], a[76:79], a[172:175], v[164:167]
  v_exp_f32 v193, v193
  v_mfma_f32_16x16x32_bf16 v[160:163], a[80:83], a[144:147], v[160:163]
  ds_read_b64_tr_b16 a[54:55], v229 offset:24832
  v_mul_f32 v195, s39, v195
  v_mfma_f32_16x16x32_bf16 v[164:167], a[80:83], a[176:179], v[164:167]
  buffer_load_dwordx4 v237, s[24:27], s36 offen offset:1024 nt lds
  v_mfma_f32_16x16x32_bf16 v[160:163], a[84:87], a[148:151], v[160:163]
  v_exp_f32 v194, v194
  v_mfma_f32_16x16x32_bf16 v[164:167], a[84:87], a[180:183], v[164:167]
  ds_read_b64_tr_b16 a[56:57], v230 offset:16640
  v_cvt_pk_bf16_f32 v212, v192, v193
  v_mfma_f32_16x16x32_bf16 v[160:163], a[88:91], a[152:155], v[160:163]
  v_exp_f32 v195, v195
  v_mfma_f32_16x16x32_bf16 v[164:167], a[88:91], a[184:187], v[164:167]
  ds_read_b64_tr_b16 a[58:59], v230 offset:24832
  v_cvt_pk_bf16_f32 v213, v194, v195
  v_mfma_f32_16x16x32_bf16 v[160:163], a[92:95], a[156:159], v[160:163]
  ds_read_b64_tr_b16 a[60:61], v231 offset:16640
  v_cvt_pk_bf16_f32 v209, v182, v183
  v_mfma_f32_16x16x32_bf16 v[164:167], a[92:95], a[188:191], v[164:167]
  ds_write_b64 v240, v[212:213] offset:0
  v_add_f32 v215, v215, v181
  v_mfma_f32_16x16x32_bf16 v[168:171], a[96:99], a[128:131], v[242:245]
  v_exp_f32 v188, v188
  v_mfma_f32_16x16x32_bf16 v[172:175], a[96:99], a[160:163], v[246:249]
  ds_read_b64_tr_b16 a[62:63], v231 offset:24832
  v_add_f32 v215, v215, v182
  v_mfma_f32_16x16x32_bf16 v[168:171], a[100:103], a[132:135], v[168:171]
  ds_read_b64_tr_b16 a[0:1], v224 offset:16384
  v_add_f32 v215, v215, v183
  v_mfma_f32_16x16x32_bf16 v[172:175], a[100:103], a[164:167], v[172:175]
  ds_read_b64_tr_b16 a[2:3], v224 offset:24576
  v_add_f32 v215, v215, v188
  v_mfma_f32_16x16x32_bf16 v[168:171], a[104:107], a[136:139], v[168:171]
  v_exp_f32 v189, v189
  v_mfma_f32_16x16x32_bf16 v[172:175], a[104:107], a[168:171], v[172:175]
  ds_read_b64_tr_b16 a[16:17], v228 offset:16384
  v_cvt_pk_bf16_f32 v210, v188, v189
  v_mfma_f32_16x16x32_bf16 v[168:171], a[108:111], a[140:143], v[168:171]
  ds_read_b64_tr_b16 a[18:19], v228 offset:24576
  v_add_f32 v215, v215, v189
  v_mfma_f32_16x16x32_bf16 v[172:175], a[108:111], a[172:175], v[172:175]
  ds_read_b64_tr_b16 a[32:33], v224 offset:16640
  v_add_f32 v216, v216, v192
  v_mfma_f32_16x16x32_bf16 v[168:171], a[112:115], a[144:147], v[168:171]
  ds_read_b64_tr_b16 a[34:35], v224 offset:24832
  v_add_f32 v216, v216, v193
  v_mfma_f32_16x16x32_bf16 v[172:175], a[112:115], a[176:179], v[172:175]
  ds_read_b64_tr_b16 a[48:49], v228 offset:16640
  v_add_f32 v216, v216, v194
  v_mfma_f32_16x16x32_bf16 v[168:171], a[116:119], a[148:151], v[168:171]
  ds_read_b64_tr_b16 a[50:51], v228 offset:24832
  v_add_f32 v216, v216, v195
  v_mfma_f32_16x16x32_bf16 v[172:175], a[116:119], a[180:183], v[172:175]
  v_exp_f32 v190, v190
  v_mfma_f32_16x16x32_bf16 v[168:171], a[120:123], a[152:155], v[168:171]
  buffer_load_dwordx4 v238, s[24:27], s36 offen offset:2048 nt lds
  v_mfma_f32_16x16x32_bf16 v[172:175], a[120:123], a[184:187], v[172:175]
  v_exp_f32 v191, v191
  v_mfma_f32_16x16x32_bf16 v[168:171], a[124:127], a[156:159], v[168:171]
  buffer_load_dwordx4 v239, s[24:27], s36 offen offset:3072 nt lds
  v_cvt_pk_bf16_f32 v211, v190, v191
  v_mfma_f32_16x16x32_bf16 v[172:175], a[124:127], a[188:191], v[172:175]
  v_add_f32 v215, v215, v190
  v_add_f32 v215, v215, v191
  s_waitcnt vmcnt(16) lgkmcnt(0)
  s_barrier
  v_mfma_f32_16x16x32_bf16 v[8:11], a[4:7], v[204:207], v[8:11]
  ds_read_b128 a[64:67], v220 offset:49152
  v_mul_f32 v160, s39, v160
  v_mfma_f32_16x16x32_bf16 v[12:15], a[4:7], v[208:211], v[12:15]
  v_exp_f32 v160, v160
  v_mfma_f32_16x16x32_bf16 v[16:19], a[8:11], v[204:207], v[16:19]
  ds_read_b128 a[68:71], v221 offset:49152
  v_mul_f32 v161, s39, v161
  v_mfma_f32_16x16x32_bf16 v[20:23], a[8:11], v[208:211], v[20:23]
  ds_read_b128 a[72:75], v222 offset:49152
  s_add_u32 s36, s36, 16384
  v_mfma_f32_16x16x32_bf16 v[24:27], a[12:15], v[204:207], v[24:27]
  ds_read_b128 a[76:79], v223 offset:49152
  s_add_u32 m0, s38, 32768
  v_mfma_f32_16x16x32_bf16 v[28:31], a[12:15], v[208:211], v[28:31]
  v_exp_f32 v161, v161
  v_mfma_f32_16x16x32_bf16 v[40:43], a[20:23], v[204:207], v[40:43]
  ds_read_b128 a[80:83], v220 offset:49408
  v_mul_f32 v162, s39, v162
  v_mfma_f32_16x16x32_bf16 v[44:47], a[20:23], v[208:211], v[44:47]
  buffer_load_dwordx4 v232, s[20:23], s36 offen offset:0 nt lds
  v_mfma_f32_16x16x32_bf16 v[48:51], a[24:27], v[204:207], v[48:51]
  ds_read_b128 a[84:87], v221 offset:49408
  v_mul_f32 v163, s39, v163
  v_mfma_f32_16x16x32_bf16 v[52:55], a[24:27], v[208:211], v[52:55]
  v_exp_f32 v162, v162
  v_mfma_f32_16x16x32_bf16 v[56:59], a[28:31], v[204:207], v[56:59]
  ds_read_b128 a[88:91], v222 offset:49408
  v_mul_f32 v168, s39, v168
  v_mfma_f32_16x16x32_bf16 v[60:63], a[28:31], v[208:211], v[60:63]
  ds_read_b128 a[92:95], v223 offset:49408
  v_mul_f32 v169, s39, v169
  v_mfma_f32_16x16x32_bf16 v[72:75], a[36:39], v[204:207], v[72:75]
  ds_read_b64_tr_b16 a[4:5], v225 offset:32768
  v_mul_f32 v170, s39, v170
  v_mfma_f32_16x16x32_bf16 v[76:79], a[36:39], v[208:211], v[76:79]
  ds_read_b128 a[224:227], v241 offset:0
  v_mul_f32 v171, s39, v171
  v_mfma_f32_16x16x32_bf16 v[80:83], a[40:43], v[204:207], v[80:83]
  v_exp_f32 v163, v163
  v_mfma_f32_16x16x32_bf16 v[84:87], a[40:43], v[208:211], v[84:87]
  ds_read_b128 a[96:99], v220 offset:57344
  v_mul_f32 v164, s39, v164
  v_mfma_f32_16x16x32_bf16 v[88:91], a[44:47], v[204:207], v[88:91]
  buffer_load_dwordx4 v233, s[20:23], s36 offen offset:1024 nt lds
  v_mfma_f32_16x16x32_bf16 v[92:95], a[44:47], v[208:211], v[92:95]
  ds_read_b128 a[100:103], v221 offset:57344
  v_mul_f32 v165, s39, v165
  v_mfma_f32_16x16x32_bf16 v[104:107], a[52:55], v[204:207], v[104:107]
  v_exp_f32 v168, v168
  v_mfma_f32_16x16x32_bf16 v[108:111], a[52:55], v[208:211], v[108:111]
  ds_read_b128 a[104:107], v222 offset:57344
  v_mul_f32 v166, s39, v166
  v_mfma_f32_16x16x32_bf16 v[112:115], a[56:59], v[204:207], v[112:115]
  ds_read_b64_tr_b16 a[6:7], v225 offset:40960
  v_mul_f32 v167, s39, v167
  v_mfma_f32_16x16x32_bf16 v[116:119], a[56:59], v[208:211], v[116:119]
  ds_read_b128 a[108:111], v223 offset:57344
  v_mul_f32 v172, s39, v172
  v_mfma_f32_16x16x32_bf16 v[120:123], a[60:63], v[204:207], v[120:123]
  ds_read_b128 a[228:231], v241 offset:1024
  v_mul_f32 v173, s39, v173
  v_mfma_f32_16x16x32_bf16 v[124:127], a[60:63], v[208:211], v[124:127]
  v_exp_f32 v169, v169
  v_mfma_f32_16x16x32_bf16 v[0:3], a[0:3], v[204:207], v[0:3]
  ds_read_b128 a[112:115], v220 offset:57600
  v_mul_f32 v174, s39, v174
  v_mfma_f32_16x16x32_bf16 v[4:7], a[0:3], v[208:211], v[4:7]
  buffer_load_dwordx4 v234, s[20:23], s36 offen offset:2048 nt lds
  v_mfma_f32_16x16x32_bf16 v[128:131], a[0:3], a[232:235], v[128:131]
  ds_read_b128 a[116:119], v221 offset:57600
  v_mul_f32 v175, s39, v175
  v_mfma_f32_16x16x32_bf16 v[132:135], a[0:3], a[236:239], v[132:135]
  v_exp_f32 v170, v170
  v_mfma_f32_16x16x32_bf16 v[32:35], a[16:19], v[204:207], v[32:35]
  ds_read_b128 a[120:123], v222 offset:57600
  v_cvt_pk_bf16_f32 v196, v160, v161
  v_mfma_f32_16x16x32_bf16 v[36:39], a[16:19], v[208:211], v[36:39]
  ds_read_b64_tr_b16 a[8:9], v226 offset:32768
  v_cvt_pk_bf16_f32 v197, v162, v163
  v_mfma_f32_16x16x32_bf16 v[136:139], a[16:19], a[232:235], v[136:139]
  ds_read_b128 a[124:127], v223 offset:57600
  v_cvt_pk_bf16_f32 v198, v168, v169
  v_mfma_f32_16x16x32_bf16 v[140:143], a[16:19], a[236:239], v[140:143]
  ds_read_b64_tr_b16 a[10:11], v226 offset:40960
  v_add_f32 v214, v214, v160
  v_mfma_f32_16x16x32_bf16 v[64:67], a[32:35], v[204:207], v[64:67]
  v_exp_f32 v171, v171
  v_mfma_f32_16x16x32_bf16 v[68:71], a[32:35], v[208:211], v[68:71]
  ds_read_b64_tr_b16 a[12:13], v227 offset:32768
  v_cvt_pk_bf16_f32 v199, v170, v171
  v_mfma_f32_16x16x32_bf16 v[144:147], a[32:35], a[232:235], v[144:147]
  buffer_load_dwordx4 v235, s[20:23], s36 offen offset:3072 nt lds
  v_mfma_f32_16x16x32_bf16 v[148:151], a[32:35], a[236:239], v[148:151]
  ds_read_b64_tr_b16 a[14:15], v227 offset:40960
  s_add_u32 m0, s38, 81920
  v_mfma_f32_16x16x32_bf16 v[96:99], a[48:51], v[204:207], v[96:99]
  v_exp_f32 v164, v164
  v_mfma_f32_16x16x32_bf16 v[100:103], a[48:51], v[208:211], v[100:103]
  ds_read_b64_tr_b16 a[20:21], v229 offset:32768
  v_add_f32 v214, v214, v161
  v_mfma_f32_16x16x32_bf16 v[152:155], a[48:51], a[232:235], v[152:155]
  ds_read_b64_tr_b16 a[22:23], v229 offset:40960
  v_add_f32 v214, v214, v162
  v_mfma_f32_16x16x32_bf16 v[156:159], a[48:51], a[236:239], v[156:159]
  ds_read_b64_tr_b16 a[24:25], v230 offset:32768
  s_waitcnt lgkmcnt(6)
  v_mfma_f32_16x16x32_bf16 v[192:195], a[64:67], a[192:195], v[250:253]
  ds_read_b64_tr_b16 a[26:27], v230 offset:40960
  v_add_f32 v214, v214, v163
  v_mfma_f32_16x16x32_bf16 v[192:195], a[68:71], a[196:199], v[192:195]
  v_exp_f32 v165, v165
  v_mfma_f32_16x16x32_bf16 v[192:195], a[72:75], a[200:203], v[192:195]
  ds_read_b64_tr_b16 a[28:29], v231 offset:32768
  v_cvt_pk_bf16_f32 v200, v164, v165
  v_mfma_f32_16x16x32_bf16 v[192:195], a[76:79], a[204:207], v[192:195]
  ds_read_b64_tr_b16 a[30:31], v231 offset:40960
  v_add_f32 v214, v214, v168
  v_mfma_f32_16x16x32_bf16 v[192:195], a[80:83], a[208:211], v[192:195]
  buffer_load_dwordx4 v236, s[24:27], s36 offen offset:0 nt lds
  v_mfma_f32_16x16x32_bf16 v[192:195], a[84:87], a[212:215], v[192:195]
  ds_read_b64_tr_b16 a[36:37], v225 offset:33024
  v_add_f32 v214, v214, v169
  v_mfma_f32_16x16x32_bf16 v[192:195], a[88:91], a[216:219], v[192:195]
  v_exp_f32 v166, v166
  v_mfma_f32_16x16x32_bf16 v[192:195], a[92:95], a[220:223], v[192:195]
  ds_read_b64_tr_b16 a[38:39], v225 offset:41216
  v_add_f32 v214, v214, v170
  v_mfma_f32_16x16x32_bf16 v[176:179], a[64:67], a[128:131], v[242:245]
  ds_read_b64_tr_b16 a[40:41], v226 offset:33024
  v_add_f32 v214, v214, v171
  v_mfma_f32_16x16x32_bf16 v[180:183], a[64:67], a[160:163], v[246:249]
  ds_read_b64_tr_b16 a[42:43], v226 offset:41216
  v_add_f32 v215, v215, v164
  v_mfma_f32_16x16x32_bf16 v[176:179], a[68:71], a[132:135], v[176:179]
  v_exp_f32 v167, v167
  v_mfma_f32_16x16x32_bf16 v[180:183], a[68:71], a[164:167], v[180:183]
  ds_read_b64_tr_b16 a[44:45], v227 offset:33024
  v_mul_f32 v192, s39, v192
  v_mfma_f32_16x16x32_bf16 v[176:179], a[72:75], a[136:139], v[176:179]
  ds_read_b64_tr_b16 a[46:47], v227 offset:41216
  v_mul_f32 v193, s39, v193
  v_mfma_f32_16x16x32_bf16 v[180:183], a[72:75], a[168:171], v[180:183]
  v_exp_f32 v192, v192
  v_mfma_f32_16x16x32_bf16 v[176:179], a[76:79], a[140:143], v[176:179]
  ds_read_b64_tr_b16 a[52:53], v229 offset:33024
  v_mul_f32 v194, s39, v194
  v_mfma_f32_16x16x32_bf16 v[180:183], a[76:79], a[172:175], v[180:183]
  v_exp_f32 v193, v193
  v_mfma_f32_16x16x32_bf16 v[176:179], a[80:83], a[144:147], v[176:179]
  ds_read_b64_tr_b16 a[54:55], v229 offset:41216
  v_mul_f32 v195, s39, v195
  v_mfma_f32_16x16x32_bf16 v[180:183], a[80:83], a[176:179], v[180:183]
  buffer_load_dwordx4 v237, s[24:27], s36 offen offset:1024 nt lds
  v_mfma_f32_16x16x32_bf16 v[176:179], a[84:87], a[148:151], v[176:179]
  v_exp_f32 v194, v194
  v_mfma_f32_16x16x32_bf16 v[180:183], a[84:87], a[180:183], v[180:183]
  ds_read_b64_tr_b16 a[56:57], v230 offset:33024
  v_cvt_pk_bf16_f32 v212, v192, v193
  v_mfma_f32_16x16x32_bf16 v[176:179], a[88:91], a[152:155], v[176:179]
  v_exp_f32 v195, v195
  v_mfma_f32_16x16x32_bf16 v[180:183], a[88:91], a[184:187], v[180:183]
  ds_read_b64_tr_b16 a[58:59], v230 offset:41216
  v_cvt_pk_bf16_f32 v213, v194, v195
  v_mfma_f32_16x16x32_bf16 v[176:179], a[92:95], a[156:159], v[176:179]
  ds_read_b64_tr_b16 a[60:61], v231 offset:33024
  v_cvt_pk_bf16_f32 v201, v166, v167
  v_mfma_f32_16x16x32_bf16 v[180:183], a[92:95], a[188:191], v[180:183]
  ds_write_b64 v240, v[212:213] offset:2048
  v_add_f32 v215, v215, v165
  v_mfma_f32_16x16x32_bf16 v[184:187], a[96:99], a[128:131], v[242:245]
  v_exp_f32 v172, v172
  v_mfma_f32_16x16x32_bf16 v[188:191], a[96:99], a[160:163], v[246:249]
  ds_read_b64_tr_b16 a[62:63], v231 offset:41216
  v_add_f32 v215, v215, v166
  v_mfma_f32_16x16x32_bf16 v[184:187], a[100:103], a[132:135], v[184:187]
  ds_read_b64_tr_b16 a[0:1], v224 offset:32768
  v_add_f32 v215, v215, v167
  v_mfma_f32_16x16x32_bf16 v[188:191], a[100:103], a[164:167], v[188:191]
  ds_read_b64_tr_b16 a[2:3], v224 offset:40960
  v_add_f32 v215, v215, v172
  v_mfma_f32_16x16x32_bf16 v[184:187], a[104:107], a[136:139], v[184:187]
  v_exp_f32 v173, v173
  v_mfma_f32_16x16x32_bf16 v[188:191], a[104:107], a[168:171], v[188:191]
  ds_read_b64_tr_b16 a[16:17], v228 offset:32768
  v_cvt_pk_bf16_f32 v202, v172, v173
  v_mfma_f32_16x16x32_bf16 v[184:187], a[108:111], a[140:143], v[184:187]
  ds_read_b64_tr_b16 a[18:19], v228 offset:40960
  v_add_f32 v215, v215, v173
  v_mfma_f32_16x16x32_bf16 v[188:191], a[108:111], a[172:175], v[188:191]
  ds_read_b64_tr_b16 a[32:33], v224 offset:33024
  v_add_f32 v216, v216, v192
  v_mfma_f32_16x16x32_bf16 v[184:187], a[112:115], a[144:147], v[184:187]
  ds_read_b64_tr_b16 a[34:35], v224 offset:41216
  v_add_f32 v216, v216, v193
  v_mfma_f32_16x16x32_bf16 v[188:191], a[112:115], a[176:179], v[188:191]
  ds_read_b64_tr_b16 a[48:49], v228 offset:33024
  v_add_f32 v216, v216, v194
  v_mfma_f32_16x16x32_bf16 v[184:187], a[116:119], a[148:151], v[184:187]
  ds_read_b64_tr_b16 a[50:51], v228 offset:41216
  v_add_f32 v216, v216, v195
  v_mfma_f32_16x16x32_bf16 v[188:191], a[116:119], a[180:183], v[188:191]
  v_exp_f32 v174, v174
  v_mfma_f32_16x16x32_bf16 v[184:187], a[120:123], a[152:155], v[184:187]
  buffer_load_dwordx4 v238, s[24:27], s36 offen offset:2048 nt lds
  v_mfma_f32_16x16x32_bf16 v[188:191], a[120:123], a[184:187], v[188:191]
  v_exp_f32 v175, v175
  v_mfma_f32_16x16x32_bf16 v[184:187], a[124:127], a[156:159], v[184:187]
  buffer_load_dwordx4 v239, s[24:27], s36 offen offset:3072 nt lds
  v_cvt_pk_bf16_f32 v203, v174, v175
  v_mfma_f32_16x16x32_bf16 v[188:191], a[124:127], a[188:191], v[188:191]
  v_add_f32 v215, v215, v174
  v_add_f32 v215, v215, v175
  s_waitcnt vmcnt(16) lgkmcnt(0)
  s_barrier
  v_mfma_f32_16x16x32_bf16 v[8:11], a[4:7], v[196:199], v[8:11]
  ds_read_b128 a[64:67], v220 offset:0
  v_mul_f32 v176, s39, v176
  v_mfma_f32_16x16x32_bf16 v[12:15], a[4:7], v[200:203], v[12:15]
  v_exp_f32 v176, v176
  v_mfma_f32_16x16x32_bf16 v[16:19], a[8:11], v[196:199], v[16:19]
  ds_read_b128 a[68:71], v221 offset:0
  v_mul_f32 v177, s39, v177
  v_mfma_f32_16x16x32_bf16 v[20:23], a[8:11], v[200:203], v[20:23]
  ds_read_b128 a[72:75], v222 offset:0
  s_add_u32 s36, s36, 16384
  v_mfma_f32_16x16x32_bf16 v[24:27], a[12:15], v[196:199], v[24:27]
  ds_read_b128 a[76:79], v223 offset:0
  s_add_u32 m0, s38, 49152
  v_mfma_f32_16x16x32_bf16 v[28:31], a[12:15], v[200:203], v[28:31]
  v_exp_f32 v177, v177
  v_mfma_f32_16x16x32_bf16 v[40:43], a[20:23], v[196:199], v[40:43]
  ds_read_b128 a[80:83], v220 offset:256
  v_mul_f32 v178, s39, v178
  v_mfma_f32_16x16x32_bf16 v[44:47], a[20:23], v[200:203], v[44:47]
  buffer_load_dwordx4 v232, s[20:23], s36 offen offset:0 nt lds
  v_mfma_f32_16x16x32_bf16 v[48:51], a[24:27], v[196:199], v[48:51]
  ds_read_b128 a[84:87], v221 offset:256
  v_mul_f32 v179, s39, v179
  v_mfma_f32_16x16x32_bf16 v[52:55], a[24:27], v[200:203], v[52:55]
  v_exp_f32 v178, v178
  v_mfma_f32_16x16x32_bf16 v[56:59], a[28:31], v[196:199], v[56:59]
  ds_read_b128 a[88:91], v222 offset:256
  v_mul_f32 v184, s39, v184
  v_mfma_f32_16x16x32_bf16 v[60:63], a[28:31], v[200:203], v[60:63]
  ds_read_b128 a[92:95], v223 offset:256
  v_mul_f32 v185, s39, v185
  v_mfma_f32_16x16x32_bf16 v[72:75], a[36:39], v[196:199], v[72:75]
  ds_read_b64_tr_b16 a[4:5], v225 offset:49152
  v_mul_f32 v186, s39, v186
  v_mfma_f32_16x16x32_bf16 v[76:79], a[36:39], v[200:203], v[76:79]
  ds_read_b128 a[232:235], v241 offset:2048
  v_mul_f32 v187, s39, v187
  v_mfma_f32_16x16x32_bf16 v[80:83], a[40:43], v[196:199], v[80:83]
  v_exp_f32 v179, v179
  v_mfma_f32_16x16x32_bf16 v[84:87], a[40:43], v[200:203], v[84:87]
  ds_read_b128 a[96:99], v220 offset:8192
  v_mul_f32 v180, s39, v180
  v_mfma_f32_16x16x32_bf16 v[88:91], a[44:47], v[196:199], v[88:91]
  buffer_load_dwordx4 v233, s[20:23], s36 offen offset:1024 nt lds
  v_mfma_f32_16x16x32_bf16 v[92:95], a[44:47], v[200:203], v[92:95]
  ds_read_b128 a[100:103], v221 offset:8192
  v_mul_f32 v181, s39, v181
  v_mfma_f32_16x16x32_bf16 v[104:107], a[52:55], v[196:199], v[104:107]
  v_exp_f32 v184, v184
  v_mfma_f32_16x16x32_bf16 v[108:111], a[52:55], v[200:203], v[108:111]
  ds_read_b128 a[104:107], v222 offset:8192
  v_mul_f32 v182, s39, v182
  v_mfma_f32_16x16x32_bf16 v[112:115], a[56:59], v[196:199], v[112:115]
  ds_read_b64_tr_b16 a[6:7], v225 offset:57344
  v_mul_f32 v183, s39, v183
  v_mfma_f32_16x16x32_bf16 v[116:119], a[56:59], v[200:203], v[116:119]
  ds_read_b128 a[108:111], v223 offset:8192
  v_mul_f32 v188, s39, v188
  v_mfma_f32_16x16x32_bf16 v[120:123], a[60:63], v[196:199], v[120:123]
  ds_read_b128 a[236:239], v241 offset:3072
  v_mul_f32 v189, s39, v189
  v_mfma_f32_16x16x32_bf16 v[124:127], a[60:63], v[200:203], v[124:127]
  v_exp_f32 v185, v185
  v_mfma_f32_16x16x32_bf16 v[0:3], a[0:3], v[196:199], v[0:3]
  ds_read_b128 a[112:115], v220 offset:8448
  v_mul_f32 v190, s39, v190
  v_mfma_f32_16x16x32_bf16 v[4:7], a[0:3], v[200:203], v[4:7]
  buffer_load_dwordx4 v234, s[20:23], s36 offen offset:2048 nt lds
  v_mfma_f32_16x16x32_bf16 v[128:131], a[0:3], a[224:227], v[128:131]
  ds_read_b128 a[116:119], v221 offset:8448
  v_mul_f32 v191, s39, v191
  v_mfma_f32_16x16x32_bf16 v[132:135], a[0:3], a[228:231], v[132:135]
  v_exp_f32 v186, v186
  v_mfma_f32_16x16x32_bf16 v[32:35], a[16:19], v[196:199], v[32:35]
  ds_read_b128 a[120:123], v222 offset:8448
  v_cvt_pk_bf16_f32 v204, v176, v177
  v_mfma_f32_16x16x32_bf16 v[36:39], a[16:19], v[200:203], v[36:39]
  ds_read_b64_tr_b16 a[8:9], v226 offset:49152
  v_cvt_pk_bf16_f32 v205, v178, v179
  v_mfma_f32_16x16x32_bf16 v[136:139], a[16:19], a[224:227], v[136:139]
  ds_read_b128 a[124:127], v223 offset:8448
  v_cvt_pk_bf16_f32 v206, v184, v185
  v_mfma_f32_16x16x32_bf16 v[140:143], a[16:19], a[228:231], v[140:143]
  ds_read_b64_tr_b16 a[10:11], v226 offset:57344
  v_add_f32 v214, v214, v176
  v_mfma_f32_16x16x32_bf16 v[64:67], a[32:35], v[196:199], v[64:67]
  v_exp_f32 v187, v187
  v_mfma_f32_16x16x32_bf16 v[68:71], a[32:35], v[200:203], v[68:71]
  ds_read_b64_tr_b16 a[12:13], v227 offset:49152
  v_cvt_pk_bf16_f32 v207, v186, v187
  v_mfma_f32_16x16x32_bf16 v[144:147], a[32:35], a[224:227], v[144:147]
  buffer_load_dwordx4 v235, s[20:23], s36 offen offset:3072 nt lds
  v_mfma_f32_16x16x32_bf16 v[148:151], a[32:35], a[228:231], v[148:151]
  ds_read_b64_tr_b16 a[14:15], v227 offset:57344
  s_add_u32 m0, s38, 98304
  v_mfma_f32_16x16x32_bf16 v[96:99], a[48:51], v[196:199], v[96:99]
  v_exp_f32 v180, v180
  v_mfma_f32_16x16x32_bf16 v[100:103], a[48:51], v[200:203], v[100:103]
  ds_read_b64_tr_b16 a[20:21], v229 offset:49152
  v_add_f32 v214, v214, v177
  v_mfma_f32_16x16x32_bf16 v[152:155], a[48:51], a[224:227], v[152:155]
  ds_read_b64_tr_b16 a[22:23], v229 offset:57344
  v_add_f32 v214, v214, v178
  v_mfma_f32_16x16x32_bf16 v[156:159], a[48:51], a[228:231], v[156:159]
  ds_read_b64_tr_b16 a[24:25], v230 offset:49152
  s_waitcnt lgkmcnt(6)
  v_mfma_f32_16x16x32_bf16 v[192:195], a[64:67], a[192:195], v[250:253]
  ds_read_b64_tr_b16 a[26:27], v230 offset:57344
  v_add_f32 v214, v214, v179
  v_mfma_f32_16x16x32_bf16 v[192:195], a[68:71], a[196:199], v[192:195]
  v_exp_f32 v181, v181
  v_mfma_f32_16x16x32_bf16 v[192:195], a[72:75], a[200:203], v[192:195]
  ds_read_b64_tr_b16 a[28:29], v231 offset:49152
  v_cvt_pk_bf16_f32 v208, v180, v181
  v_mfma_f32_16x16x32_bf16 v[192:195], a[76:79], a[204:207], v[192:195]
  ds_read_b64_tr_b16 a[30:31], v231 offset:57344
  v_add_f32 v214, v214, v184
  v_mfma_f32_16x16x32_bf16 v[192:195], a[80:83], a[208:211], v[192:195]
  buffer_load_dwordx4 v236, s[24:27], s36 offen offset:0 nt lds
  v_mfma_f32_16x16x32_bf16 v[192:195], a[84:87], a[212:215], v[192:195]
  ds_read_b64_tr_b16 a[36:37], v225 offset:49408
  v_add_f32 v214, v214, v185
  v_mfma_f32_16x16x32_bf16 v[192:195], a[88:91], a[216:219], v[192:195]
  v_exp_f32 v182, v182
  v_mfma_f32_16x16x32_bf16 v[192:195], a[92:95], a[220:223], v[192:195]
  ds_read_b64_tr_b16 a[38:39], v225 offset:57600
  v_add_f32 v214, v214, v186
  v_mfma_f32_16x16x32_bf16 v[160:163], a[64:67], a[128:131], v[242:245]
  ds_read_b64_tr_b16 a[40:41], v226 offset:49408
  v_add_f32 v214, v214, v187
  v_mfma_f32_16x16x32_bf16 v[164:167], a[64:67], a[160:163], v[246:249]
  ds_read_b64_tr_b16 a[42:43], v226 offset:57600
  v_add_f32 v215, v215, v180
  v_mfma_f32_16x16x32_bf16 v[160:163], a[68:71], a[132:135], v[160:163]
  v_exp_f32 v183, v183
  v_mfma_f32_16x16x32_bf16 v[164:167], a[68:71], a[164:167], v[164:167]
  ds_read_b64_tr_b16 a[44:45], v227 offset:49408
  v_mul_f32 v192, s39, v192
  v_mfma_f32_16x16x32_bf16 v[160:163], a[72:75], a[136:139], v[160:163]
  ds_read_b64_tr_b16 a[46:47], v227 offset:57600
  v_mul_f32 v193, s39, v193
  v_mfma_f32_16x16x32_bf16 v[164:167], a[72:75], a[168:171], v[164:167]
  v_exp_f32 v192, v192
  v_mfma_f32_16x16x32_bf16 v[160:163], a[76:79], a[140:143], v[160:163]
  ds_read_b64_tr_b16 a[52:53], v229 offset:49408
  v_mul_f32 v194, s39, v194
  v_mfma_f32_16x16x32_bf16 v[164:167], a[76:79], a[172:175], v[164:167]
  v_exp_f32 v193, v193
  v_mfma_f32_16x16x32_bf16 v[160:163], a[80:83], a[144:147], v[160:163]
  ds_read_b64_tr_b16 a[54:55], v229 offset:57600
  v_mul_f32 v195, s39, v195
  v_mfma_f32_16x16x32_bf16 v[164:167], a[80:83], a[176:179], v[164:167]
  buffer_load_dwordx4 v237, s[24:27], s36 offen offset:1024 nt lds
  v_mfma_f32_16x16x32_bf16 v[160:163], a[84:87], a[148:151], v[160:163]
  v_exp_f32 v194, v194
  v_mfma_f32_16x16x32_bf16 v[164:167], a[84:87], a[180:183], v[164:167]
  ds_read_b64_tr_b16 a[56:57], v230 offset:49408
  v_cvt_pk_bf16_f32 v212, v192, v193
  v_mfma_f32_16x16x32_bf16 v[160:163], a[88:91], a[152:155], v[160:163]
  v_exp_f32 v195, v195
  v_mfma_f32_16x16x32_bf16 v[164:167], a[88:91], a[184:187], v[164:167]
  ds_read_b64_tr_b16 a[58:59], v230 offset:57600
  v_cvt_pk_bf16_f32 v213, v194, v195
  v_mfma_f32_16x16x32_bf16 v[160:163], a[92:95], a[156:159], v[160:163]
  ds_read_b64_tr_b16 a[60:61], v231 offset:49408
  v_cvt_pk_bf16_f32 v209, v182, v183
  v_mfma_f32_16x16x32_bf16 v[164:167], a[92:95], a[188:191], v[164:167]
  ds_write_b64 v240, v[212:213] offset:0
  v_add_f32 v215, v215, v181
  v_mfma_f32_16x16x32_bf16 v[168:171], a[96:99], a[128:131], v[242:245]
  v_exp_f32 v188, v188
  v_mfma_f32_16x16x32_bf16 v[172:175], a[96:99], a[160:163], v[246:249]
  ds_read_b64_tr_b16 a[62:63], v231 offset:57600
  v_add_f32 v215, v215, v182
  v_mfma_f32_16x16x32_bf16 v[168:171], a[100:103], a[132:135], v[168:171]
  ds_read_b64_tr_b16 a[0:1], v224 offset:49152
  v_add_f32 v215, v215, v183
  v_mfma_f32_16x16x32_bf16 v[172:175], a[100:103], a[164:167], v[172:175]
  ds_read_b64_tr_b16 a[2:3], v224 offset:57344
  v_add_f32 v215, v215, v188
  v_mfma_f32_16x16x32_bf16 v[168:171], a[104:107], a[136:139], v[168:171]
  v_exp_f32 v189, v189
  v_mfma_f32_16x16x32_bf16 v[172:175], a[104:107], a[168:171], v[172:175]
  ds_read_b64_tr_b16 a[16:17], v228 offset:49152
  v_cvt_pk_bf16_f32 v210, v188, v189
  v_mfma_f32_16x16x32_bf16 v[168:171], a[108:111], a[140:143], v[168:171]
  ds_read_b64_tr_b16 a[18:19], v228 offset:57344
  v_add_f32 v215, v215, v189
  v_mfma_f32_16x16x32_bf16 v[172:175], a[108:111], a[172:175], v[172:175]
  ds_read_b64_tr_b16 a[32:33], v224 offset:49408
  v_add_f32 v216, v216, v192
  v_mfma_f32_16x16x32_bf16 v[168:171], a[112:115], a[144:147], v[168:171]
  ds_read_b64_tr_b16 a[34:35], v224 offset:57600
  v_add_f32 v216, v216, v193
  v_mfma_f32_16x16x32_bf16 v[172:175], a[112:115], a[176:179], v[172:175]
  ds_read_b64_tr_b16 a[48:49], v228 offset:49408
  v_add_f32 v216, v216, v194
  v_mfma_f32_16x16x32_bf16 v[168:171], a[116:119], a[148:151], v[168:171]
  ds_read_b64_tr_b16 a[50:51], v228 offset:57600
  v_add_f32 v216, v216, v195
  v_mfma_f32_16x16x32_bf16 v[172:175], a[116:119], a[180:183], v[172:175]
  v_exp_f32 v190, v190
  v_mfma_f32_16x16x32_bf16 v[168:171], a[120:123], a[152:155], v[168:171]
  buffer_load_dwordx4 v238, s[24:27], s36 offen offset:2048 nt lds
  v_mfma_f32_16x16x32_bf16 v[172:175], a[120:123], a[184:187], v[172:175]
  v_exp_f32 v191, v191
  v_mfma_f32_16x16x32_bf16 v[168:171], a[124:127], a[156:159], v[168:171]
  buffer_load_dwordx4 v239, s[24:27], s36 offen offset:3072 nt lds
  v_cvt_pk_bf16_f32 v211, v190, v191
  v_mfma_f32_16x16x32_bf16 v[172:175], a[124:127], a[188:191], v[172:175]
  v_add_f32 v215, v215, v190
  v_add_f32 v215, v215, v191
  s_waitcnt vmcnt(16) lgkmcnt(0)
  s_barrier
  v_mfma_f32_16x16x32_bf16 v[8:11], a[4:7], v[204:207], v[8:11]
  ds_read_b128 a[64:67], v220 offset:16384
  v_mul_f32 v160, s39, v160
  v_mfma_f32_16x16x32_bf16 v[12:15], a[4:7], v[208:211], v[12:15]
  v_exp_f32 v160, v160
  v_mfma_f32_16x16x32_bf16 v[16:19], a[8:11], v[204:207], v[16:19]
  ds_read_b128 a[68:71], v221 offset:16384
  v_mul_f32 v161, s39, v161
  v_mfma_f32_16x16x32_bf16 v[20:23], a[8:11], v[208:211], v[20:23]
  ds_read_b128 a[72:75], v222 offset:16384
  s_add_u32 s36, s36, 16384
  v_mfma_f32_16x16x32_bf16 v[24:27], a[12:15], v[204:207], v[24:27]
  ds_read_b128 a[76:79], v223 offset:16384
  s_add_u32 m0, s38, 0
  v_mfma_f32_16x16x32_bf16 v[28:31], a[12:15], v[208:211], v[28:31]
  v_exp_f32 v161, v161
  v_mfma_f32_16x16x32_bf16 v[40:43], a[20:23], v[204:207], v[40:43]
  ds_read_b128 a[80:83], v220 offset:16640
  v_mul_f32 v162, s39, v162
  v_mfma_f32_16x16x32_bf16 v[44:47], a[20:23], v[208:211], v[44:47]
  buffer_load_dwordx4 v232, s[20:23], s36 offen offset:0 nt lds
  v_mfma_f32_16x16x32_bf16 v[48:51], a[24:27], v[204:207], v[48:51]
  ds_read_b128 a[84:87], v221 offset:16640
  v_mul_f32 v163, s39, v163
  v_mfma_f32_16x16x32_bf16 v[52:55], a[24:27], v[208:211], v[52:55]
  v_exp_f32 v162, v162
  v_mfma_f32_16x16x32_bf16 v[56:59], a[28:31], v[204:207], v[56:59]
  ds_read_b128 a[88:91], v222 offset:16640
  v_mul_f32 v168, s39, v168
  v_mfma_f32_16x16x32_bf16 v[60:63], a[28:31], v[208:211], v[60:63]
  ds_read_b128 a[92:95], v223 offset:16640
  v_mul_f32 v169, s39, v169
  v_mfma_f32_16x16x32_bf16 v[72:75], a[36:39], v[204:207], v[72:75]
  ds_read_b64_tr_b16 a[4:5], v225 offset:0
  v_mul_f32 v170, s39, v170
  v_mfma_f32_16x16x32_bf16 v[76:79], a[36:39], v[208:211], v[76:79]
  ds_read_b128 a[224:227], v241 offset:0
  v_mul_f32 v171, s39, v171
  v_mfma_f32_16x16x32_bf16 v[80:83], a[40:43], v[204:207], v[80:83]
  v_exp_f32 v163, v163
  v_mfma_f32_16x16x32_bf16 v[84:87], a[40:43], v[208:211], v[84:87]
  ds_read_b128 a[96:99], v220 offset:24576
  v_mul_f32 v164, s39, v164
  v_mfma_f32_16x16x32_bf16 v[88:91], a[44:47], v[204:207], v[88:91]
  buffer_load_dwordx4 v233, s[20:23], s36 offen offset:1024 nt lds
  v_mfma_f32_16x16x32_bf16 v[92:95], a[44:47], v[208:211], v[92:95]
  ds_read_b128 a[100:103], v221 offset:24576
  v_mul_f32 v165, s39, v165
  v_mfma_f32_16x16x32_bf16 v[104:107], a[52:55], v[204:207], v[104:107]
  v_exp_f32 v168, v168
  v_mfma_f32_16x16x32_bf16 v[108:111], a[52:55], v[208:211], v[108:111]
  ds_read_b128 a[104:107], v222 offset:24576
  v_mul_f32 v166, s39, v166
  v_mfma_f32_16x16x32_bf16 v[112:115], a[56:59], v[204:207], v[112:115]
  ds_read_b64_tr_b16 a[6:7], v225 offset:8192
  v_mul_f32 v167, s39, v167
  v_mfma_f32_16x16x32_bf16 v[116:119], a[56:59], v[208:211], v[116:119]
  ds_read_b128 a[108:111], v223 offset:24576
  v_mul_f32 v172, s39, v172
  v_mfma_f32_16x16x32_bf16 v[120:123], a[60:63], v[204:207], v[120:123]
  ds_read_b128 a[228:231], v241 offset:1024
  v_mul_f32 v173, s39, v173
  v_mfma_f32_16x16x32_bf16 v[124:127], a[60:63], v[208:211], v[124:127]
  v_exp_f32 v169, v169
  v_mfma_f32_16x16x32_bf16 v[0:3], a[0:3], v[204:207], v[0:3]
  ds_read_b128 a[112:115], v220 offset:24832
  v_mul_f32 v174, s39, v174
  v_mfma_f32_16x16x32_bf16 v[4:7], a[0:3], v[208:211], v[4:7]
  buffer_load_dwordx4 v234, s[20:23], s36 offen offset:2048 nt lds
  v_mfma_f32_16x16x32_bf16 v[128:131], a[0:3], a[232:235], v[128:131]
  ds_read_b128 a[116:119], v221 offset:24832
  v_mul_f32 v175, s39, v175
  v_mfma_f32_16x16x32_bf16 v[132:135], a[0:3], a[236:239], v[132:135]
  v_exp_f32 v170, v170
  v_mfma_f32_16x16x32_bf16 v[32:35], a[16:19], v[204:207], v[32:35]
  ds_read_b128 a[120:123], v222 offset:24832
  v_cvt_pk_bf16_f32 v196, v160, v161
  v_mfma_f32_16x16x32_bf16 v[36:39], a[16:19], v[208:211], v[36:39]
  ds_read_b64_tr_b16 a[8:9], v226 offset:0
  v_cvt_pk_bf16_f32 v197, v162, v163
  v_mfma_f32_16x16x32_bf16 v[136:139], a[16:19], a[232:235], v[136:139]
  ds_read_b128 a[124:127], v223 offset:24832
  v_cvt_pk_bf16_f32 v198, v168, v169
  v_mfma_f32_16x16x32_bf16 v[140:143], a[16:19], a[236:239], v[140:143]
  ds_read_b64_tr_b16 a[10:11], v226 offset:8192
  v_add_f32 v214, v214, v160
  v_mfma_f32_16x16x32_bf16 v[64:67], a[32:35], v[204:207], v[64:67]
  v_exp_f32 v171, v171
  v_mfma_f32_16x16x32_bf16 v[68:71], a[32:35], v[208:211], v[68:71]
  ds_read_b64_tr_b16 a[12:13], v227 offset:0
  v_cvt_pk_bf16_f32 v199, v170, v171
  v_mfma_f32_16x16x32_bf16 v[144:147], a[32:35], a[232:235], v[144:147]
  buffer_load_dwordx4 v235, s[20:23], s36 offen offset:3072 nt lds
  v_mfma_f32_16x16x32_bf16 v[148:151], a[32:35], a[236:239], v[148:151]
  ds_read_b64_tr_b16 a[14:15], v227 offset:8192
  s_add_u32 m0, s38, 114688
  v_mfma_f32_16x16x32_bf16 v[96:99], a[48:51], v[204:207], v[96:99]
  v_exp_f32 v164, v164
  v_mfma_f32_16x16x32_bf16 v[100:103], a[48:51], v[208:211], v[100:103]
  ds_read_b64_tr_b16 a[20:21], v229 offset:0
  v_add_f32 v214, v214, v161
  v_mfma_f32_16x16x32_bf16 v[152:155], a[48:51], a[232:235], v[152:155]
  ds_read_b64_tr_b16 a[22:23], v229 offset:8192
  v_add_f32 v214, v214, v162
  v_mfma_f32_16x16x32_bf16 v[156:159], a[48:51], a[236:239], v[156:159]
  ds_read_b64_tr_b16 a[24:25], v230 offset:0
  s_waitcnt lgkmcnt(6)
  v_mfma_f32_16x16x32_bf16 v[192:195], a[64:67], a[192:195], v[250:253]
  ds_read_b64_tr_b16 a[26:27], v230 offset:8192
  v_add_f32 v214, v214, v163
  v_mfma_f32_16x16x32_bf16 v[192:195], a[68:71], a[196:199], v[192:195]
  v_exp_f32 v165, v165
  v_mfma_f32_16x16x32_bf16 v[192:195], a[72:75], a[200:203], v[192:195]
  ds_read_b64_tr_b16 a[28:29], v231 offset:0
  v_cvt_pk_bf16_f32 v200, v164, v165
  v_mfma_f32_16x16x32_bf16 v[192:195], a[76:79], a[204:207], v[192:195]
  ds_read_b64_tr_b16 a[30:31], v231 offset:8192
  v_add_f32 v214, v214, v168
  v_mfma_f32_16x16x32_bf16 v[192:195], a[80:83], a[208:211], v[192:195]
  buffer_load_dwordx4 v236, s[24:27], s36 offen offset:0 nt lds
  v_mfma_f32_16x16x32_bf16 v[192:195], a[84:87], a[212:215], v[192:195]
  ds_read_b64_tr_b16 a[36:37], v225 offset:256
  v_add_f32 v214, v214, v169
  v_mfma_f32_16x16x32_bf16 v[192:195], a[88:91], a[216:219], v[192:195]
  v_exp_f32 v166, v166
  v_mfma_f32_16x16x32_bf16 v[192:195], a[92:95], a[220:223], v[192:195]
  ds_read_b64_tr_b16 a[38:39], v225 offset:8448
  v_add_f32 v214, v214, v170
  v_mfma_f32_16x16x32_bf16 v[176:179], a[64:67], a[128:131], v[242:245]
  ds_read_b64_tr_b16 a[40:41], v226 offset:256
  v_add_f32 v214, v214, v171
  v_mfma_f32_16x16x32_bf16 v[180:183], a[64:67], a[160:163], v[246:249]
  ds_read_b64_tr_b16 a[42:43], v226 offset:8448
  v_add_f32 v215, v215, v164
  v_mfma_f32_16x16x32_bf16 v[176:179], a[68:71], a[132:135], v[176:179]
  v_exp_f32 v167, v167
  v_mfma_f32_16x16x32_bf16 v[180:183], a[68:71], a[164:167], v[180:183]
  ds_read_b64_tr_b16 a[44:45], v227 offset:256
  v_mul_f32 v192, s39, v192
  v_mfma_f32_16x16x32_bf16 v[176:179], a[72:75], a[136:139], v[176:179]
  ds_read_b64_tr_b16 a[46:47], v227 offset:8448
  v_mul_f32 v193, s39, v193
  v_mfma_f32_16x16x32_bf16 v[180:183], a[72:75], a[168:171], v[180:183]
  v_exp_f32 v192, v192
  v_mfma_f32_16x16x32_bf16 v[176:179], a[76:79], a[140:143], v[176:179]
  ds_read_b64_tr_b16 a[52:53], v229 offset:256
  v_mul_f32 v194, s39, v194
  v_mfma_f32_16x16x32_bf16 v[180:183], a[76:79], a[172:175], v[180:183]
  v_exp_f32 v193, v193
  v_mfma_f32_16x16x32_bf16 v[176:179], a[80:83], a[144:147], v[176:179]
  ds_read_b64_tr_b16 a[54:55], v229 offset:8448
  v_mul_f32 v195, s39, v195
  v_mfma_f32_16x16x32_bf16 v[180:183], a[80:83], a[176:179], v[180:183]
  buffer_load_dwordx4 v237, s[24:27], s36 offen offset:1024 nt lds
  v_mfma_f32_16x16x32_bf16 v[176:179], a[84:87], a[148:151], v[176:179]
  v_exp_f32 v194, v194
  v_mfma_f32_16x16x32_bf16 v[180:183], a[84:87], a[180:183], v[180:183]
  ds_read_b64_tr_b16 a[56:57], v230 offset:256
  v_cvt_pk_bf16_f32 v212, v192, v193
  v_mfma_f32_16x16x32_bf16 v[176:179], a[88:91], a[152:155], v[176:179]
  v_exp_f32 v195, v195
  v_mfma_f32_16x16x32_bf16 v[180:183], a[88:91], a[184:187], v[180:183]
  ds_read_b64_tr_b16 a[58:59], v230 offset:8448
  v_cvt_pk_bf16_f32 v213, v194, v195
  v_mfma_f32_16x16x32_bf16 v[176:179], a[92:95], a[156:159], v[176:179]
  ds_read_b64_tr_b16 a[60:61], v231 offset:256
  v_cvt_pk_bf16_f32 v201, v166, v167
  v_mfma_f32_16x16x32_bf16 v[180:183], a[92:95], a[188:191], v[180:183]
  ds_write_b64 v240, v[212:213] offset:2048
  v_add_f32 v215, v215, v165
  v_mfma_f32_16x16x32_bf16 v[184:187], a[96:99], a[128:131], v[242:245]
  v_exp_f32 v172, v172
  v_mfma_f32_16x16x32_bf16 v[188:191], a[96:99], a[160:163], v[246:249]
  ds_read_b64_tr_b16 a[62:63], v231 offset:8448
  v_add_f32 v215, v215, v166
  v_mfma_f32_16x16x32_bf16 v[184:187], a[100:103], a[132:135], v[184:187]
  ds_read_b64_tr_b16 a[0:1], v224 offset:0
  v_add_f32 v215, v215, v167
  v_mfma_f32_16x16x32_bf16 v[188:191], a[100:103], a[164:167], v[188:191]
  ds_read_b64_tr_b16 a[2:3], v224 offset:8192
  v_add_f32 v215, v215, v172
  v_mfma_f32_16x16x32_bf16 v[184:187], a[104:107], a[136:139], v[184:187]
  v_exp_f32 v173, v173
  v_mfma_f32_16x16x32_bf16 v[188:191], a[104:107], a[168:171], v[188:191]
  ds_read_b64_tr_b16 a[16:17], v228 offset:0
  v_cvt_pk_bf16_f32 v202, v172, v173
  v_mfma_f32_16x16x32_bf16 v[184:187], a[108:111], a[140:143], v[184:187]
  ds_read_b64_tr_b16 a[18:19], v228 offset:8192
  v_add_f32 v215, v215, v173
  v_mfma_f32_16x16x32_bf16 v[188:191], a[108:111], a[172:175], v[188:191]
  ds_read_b64_tr_b16 a[32:33], v224 offset:256
  v_add_f32 v216, v216, v192
  v_mfma_f32_16x16x32_bf16 v[184:187], a[112:115], a[144:147], v[184:187]
  ds_read_b64_tr_b16 a[34:35], v224 offset:8448
  v_add_f32 v216, v216, v193
  v_mfma_f32_16x16x32_bf16 v[188:191], a[112:115], a[176:179], v[188:191]
  ds_read_b64_tr_b16 a[48:49], v228 offset:256
  v_add_f32 v216, v216, v194
  v_mfma_f32_16x16x32_bf16 v[184:187], a[116:119], a[148:151], v[184:187]
  ds_read_b64_tr_b16 a[50:51], v228 offset:8448
  v_add_f32 v216, v216, v195
  v_mfma_f32_16x16x32_bf16 v[188:191], a[116:119], a[180:183], v[188:191]
  v_exp_f32 v174, v174
  v_mfma_f32_16x16x32_bf16 v[184:187], a[120:123], a[152:155], v[184:187]
  buffer_load_dwordx4 v238, s[24:27], s36 offen offset:2048 nt lds
  v_mfma_f32_16x16x32_bf16 v[188:191], a[120:123], a[184:187], v[188:191]
  v_exp_f32 v175, v175
  v_mfma_f32_16x16x32_bf16 v[184:187], a[124:127], a[156:159], v[184:187]
  buffer_load_dwordx4 v239, s[24:27], s36 offen offset:3072 nt lds
  v_cvt_pk_bf16_f32 v203, v174, v175
  v_mfma_f32_16x16x32_bf16 v[188:191], a[124:127], a[188:191], v[188:191]
  v_add_f32 v215, v215, v174
  v_add_f32 v215, v215, v175
  s_waitcnt vmcnt(16) lgkmcnt(0)
  s_barrier
  v_mfma_f32_16x16x32_bf16 v[8:11], a[4:7], v[196:199], v[8:11]
  ds_read_b128 a[64:67], v220 offset:32768
  v_mul_f32 v176, s39, v176
  v_mfma_f32_16x16x32_bf16 v[12:15], a[4:7], v[200:203], v[12:15]
  v_exp_f32 v176, v176
  v_mfma_f32_16x16x32_bf16 v[16:19], a[8:11], v[196:199], v[16:19]
  ds_read_b128 a[68:71], v221 offset:32768
  v_mul_f32 v177, s39, v177
  v_mfma_f32_16x16x32_bf16 v[20:23], a[8:11], v[200:203], v[20:23]
  ds_read_b128 a[72:75], v222 offset:32768
  s_add_u32 s36, s36, 16384
  v_mfma_f32_16x16x32_bf16 v[24:27], a[12:15], v[196:199], v[24:27]
  ds_read_b128 a[76:79], v223 offset:32768
  s_add_u32 m0, s38, 16384
  v_mfma_f32_16x16x32_bf16 v[28:31], a[12:15], v[200:203], v[28:31]
  v_exp_f32 v177, v177
  v_mfma_f32_16x16x32_bf16 v[40:43], a[20:23], v[196:199], v[40:43]
  ds_read_b128 a[80:83], v220 offset:33024
  v_mul_f32 v178, s39, v178
  v_mfma_f32_16x16x32_bf16 v[44:47], a[20:23], v[200:203], v[44:47]
  buffer_load_dwordx4 v232, s[20:23], s36 offen offset:0 nt lds
  v_mfma_f32_16x16x32_bf16 v[48:51], a[24:27], v[196:199], v[48:51]
  ds_read_b128 a[84:87], v221 offset:33024
  v_mul_f32 v179, s39, v179
  v_mfma_f32_16x16x32_bf16 v[52:55], a[24:27], v[200:203], v[52:55]
  v_exp_f32 v178, v178
  v_mfma_f32_16x16x32_bf16 v[56:59], a[28:31], v[196:199], v[56:59]
  ds_read_b128 a[88:91], v222 offset:33024
  v_mul_f32 v184, s39, v184
  v_mfma_f32_16x16x32_bf16 v[60:63], a[28:31], v[200:203], v[60:63]
  ds_read_b128 a[92:95], v223 offset:33024
  v_mul_f32 v185, s39, v185
  v_mfma_f32_16x16x32_bf16 v[72:75], a[36:39], v[196:199], v[72:75]
  ds_read_b64_tr_b16 a[4:5], v225 offset:16384
  v_mul_f32 v186, s39, v186
  v_mfma_f32_16x16x32_bf16 v[76:79], a[36:39], v[200:203], v[76:79]
  ds_read_b128 a[232:235], v241 offset:2048
  v_mul_f32 v187, s39, v187
  v_mfma_f32_16x16x32_bf16 v[80:83], a[40:43], v[196:199], v[80:83]
  v_exp_f32 v179, v179
  v_mfma_f32_16x16x32_bf16 v[84:87], a[40:43], v[200:203], v[84:87]
  ds_read_b128 a[96:99], v220 offset:40960
  v_mul_f32 v180, s39, v180
  v_mfma_f32_16x16x32_bf16 v[88:91], a[44:47], v[196:199], v[88:91]
  buffer_load_dwordx4 v233, s[20:23], s36 offen offset:1024 nt lds
  v_mfma_f32_16x16x32_bf16 v[92:95], a[44:47], v[200:203], v[92:95]
  ds_read_b128 a[100:103], v221 offset:40960
  v_mul_f32 v181, s39, v181
  v_mfma_f32_16x16x32_bf16 v[104:107], a[52:55], v[196:199], v[104:107]
  v_exp_f32 v184, v184
  v_mfma_f32_16x16x32_bf16 v[108:111], a[52:55], v[200:203], v[108:111]
  ds_read_b128 a[104:107], v222 offset:40960
  v_mul_f32 v182, s39, v182
  v_mfma_f32_16x16x32_bf16 v[112:115], a[56:59], v[196:199], v[112:115]
  ds_read_b64_tr_b16 a[6:7], v225 offset:24576
  v_mul_f32 v183, s39, v183
  v_mfma_f32_16x16x32_bf16 v[116:119], a[56:59], v[200:203], v[116:119]
  ds_read_b128 a[108:111], v223 offset:40960
  v_mul_f32 v188, s39, v188
  v_mfma_f32_16x16x32_bf16 v[120:123], a[60:63], v[196:199], v[120:123]
  ds_read_b128 a[236:239], v241 offset:3072
  v_mul_f32 v189, s39, v189
  v_mfma_f32_16x16x32_bf16 v[124:127], a[60:63], v[200:203], v[124:127]
  v_exp_f32 v185, v185
  v_mfma_f32_16x16x32_bf16 v[0:3], a[0:3], v[196:199], v[0:3]
  ds_read_b128 a[112:115], v220 offset:41216
  v_mul_f32 v190, s39, v190
  v_mfma_f32_16x16x32_bf16 v[4:7], a[0:3], v[200:203], v[4:7]
  buffer_load_dwordx4 v234, s[20:23], s36 offen offset:2048 nt lds
  v_mfma_f32_16x16x32_bf16 v[128:131], a[0:3], a[224:227], v[128:131]
  ds_read_b128 a[116:119], v221 offset:41216
  v_mul_f32 v191, s39, v191
  v_mfma_f32_16x16x32_bf16 v[132:135], a[0:3], a[228:231], v[132:135]
  v_exp_f32 v186, v186
  v_mfma_f32_16x16x32_bf16 v[32:35], a[16:19], v[196:199], v[32:35]
  ds_read_b128 a[120:123], v222 offset:41216
  v_cvt_pk_bf16_f32 v204, v176, v177
  v_mfma_f32_16x16x32_bf16 v[36:39], a[16:19], v[200:203], v[36:39]
  ds_read_b64_tr_b16 a[8:9], v226 offset:16384
  v_cvt_pk_bf16_f32 v205, v178, v179
  v_mfma_f32_16x16x32_bf16 v[136:139], a[16:19], a[224:227], v[136:139]
  ds_read_b128 a[124:127], v223 offset:41216
  v_cvt_pk_bf16_f32 v206, v184, v185
  v_mfma_f32_16x16x32_bf16 v[140:143], a[16:19], a[228:231], v[140:143]
  ds_read_b64_tr_b16 a[10:11], v226 offset:24576
  v_add_f32 v214, v214, v176
  v_mfma_f32_16x16x32_bf16 v[64:67], a[32:35], v[196:199], v[64:67]
  v_exp_f32 v187, v187
  v_mfma_f32_16x16x32_bf16 v[68:71], a[32:35], v[200:203], v[68:71]
  ds_read_b64_tr_b16 a[12:13], v227 offset:16384
  v_cvt_pk_bf16_f32 v207, v186, v187
  v_mfma_f32_16x16x32_bf16 v[144:147], a[32:35], a[224:227], v[144:147]
  buffer_load_dwordx4 v235, s[20:23], s36 offen offset:3072 nt lds
  v_mfma_f32_16x16x32_bf16 v[148:151], a[32:35], a[228:231], v[148:151]
  ds_read_b64_tr_b16 a[14:15], v227 offset:24576
  s_add_u32 m0, s38, 65536
  v_mfma_f32_16x16x32_bf16 v[96:99], a[48:51], v[196:199], v[96:99]
  v_exp_f32 v180, v180
  v_mfma_f32_16x16x32_bf16 v[100:103], a[48:51], v[200:203], v[100:103]
  ds_read_b64_tr_b16 a[20:21], v229 offset:16384
  v_add_f32 v214, v214, v177
  v_mfma_f32_16x16x32_bf16 v[152:155], a[48:51], a[224:227], v[152:155]
  ds_read_b64_tr_b16 a[22:23], v229 offset:24576
  v_add_f32 v214, v214, v178
  v_mfma_f32_16x16x32_bf16 v[156:159], a[48:51], a[228:231], v[156:159]
  ds_read_b64_tr_b16 a[24:25], v230 offset:16384
  s_waitcnt lgkmcnt(6)
  s_add_u32 s40, s40, 1
  s_cmp_lt_u32 s40, 7
  s_cbranch_scc1 L_loop_k0q1p1
  v_mfma_f32_16x16x32_bf16 v[192:195], a[64:67], a[192:195], v[250:253]
  ds_read_b64_tr_b16 a[26:27], v230 offset:24576
  v_add_f32 v214, v214, v179
  v_mfma_f32_16x16x32_bf16 v[192:195], a[68:71], a[196:199], v[192:195]
  v_exp_f32 v181, v181
  v_mfma_f32_16x16x32_bf16 v[192:195], a[72:75], a[200:203], v[192:195]
  ds_read_b64_tr_b16 a[28:29], v231 offset:16384
  v_cvt_pk_bf16_f32 v208, v180, v181
  v_mfma_f32_16x16x32_bf16 v[192:195], a[76:79], a[204:207], v[192:195]
  ds_read_b64_tr_b16 a[30:31], v231 offset:24576
  v_add_f32 v214, v214, v184
  v_mfma_f32_16x16x32_bf16 v[192:195], a[80:83], a[208:211], v[192:195]
  v_mfma_f32_16x16x32_bf16 v[192:195], a[84:87], a[212:215], v[192:195]
  ds_read_b64_tr_b16 a[36:37], v225 offset:16640
  v_add_f32 v214, v214, v185
  v_mfma_f32_16x16x32_bf16 v[192:195], a[88:91], a[216:219], v[192:195]
  v_exp_f32 v182, v182
  v_mfma_f32_16x16x32_bf16 v[192:195], a[92:95], a[220:223], v[192:195]
  ds_read_b64_tr_b16 a[38:39], v225 offset:24832
  v_add_f32 v214, v214, v186
  v_mfma_f32_16x16x32_bf16 v[160:163], a[64:67], a[128:131], v[242:245]
  ds_read_b64_tr_b16 a[40:41], v226 offset:16640
  v_add_f32 v214, v214, v187
  v_mfma_f32_16x16x32_bf16 v[164:167], a[64:67], a[160:163], v[246:249]
  ds_read_b64_tr_b16 a[42:43], v226 offset:24832
  v_add_f32 v215, v215, v180
  v_mfma_f32_16x16x32_bf16 v[160:163], a[68:71], a[132:135], v[160:163]
  v_exp_f32 v183, v183
  v_mfma_f32_16x16x32_bf16 v[164:167], a[68:71], a[164:167], v[164:167]
  ds_read_b64_tr_b16 a[44:45], v227 offset:16640
  v_mul_f32 v192, s39, v192
  v_mfma_f32_16x16x32_bf16 v[160:163], a[72:75], a[136:139], v[160:163]
  ds_read_b64_tr_b16 a[46:47], v227 offset:24832
  v_mul_f32 v193, s39, v193
  v_mfma_f32_16x16x32_bf16 v[164:167], a[72:75], a[168:171], v[164:167]
  v_exp_f32 v192, v192
  v_mfma_f32_16x16x32_bf16 v[160:163], a[76:79], a[140:143], v[160:163]
  ds_read_b64_tr_b16 a[52:53], v229 offset:16640
  v_mul_f32 v194, s39, v194
  v_mfma_f32_16x16x32_bf16 v[164:167], a[76:79], a[172:175], v[164:167]
  v_exp_f32 v193, v193
  v_mfma_f32_16x16x32_bf16 v[160:163], a[80:83], a[144:147], v[160:163]
  ds_read_b64_tr_b16 a[54:55], v229 offset:24832
  v_mul_f32 v195, s39, v195
  v_mfma_f32_16x16x32_bf16 v[164:167], a[80:83], a[176:179], v[164:167]
  v_mfma_f32_16x16x32_bf16 v[160:163], a[84:87], a[148:151], v[160:163]
  v_exp_f32 v194, v194
  v_mfma_f32_16x16x32_bf16 v[164:167], a[84:87], a[180:183], v[164:167]
  ds_read_b64_tr_b16 a[56:57], v230 offset:16640
  v_cvt_pk_bf16_f32 v212, v192, v193
  v_mfma_f32_16x16x32_bf16 v[160:163], a[88:91], a[152:155], v[160:163]
  v_exp_f32 v195, v195
  v_mfma_f32_16x16x32_bf16 v[164:167], a[88:91], a[184:187], v[164:167]
  ds_read_b64_tr_b16 a[58:59], v230 offset:24832
  v_cvt_pk_bf16_f32 v213, v194, v195
  v_mfma_f32_16x16x32_bf16 v[160:163], a[92:95], a[156:159], v[160:163]
  ds_read_b64_tr_b16 a[60:61], v231 offset:16640
  v_cvt_pk_bf16_f32 v209, v182, v183
  v_mfma_f32_16x16x32_bf16 v[164:167], a[92:95], a[188:191], v[164:167]
  ds_write_b64 v240, v[212:213] offset:0
  v_add_f32 v215, v215, v181
  v_mfma_f32_16x16x32_bf16 v[168:171], a[96:99], a[128:131], v[242:245]
  v_exp_f32 v188, v188
  v_mfma_f32_16x16x32_bf16 v[172:175], a[96:99], a[160:163], v[246:249]
  ds_read_b64_tr_b16 a[62:63], v231 offset:24832
  v_add_f32 v215, v215, v182
  v_mfma_f32_16x16x32_bf16 v[168:171], a[100:103], a[132:135], v[168:171]
  ds_read_b64_tr_b16 a[0:1], v224 offset:16384
  v_add_f32 v215, v215, v183
  v_mfma_f32_16x16x32_bf16 v[172:175], a[100:103], a[164:167], v[172:175]
  ds_read_b64_tr_b16 a[2:3], v224 offset:24576
  v_add_f32 v215, v215, v188
  v_mfma_f32_16x16x32_bf16 v[168:171], a[104:107], a[136:139], v[168:171]
  v_exp_f32 v189, v189
  v_mfma_f32_16x16x32_bf16 v[172:175], a[104:107], a[168:171], v[172:175]
  ds_read_b64_tr_b16 a[16:17], v228 offset:16384
  v_cvt_pk_bf16_f32 v210, v188, v189
  v_mfma_f32_16x16x32_bf16 v[168:171], a[108:111], a[140:143], v[168:171]
  ds_read_b64_tr_b16 a[18:19], v228 offset:24576
  v_add_f32 v215, v215, v189
  v_mfma_f32_16x16x32_bf16 v[172:175], a[108:111], a[172:175], v[172:175]
  ds_read_b64_tr_b16 a[32:33], v224 offset:16640
  v_add_f32 v216, v216, v192
  v_mfma_f32_16x16x32_bf16 v[168:171], a[112:115], a[144:147], v[168:171]
  ds_read_b64_tr_b16 a[34:35], v224 offset:24832
  v_add_f32 v216, v216, v193
  v_mfma_f32_16x16x32_bf16 v[172:175], a[112:115], a[176:179], v[172:175]
  ds_read_b64_tr_b16 a[48:49], v228 offset:16640
  v_add_f32 v216, v216, v194
  v_mfma_f32_16x16x32_bf16 v[168:171], a[116:119], a[148:151], v[168:171]
  ds_read_b64_tr_b16 a[50:51], v228 offset:24832
  v_add_f32 v216, v216, v195
  v_mfma_f32_16x16x32_bf16 v[172:175], a[116:119], a[180:183], v[172:175]
  v_exp_f32 v190, v190
  v_mfma_f32_16x16x32_bf16 v[168:171], a[120:123], a[152:155], v[168:171]
  v_mfma_f32_16x16x32_bf16 v[172:175], a[120:123], a[184:187], v[172:175]
  v_exp_f32 v191, v191
  v_mfma_f32_16x16x32_bf16 v[168:171], a[124:127], a[156:159], v[168:171]
  v_cvt_pk_bf16_f32 v211, v190, v191
  v_mfma_f32_16x16x32_bf16 v[172:175], a[124:127], a[188:191], v[172:175]
  v_add_f32 v215, v215, v190
  v_add_f32 v215, v215, v191
  s_waitcnt vmcnt(12) lgkmcnt(0)
  s_barrier
  v_mfma_f32_16x16x32_bf16 v[8:11], a[4:7], v[204:207], v[8:11]
  ds_read_b128 a[64:67], v220 offset:49152
  v_mul_f32 v160, s39, v160
  v_mfma_f32_16x16x32_bf16 v[12:15], a[4:7], v[208:211], v[12:15]
  v_exp_f32 v160, v160
  v_mfma_f32_16x16x32_bf16 v[16:19], a[8:11], v[204:207], v[16:19]
  ds_read_b128 a[68:71], v221 offset:49152
  v_mul_f32 v161, s39, v161
  v_mfma_f32_16x16x32_bf16 v[20:23], a[8:11], v[208:211], v[20:23]
  ds_read_b128 a[72:75], v222 offset:49152
  v_mfma_f32_16x16x32_bf16 v[24:27], a[12:15], v[204:207], v[24:27]
  ds_read_b128 a[76:79], v223 offset:49152
  v_mfma_f32_16x16x32_bf16 v[28:31], a[12:15], v[208:211], v[28:31]
  v_exp_f32 v161, v161
  v_mfma_f32_16x16x32_bf16 v[40:43], a[20:23], v[204:207], v[40:43]
  ds_read_b128 a[80:83], v220 offset:49408
  v_mul_f32 v162, s39, v162
  v_mfma_f32_16x16x32_bf16 v[44:47], a[20:23], v[208:211], v[44:47]
  v_mfma_f32_16x16x32_bf16 v[48:51], a[24:27], v[204:207], v[48:51]
  ds_read_b128 a[84:87], v221 offset:49408
  v_mul_f32 v163, s39, v163
  v_mfma_f32_16x16x32_bf16 v[52:55], a[24:27], v[208:211], v[52:55]
  v_exp_f32 v162, v162
  v_mfma_f32_16x16x32_bf16 v[56:59], a[28:31], v[204:207], v[56:59]
  ds_read_b128 a[88:91], v222 offset:49408
  v_mul_f32 v168, s39, v168
  v_mfma_f32_16x16x32_bf16 v[60:63], a[28:31], v[208:211], v[60:63]
  ds_read_b128 a[92:95], v223 offset:49408
  v_mul_f32 v169, s39, v169
  v_mfma_f32_16x16x32_bf16 v[72:75], a[36:39], v[204:207], v[72:75]
  ds_read_b64_tr_b16 a[4:5], v225 offset:32768
  v_mul_f32 v170, s39, v170
  v_mfma_f32_16x16x32_bf16 v[76:79], a[36:39], v[208:211], v[76:79]
  ds_read_b128 a[224:227], v241 offset:0
  v_mul_f32 v171, s39, v171
  v_mfma_f32_16x16x32_bf16 v[80:83], a[40:43], v[204:207], v[80:83]
  v_exp_f32 v163, v163
  v_mfma_f32_16x16x32_bf16 v[84:87], a[40:43], v[208:211], v[84:87]
  ds_read_b128 a[96:99], v220 offset:57344
  v_mul_f32 v164, s39, v164
  v_mfma_f32_16x16x32_bf16 v[88:91], a[44:47], v[204:207], v[88:91]
  v_mfma_f32_16x16x32_bf16 v[92:95], a[44:47], v[208:211], v[92:95]
  ds_read_b128 a[100:103], v221 offset:57344
  v_mul_f32 v165, s39, v165
  v_mfma_f32_16x16x32_bf16 v[104:107], a[52:55], v[204:207], v[104:107]
  v_exp_f32 v168, v168
  v_mfma_f32_16x16x32_bf16 v[108:111], a[52:55], v[208:211], v[108:111]
  ds_read_b128 a[104:107], v222 offset:57344
  v_mul_f32 v166, s39, v166
  v_mfma_f32_16x16x32_bf16 v[112:115], a[56:59], v[204:207], v[112:115]
  ds_read_b64_tr_b16 a[6:7], v225 offset:40960
  v_mul_f32 v167, s39, v167
  v_mfma_f32_16x16x32_bf16 v[116:119], a[56:59], v[208:211], v[116:119]
  ds_read_b128 a[108:111], v223 offset:57344
  v_mul_f32 v172, s39, v172
  v_mfma_f32_16x16x32_bf16 v[120:123], a[60:63], v[204:207], v[120:123]
  ds_read_b128 a[228:231], v241 offset:1024
  v_mul_f32 v173, s39, v173
  v_mfma_f32_16x16x32_bf16 v[124:127], a[60:63], v[208:211], v[124:127]
  v_exp_f32 v169, v169
  v_mfma_f32_16x16x32_bf16 v[0:3], a[0:3], v[204:207], v[0:3]
  ds_read_b128 a[112:115], v220 offset:57600
  v_mul_f32 v174, s39, v174
  v_mfma_f32_16x16x32_bf16 v[4:7], a[0:3], v[208:211], v[4:7]
  v_mfma_f32_16x16x32_bf16 v[128:131], a[0:3], a[232:235], v[128:131]
  ds_read_b128 a[116:119], v221 offset:57600
  v_mul_f32 v175, s39, v175
  v_mfma_f32_16x16x32_bf16 v[132:135], a[0:3], a[236:239], v[132:135]
  v_exp_f32 v170, v170
  v_mfma_f32_16x16x32_bf16 v[32:35], a[16:19], v[204:207], v[32:35]
  ds_read_b128 a[120:123], v222 offset:57600
  v_cvt_pk_bf16_f32 v196, v160, v161
  v_mfma_f32_16x16x32_bf16 v[36:39], a[16:19], v[208:211], v[36:39]
  ds_read_b64_tr_b16 a[8:9], v226 offset:32768
  v_cvt_pk_bf16_f32 v197, v162, v163
  v_mfma_f32_16x16x32_bf16 v[136:139], a[16:19], a[232:235], v[136:139]
  ds_read_b128 a[124:127], v223 offset:57600
  v_cvt_pk_bf16_f32 v198, v168, v169
  v_mfma_f32_16x16x32_bf16 v[140:143], a[16:19], a[236:239], v[140:143]
  ds_read_b64_tr_b16 a[10:11], v226 offset:40960
  v_add_f32 v214, v214, v160
  v_mfma_f32_16x16x32_bf16 v[64:67], a[32:35], v[204:207], v[64:67]
  v_exp_f32 v171, v171
  v_mfma_f32_16x16x32_bf16 v[68:71], a[32:35], v[208:211], v[68:71]
  ds_read_b64_tr_b16 a[12:13], v227 offset:32768
  v_cvt_pk_bf16_f32 v199, v170, v171
  v_mfma_f32_16x16x32_bf16 v[144:147], a[32:35], a[232:235], v[144:147]
  v_mfma_f32_16x16x32_bf16 v[148:151], a[32:35], a[236:239], v[148:151]
  ds_read_b64_tr_b16 a[14:15], v227 offset:40960
  v_mfma_f32_16x16x32_bf16 v[96:99], a[48:51], v[204:207], v[96:99]
  v_exp_f32 v164, v164
  v_mfma_f32_16x16x32_bf16 v[100:103], a[48:51], v[208:211], v[100:103]
  ds_read_b64_tr_b16 a[20:21], v229 offset:32768
  v_add_f32 v214, v214, v161
  v_mfma_f32_16x16x32_bf16 v[152:155], a[48:51], a[232:235], v[152:155]
  ds_read_b64_tr_b16 a[22:23], v229 offset:40960
  v_add_f32 v214, v214, v162
  v_mfma_f32_16x16x32_bf16 v[156:159], a[48:51], a[236:239], v[156:159]
  ds_read_b64_tr_b16 a[24:25], v230 offset:32768
  s_waitcnt lgkmcnt(6)
  v_mfma_f32_16x16x32_bf16 v[192:195], a[64:67], a[192:195], v[250:253]
  ds_read_b64_tr_b16 a[26:27], v230 offset:40960
  v_add_f32 v214, v214, v163
  v_mfma_f32_16x16x32_bf16 v[192:195], a[68:71], a[196:199], v[192:195]
  v_exp_f32 v165, v165
  v_mfma_f32_16x16x32_bf16 v[192:195], a[72:75], a[200:203], v[192:195]
  ds_read_b64_tr_b16 a[28:29], v231 offset:32768
  v_cvt_pk_bf16_f32 v200, v164, v165
  v_mfma_f32_16x16x32_bf16 v[192:195], a[76:79], a[204:207], v[192:195]
  ds_read_b64_tr_b16 a[30:31], v231 offset:40960
  v_add_f32 v214, v214, v168
  v_mfma_f32_16x16x32_bf16 v[192:195], a[80:83], a[208:211], v[192:195]
  v_mfma_f32_16x16x32_bf16 v[192:195], a[84:87], a[212:215], v[192:195]
  ds_read_b64_tr_b16 a[36:37], v225 offset:33024
  v_add_f32 v214, v214, v169
  v_mfma_f32_16x16x32_bf16 v[192:195], a[88:91], a[216:219], v[192:195]
  v_exp_f32 v166, v166
  v_mfma_f32_16x16x32_bf16 v[192:195], a[92:95], a[220:223], v[192:195]
  ds_read_b64_tr_b16 a[38:39], v225 offset:41216
  v_add_f32 v214, v214, v170
  v_mfma_f32_16x16x32_bf16 v[176:179], a[64:67], a[128:131], v[242:245]
  ds_read_b64_tr_b16 a[40:41], v226 offset:33024
  v_add_f32 v214, v214, v171
  v_mfma_f32_16x16x32_bf16 v[180:183], a[64:67], a[160:163], v[246:249]
  ds_read_b64_tr_b16 a[42:43], v226 offset:41216
  v_add_f32 v215, v215, v164
  v_mfma_f32_16x16x32_bf16 v[176:179], a[68:71], a[132:135], v[176:179]
  v_exp_f32 v167, v167
  v_mfma_f32_16x16x32_bf16 v[180:183], a[68:71], a[164:167], v[180:183]
  ds_read_b64_tr_b16 a[44:45], v227 offset:33024
  v_mul_f32 v192, s39, v192
  v_mfma_f32_16x16x32_bf16 v[176:179], a[72:75], a[136:139], v[176:179]
  ds_read_b64_tr_b16 a[46:47], v227 offset:41216
  v_mul_f32 v193, s39, v193
  v_mfma_f32_16x16x32_bf16 v[180:183], a[72:75], a[168:171], v[180:183]
  v_exp_f32 v192, v192
  v_mfma_f32_16x16x32_bf16 v[176:179], a[76:79], a[140:143], v[176:179]
  ds_read_b64_tr_b16 a[52:53], v229 offset:33024
  v_mul_f32 v194, s39, v194
  v_mfma_f32_16x16x32_bf16 v[180:183], a[76:79], a[172:175], v[180:183]
  v_exp_f32 v193, v193
  v_mfma_f32_16x16x32_bf16 v[176:179], a[80:83], a[144:147], v[176:179]
  ds_read_b64_tr_b16 a[54:55], v229 offset:41216
  v_mul_f32 v195, s39, v195
  v_mfma_f32_16x16x32_bf16 v[180:183], a[80:83], a[176:179], v[180:183]
  v_mfma_f32_16x16x32_bf16 v[176:179], a[84:87], a[148:151], v[176:179]
  v_exp_f32 v194, v194
  v_mfma_f32_16x16x32_bf16 v[180:183], a[84:87], a[180:183], v[180:183]
  ds_read_b64_tr_b16 a[56:57], v230 offset:33024
  v_cvt_pk_bf16_f32 v212, v192, v193
  v_mfma_f32_16x16x32_bf16 v[176:179], a[88:91], a[152:155], v[176:179]
  v_exp_f32 v195, v195
  v_mfma_f32_16x16x32_bf16 v[180:183], a[88:91], a[184:187], v[180:183]
  ds_read_b64_tr_b16 a[58:59], v230 offset:41216
  v_cvt_pk_bf16_f32 v213, v194, v195
  v_mfma_f32_16x16x32_bf16 v[176:179], a[92:95], a[156:159], v[176:179]
  ds_read_b64_tr_b16 a[60:61], v231 offset:33024
  v_cvt_pk_bf16_f32 v201, v166, v167
  v_mfma_f32_16x16x32_bf16 v[180:183], a[92:95], a[188:191], v[180:183]
  ds_write_b64 v240, v[212:213] offset:2048
  v_add_f32 v215, v215, v165
  v_mfma_f32_16x16x32_bf16 v[184:187], a[96:99], a[128:131], v[242:245]
  v_exp_f32 v172, v172
  v_mfma_f32_16x16x32_bf16 v[188:191], a[96:99], a[160:163], v[246:249]
  ds_read_b64_tr_b16 a[62:63], v231 offset:41216
  v_add_f32 v215, v215, v166
  v_mfma_f32_16x16x32_bf16 v[184:187], a[100:103], a[132:135], v[184:187]
  ds_read_b64_tr_b16 a[0:1], v224 offset:32768
  v_add_f32 v215, v215, v167
  v_mfma_f32_16x16x32_bf16 v[188:191], a[100:103], a[164:167], v[188:191]
  ds_read_b64_tr_b16 a[2:3], v224 offset:40960
  v_add_f32 v215, v215, v172
  v_mfma_f32_16x16x32_bf16 v[184:187], a[104:107], a[136:139], v[184:187]
  v_exp_f32 v173, v173
  v_mfma_f32_16x16x32_bf16 v[188:191], a[104:107], a[168:171], v[188:191]
  ds_read_b64_tr_b16 a[16:17], v228 offset:32768
  v_cvt_pk_bf16_f32 v202, v172, v173
  v_mfma_f32_16x16x32_bf16 v[184:187], a[108:111], a[140:143], v[184:187]
  ds_read_b64_tr_b16 a[18:19], v228 offset:40960
  v_add_f32 v215, v215, v173
  v_mfma_f32_16x16x32_bf16 v[188:191], a[108:111], a[172:175], v[188:191]
  ds_read_b64_tr_b16 a[32:33], v224 offset:33024
  v_add_f32 v216, v216, v192
  v_mfma_f32_16x16x32_bf16 v[184:187], a[112:115], a[144:147], v[184:187]
  ds_read_b64_tr_b16 a[34:35], v224 offset:41216
  v_add_f32 v216, v216, v193
  v_mfma_f32_16x16x32_bf16 v[188:191], a[112:115], a[176:179], v[188:191]
  ds_read_b64_tr_b16 a[48:49], v228 offset:33024
  v_add_f32 v216, v216, v194
  v_mfma_f32_16x16x32_bf16 v[184:187], a[116:119], a[148:151], v[184:187]
  ds_read_b64_tr_b16 a[50:51], v228 offset:41216
  v_add_f32 v216, v216, v195
  v_mfma_f32_16x16x32_bf16 v[188:191], a[116:119], a[180:183], v[188:191]
  v_exp_f32 v174, v174
  v_mfma_f32_16x16x32_bf16 v[184:187], a[120:123], a[152:155], v[184:187]
  v_mfma_f32_16x16x32_bf16 v[188:191], a[120:123], a[184:187], v[188:191]
  v_exp_f32 v175, v175
  v_mfma_f32_16x16x32_bf16 v[184:187], a[124:127], a[156:159], v[184:187]
  v_cvt_pk_bf16_f32 v203, v174, v175
  v_mfma_f32_16x16x32_bf16 v[188:191], a[124:127], a[188:191], v[188:191]
  v_add_f32 v215, v215, v174
  v_add_f32 v215, v215, v175
  s_waitcnt vmcnt(4) lgkmcnt(0)
  s_barrier
  v_mfma_f32_16x16x32_bf16 v[8:11], a[4:7], v[196:199], v[8:11]
  v_mul_f32 v176, s39, v176
  v_mfma_f32_16x16x32_bf16 v[12:15], a[4:7], v[200:203], v[12:15]
  ds_read_b64_tr_b16 a[4:5], v225 offset:49152
  v_exp_f32 v176, v176
  v_mfma_f32_16x16x32_bf16 v[16:19], a[8:11], v[196:199], v[16:19]
  ds_read_b64_tr_b16 a[6:7], v225 offset:57344
  v_mul_f32 v177, s39, v177
  v_mfma_f32_16x16x32_bf16 v[20:23], a[8:11], v[200:203], v[20:23]
  ds_read_b64_tr_b16 a[8:9], v226 offset:49152
  v_mfma_f32_16x16x32_bf16 v[24:27], a[12:15], v[196:199], v[24:27]
  ds_read_b64_tr_b16 a[10:11], v226 offset:57344
  v_mfma_f32_16x16x32_bf16 v[28:31], a[12:15], v[200:203], v[28:31]
  ds_read_b64_tr_b16 a[12:13], v227 offset:49152
  v_exp_f32 v177, v177
  v_mfma_f32_16x16x32_bf16 v[40:43], a[20:23], v[196:199], v[40:43]
  ds_read_b64_tr_b16 a[14:15], v227 offset:57344
  v_mul_f32 v178, s39, v178
  v_mfma_f32_16x16x32_bf16 v[44:47], a[20:23], v[200:203], v[44:47]
  ds_read_b64_tr_b16 a[20:21], v229 offset:49152
  v_mfma_f32_16x16x32_bf16 v[48:51], a[24:27], v[196:199], v[48:51]
  ds_read_b64_tr_b16 a[22:23], v229 offset:57344
  v_mul_f32 v179, s39, v179
  v_mfma_f32_16x16x32_bf16 v[52:55], a[24:27], v[200:203], v[52:55]
  ds_read_b64_tr_b16 a[24:25], v230 offset:49152
  v_exp_f32 v178, v178
  v_mfma_f32_16x16x32_bf16 v[56:59], a[28:31], v[196:199], v[56:59]
  ds_read_b64_tr_b16 a[26:27], v230 offset:57344
  v_mul_f32 v184, s39, v184
  v_mfma_f32_16x16x32_bf16 v[60:63], a[28:31], v[200:203], v[60:63]
  ds_read_b64_tr_b16 a[28:29], v231 offset:49152
  v_mul_f32 v185, s39, v185
  v_mfma_f32_16x16x32_bf16 v[72:75], a[36:39], v[196:199], v[72:75]
  ds_read_b64_tr_b16 a[30:31], v231 offset:57344
  v_mul_f32 v186, s39, v186
  v_mfma_f32_16x16x32_bf16 v[76:79], a[36:39], v[200:203], v[76:79]
  ds_read_b128 a[232:235], v241 offset:2048
  v_mul_f32 v187, s39, v187
  v_mfma_f32_16x16x32_bf16 v[80:83], a[40:43], v[196:199], v[80:83]
  ds_read_b64_tr_b16 a[36:37], v225 offset:49408
  v_exp_f32 v179, v179
  v_mfma_f32_16x16x32_bf16 v[84:87], a[40:43], v[200:203], v[84:87]
  ds_read_b64_tr_b16 a[38:39], v225 offset:57600
  v_mul_f32 v180, s39, v180
  v_mfma_f32_16x16x32_bf16 v[88:91], a[44:47], v[196:199], v[88:91]
  ds_read_b64_tr_b16 a[40:41], v226 offset:49408
  v_mfma_f32_16x16x32_bf16 v[92:95], a[44:47], v[200:203], v[92:95]
  ds_read_b64_tr_b16 a[42:43], v226 offset:57600
  v_mul_f32 v181, s39, v181
  v_mfma_f32_16x16x32_bf16 v[104:107], a[52:55], v[196:199], v[104:107]
  ds_read_b64_tr_b16 a[44:45], v227 offset:49408
  v_exp_f32 v184, v184
  v_mfma_f32_16x16x32_bf16 v[108:111], a[52:55], v[200:203], v[108:111]
  ds_read_b64_tr_b16 a[46:47], v227 offset:57600
  v_mul_f32 v182, s39, v182
  v_mfma_f32_16x16x32_bf16 v[112:115], a[56:59], v[196:199], v[112:115]
  ds_read_b64_tr_b16 a[52:53], v229 offset:49408
  v_mul_f32 v183, s39, v183
  v_mfma_f32_16x16x32_bf16 v[116:119], a[56:59], v[200:203], v[116:119]
  ds_read_b64_tr_b16 a[54:55], v229 offset:57600
  v_mul_f32 v188, s39, v188
  v_mfma_f32_16x16x32_bf16 v[120:123], a[60:63], v[196:199], v[120:123]
  ds_read_b128 a[236:239], v241 offset:3072
  v_mul_f32 v189, s39, v189
  v_mfma_f32_16x16x32_bf16 v[124:127], a[60:63], v[200:203], v[124:127]
  ds_read_b64_tr_b16 a[56:57], v230 offset:49408
  v_exp_f32 v185, v185
  v_mfma_f32_16x16x32_bf16 v[0:3], a[0:3], v[196:199], v[0:3]
  ds_read_b64_tr_b16 a[58:59], v230 offset:57600
  v_mul_f32 v190, s39, v190
  v_mfma_f32_16x16x32_bf16 v[4:7], a[0:3], v[200:203], v[4:7]
  ds_read_b64_tr_b16 a[60:61], v231 offset:49408
  v_mfma_f32_16x16x32_bf16 v[128:131], a[0:3], a[224:227], v[128:131]
  ds_read_b64_tr_b16 a[62:63], v231 offset:57600
  v_mul_f32 v191, s39, v191
  v_mfma_f32_16x16x32_bf16 v[132:135], a[0:3], a[228:231], v[132:135]
  ds_read_b64_tr_b16 a[0:1], v224 offset:49152
  v_exp_f32 v186, v186
  v_mfma_f32_16x16x32_bf16 v[32:35], a[16:19], v[196:199], v[32:35]
  ds_read_b64_tr_b16 a[2:3], v224 offset:57344
  v_cvt_pk_bf16_f32 v204, v176, v177
  v_mfma_f32_16x16x32_bf16 v[36:39], a[16:19], v[200:203], v[36:39]
  v_cvt_pk_bf16_f32 v205, v178, v179
  v_mfma_f32_16x16x32_bf16 v[136:139], a[16:19], a[224:227], v[136:139]
  v_cvt_pk_bf16_f32 v206, v184, v185
  v_mfma_f32_16x16x32_bf16 v[140:143], a[16:19], a[228:231], v[140:143]
  ds_read_b64_tr_b16 a[16:17], v228 offset:49152
  v_add_f32 v214, v214, v176
  v_mfma_f32_16x16x32_bf16 v[64:67], a[32:35], v[196:199], v[64:67]
  ds_read_b64_tr_b16 a[18:19], v228 offset:57344
  v_exp_f32 v187, v187
  v_mfma_f32_16x16x32_bf16 v[68:71], a[32:35], v[200:203], v[68:71]
  v_cvt_pk_bf16_f32 v207, v186, v187
  v_mfma_f32_16x16x32_bf16 v[144:147], a[32:35], a[224:227], v[144:147]
  v_mfma_f32_16x16x32_bf16 v[148:151], a[32:35], a[228:231], v[148:151]
  ds_read_b64_tr_b16 a[32:33], v224 offset:49408
  v_mfma_f32_16x16x32_bf16 v[96:99], a[48:51], v[196:199], v[96:99]
  ds_read_b64_tr_b16 a[34:35], v224 offset:57600
  v_exp_f32 v180, v180
  v_mfma_f32_16x16x32_bf16 v[100:103], a[48:51], v[200:203], v[100:103]
  v_add_f32 v214, v214, v177
  v_mfma_f32_16x16x32_bf16 v[152:155], a[48:51], a[224:227], v[152:155]
  v_add_f32 v214, v214, v178
  v_mfma_f32_16x16x32_bf16 v[156:159], a[48:51], a[228:231], v[156:159]
  ds_read_b64_tr_b16 a[48:49], v228 offset:49408
  s_waitcnt lgkmcnt(15)
  v_mfma_f32_16x16x32_bf16 v[8:11], a[4:7], v[204:207], v[8:11]
  ds_read_b64_tr_b16 a[50:51], v228 offset:57600
  v_mfma_f32_16x16x32_bf16 v[16:19], a[8:11], v[204:207], v[16:19]
  v_exp_f32 v181, v181
  v_mfma_f32_16x16x32_bf16 v[24:27], a[12:15], v[204:207], v[24:27]
  v_cvt_pk_bf16_f32 v208, v180, v181
  v_mfma_f32_16x16x32_bf16 v[40:43], a[20:23], v[204:207], v[40:43]
  v_exp_f32 v182, v182
  v_mfma_f32_16x16x32_bf16 v[48:51], a[24:27], v[204:207], v[48:51]
  v_exp_f32 v183, v183
  v_mfma_f32_16x16x32_bf16 v[56:59], a[28:31], v[204:207], v[56:59]
  v_cvt_pk_bf16_f32 v209, v182, v183
  v_mfma_f32_16x16x32_bf16 v[72:75], a[36:39], v[204:207], v[72:75]
  v_exp_f32 v188, v188
  v_mfma_f32_16x16x32_bf16 v[80:83], a[40:43], v[204:207], v[80:83]
  v_exp_f32 v189, v189
  s_waitcnt lgkmcnt(15)
  v_mfma_f32_16x16x32_bf16 v[88:91], a[44:47], v[204:207], v[88:91]
  v_cvt_pk_bf16_f32 v210, v188, v189
  s_waitcnt lgkmcnt(13)
  v_mfma_f32_16x16x32_bf16 v[104:107], a[52:55], v[204:207], v[104:107]
  v_exp_f32 v190, v190
  s_waitcnt lgkmcnt(10)
  v_mfma_f32_16x16x32_bf16 v[112:115], a[56:59], v[204:207], v[112:115]
  v_exp_f32 v191, v191
  s_waitcnt lgkmcnt(8)
  v_mfma_f32_16x16x32_bf16 v[120:123], a[60:63], v[204:207], v[120:123]
  v_cvt_pk_bf16_f32 v211, v190, v191
  v_add_f32 v214, v214, v179
  s_waitcnt lgkmcnt(6)
  v_mfma_f32_16x16x32_bf16 v[0:3], a[0:3], v[204:207], v[0:3]
  v_add_f32 v214, v214, v184
  v_add_f32 v214, v214, v185
  s_waitcnt lgkmcnt(4)
  v_mfma_f32_16x16x32_bf16 v[32:35], a[16:19], v[204:207], v[32:35]
  v_add_f32 v214, v214, v186
  v_add_f32 v214, v214, v187
  s_waitcnt lgkmcnt(2)
  v_mfma_f32_16x16x32_bf16 v[64:67], a[32:35], v[204:207], v[64:67]
  v_add_f32 v215, v215, v180
  v_add_f32 v215, v215, v181
  s_waitcnt lgkmcnt(0)
  v_mfma_f32_16x16x32_bf16 v[96:99], a[48:51], v[204:207], v[96:99]
  v_add_f32 v215, v215, v182
  v_add_f32 v215, v215, v183
  v_mfma_f32_16x16x32_bf16 v[12:15], a[4:7], v[208:211], v[12:15]
  v_add_f32 v215, v215, v188
  v_add_f32 v215, v215, v189
  v_mfma_f32_16x16x32_bf16 v[20:23], a[8:11], v[208:211], v[20:23]
  v_add_f32 v215, v215, v190
  v_add_f32 v215, v215, v191
  v_mfma_f32_16x16x32_bf16 v[28:31], a[12:15], v[208:211], v[28:31]
  v_mbcnt_lo_u32_b32 v250, -1, 0
  v_mbcnt_hi_u32_b32 v250, -1, v250
  v_mov_b32 v247, v214
  v_mov_b32 v248, v215
  v_mov_b32 v249, v216
  v_permlane32_swap_b32 v214, v247
  v_mfma_f32_16x16x32_bf16 v[44:47], a[20:23], v[208:211], v[44:47]
  v_permlane32_swap_b32 v215, v248
  v_permlane32_swap_b32 v216, v249
  v_add_f32 v214, v214, v247
  v_add_f32 v215, v215, v248
  v_add_f32 v216, v216, v249
  v_mov_b32 v247, v214
  v_mfma_f32_16x16x32_bf16 v[52:55], a[24:27], v[208:211], v[52:55]
  v_mov_b32 v248, v215
  v_mov_b32 v249, v216
  v_permlane16_swap_b32 v214, v247
  v_permlane16_swap_b32 v215, v248
  v_permlane16_swap_b32 v216, v249
  v_add_f32 v214, v214, v247
  v_mfma_f32_16x16x32_bf16 v[60:63], a[28:31], v[208:211], v[60:63]
  v_add_f32 v215, v215, v248
  v_add_f32 v216, v216, v249
  v_and_b32 v253, 15, v250
  v_lshrrev_b32 v254, 4, v250
  s_lshr_b32 s48, s16, 1
  s_lshl_b32 s48, s48, 7
  v_mfma_f32_16x16x32_bf16 v[76:79], a[36:39], v[208:211], v[76:79]
  s_and_b32 s49, s16, 1
  s_lshl_b32 s49, s49, 6
  s_add_u32 s48, s48, s49
  s_add_u32 s48, s48, 135168
  v_lshlrev_b32 v242, 2, v253
  v_max3_f32 v244, v214, v215, v216
  v_mfma_f32_16x16x32_bf16 v[84:87], a[40:43], v[208:211], v[84:87]
  v_add_u32 v243, s48, v242
  v_cmp_lt_f32 vcc, s42, v244
  ds_write_b32 v243, v216
  v_rcp_f32 v214, v214
  v_rcp_f32 v215, v215
  s_lshl_b32 s51, s16, 2
  v_mfma_f32_16x16x32_bf16 v[92:95], a[44:47], v[208:211], v[92:95]
  s_add_u32 s51, s51, 135424
  v_mov_b32 v244, s51
  s_cmp_lg_u64 vcc, 0
  s_cselect_b32 s50, 1, 0
  v_mov_b32 v243, s50
  ds_write_b32 v244, v243
  v_mfma_f32_16x16x32_bf16 v[108:111], a[52:55], v[208:211], v[108:111]
  v_and_b32 v246, 1, v254
  v_lshlrev_b32 v246, 1, v246
  v_lshrrev_b32 v247, 1, v254
  v_xor_b32 v248, v246, v247
  s_lshl_b32 s48, s16, 1
  v_xor_b32 v248, s48, v248
  v_mfma_f32_16x16x32_bf16 v[116:119], a[56:59], v[208:211], v[116:119]
  v_xor_b32 v248, v248, v253
  v_lshlrev_b32 v249, 9, v253
  s_lshl_b32 s49, s16, 14
  v_add_u32 v245, s49, v249
  s_waitcnt vmcnt(0) lgkmcnt(0)
  s_barrier
  v_mfma_f32_16x16x32_bf16 v[124:127], a[60:63], v[208:211], v[124:127]
  v_add_u32 v242, 135168, v242
  ds_read_b32 v217, v242
  ds_read_b32 v218, v242 offset:64
  ds_read_b32 v219, v242 offset:128
  ds_read_b32 v212, v242 offset:192
  v_mov_b32 v243, 135424
  v_mfma_f32_16x16x32_bf16 v[4:7], a[0:3], v[208:211], v[4:7]
  ds_read_b128 v[196:199], v243
  v_xor_b32 v244, 0, v248
  v_lshl_add_u32 v160, v244, 4, v245
  v_xor_b32 v244, 4, v248
  v_lshl_add_u32 v161, v244, 4, v245
  v_xor_b32 v244, 8, v248
  v_mfma_f32_16x16x32_bf16 v[128:131], a[0:3], a[232:235], v[128:131]
  v_lshl_add_u32 v162, v244, 4, v245
  v_xor_b32 v244, 12, v248
  v_lshl_add_u32 v163, v244, 4, v245
  v_lshlrev_b32 v246, 2, v246
  v_add_u32 v246, v246, v247
  v_add_u32 v246, s48, v246
  v_mfma_f32_16x16x32_bf16 v[132:135], a[0:3], a[236:239], v[132:135]
  v_xor_b32 v246, v246, v253
  v_lshl_add_u32 v164, v246, 4, v249
  v_add_u32 v164, 65536, v164
  v_and_b32 v251, 31, v250
  v_lshrrev_b32 v252, 5, v250
  v_lshlrev_b32 v245, 9, v252
  v_mfma_f32_16x16x32_bf16 v[36:39], a[16:19], v[208:211], v[36:39]
  v_add_u32 v245, s49, v245
  v_add_u32 v244, 0, v252
  v_xor_b32 v244, v244, v251
  v_lshl_add_u32 v176, v244, 4, v245
  v_add_u32 v244, 2, v252
  v_xor_b32 v244, v244, v251
  v_mfma_f32_16x16x32_bf16 v[136:139], a[16:19], a[232:235], v[136:139]
  v_lshl_add_u32 v177, v244, 4, v245
  v_add_u32 v244, 4, v252
  v_xor_b32 v244, v244, v251
  v_lshl_add_u32 v178, v244, 4, v245
  v_add_u32 v244, 6, v252
  v_xor_b32 v244, v244, v251
  v_mfma_f32_16x16x32_bf16 v[140:143], a[16:19], a[236:239], v[140:143]
  v_lshl_add_u32 v179, v244, 4, v245
  v_add_u32 v244, 8, v252
  v_xor_b32 v244, v244, v251
  v_lshl_add_u32 v180, v244, 4, v245
  v_add_u32 v244, 10, v252
  v_xor_b32 v244, v244, v251
  v_mfma_f32_16x16x32_bf16 v[68:71], a[32:35], v[208:211], v[68:71]
  v_lshl_add_u32 v181, v244, 4, v245
  v_add_u32 v244, 12, v252
  v_xor_b32 v244, v244, v251
  v_lshl_add_u32 v182, v244, 4, v245
  v_add_u32 v244, 14, v252
  v_xor_b32 v244, v244, v251
  v_mfma_f32_16x16x32_bf16 v[144:147], a[32:35], a[232:235], v[144:147]
  v_lshl_add_u32 v183, v244, 4, v245
  v_lshlrev_b32 v249, 4, v250
  v_add_u32 v248, s49, v249
  s_waitcnt lgkmcnt(0)
  v_or_b32 v196, v196, v197
  v_add_f32 v200, v217, v218
  v_mfma_f32_16x16x32_bf16 v[148:151], a[32:35], a[236:239], v[148:151]
  v_or3_b32 v196, v196, v198, v199
  v_add_f32 v201, v219, v212
  v_readfirstlane_b32 s54, v196
  v_rcp_f32 v200, v200
  v_rcp_f32 v201, v201
  v_mfma_f32_16x16x32_bf16 v[100:103], a[48:51], v[208:211], v[100:103]
  v_mfma_f32_16x16x32_bf16 v[152:155], a[48:51], a[232:235], v[152:155]
  v_mfma_f32_16x16x32_bf16 v[156:159], a[48:51], a[236:239], v[156:159]
  s_branch L_epi
L_var_k1q1p1:
  ds_read_b128 a[96:99], v220 offset:24576
  ds_read_b128 a[100:103], v221 offset:24576
  ds_read_b128 a[104:107], v222 offset:24576
  ds_read_b128 a[108:111], v223 offset:24576
  ds_read_b128 a[112:115], v220 offset:24832
  ds_read_b128 a[116:119], v221 offset:24832
  ds_read_b128 a[120:123], v222 offset:24832
  ds_read_b128 a[124:127], v223 offset:24832
  ds_read_b64_tr_b16 a[4:5], v225 offset:0
  ds_read_b128 a[64:67], v220 offset:16384
  ds_read_b64_tr_b16 a[6:7], v225 offset:8192
  ds_read_b128 a[68:71], v221 offset:16384
  ds_read_b128 a[72:75], v222 offset:16384
  ds_read_b128 a[76:79], v223 offset:16384
  ds_read_b128 a[80:83], v220 offset:16640
  ds_read_b64_tr_b16 a[8:9], v226 offset:0
  ds_read_b128 a[84:87], v221 offset:16640
  ds_read_b128 a[88:91], v222 offset:16640
  ds_read_b128 a[92:95], v223 offset:16640
  ds_read_b64_tr_b16 a[10:11], v226 offset:8192
  ds_read_b64_tr_b16 a[12:13], v227 offset:0
  ds_read_b64_tr_b16 a[14:15], v227 offset:8192
  ds_read_b64_tr_b16 a[20:21], v229 offset:0
  ds_read_b64_tr_b16 a[22:23], v229 offset:8192
  ds_read_b64_tr_b16 a[24:25], v230 offset:0
  v_sub_f32 v242, 0, v217
  v_sub_f32 v243, 0, v217
  v_sub_f32 v244, 0, v217
  v_sub_f32 v245, 0, v217
  v_sub_f32 v246, 0, v218
  v_sub_f32 v247, 0, v218
  v_sub_f32 v248, 0, v218
  v_sub_f32 v249, 0, v218
  v_sub_f32 v250, 0, v219
  v_sub_f32 v251, 0, v219
  v_sub_f32 v252, 0, v219
  v_sub_f32 v253, 0, v219
  v_mul_f32 v217, s39, v217
  v_mul_f32 v218, s39, v218
  v_mul_f32 v219, s39, v219
  v_mov_b32 v192, v196
  v_mov_b32 v193, v197
  v_mov_b32 v194, v198
  v_mov_b32 v195, v199
  v_fma_f32 v192, v192, s39, -v219
  v_fma_f32 v193, v193, s39, -v219
  v_fma_f32 v194, v194, s39, -v219
  v_fma_f32 v195, v195, s39, -v219
  v_exp_f32 v192, v192
  v_exp_f32 v193, v193
  v_exp_f32 v194, v194
  v_exp_f32 v195, v195
  s_nop 0
  v_add_f32 v216, v216, v192
  v_add_f32 v216, v216, v193
  v_add_f32 v216, v216, v194
  v_add_f32 v216, v216, v195
  v_cvt_pk_bf16_f32 v212, v192, v193
  v_cvt_pk_bf16_f32 v213, v194, v195
  ds_write_b64 v240, v[212:213] offset:0
  v_fma_f32 v160, v160, s39, -v217
  v_fma_f32 v161, v161, s39, -v217
  v_fma_f32 v162, v162, s39, -v217
  v_fma_f32 v163, v163, s39, -v217
  v_fma_f32 v168, v168, s39, -v217
  v_fma_f32 v169, v169, s39, -v217
  v_fma_f32 v170, v170, s39, -v217
  v_fma_f32 v171, v171, s39, -v217
  v_fma_f32 v164, v164, s39, -v218
  v_fma_f32 v165, v165, s39, -v218
  v_fma_f32 v166, v166, s39, -v218
  v_fma_f32 v167, v167, s39, -v218
  v_fma_f32 v172, v172, s39, -v218
  v_fma_f32 v173, v173, s39, -v218
  v_fma_f32 v174, v174, s39, -v218
  v_fma_f32 v175, v175, s39, -v218
  v_exp_f32 v160, v160
  v_exp_f32 v161, v161
  v_exp_f32 v162, v162
  v_exp_f32 v163, v163
  v_exp_f32 v168, v168
  v_exp_f32 v169, v169
  v_exp_f32 v170, v170
  v_exp_f32 v171, v171
  v_exp_f32 v164, v164
  v_cvt_pk_bf16_f32 v196, v160, v161
  v_cvt_pk_bf16_f32 v197, v162, v163
  v_cvt_pk_bf16_f32 v198, v168, v169
  v_add_f32 v214, v214, v160
  v_cvt_pk_bf16_f32 v199, v170, v171
  v_add_f32 v214, v214, v161
  v_add_f32 v214, v214, v162
  v_add_f32 v214, v214, v163
  s_waitcnt lgkmcnt(0)
  v_mfma_f32_16x16x32_bf16 v[192:195], a[96:99], a[192:195], v[250:253]
  s_add_u32 s36, s36, 16384
  ds_read_b64_tr_b16 a[26:27], v230 offset:8192
  v_mfma_f32_16x16x32_bf16 v[192:195], a[100:103], a[196:199], v[192:195]
  v_exp_f32 v165, v165
  v_mfma_f32_16x16x32_bf16 v[192:195], a[104:107], a[200:203], v[192:195]
  s_add_u32 m0, s38, 49152
  ds_read_b64_tr_b16 a[28:29], v231 offset:0
  v_cvt_pk_bf16_f32 v200, v164, v165
  v_mfma_f32_16x16x32_bf16 v[192:195], a[108:111], a[204:207], v[192:195]
  ds_read_b64_tr_b16 a[30:31], v231 offset:8192
  v_add_f32 v214, v214, v168
  v_mfma_f32_16x16x32_bf16 v[192:195], a[112:115], a[208:211], v[192:195]
  buffer_load_dwordx4 v232, s[20:23], s36 offen offset:0 nt lds
  ds_read_b64_tr_b16 a[36:37], v225 offset:256
  v_add_f32 v214, v214, v169
  v_mfma_f32_16x16x32_bf16 v[192:195], a[116:119], a[212:215], v[192:195]
  ds_read_b64_tr_b16 a[38:39], v225 offset:8448
  v_add_f32 v214, v214, v170
  v_mfma_f32_16x16x32_bf16 v[192:195], a[120:123], a[216:219], v[192:195]
  v_exp_f32 v166, v166
  v_mfma_f32_16x16x32_bf16 v[192:195], a[124:127], a[220:223], v[192:195]
  buffer_load_dwordx4 v233, s[20:23], s36 offen offset:1024 nt lds
  ds_read_b64_tr_b16 a[40:41], v226 offset:256
  v_add_f32 v214, v214, v171
  v_mfma_f32_16x16x32_bf16 v[176:179], a[64:67], a[128:131], v[242:245]
  v_mfma_f32_16x16x32_bf16 v[180:183], a[64:67], a[160:163], v[246:249]
  buffer_load_dwordx4 v234, s[20:23], s36 offen offset:2048 nt lds
  ds_read_b64_tr_b16 a[42:43], v226 offset:8448
  v_add_f32 v215, v215, v164
  v_mfma_f32_16x16x32_bf16 v[176:179], a[68:71], a[132:135], v[176:179]
  v_exp_f32 v167, v167
  v_mfma_f32_16x16x32_bf16 v[180:183], a[68:71], a[164:167], v[180:183]
  buffer_load_dwordx4 v235, s[20:23], s36 offen offset:3072 nt lds
  ds_read_b64_tr_b16 a[44:45], v227 offset:256
  v_mul_f32 v192, s39, v192
  v_mfma_f32_16x16x32_bf16 v[176:179], a[72:75], a[136:139], v[176:179]
  ds_read_b64_tr_b16 a[46:47], v227 offset:8448
  v_mul_f32 v193, s39, v193
  v_mfma_f32_16x16x32_bf16 v[180:183], a[72:75], a[168:171], v[180:183]
  v_exp_f32 v192, v192
  v_mfma_f32_16x16x32_bf16 v[176:179], a[76:79], a[140:143], v[176:179]
  s_add_u32 m0, s38, 98304
  ds_read_b64_tr_b16 a[52:53], v229 offset:256
  v_mul_f32 v194, s39, v194
  v_mfma_f32_16x16x32_bf16 v[180:183], a[76:79], a[172:175], v[180:183]
  v_exp_f32 v193, v193
  v_mfma_f32_16x16x32_bf16 v[176:179], a[80:83], a[144:147], v[176:179]
  buffer_load_dwordx4 v236, s[24:27], s36 offen offset:0 nt lds
  ds_read_b64_tr_b16 a[54:55], v229 offset:8448
  v_mul_f32 v195, s39, v195
  v_mfma_f32_16x16x32_bf16 v[180:183], a[80:83], a[176:179], v[180:183]
  ds_read_b64_tr_b16 a[56:57], v230 offset:256
  v_cvt_pk_bf16_f32 v212, v192, v193
  v_mfma_f32_16x16x32_bf16 v[176:179], a[84:87], a[148:151], v[176:179]
  v_exp_f32 v194, v194
  v_mfma_f32_16x16x32_bf16 v[180:183], a[84:87], a[180:183], v[180:183]
  buffer_load_dwordx4 v237, s[24:27], s36 offen offset:1024 nt lds
  ds_read_b64_tr_b16 a[58:59], v230 offset:8448
  v_cvt_pk_bf16_f32 v201, v166, v167
  v_mfma_f32_16x16x32_bf16 v[176:179], a[88:91], a[152:155], v[176:179]
  v_exp_f32 v195, v195
  v_mfma_f32_16x16x32_bf16 v[180:183], a[88:91], a[184:187], v[180:183]
  buffer_load_dwordx4 v238, s[24:27], s36 offen offset:2048 nt lds
  ds_read_b64_tr_b16 a[60:61], v231 offset:256
  v_cvt_pk_bf16_f32 v213, v194, v195
  v_mfma_f32_16x16x32_bf16 v[176:179], a[92:95], a[156:159], v[176:179]
  v_mfma_f32_16x16x32_bf16 v[180:183], a[92:95], a[188:191], v[180:183]
  buffer_load_dwordx4 v239, s[24:27], s36 offen offset:3072 nt lds
  ds_write_b64 v240, v[212:213] offset:2048
  v_add_f32 v215, v215, v165
  v_mfma_f32_16x16x32_bf16 v[184:187], a[96:99], a[128:131], v[242:245]
  v_exp_f32 v172, v172
  v_mfma_f32_16x16x32_bf16 v[188:191], a[96:99], a[160:163], v[246:249]
  ds_read_b64_tr_b16 a[62:63], v231 offset:8448
  v_add_f32 v215, v215, v166
  v_mfma_f32_16x16x32_bf16 v[184:187], a[100:103], a[132:135], v[184:187]
  s_add_u32 s36, s36, 16384
  ds_read_b64_tr_b16 a[0:1], v224 offset:0
  v_add_f32 v215, v215, v167
  v_mfma_f32_16x16x32_bf16 v[188:191], a[100:103], a[164:167], v[188:191]
  ds_read_b64_tr_b16 a[2:3], v224 offset:8192
  v_add_f32 v215, v215, v172
  v_mfma_f32_16x16x32_bf16 v[184:187], a[104:107], a[136:139], v[184:187]
  s_add_u32 m0, s38, 0
  v_exp_f32 v173, v173
  v_mfma_f32_16x16x32_bf16 v[188:191], a[104:107], a[168:171], v[188:191]
  ds_read_b64_tr_b16 a[16:17], v228 offset:0
  v_cvt_pk_bf16_f32 v202, v172, v173
  v_mfma_f32_16x16x32_bf16 v[184:187], a[108:111], a[140:143], v[184:187]
  buffer_load_dwordx4 v232, s[20:23], s36 offen offset:0 nt lds
  ds_read_b64_tr_b16 a[18:19], v228 offset:8192
  v_add_f32 v215, v215, v173
  v_mfma_f32_16x16x32_bf16 v[188:191], a[108:111], a[172:175], v[188:191]
  ds_read_b64_tr_b16 a[32:33], v224 offset:256
  v_add_f32 v216, v216, v192
  v_mfma_f32_16x16x32_bf16 v[184:187], a[112:115], a[144:147], v[184:187]
  ds_read_b64_tr_b16 a[34:35], v224 offset:8448
  v_add_f32 v216, v216, v193
  v_mfma_f32_16x16x32_bf16 v[188:191], a[112:115], a[176:179], v[188:191]
  buffer_load_dwordx4 v233, s[20:23], s36 offen offset:1024 nt lds
  ds_read_b64_tr_b16 a[48:49], v228 offset:256
  v_add_f32 v216, v216, v194
  v_mfma_f32_16x16x32_bf16 v[184:187], a[116:119], a[148:151], v[184:187]
  ds_read_b64_tr_b16 a[50:51], v228 offset:8448
  v_add_f32 v216, v216, v195
  v_mfma_f32_16x16x32_bf16 v[188:191], a[116:119], a[180:183], v[188:191]
  buffer_load_dwordx4 v234, s[20:23], s36 offen offset:2048 nt lds
  v_mfma_f32_16x16x32_bf16 v[184:187], a[120:123], a[152:155], v[184:187]
  v_exp_f32 v174, v174
  v_mfma_f32_16x16x32_bf16 v[188:191], a[120:123], a[184:187], v[188:191]
  v_mfma_f32_16x16x32_bf16 v[184:187], a[124:127], a[156:159], v[184:187]
  buffer_load_dwordx4 v235, s[20:23], s36 offen offset:3072 nt lds
  v_exp_f32 v175, v175
  v_mfma_f32_16x16x32_bf16 v[188:191], a[124:127], a[188:191], v[188:191]
  v_cvt_pk_bf16_f32 v203, v174, v175
  v_add_f32 v215, v215, v174
  v_add_f32 v215, v215, v175
  s_waitcnt vmcnt(12) lgkmcnt(0)
  s_barrier
  ds_read_b128 a[224:227], v241 offset:0
  ds_read_b128 a[228:231], v241 offset:1024
  v_mfma_f32_16x16x32_bf16 v[8:11], a[4:7], v[196:199], v[8:11]
  ds_read_b128 a[96:99], v220 offset:40960
  v_mul_f32 v176, s39, v176
  v_mfma_f32_16x16x32_bf16 v[12:15], a[4:7], v[200:203], v[12:15]
  s_add_u32 m0, s38, 114688
  v_exp_f32 v176, v176
  v_mfma_f32_16x16x32_bf16 v[16:19], a[8:11], v[196:199], v[16:19]
  ds_read_b128 a[100:103], v221 offset:40960
  v_mul_f32 v177, s39, v177
  v_mfma_f32_16x16x32_bf16 v[20:23], a[8:11], v[200:203], v[20:23]
  ds_read_b128 a[104:107], v222 offset:40960
  v_mul_f32 v178, s39, v178
  v_mfma_f32_16x16x32_bf16 v[24:27], a[12:15], v[196:199], v[24:27]
  buffer_load_dwordx4 v236, s[24:27], s36 offen offset:0 nt lds
  ds_read_b128 a[108:111], v223 offset:40960
  v_mfma_f32_16x16x32_bf16 v[28:31], a[12:15], v[200:203], v[28:31]
  v_exp_f32 v177, v177
  v_mfma_f32_16x16x32_bf16 v[40:43], a[20:23], v[196:199], v[40:43]
  ds_read_b128 a[112:115], v220 offset:41216
  v_mfma_f32_16x16x32_bf16 v[44:47], a[20:23], v[200:203], v[44:47]
  buffer_load_dwordx4 v237, s[24:27], s36 offen offset:1024 nt lds
  ds_read_b128 a[116:119], v221 offset:41216
  v_mul_f32 v179, s39, v179
  v_mfma_f32_16x16x32_bf16 v[48:51], a[24:27], v[196:199], v[48:51]
  ds_read_b128 a[120:123], v222 offset:41216
  v_mul_f32 v184, s39, v184
  v_mfma_f32_16x16x32_bf16 v[52:55], a[24:27], v[200:203], v[52:55]
  v_exp_f32 v178, v178
  v_mfma_f32_16x16x32_bf16 v[56:59], a[28:31], v[196:199], v[56:59]
  ds_read_b128 a[124:127], v223 offset:41216
  v_mul_f32 v185, s39, v185
  v_mfma_f32_16x16x32_bf16 v[60:63], a[28:31], v[200:203], v[60:63]
  buffer_load_dwordx4 v238, s[24:27], s36 offen offset:2048 nt lds
  v_mfma_f32_16x16x32_bf16 v[72:75], a[36:39], v[196:199], v[72:75]
  ds_read_b64_tr_b16 a[4:5], v225 offset:16384
  v_mul_f32 v186, s39, v186
  v_mfma_f32_16x16x32_bf16 v[76:79], a[36:39], v[200:203], v[76:79]
  ds_read_b128 a[232:235], v241 offset:2048
  v_mul_f32 v187, s39, v187
  v_mfma_f32_16x16x32_bf16 v[80:83], a[40:43], v[196:199], v[80:83]
  buffer_load_dwordx4 v239, s[24:27], s36 offen offset:3072 nt lds
  v_exp_f32 v179, v179
  v_mfma_f32_16x16x32_bf16 v[84:87], a[40:43], v[200:203], v[84:87]
  ds_read_b128 a[64:67], v220 offset:32768
  v_mul_f32 v180, s39, v180
  v_mfma_f32_16x16x32_bf16 v[88:91], a[44:47], v[196:199], v[88:91]
  ds_read_b64_tr_b16 a[6:7], v225 offset:24576
  v_mul_f32 v181, s39, v181
  v_mfma_f32_16x16x32_bf16 v[92:95], a[44:47], v[200:203], v[92:95]
  s_add_u32 s36, s36, 16384
  ds_read_b128 a[68:71], v221 offset:32768
  v_mul_f32 v182, s39, v182
  v_mfma_f32_16x16x32_bf16 v[104:107], a[52:55], v[196:199], v[104:107]
  v_exp_f32 v184, v184
  v_mfma_f32_16x16x32_bf16 v[108:111], a[52:55], v[200:203], v[108:111]
  ds_read_b128 a[72:75], v222 offset:32768
  v_mul_f32 v183, s39, v183
  v_mfma_f32_16x16x32_bf16 v[112:115], a[56:59], v[196:199], v[112:115]
  v_mfma_f32_16x16x32_bf16 v[116:119], a[56:59], v[200:203], v[116:119]
  s_add_u32 m0, s38, 16384
  ds_read_b128 a[76:79], v223 offset:32768
  v_mul_f32 v188, s39, v188
  v_mfma_f32_16x16x32_bf16 v[120:123], a[60:63], v[196:199], v[120:123]
  ds_read_b128 a[236:239], v241 offset:3072
  v_mul_f32 v189, s39, v189
  v_mfma_f32_16x16x32_bf16 v[124:127], a[60:63], v[200:203], v[124:127]
  v_exp_f32 v185, v185
  v_mfma_f32_16x16x32_bf16 v[0:3], a[0:3], v[196:199], v[0:3]
  buffer_load_dwordx4 v232, s[20:23], s36 offen offset:0 nt lds
  ds_read_b128 a[80:83], v220 offset:33024
  v_mul_f32 v190, s39, v190
  v_mfma_f32_16x16x32_bf16 v[4:7], a[0:3], v[200:203], v[4:7]
  ds_read_b64_tr_b16 a[8:9], v226 offset:16384
  v_mul_f32 v191, s39, v191
  s_waitcnt lgkmcnt(15)
  v_mfma_f32_16x16x32_bf16 v[128:131], a[0:3], a[224:227], v[128:131]
  ds_read_b128 a[84:87], v221 offset:33024
  v_cvt_pk_bf16_f32 v204, v176, v177
  v_mfma_f32_16x16x32_bf16 v[132:135], a[0:3], a[228:231], v[132:135]
  buffer_load_dwordx4 v233, s[20:23], s36 offen offset:1024 nt lds
  v_exp_f32 v186, v186
  v_mfma_f32_16x16x32_bf16 v[32:35], a[16:19], v[196:199], v[32:35]
  ds_read_b128 a[88:91], v222 offset:33024
  v_cvt_pk_bf16_f32 v205, v178, v179
  v_mfma_f32_16x16x32_bf16 v[36:39], a[16:19], v[200:203], v[36:39]
  v_mfma_f32_16x16x32_bf16 v[136:139], a[16:19], a[224:227], v[136:139]
  ds_read_b128 a[92:95], v223 offset:33024
  v_cvt_pk_bf16_f32 v206, v184, v185
  v_mfma_f32_16x16x32_bf16 v[140:143], a[16:19], a[228:231], v[140:143]
  buffer_load_dwordx4 v234, s[20:23], s36 offen offset:2048 nt lds
  ds_read_b64_tr_b16 a[10:11], v226 offset:24576
  v_add_f32 v214, v214, v176
  v_mfma_f32_16x16x32_bf16 v[64:67], a[32:35], v[196:199], v[64:67]
  v_exp_f32 v187, v187
  v_mfma_f32_16x16x32_bf16 v[68:71], a[32:35], v[200:203], v[68:71]
  ds_read_b64_tr_b16 a[12:13], v227 offset:16384
  v_cvt_pk_bf16_f32 v207, v186, v187
  v_mfma_f32_16x16x32_bf16 v[144:147], a[32:35], a[224:227], v[144:147]
  buffer_load_dwordx4 v235, s[20:23], s36 offen offset:3072 nt lds
  ds_read_b64_tr_b16 a[14:15], v227 offset:24576
  v_add_f32 v214, v214, v177
  v_mfma_f32_16x16x32_bf16 v[148:151], a[32:35], a[228:231], v[148:151]
  ds_read_b64_tr_b16 a[20:21], v229 offset:16384
  v_add_f32 v214, v214, v178
  v_mfma_f32_16x16x32_bf16 v[96:99], a[48:51], v[196:199], v[96:99]
  v_exp_f32 v180, v180
  v_mfma_f32_16x16x32_bf16 v[100:103], a[48:51], v[200:203], v[100:103]
  ds_read_b64_tr_b16 a[22:23], v229 offset:24576
  v_add_f32 v214, v214, v179
  v_mfma_f32_16x16x32_bf16 v[152:155], a[48:51], a[224:227], v[152:155]
  s_add_u32 m0, s38, 65536
  v_mfma_f32_16x16x32_bf16 v[156:159], a[48:51], a[228:231], v[156:159]
  ds_read_b64_tr_b16 a[24:25], v230 offset:16384
  s_waitcnt lgkmcnt(6)
  s_mov_b32 s40, 0
.p2align 6
L_loop_k1q1p1:
  v_mfma_f32_16x16x32_bf16 v[192:195], a[96:99], a[192:195], v[250:253]
  ds_read_b64_tr_b16 a[26:27], v230 offset:24576
  s_add_u32 m0, s38, 65536
  v_mfma_f32_16x16x32_bf16 v[192:195], a[100:103], a[196:199], v[192:195]
  v_exp_f32 v181, v181
  v_mfma_f32_16x16x32_bf16 v[192:195], a[104:107], a[200:203], v[192:195]
  ds_read_b64_tr_b16 a[28:29], v231 offset:16384
  v_cvt_pk_bf16_f32 v208, v180, v181
  v_mfma_f32_16x16x32_bf16 v[192:195], a[108:111], a[204:207], v[192:195]
  ds_read_b64_tr_b16 a[30:31], v231 offset:24576
  v_add_f32 v214, v214, v184
  v_mfma_f32_16x16x32_bf16 v[192:195], a[112:115], a[208:211], v[192:195]
  ds_read_b64_tr_b16 a[36:37], v225 offset:16640
  v_add_f32 v214, v214, v185
  v_mfma_f32_16x16x32_bf16 v[192:195], a[116:119], a[212:215], v[192:195]
  ds_read_b64_tr_b16 a[38:39], v225 offset:24832
  v_add_f32 v214, v214, v186
  v_mfma_f32_16x16x32_bf16 v[192:195], a[120:123], a[216:219], v[192:195]
  v_exp_f32 v182, v182
  v_mfma_f32_16x16x32_bf16 v[192:195], a[124:127], a[220:223], v[192:195]
  ds_read_b64_tr_b16 a[40:41], v226 offset:16640
  v_add_f32 v214, v214, v187
  v_mfma_f32_16x16x32_bf16 v[160:163], a[64:67], a[128:131], v[242:245]
  buffer_load_dwordx4 v236, s[24:27], s36 offen offset:0 nt lds
  v_mfma_f32_16x16x32_bf16 v[164:167], a[64:67], a[160:163], v[246:249]
  ds_read_b64_tr_b16 a[42:43], v226 offset:24832
  v_add_f32 v215, v215, v180
  v_mfma_f32_16x16x32_bf16 v[160:163], a[68:71], a[132:135], v[160:163]
  v_exp_f32 v183, v183
  v_mfma_f32_16x16x32_bf16 v[164:167], a[68:71], a[164:167], v[164:167]
  ds_read_b64_tr_b16 a[44:45], v227 offset:16640
  v_mul_f32 v192, s39, v192
  v_mfma_f32_16x16x32_bf16 v[160:163], a[72:75], a[136:139], v[160:163]
  ds_read_b64_tr_b16 a[46:47], v227 offset:24832
  v_mul_f32 v193, s39, v193
  v_mfma_f32_16x16x32_bf16 v[164:167], a[72:75], a[168:171], v[164:167]
  v_exp_f32 v192, v192
  v_mfma_f32_16x16x32_bf16 v[160:163], a[76:79], a[140:143], v[160:163]
  ds_read_b64_tr_b16 a[52:53], v229 offset:16640
  v_mul_f32 v194, s39, v194
  v_mfma_f32_16x16x32_bf16 v[164:167], a[76:79], a[172:175], v[164:167]
  v_exp_f32 v193, v193
  v_mfma_f32_16x16x32_bf16 v[160:163], a[80:83], a[144:147], v[160:163]
  ds_read_b64_tr_b16 a[54:55], v229 offset:24832
  v_mul_f32 v195, s39, v195
  v_mfma_f32_16x16x32_bf16 v[164:167], a[80:83], a[176:179], v[164:167]
  ds_read_b64_tr_b16 a[56:57], v230 offset:16640
  v_cvt_pk_bf16_f32 v212, v192, v193
  v_mfma_f32_16x16x32_bf16 v[160:163], a[84:87], a[148:151], v[160:163]
  v_exp_f32 v194, v194
  v_mfma_f32_16x16x32_bf16 v[164:167], a[84:87], a[180:183], v[164:167]
  ds_read_b64_tr_b16 a[58:59], v230 offset:24832
  v_cvt_pk_bf16_f32 v209, v182, v183
  v_mfma_f32_16x16x32_bf16 v[160:163], a[88:91], a[152:155], v[160:163]
  v_exp_f32 v195, v195
  v_mfma_f32_16x16x32_bf16 v[164:167], a[88:91], a[184:187], v[164:167]
  ds_read_b64_tr_b16 a[60:61], v231 offset:16640
  v_cvt_pk_bf16_f32 v213, v194, v195
  v_mfma_f32_16x16x32_bf16 v[160:163], a[92:95], a[156:159], v[160:163]
  buffer_load_dwordx4 v237, s[24:27], s36 offen offset:1024 nt lds
  v_mfma_f32_16x16x32_bf16 v[164:167], a[92:95], a[188:191], v[164:167]
  ds_write_b64 v240, v[212:213] offset:0
  v_add_f32 v215, v215, v181
  v_mfma_f32_16x16x32_bf16 v[168:171], a[96:99], a[128:131], v[242:245]
  v_exp_f32 v188, v188
  v_mfma_f32_16x16x32_bf16 v[172:175], a[96:99], a[160:163], v[246:249]
  ds_read_b64_tr_b16 a[62:63], v231 offset:24832
  v_add_f32 v215, v215, v182
  v_mfma_f32_16x16x32_bf16 v[168:171], a[100:103], a[132:135], v[168:171]
  ds_read_b64_tr_b16 a[0:1], v224 offset:16384
  v_add_f32 v215, v215, v183
  v_mfma_f32_16x16x32_bf16 v[172:175], a[100:103], a[164:167], v[172:175]
  ds_read_b64_tr_b16 a[2:3], v224 offset:24576
  v_add_f32 v215, v215, v188
  v_mfma_f32_16x16x32_bf16 v[168:171], a[104:107], a[136:139], v[168:171]
  v_exp_f32 v189, v189
  v_mfma_f32_16x16x32_bf16 v[172:175], a[104:107], a[168:171], v[172:175]
  ds_read_b64_tr_b16 a[16:17], v228 offset:16384
  v_cvt_pk_bf16_f32 v210, v188, v189
  v_mfma_f32_16x16x32_bf16 v[168:171], a[108:111], a[140:143], v[168:171]
  ds_read_b64_tr_b16 a[18:19], v228 offset:24576
  v_add_f32 v215, v215, v189
  v_mfma_f32_16x16x32_bf16 v[172:175], a[108:111], a[172:175], v[172:175]
  ds_read_b64_tr_b16 a[32:33], v224 offset:16640
  v_add_f32 v216, v216, v192
  v_mfma_f32_16x16x32_bf16 v[168:171], a[112:115], a[144:147], v[168:171]
  ds_read_b64_tr_b16 a[34:35], v224 offset:24832
  v_add_f32 v216, v216, v193
  v_mfma_f32_16x16x32_bf16 v[172:175], a[112:115], a[176:179], v[172:175]
  ds_read_b64_tr_b16 a[48:49], v228 offset:16640
  v_add_f32 v216, v216, v194
  v_mfma_f32_16x16x32_bf16 v[168:171], a[116:119], a[148:151], v[168:171]
  ds_read_b64_tr_b16 a[50:51], v228 offset:24832
  v_add_f32 v216, v216, v195
  v_mfma_f32_16x16x32_bf16 v[172:175], a[116:119], a[180:183], v[172:175]
  buffer_load_dwordx4 v238, s[24:27], s36 offen offset:2048 nt lds
  v_mfma_f32_16x16x32_bf16 v[168:171], a[120:123], a[152:155], v[168:171]
  v_exp_f32 v190, v190
  v_mfma_f32_16x16x32_bf16 v[172:175], a[120:123], a[184:187], v[172:175]
  buffer_load_dwordx4 v239, s[24:27], s36 offen offset:3072 nt lds
  v_mfma_f32_16x16x32_bf16 v[168:171], a[124:127], a[156:159], v[168:171]
  v_exp_f32 v191, v191
  v_mfma_f32_16x16x32_bf16 v[172:175], a[124:127], a[188:191], v[172:175]
  v_cvt_pk_bf16_f32 v211, v190, v191
  v_add_f32 v215, v215, v190
  v_add_f32 v215, v215, v191
  s_waitcnt vmcnt(16) lgkmcnt(0)
  s_barrier
  v_mfma_f32_16x16x32_bf16 v[8:11], a[4:7], v[204:207], v[8:11]
  ds_read_b128 a[96:99], v220 offset:57344
  v_mul_f32 v160, s39, v160
  v_mfma_f32_16x16x32_bf16 v[12:15], a[4:7], v[208:211], v[12:15]
  v_exp_f32 v160, v160
  v_mfma_f32_16x16x32_bf16 v[16:19], a[8:11], v[204:207], v[16:19]
  ds_read_b128 a[100:103], v221 offset:57344
  v_mul_f32 v161, s39, v161
  v_mfma_f32_16x16x32_bf16 v[20:23], a[8:11], v[208:211], v[20:23]
  ds_read_b128 a[104:107], v222 offset:57344
  v_mul_f32 v162, s39, v162
  v_mfma_f32_16x16x32_bf16 v[24:27], a[12:15], v[204:207], v[24:27]
  ds_read_b128 a[108:111], v223 offset:57344
  s_add_u32 s36, s36, 16384
  v_mfma_f32_16x16x32_bf16 v[28:31], a[12:15], v[208:211], v[28:31]
  v_exp_f32 v161, v161
  v_mfma_f32_16x16x32_bf16 v[40:43], a[20:23], v[204:207], v[40:43]
  ds_read_b128 a[112:115], v220 offset:57600
  s_add_u32 m0, s38, 32768
  v_mfma_f32_16x16x32_bf16 v[44:47], a[20:23], v[208:211], v[44:47]
  ds_read_b128 a[116:119], v221 offset:57600
  v_mul_f32 v163, s39, v163
  v_mfma_f32_16x16x32_bf16 v[48:51], a[24:27], v[204:207], v[48:51]
  ds_read_b128 a[120:123], v222 offset:57600
  v_mul_f32 v168, s39, v168
  v_mfma_f32_16x16x32_bf16 v[52:55], a[24:27], v[208:211], v[52:55]
  v_exp_f32 v162, v162
  v_mfma_f32_16x16x32_bf16 v[56:59], a[28:31], v[204:207], v[56:59]
  ds_read_b128 a[124:127], v223 offset:57600
  v_mul_f32 v169, s39, v169
  v_mfma_f32_16x16x32_bf16 v[60:63], a[28:31], v[208:211], v[60:63]
  buffer_load_dwordx4 v232, s[20:23], s36 offen offset:0 nt lds
  v_mfma_f32_16x16x32_bf16 v[72:75], a[36:39], v[204:207], v[72:75]
  ds_read_b64_tr_b16 a[4:5], v225 offset:32768
  v_mul_f32 v170, s39, v170
  v_mfma_f32_16x16x32_bf16 v[76:79], a[36:39], v[208:211], v[76:79]
  ds_read_b128 a[224:227], v241 offset:0
  v_mul_f32 v171, s39, v171
  v_mfma_f32_16x16x32_bf16 v[80:83], a[40:43], v[204:207], v[80:83]
  v_exp_f32 v163, v163
  v_mfma_f32_16x16x32_bf16 v[84:87], a[40:43], v[208:211], v[84:87]
  ds_read_b128 a[64:67], v220 offset:49152
  v_mul_f32 v164, s39, v164
  v_mfma_f32_16x16x32_bf16 v[88:91], a[44:47], v[204:207], v[88:91]
  ds_read_b64_tr_b16 a[6:7], v225 offset:40960
  v_mul_f32 v165, s39, v165
  v_mfma_f32_16x16x32_bf16 v[92:95], a[44:47], v[208:211], v[92:95]
  ds_read_b128 a[68:71], v221 offset:49152
  v_mul_f32 v166, s39, v166
  v_mfma_f32_16x16x32_bf16 v[104:107], a[52:55], v[204:207], v[104:107]
  v_exp_f32 v168, v168
  v_mfma_f32_16x16x32_bf16 v[108:111], a[52:55], v[208:211], v[108:111]
  ds_read_b128 a[72:75], v222 offset:49152
  v_mul_f32 v167, s39, v167
  v_mfma_f32_16x16x32_bf16 v[112:115], a[56:59], v[204:207], v[112:115]
  buffer_load_dwordx4 v233, s[20:23], s36 offen offset:1024 nt lds
  v_mfma_f32_16x16x32_bf16 v[116:119], a[56:59], v[208:211], v[116:119]
  ds_read_b128 a[76:79], v223 offset:49152
  v_mul_f32 v172, s39, v172
  v_mfma_f32_16x16x32_bf16 v[120:123], a[60:63], v[204:207], v[120:123]
  ds_read_b128 a[228:231], v241 offset:1024
  v_mul_f32 v173, s39, v173
  v_mfma_f32_16x16x32_bf16 v[124:127], a[60:63], v[208:211], v[124:127]
  v_exp_f32 v169, v169
  v_mfma_f32_16x16x32_bf16 v[0:3], a[0:3], v[204:207], v[0:3]
  ds_read_b128 a[80:83], v220 offset:49408
  v_mul_f32 v174, s39, v174
  v_mfma_f32_16x16x32_bf16 v[4:7], a[0:3], v[208:211], v[4:7]
  ds_read_b64_tr_b16 a[8:9], v226 offset:32768
  v_mul_f32 v175, s39, v175
  v_mfma_f32_16x16x32_bf16 v[128:131], a[0:3], a[232:235], v[128:131]
  ds_read_b128 a[84:87], v221 offset:49408
  v_cvt_pk_bf16_f32 v196, v160, v161
  v_mfma_f32_16x16x32_bf16 v[132:135], a[0:3], a[236:239], v[132:135]
  v_exp_f32 v170, v170
  v_mfma_f32_16x16x32_bf16 v[32:35], a[16:19], v[204:207], v[32:35]
  ds_read_b128 a[88:91], v222 offset:49408
  v_cvt_pk_bf16_f32 v197, v162, v163
  v_mfma_f32_16x16x32_bf16 v[36:39], a[16:19], v[208:211], v[36:39]
  buffer_load_dwordx4 v234, s[20:23], s36 offen offset:2048 nt lds
  v_mfma_f32_16x16x32_bf16 v[136:139], a[16:19], a[232:235], v[136:139]
  ds_read_b128 a[92:95], v223 offset:49408
  v_cvt_pk_bf16_f32 v198, v168, v169
  v_mfma_f32_16x16x32_bf16 v[140:143], a[16:19], a[236:239], v[140:143]
  ds_read_b64_tr_b16 a[10:11], v226 offset:40960
  v_add_f32 v214, v214, v160
  v_mfma_f32_16x16x32_bf16 v[64:67], a[32:35], v[204:207], v[64:67]
  v_exp_f32 v171, v171
  v_mfma_f32_16x16x32_bf16 v[68:71], a[32:35], v[208:211], v[68:71]
  ds_read_b64_tr_b16 a[12:13], v227 offset:32768
  v_cvt_pk_bf16_f32 v199, v170, v171
  v_mfma_f32_16x16x32_bf16 v[144:147], a[32:35], a[232:235], v[144:147]
  ds_read_b64_tr_b16 a[14:15], v227 offset:40960
  v_add_f32 v214, v214, v161
  v_mfma_f32_16x16x32_bf16 v[148:151], a[32:35], a[236:239], v[148:151]
  ds_read_b64_tr_b16 a[20:21], v229 offset:32768
  v_add_f32 v214, v214, v162
  v_mfma_f32_16x16x32_bf16 v[96:99], a[48:51], v[204:207], v[96:99]
  v_exp_f32 v164, v164
  v_mfma_f32_16x16x32_bf16 v[100:103], a[48:51], v[208:211], v[100:103]
  ds_read_b64_tr_b16 a[22:23], v229 offset:40960
  v_add_f32 v214, v214, v163
  v_mfma_f32_16x16x32_bf16 v[152:155], a[48:51], a[232:235], v[152:155]
  buffer_load_dwordx4 v235, s[20:23], s36 offen offset:3072 nt lds
  v_mfma_f32_16x16x32_bf16 v[156:159], a[48:51], a[236:239], v[156:159]
  ds_read_b64_tr_b16 a[24:25], v230 offset:32768
  s_waitcnt lgkmcnt(6)
  v_mfma_f32_16x16x32_bf16 v[192:195], a[96:99], a[192:195], v[250:253]
  ds_read_b64_tr_b16 a[26:27], v230 offset:40960
  s_add_u32 m0, s38, 81920
  v_mfma_f32_16x16x32_bf16 v[192:195], a[100:103], a[196:199], v[192:195]
  v_exp_f32 v165, v165
  v_mfma_f32_16x16x32_bf16 v[192:195], a[104:107], a[200:203], v[192:195]
  ds_read_b64_tr_b16 a[28:29], v231 offset:32768
  v_cvt_pk_bf16_f32 v200, v164, v165
  v_mfma_f32_16x16x32_bf16 v[192:195], a[108:111], a[204:207], v[192:195]
  ds_read_b64_tr_b16 a[30:31], v231 offset:40960
  v_add_f32 v214, v214, v168
  v_mfma_f32_16x16x32_bf16 v[192:195], a[112:115], a[208:211], v[192:195]
  ds_read_b64_tr_b16 a[36:37], v225 offset:33024
  v_add_f32 v214, v214, v169
  v_mfma_f32_16x16x32_bf16 v[192:195], a[116:119], a[212:215], v[192:195]
  ds_read_b64_tr_b16 a[38:39], v225 offset:41216
  v_add_f32 v214, v214, v170
  v_mfma_f32_16x16x32_bf16 v[192:195], a[120:123], a[216:219], v[192:195]
  v_exp_f32 v166, v166
  v_mfma_f32_16x16x32_bf16 v[192:195], a[124:127], a[220:223], v[192:195]
  ds_read_b64_tr_b16 a[40:41], v226 offset:33024
  v_add_f32 v214, v214, v171
  v_mfma_f32_16x16x32_bf16 v[176:179], a[64:67], a[128:131], v[242:245]
  buffer_load_dwordx4 v236, s[24:27], s36 offen offset:0 nt lds
  v_mfma_f32_16x16x32_bf16 v[180:183], a[64:67], a[160:163], v[246:249]
  ds_read_b64_tr_b16 a[42:43], v226 offset:41216
  v_add_f32 v215, v215, v164
  v_mfma_f32_16x16x32_bf16 v[176:179], a[68:71], a[132:135], v[176:179]
  v_exp_f32 v167, v167
  v_mfma_f32_16x16x32_bf16 v[180:183], a[68:71], a[164:167], v[180:183]
  ds_read_b64_tr_b16 a[44:45], v227 offset:33024
  v_mul_f32 v192, s39, v192
  v_mfma_f32_16x16x32_bf16 v[176:179], a[72:75], a[136:139], v[176:179]
  ds_read_b64_tr_b16 a[46:47], v227 offset:41216
  v_mul_f32 v193, s39, v193
  v_mfma_f32_16x16x32_bf16 v[180:183], a[72:75], a[168:171], v[180:183]
  v_exp_f32 v192, v192
  v_mfma_f32_16x16x32_bf16 v[176:179], a[76:79], a[140:143], v[176:179]
  ds_read_b64_tr_b16 a[52:53], v229 offset:33024
  v_mul_f32 v194, s39, v194
  v_mfma_f32_16x16x32_bf16 v[180:183], a[76:79], a[172:175], v[180:183]
  v_exp_f32 v193, v193
  v_mfma_f32_16x16x32_bf16 v[176:179], a[80:83], a[144:147], v[176:179]
  ds_read_b64_tr_b16 a[54:55], v229 offset:41216
  v_mul_f32 v195, s39, v195
  v_mfma_f32_16x16x32_bf16 v[180:183], a[80:83], a[176:179], v[180:183]
  ds_read_b64_tr_b16 a[56:57], v230 offset:33024
  v_cvt_pk_bf16_f32 v212, v192, v193
  v_mfma_f32_16x16x32_bf16 v[176:179], a[84:87], a[148:151], v[176:179]
  v_exp_f32 v194, v194
  v_mfma_f32_16x16x32_bf16 v[180:183], a[84:87], a[180:183], v[180:183]
  ds_read_b64_tr_b16 a[58:59], v230 offset:41216
  v_cvt_pk_bf16_f32 v201, v166, v167
  v_mfma_f32_16x16x32_bf16 v[176:179], a[88:91], a[152:155], v[176:179]
  v_exp_f32 v195, v195
  v_mfma_f32_16x16x32_bf16 v[180:183], a[88:91], a[184:187], v[180:183]
  ds_read_b64_tr_b16 a[60:61], v231 offset:33024
  v_cvt_pk_bf16_f32 v213, v194, v195
  v_mfma_f32_16x16x32_bf16 v[176:179], a[92:95], a[156:159], v[176:179]
  buffer_load_dwordx4 v237, s[24:27], s36 offen offset:1024 nt lds
  v_mfma_f32_16x16x32_bf16 v[180:183], a[92:95], a[188:191], v[180:183]
  ds_write_b64 v240, v[212:213] offset:2048
  v_add_f32 v215, v215, v165
  v_mfma_f32_16x16x32_bf16 v[184:187], a[96:99], a[128:131], v[242:245]
  v_exp_f32 v172, v172
  v_mfma_f32_16x16x32_bf16 v[188:191], a[96:99], a[160:163], v[246:249]
  ds_read_b64_tr_b16 a[62:63], v231 offset:41216
  v_add_f32 v215, v215, v166
  v_mfma_f32_16x16x32_bf16 v[184:187], a[100:103], a[132:135], v[184:187]
  ds_read_b64_tr_b16 a[0:1], v224 offset:32768
  v_add_f32 v215, v215, v167
  v_mfma_f32_16x16x32_bf16 v[188:191], a[100:103], a[164:167], v[188:191]
  ds_read_b64_tr_b16 a[2:3], v224 offset:40960
  v_add_f32 v215, v215, v172
  v_mfma_f32_16x16x32_bf16 v[184:187], a[104:107], a[136:139], v[184:187]
  v_exp_f32 v173, v173
  v_mfma_f32_16x16x32_bf16 v[188:191], a[104:107], a[168:171], v[188:191]
  ds_read_b64_tr_b16 a[16:17], v228 offset:32768
  v_cvt_pk_bf16_f32 v202, v172, v173
  v_mfma_f32_16x16x32_bf16 v[184:187], a[108:111], a[140:143], v[184:187]
  ds_read_b64_tr_b16 a[18:19], v228 offset:40960
  v_add_f32 v215, v215, v173
  v_mfma_f32_16x16x32_bf16 v[188:191], a[108:111], a[172:175], v[188:191]
  ds_read_b64_tr_b16 a[32:33], v224 offset:33024
  v_add_f32 v216, v216, v192
  v_mfma_f32_16x16x32_bf16 v[184:187], a[112:115], a[144:147], v[184:187]
  ds_read_b64_tr_b16 a[34:35], v224 offset:41216
  v_add_f32 v216, v216, v193
  v_mfma_f32_16x16x32_bf16 v[188:191], a[112:115], a[176:179], v[188:191]
  ds_read_b64_tr_b16 a[48:49], v228 offset:33024
  v_add_f32 v216, v216, v194
  v_mfma_f32_16x16x32_bf16 v[184:187], a[116:119], a[148:151], v[184:187]
  ds_read_b64_tr_b16 a[50:51], v228 offset:41216
  v_add_f32 v216, v216, v195
  v_mfma_f32_16x16x32_bf16 v[188:191], a[116:119], a[180:183], v[188:191]
  buffer_load_dwordx4 v238, s[24:27], s36 offen offset:2048 nt lds
  v_mfma_f32_16x16x32_bf16 v[184:187], a[120:123], a[152:155], v[184:187]
  v_exp_f32 v174, v174
  v_mfma_f32_16x16x32_bf16 v[188:191], a[120:123], a[184:187], v[188:191]
  buffer_load_dwordx4 v239, s[24:27], s36 offen offset:3072 nt lds
  v_mfma_f32_16x16x32_bf16 v[184:187], a[124:127], a[156:159], v[184:187]
  v_exp_f32 v175, v175
  v_mfma_f32_16x16x32_bf16 v[188:191], a[124:127], a[188:191], v[188:191]
  v_cvt_pk_bf16_f32 v203, v174, v175
  v_add_f32 v215, v215, v174
  v_add_f32 v215, v215, v175
  s_waitcnt vmcnt(16) lgkmcnt(0)
  s_barrier
  v_mfma_f32_16x16x32_bf16 v[8:11], a[4:7], v[196:199], v[8:11]
  ds_read_b128 a[96:99], v220 offset:8192
  v_mul_f32 v176, s39, v176
  v_mfma_f32_16x16x32_bf16 v[12:15], a[4:7], v[200:203], v[12:15]
  v_exp_f32 v176, v176
  v_mfma_f32_16x16x32_bf16 v[16:19], a[8:11], v[196:199], v[16:19]
  ds_read_b128 a[100:103], v221 offset:8192
  v_mul_f32 v177, s39, v177
  v_mfma_f32_16x16x32_bf16 v[20:23], a[8:11], v[200:203], v[20:23]
  ds_read_b128 a[104:107], v222 offset:8192
  v_mul_f32 v178, s39, v178
  v_mfma_f32_16x16x32_bf16 v[24:27], a[12:15], v[196:199], v[24:27]
  ds_read_b128 a[108:111], v223 offset:8192
  s_add_u32 s36, s36, 16384
  v_mfma_f32_16x16x32_bf16 v[28:31], a[12:15], v[200:203], v[28:31]
  v_exp_f32 v177, v177
  v_mfma_f32_16x16x32_bf16 v[40:43], a[20:23], v[196:199], v[40:43]
  ds_read_b128 a[112:115], v220 offset:8448
  s_add_u32 m0, s38, 49152
  v_mfma_f32_16x16x32_bf16 v[44:47], a[20:23], v[200:203], v[44:47]
  ds_read_b128 a[116:119], v221 offset:8448
  v_mul_f32 v179, s39, v179
  v_mfma_f32_16x16x32_bf16 v[48:51], a[24:27], v[196:199], v[48:51]
  ds_read_b128 a[120:123], v222 offset:8448
  v_mul_f32 v184, s39, v184
  v_mfma_f32_16x16x32_bf16 v[52:55], a[24:27], v[200:203], v[52:55]
  v_exp_f32 v178, v178
  v_mfma_f32_16x16x32_bf16 v[56:59], a[28:31], v[196:199], v[56:59]
  ds_read_b128 a[124:127], v223 offset:8448
  v_mul_f32 v185, s39, v185
  v_mfma_f32_16x16x32_bf16 v[60:63], a[28:31], v[200:203], v[60:63]
  buffer_load_dwordx4 v232, s[20:23], s36 offen offset:0 nt lds
  v_mfma_f32_16x16x32_bf16 v[72:75], a[36:39], v[196:199], v[72:75]
  ds_read_b64_tr_b16 a[4:5], v225 offset:49152
  v_mul_f32 v186, s39, v186
  v_mfma_f32_16x16x32_bf16 v[76:79], a[36:39], v[200:203], v[76:79]
  ds_read_b128 a[232:235], v241 offset:2048
  v_mul_f32 v187, s39, v187
  v_mfma_f32_16x16x32_bf16 v[80:83], a[40:43], v[196:199], v[80:83]
  v_exp_f32 v179, v179
  v_mfma_f32_16x16x32_bf16 v[84:87], a[40:43], v[200:203], v[84:87]
  ds_read_b128 a[64:67], v220 offset:0
  v_mul_f32 v180, s39, v180
  v_mfma_f32_16x16x32_bf16 v[88:91], a[44:47], v[196:199], v[88:91]
  ds_read_b64_tr_b16 a[6:7], v225 offset:57344
  v_mul_f32 v181, s39, v181
  v_mfma_f32_16x16x32_bf16 v[92:95], a[44:47], v[200:203], v[92:95]
  ds_read_b128 a[68:71], v221 offset:0
  v_mul_f32 v182, s39, v182
  v_mfma_f32_16x16x32_bf16 v[104:107], a[52:55], v[196:199], v[104:107]
  v_exp_f32 v184, v184
  v_mfma_f32_16x16x32_bf16 v[108:111], a[52:55], v[200:203], v[108:111]
  ds_read_b128 a[72:75], v222 offset:0
  v_mul_f32 v183, s39, v183
  v_mfma_f32_16x16x32_bf16 v[112:115], a[56:59], v[196:199], v[112:115]
  buffer_load_dwordx4 v233, s[20:23], s36 offen offset:1024 nt lds
  v_mfma_f32_16x16x32_bf16 v[116:119], a[56:59], v[200:203], v[116:119]
  ds_read_b128 a[76:79], v223 offset:0
  v_mul_f32 v188, s39, v188
  v_mfma_f32_16x16x32_bf16 v[120:123], a[60:63], v[196:199], v[120:123]
  ds_read_b128 a[236:239], v241 offset:3072
  v_mul_f32 v189, s39, v189
  v_mfma_f32_16x16x32_bf16 v[124:127], a[60:63], v[200:203], v[124:127]
  v_exp_f32 v185, v185
  v_mfma_f32_16x16x32_bf16 v[0:3], a[0:3], v[196:199], v[0:3]
  ds_read_b128 a[80:83], v220 offset:256
  v_mul_f32 v190, s39, v190
  v_mfma_f32_16x16x32_bf16 v[4:7], a[0:3], v[200:203], v[4:7]
  ds_read_b64_tr_b16 a[8:9], v226 offset:49152
  v_mul_f32 v191, s39, v191
  v_mfma_f32_16x16x32_bf16 v[128:131], a[0:3], a[224:227], v[128:131]
  ds_read_b128 a[84:87], v221 offset:256
  v_cvt_pk_bf16_f32 v204, v176, v177
  v_mfma_f32_16x16x32_bf16 v[132:135], a[0:3], a[228:231], v[132:135]
  v_exp_f32 v186, v186
  v_mfma_f32_16x16x32_bf16 v[32:35], a[16:19], v[196:199], v[32:35]
  ds_read_b128 a[88:91], v222 offset:256
  v_cvt_pk_bf16_f32 v205, v178, v179
  v_mfma_f32_16x16x32_bf16 v[36:39], a[16:19], v[200:203], v[36:39]
  buffer_load_dwordx4 v234, s[20:23], s36 offen offset:2048 nt lds
  v_mfma_f32_16x16x32_bf16 v[136:139], a[16:19], a[224:227], v[136:139]
  ds_read_b128 a[92:95], v223 offset:256
  v_cvt_pk_bf16_f32 v206, v184, v185
  v_mfma_f32_16x16x32_bf16 v[140:143], a[16:19], a[228:231], v[140:143]
  ds_read_b64_tr_b16 a[10:11], v226 offset:57344
  v_add_f32 v214, v214, v176
  v_mfma_f32_16x16x32_bf16 v[64:67], a[32:35], v[196:199], v[64:67]
  v_exp_f32 v187, v187
  v_mfma_f32_16x16x32_bf16 v[68:71], a[32:35], v[200:203], v[68:71]
  ds_read_b64_tr_b16 a[12:13], v227 offset:49152
  v_cvt_pk_bf16_f32 v207, v186, v187
  v_mfma_f32_16x16x32_bf16 v[144:147], a[32:35], a[224:227], v[144:147]
  ds_read_b64_tr_b16 a[14:15], v227 offset:57344
  v_add_f32 v214, v214, v177
  v_mfma_f32_16x16x32_bf16 v[148:151], a[32:35], a[228:231], v[148:151]
  ds_read_b64_tr_b16 a[20:21], v229 offset:49152
  v_add_f32 v214, v214, v178
  v_mfma_f32_16x16x32_bf16 v[96:99], a[48:51], v[196:199], v[96:99]
  v_exp_f32 v180, v180
  v_mfma_f32_16x16x32_bf16 v[100:103], a[48:51], v[200:203], v[100:103]
  ds_read_b64_tr_b16 a[22:23], v229 offset:57344
  v_add_f32 v214, v214, v179
  v_mfma_f32_16x16x32_bf16 v[152:155], a[48:51], a[224:227], v[152:155]
  buffer_load_dwordx4 v235, s[20:23], s36 offen offset:3072 nt lds
  v_mfma_f32_16x16x32_bf16 v[156:159], a[48:51], a[228:231], v[156:159]
  ds_read_b64_tr_b16 a[24:25], v230 offset:49152
  s_waitcnt lgkmcnt(6)
  v_mfma_f32_16x16x32_bf16 v[192:195], a[96:99], a[192:195], v[250:253]
  ds_read_b64_tr_b16 a[26:27], v230 offset:57344
  s_add_u32 m0, s38, 98304
  v_mfma_f32_16x16x32_bf16 v[192:195], a[100:103], a[196:199], v[192:195]
  v_exp_f32 v181, v181
  v_mfma_f32_16x16x32_bf16 v[192:195], a[104:107], a[200:203], v[192:195]
  ds_read_b64_tr_b16 a[28:29], v231 offset:49152
  v_cvt_pk_bf16_f32 v208, v180, v181
  v_mfma_f32_16x16x32_bf16 v[192:195], a[108:111], a[204:207], v[192:195]
  ds_read_b64_tr_b16 a[30:31], v231 offset:57344
  v_add_f32 v214, v214, v184
  v_mfma_f32_16x16x32_bf16 v[192:195], a[112:115], a[208:211], v[192:195]
  ds_read_b64_tr_b16 a[36:37], v225 offset:49408
  v_add_f32 v214, v214, v185
  v_mfma_f32_16x16x32_bf16 v[192:195], a[116:119], a[212:215], v[192:195]
  ds_read_b64_tr_b16 a[38:39], v225 offset:57600
  v_add_f32 v214, v214, v186
  v_mfma_f32_16x16x32_bf16 v[192:195], a[120:123], a[216:219], v[192:195]
  v_exp_f32 v182, v182
  v_mfma_f32_16x16x32_bf16 v[192:195], a[124:127], a[220:223], v[192:195]
  ds_read_b64_tr_b16 a[40:41], v226 offset:49408
  v_add_f32 v214, v214, v187
  v_mfma_f32_16x16x32_bf16 v[160:163], a[64:67], a[128:131], v[242:245]
  buffer_load_dwordx4 v236, s[24:27], s36 offen offset:0 nt lds
  v_mfma_f32_16x16x32_bf16 v[164:167], a[64:67], a[160:163], v[246:249]
  ds_read_b64_tr_b16 a[42:43], v226 offset:57600
  v_add_f32 v215, v215, v180
  v_mfma_f32_16x16x32_bf16 v[160:163], a[68:71], a[132:135], v[160:163]
  v_exp_f32 v183, v183
  v_mfma_f32_16x16x32_bf16 v[164:167], a[68:71], a[164:167], v[164:167]
  ds_read_b64_tr_b16 a[44:45], v227 offset:49408
  v_mul_f32 v192, s39, v192
  v_mfma_f32_16x16x32_bf16 v[160:163], a[72:75], a[136:139], v[160:163]
  ds_read_b64_tr_b16 a[46:47], v227 offset:57600
  v_mul_f32 v193, s39, v193
  v_mfma_f32_16x16x32_bf16 v[164:167], a[72:75], a[168:171], v[164:167]
  v_exp_f32 v192, v192
  v_mfma_f32_16x16x32_bf16 v[160:163], a[76:79], a[140:143], v[160:163]
  ds_read_b64_tr_b16 a[52:53], v229 offset:49408
  v_mul_f32 v194, s39, v194
  v_mfma_f32_16x16x32_bf16 v[164:167], a[76:79], a[172:175], v[164:167]
  v_exp_f32 v193, v193
  v_mfma_f32_16x16x32_bf16 v[160:163], a[80:83], a[144:147], v[160:163]
  ds_read_b64_tr_b16 a[54:55], v229 offset:57600
  v_mul_f32 v195, s39, v195
  v_mfma_f32_16x16x32_bf16 v[164:167], a[80:83], a[176:179], v[164:167]
  ds_read_b64_tr_b16 a[56:57], v230 offset:49408
  v_cvt_pk_bf16_f32 v212, v192, v193
  v_mfma_f32_16x16x32_bf16 v[160:163], a[84:87], a[148:151], v[160:163]
  v_exp_f32 v194, v194
  v_mfma_f32_16x16x32_bf16 v[164:167], a[84:87], a[180:183], v[164:167]
  ds_read_b64_tr_b16 a[58:59], v230 offset:57600
  v_cvt_pk_bf16_f32 v209, v182, v183
  v_mfma_f32_16x16x32_bf16 v[160:163], a[88:91], a[152:155], v[160:163]
  v_exp_f32 v195, v195
  v_mfma_f32_16x16x32_bf16 v[164:167], a[88:91], a[184:187], v[164:167]
  ds_read_b64_tr_b16 a[60:61], v231 offset:49408
  v_cvt_pk_bf16_f32 v213, v194, v195
  v_mfma_f32_16x16x32_bf16 v[160:163], a[92:95], a[156:159], v[160:163]
  buffer_load_dwordx4 v237, s[24:27], s36 offen offset:1024 nt lds
  v_mfma_f32_16x16x32_bf16 v[164:167], a[92:95], a[188:191], v[164:167]
  ds_write_b64 v240, v[212:213] offset:0
  v_add_f32 v215, v215, v181
  v_mfma_f32_16x16x32_bf16 v[168:171], a[96:99], a[128:131], v[242:245]
  v_exp_f32 v188, v188
  v_mfma_f32_16x16x32_bf16 v[172:175], a[96:99], a[160:163], v[246:249]
  ds_read_b64_tr_b16 a[62:63], v231 offset:57600
  v_add_f32 v215, v215, v182
  v_mfma_f32_16x16x32_bf16 v[168:171], a[100:103], a[132:135], v[168:171]
  ds_read_b64_tr_b16 a[0:1], v224 offset:49152
  v_add_f32 v215, v215, v183
  v_mfma_f32_16x16x32_bf16 v[172:175], a[100:103], a[164:167], v[172:175]
  ds_read_b64_tr_b16 a[2:3], v224 offset:57344
  v_add_f32 v215, v215, v188
  v_mfma_f32_16x16x32_bf16 v[168:171], a[104:107], a[136:139], v[168:171]
  v_exp_f32 v189, v189
  v_mfma_f32_16x16x32_bf16 v[172:175], a[104:107], a[168:171], v[172:175]
  ds_read_b64_tr_b16 a[16:17], v228 offset:49152
  v_cvt_pk_bf16_f32 v210, v188, v189
  v_mfma_f32_16x16x32_bf16 v[168:171], a[108:111], a[140:143], v[168:171]
  ds_read_b64_tr_b16 a[18:19], v228 offset:57344
  v_add_f32 v215, v215, v189
  v_mfma_f32_16x16x32_bf16 v[172:175], a[108:111], a[172:175], v[172:175]
  ds_read_b64_tr_b16 a[32:33], v224 offset:49408
  v_add_f32 v216, v216, v192
  v_mfma_f32_16x16x32_bf16 v[168:171], a[112:115], a[144:147], v[168:171]
  ds_read_b64_tr_b16 a[34:35], v224 offset:57600
  v_add_f32 v216, v216, v193
  v_mfma_f32_16x16x32_bf16 v[172:175], a[112:115], a[176:179], v[172:175]
  ds_read_b64_tr_b16 a[48:49], v228 offset:49408
  v_add_f32 v216, v216, v194
  v_mfma_f32_16x16x32_bf16 v[168:171], a[116:119], a[148:151], v[168:171]
  ds_read_b64_tr_b16 a[50:51], v228 offset:57600
  v_add_f32 v216, v216, v195
  v_mfma_f32_16x16x32_bf16 v[172:175], a[116:119], a[180:183], v[172:175]
  buffer_load_dwordx4 v238, s[24:27], s36 offen offset:2048 nt lds
  v_mfma_f32_16x16x32_bf16 v[168:171], a[120:123], a[152:155], v[168:171]
  v_exp_f32 v190, v190
  v_mfma_f32_16x16x32_bf16 v[172:175], a[120:123], a[184:187], v[172:175]
  buffer_load_dwordx4 v239, s[24:27], s36 offen offset:3072 nt lds
  v_mfma_f32_16x16x32_bf16 v[168:171], a[124:127], a[156:159], v[168:171]
  v_exp_f32 v191, v191
  v_mfma_f32_16x16x32_bf16 v[172:175], a[124:127], a[188:191], v[172:175]
  v_cvt_pk_bf16_f32 v211, v190, v191
  v_add_f32 v215, v215, v190
  v_add_f32 v215, v215, v191
  s_waitcnt vmcnt(16) lgkmcnt(0)
  s_barrier
  v_mfma_f32_16x16x32_bf16 v[8:11], a[4:7], v[204:207], v[8:11]
  ds_read_b128 a[96:99], v220 offset:24576
  v_mul_f32 v160, s39, v160
  v_mfma_f32_16x16x32_bf16 v[12:15], a[4:7], v[208:211], v[12:15]
  v_exp_f32 v160, v160
  v_mfma_f32_16x16x32_bf16 v[16:19], a[8:11], v[204:207], v[16:19]
  ds_read_b128 a[100:103], v221 offset:24576
  v_mul_f32 v161, s39, v161
  v_mfma_f32_16x16x32_bf16 v[20:23], a[8:11], v[208:211], v[20:23]
  ds_read_b128 a[104:107], v222 offset:24576
  v_mul_f32 v162, s39, v162
  v_mfma_f32_16x16x32_bf16 v[24:27], a[12:15], v[204:207], v[24:27]
  ds_read_b128 a[108:111], v223 offset:24576
  s_add_u32 s36, s36, 16384
  v_mfma_f32_16x16x32_bf16 v[28:31], a[12:15], v[208:211], v[28:31]
  v_exp_f32 v161, v161
  v_mfma_f32_16x16x32_bf16 v[40:43], a[20:23], v[204:207], v[40:43]
  ds_read_b128 a[112:115], v220 offset:24832
  s_add_u32 m0, s38, 0
  v_mfma_f32_16x16x32_bf16 v[44:47], a[20:23], v[208:211], v[44:47]
  ds_read_b128 a[116:119], v221 offset:24832
  v_mul_f32 v163, s39, v163
  v_mfma_f32_16x16x32_bf16 v[48:51], a[24:27], v[204:207], v[48:51]
  ds_read_b128 a[120:123], v222 offset:24832
  v_mul_f32 v168, s39, v168
  v_mfma_f32_16x16x32_bf16 v[52:55], a[24:27], v[208:211], v[52:55]
  v_exp_f32 v162, v162
  v_mfma_f32_16x16x32_bf16 v[56:59], a[28:31], v[204:207], v[56:59]
  ds_read_b128 a[124:127], v223 offset:24832
  v_mul_f32 v169, s39, v169
  v_mfma_f32_16x16x32_bf16 v[60:63], a[28:31], v[208:211], v[60:63]
  buffer_load_dwordx4 v232, s[20:23], s36 offen offset:0 nt lds
  v_mfma_f32_16x16x32_bf16 v[72:75], a[36:39], v[204:207], v[72:75]
  ds_read_b64_tr_b16 a[4:5], v225 offset:0
  v_mul_f32 v170, s39, v170
  v_mfma_f32_16x16x32_bf16 v[76:79], a[36:39], v[208:211], v[76:79]
  ds_read_b128 a[224:227], v241 offset:0
  v_mul_f32 v171, s39, v171
  v_mfma_f32_16x16x32_bf16 v[80:83], a[40:43], v[204:207], v[80:83]
  v_exp_f32 v163, v163
  v_mfma_f32_16x16x32_bf16 v[84:87], a[40:43], v[208:211], v[84:87]
  ds_read_b128 a[64:67], v220 offset:16384
  v_mul_f32 v164, s39, v164
  v_mfma_f32_16x16x32_bf16 v[88:91], a[44:47], v[204:207], v[88:91]
  ds_read_b64_tr_b16 a[6:7], v225 offset:8192
  v_mul_f32 v165, s39, v165
  v_mfma_f32_16x16x32_bf16 v[92:95], a[44:47], v[208:211], v[92:95]
  ds_read_b128 a[68:71], v221 offset:16384
  v_mul_f32 v166, s39, v166
  v_mfma_f32_16x16x32_bf16 v[104:107], a[52:55], v[204:207], v[104:107]
  v_exp_f32 v168, v168
  v_mfma_f32_16x16x32_bf16 v[108:111], a[52:55], v[208:211], v[108:111]
  ds_read_b128 a[72:75], v222 offset:16384
  v_mul_f32 v167, s39, v167
  v_mfma_f32_16x16x32_bf16 v[112:115], a[56:59], v[204:207], v[112:115]
  buffer_load_dwordx4 v233, s[20:23], s36 offen offset:1024 nt lds
  v_mfma_f32_16x16x32_bf16 v[116:119], a[56:59], v[208:211], v[116:119]
  ds_read_b128 a[76:79], v223 offset:16384
  v_mul_f32 v172, s39, v172
  v_mfma_f32_16x16x32_bf16 v[120:123], a[60:63], v[204:207], v[120:123]
  ds_read_b128 a[228:231], v241 offset:1024
  v_mul_f32 v173, s39, v173
  v_mfma_f32_16x16x32_bf16 v[124:127], a[60:63], v[208:211], v[124:127]
  v_exp_f32 v169, v169
  v_mfma_f32_16x16x32_bf16 v[0:3], a[0:3], v[204:207], v[0:3]
  ds_read_b128 a[80:83], v220 offset:16640
  v_mul_f32 v174, s39, v174
  v_mfma_f32_16x16x32_bf16 v[4:7], a[0:3], v[208:211], v[4:7]
  ds_read_b64_tr_b16 a[8:9], v226 offset:0
  v_mul_f32 v175, s39, v175
  v_mfma_f32_16x16x32_bf16 v[128:131], a[0:3], a[232:235], v[128:131]
  ds_read_b128 a[84:87], v221 offset:16640
  v_cvt_pk_bf16_f32 v196, v160, v161
  v_mfma_f32_16x16x32_bf16 v[132:135], a[0:3], a[236:239], v[132:135]
  v_exp_f32 v170, v170
  v_mfma_f32_16x16x32_bf16 v[32:35], a[16:19], v[204:207], v[32:35]
  ds_read_b128 a[88:91], v222 offset:16640
  v_cvt_pk_bf16_f32 v197, v162, v163
  v_mfma_f32_16x16x32_bf16 v[36:39], a[16:19], v[208:211], v[36:39]
  buffer_load_dwordx4 v234, s[20:23], s36 offen offset:2048 nt lds
  v_mfma_f32_16x16x32_bf16 v[136:139], a[16:19], a[232:235], v[136:139]
  ds_read_b128 a[92:95], v223 offset:16640
  v_cvt_pk_bf16_f32 v198, v168, v169
  v_mfma_f32_16x16x32_bf16 v[140:143], a[16:19], a[236:239], v[140:143]
  ds_read_b64_tr_b16 a[10:11], v226 offset:8192
  v_add_f32 v214, v214, v160
  v_mfma_f32_16x16x32_bf16 v[64:67], a[32:35], v[204:207], v[64:67]
  v_exp_f32 v171, v171
  v_mfma_f32_16x16x32_bf16 v[68:71], a[32:35], v[208:211], v[68:71]
  ds_read_b64_tr_b16 a[12:13], v227 offset:0
  v_cvt_pk_bf16_f32 v199, v170, v171
  v_mfma_f32_16x16x32_bf16 v[144:147], a[32:35], a[232:235], v[144:147]
  ds_read_b64_tr_b16 a[14:15], v227 offset:8192
  v_add_f32 v214, v214, v161
  v_mfma_f32_16x16x32_bf16 v[148:151], a[32:35], a[236:239], v[148:151]
  ds_read_b64_tr_b16 a[20:21], v229 offset:0
  v_add_f32 v214, v214, v162
  v_mfma_f32_16x16x32_bf16 v[96:99], a[48:51], v[204:207], v[96:99]
  v_exp_f32 v164, v164
  v_mfma_f32_16x16x32_bf16 v[100:103], a[48:51], v[208:211], v[100:103]
  ds_read_b64_tr_b16 a[22:23], v229 offset:8192
  v_add_f32 v214, v214, v163
  v_mfma_f32_16x16x32_bf16 v[152:155], a[48:51], a[232:235], v[152:155]
  buffer_load_dwordx4 v235, s[20:23], s36 offen offset:3072 nt lds
  v_mfma_f32_16x16x32_bf16 v[156:159], a[48:51], a[236:239], v[156:159]
  ds_read_b64_tr_b16 a[24:25], v230 offset:0
  s_waitcnt lgkmcnt(6)
  v_mfma_f32_16x16x32_bf16 v[192:195], a[96:99], a[192:195], v[250:253]
  ds_read_b64_tr_b16 a[26:27], v230 offset:8192
  s_add_u32 m0, s38, 114688
  v_mfma_f32_16x16x32_bf16 v[192:195], a[100:103], a[196:199], v[192:195]
  v_exp_f32 v165, v165
  v_mfma_f32_16x16x32_bf16 v[192:195], a[104:107], a[200:203], v[192:195]
  ds_read_b64_tr_b16 a[28:29], v231 offset:0
  v_cvt_pk_bf16_f32 v200, v164, v165
  v_mfma_f32_16x16x32_bf16 v[192:195], a[108:111], a[204:207], v[192:195]
  ds_read_b64_tr_b16 a[30:31], v231 offset:8192
  v_add_f32 v214, v214, v168
  v_mfma_f32_16x16x32_bf16 v[192:195], a[112:115], a[208:211], v[192:195]
  ds_read_b64_tr_b16 a[36:37], v225 offset:256
  v_add_f32 v214, v214, v169
  v_mfma_f32_16x16x32_bf16 v[192:195], a[116:119], a[212:215], v[192:195]
  ds_read_b64_tr_b16 a[38:39], v225 offset:8448
  v_add_f32 v214, v214, v170
  v_mfma_f32_16x16x32_bf16 v[192:195], a[120:123], a[216:219], v[192:195]
  v_exp_f32 v166, v166
  v_mfma_f32_16x16x32_bf16 v[192:195], a[124:127], a[220:223], v[192:195]
  ds_read_b64_tr_b16 a[40:41], v226 offset:256
  v_add_f32 v214, v214, v171
  v_mfma_f32_16x16x32_bf16 v[176:179], a[64:67], a[128:131], v[242:245]
  buffer_load_dwordx4 v236, s[24:27], s36 offen offset:0 nt lds
  v_mfma_f32_16x16x32_bf16 v[180:183], a[64:67], a[160:163], v[246:249]
  ds_read_b64_tr_b16 a[42:43], v226 offset:8448
  v_add_f32 v215, v215, v164
  v_mfma_f32_16x16x32_bf16 v[176:179], a[68:71], a[132:135], v[176:179]
  v_exp_f32 v167, v167
  v_mfma_f32_16x16x32_bf16 v[180:183], a[68:71], a[164:167], v[180:183]
  ds_read_b64_tr_b16 a[44:45], v227 offset:256
  v_mul_f32 v192, s39, v192
  v_mfma_f32_16x16x32_bf16 v[176:179], a[72:75], a[136:139], v[176:179]
  ds_read_b64_tr_b16 a[46:47], v227 offset:8448
  v_mul_f32 v193, s39, v193
  v_mfma_f32_16x16x32_bf16 v[180:183], a[72:75], a[168:171], v[180:183]
  v_exp_f32 v192, v192
  v_mfma_f32_16x16x32_bf16 v[176:179], a[76:79], a[140:143], v[176:179]
  ds_read_b64_tr_b16 a[52:53], v229 offset:256
  v_mul_f32 v194, s39, v194
  v_mfma_f32_16x16x32_bf16 v[180:183], a[76:79], a[172:175], v[180:183]
  v_exp_f32 v193, v193
  v_mfma_f32_16x16x32_bf16 v[176:179], a[80:83], a[144:147], v[176:179]
  ds_read_b64_tr_b16 a[54:55], v229 offset:8448
  v_mul_f32 v195, s39, v195
  v_mfma_f32_16x16x32_bf16 v[180:183], a[80:83], a[176:179], v[180:183]
  ds_read_b64_tr_b16 a[56:57], v230 offset:256
  v_cvt_pk_bf16_f32 v212, v192, v193
  v_mfma_f32_16x16x32_bf16 v[176:179], a[84:87], a[148:151], v[176:179]
  v_exp_f32 v194, v194
  v_mfma_f32_16x16x32_bf16 v[180:183], a[84:87], a[180:183], v[180:183]
  ds_read_b64_tr_b16 a[58:59], v230 offset:8448
  v_cvt_pk_bf16_f32 v201, v166, v167
  v_mfma_f32_16x16x32_bf16 v[176:179], a[88:91], a[152:155], v[176:179]
  v_exp_f32 v195, v195
  v_mfma_f32_16x16x32_bf16 v[180:183], a[88:91], a[184:187], v[180:183]
  ds_read_b64_tr_b16 a[60:61], v231 offset:256
  v_cvt_pk_bf16_f32 v213, v194, v195
  v_mfma_f32_16x16x32_bf16 v[176:179], a[92:95], a[156:159], v[176:179]
  buffer_load_dwordx4 v237, s[24:27], s36 offen offset:1024 nt lds
  v_mfma_f32_16x16x32_bf16 v[180:183], a[92:95], a[188:191], v[180:183]
  ds_write_b64 v240, v[212:213] offset:2048
  v_add_f32 v215, v215, v165
  v_mfma_f32_16x16x32_bf16 v[184:187], a[96:99], a[128:131], v[242:245]
  v_exp_f32 v172, v172
  v_mfma_f32_16x16x32_bf16 v[188:191], a[96:99], a[160:163], v[246:249]
  ds_read_b64_tr_b16 a[62:63], v231 offset:8448
  v_add_f32 v215, v215, v166
  v_mfma_f32_16x16x32_bf16 v[184:187], a[100:103], a[132:135], v[184:187]
  ds_read_b64_tr_b16 a[0:1], v224 offset:0
  v_add_f32 v215, v215, v167
  v_mfma_f32_16x16x32_bf16 v[188:191], a[100:103], a[164:167], v[188:191]
  ds_read_b64_tr_b16 a[2:3], v224 offset:8192
  v_add_f32 v215, v215, v172
  v_mfma_f32_16x16x32_bf16 v[184:187], a[104:107], a[136:139], v[184:187]
  v_exp_f32 v173, v173
  v_mfma_f32_16x16x32_bf16 v[188:191], a[104:107], a[168:171], v[188:191]
  ds_read_b64_tr_b16 a[16:17], v228 offset:0
  v_cvt_pk_bf16_f32 v202, v172, v173
  v_mfma_f32_16x16x32_bf16 v[184:187], a[108:111], a[140:143], v[184:187]
  ds_read_b64_tr_b16 a[18:19], v228 offset:8192
  v_add_f32 v215, v215, v173
  v_mfma_f32_16x16x32_bf16 v[188:191], a[108:111], a[172:175], v[188:191]
  ds_read_b64_tr_b16 a[32:33], v224 offset:256
  v_add_f32 v216, v216, v192
  v_mfma_f32_16x16x32_bf16 v[184:187], a[112:115], a[144:147], v[184:187]
  ds_read_b64_tr_b16 a[34:35], v224 offset:8448
  v_add_f32 v216, v216, v193
  v_mfma_f32_16x16x32_bf16 v[188:191], a[112:115], a[176:179], v[188:191]
  ds_read_b64_tr_b16 a[48:49], v228 offset:256
  v_add_f32 v216, v216, v194
  v_mfma_f32_16x16x32_bf16 v[184:187], a[116:119], a[148:151], v[184:187]
  ds_read_b64_tr_b16 a[50:51], v228 offset:8448
  v_add_f32 v216, v216, v195
  v_mfma_f32_16x16x32_bf16 v[188:191], a[116:119], a[180:183], v[188:191]
  buffer_load_dwordx4 v238, s[24:27], s36 offen offset:2048 nt lds
  v_mfma_f32_16x16x32_bf16 v[184:187], a[120:123], a[152:155], v[184:187]
  v_exp_f32 v174, v174
  v_mfma_f32_16x16x32_bf16 v[188:191], a[120:123], a[184:187], v[188:191]
  buffer_load_dwordx4 v239, s[24:27], s36 offen offset:3072 nt lds
  v_mfma_f32_16x16x32_bf16 v[184:187], a[124:127], a[156:159], v[184:187]
  v_exp_f32 v175, v175
  v_mfma_f32_16x16x32_bf16 v[188:191], a[124:127], a[188:191], v[188:191]
  v_cvt_pk_bf16_f32 v203, v174, v175
  v_add_f32 v215, v215, v174
  v_add_f32 v215, v215, v175
  s_waitcnt vmcnt(16) lgkmcnt(0)
  s_barrier
  v_mfma_f32_16x16x32_bf16 v[8:11], a[4:7], v[196:199], v[8:11]
  ds_read_b128 a[96:99], v220 offset:40960
  v_mul_f32 v176, s39, v176
  v_mfma_f32_16x16x32_bf16 v[12:15], a[4:7], v[200:203], v[12:15]
  v_exp_f32 v176, v176
  v_mfma_f32_16x16x32_bf16 v[16:19], a[8:11], v[196:199], v[16:19]
  ds_read_b128 a[100:103], v221 offset:40960
  v_mul_f32 v177, s39, v177
  v_mfma_f32_16x16x32_bf16 v[20:23], a[8:11], v[200:203], v[20:23]
  ds_read_b128 a[104:107], v222 offset:40960
  v_mul_f32 v178, s39, v178
  v_mfma_f32_16x16x32_bf16 v[24:27], a[12:15], v[196:199], v[24:27]
  ds_read_b128 a[108:111], v223 offset:40960
  s_add_u32 s36, s36, 16384
  v_mfma_f32_16x16x32_bf16 v[28:31], a[12:15], v[200:203], v[28:31]
  v_exp_f32 v177, v177
  v_mfma_f32_16x16x32_bf16 v[40:43], a[20:23], v[196:199], v[40:43]
  ds_read_b128 a[112:115], v220 offset:41216
  s_add_u32 m0, s38, 16384
  v_mfma_f32_16x16x32_bf16 v[44:47], a[20:23], v[200:203], v[44:47]
  ds_read_b128 a[116:119], v221 offset:41216
  v_mul_f32 v179, s39, v179
  v_mfma_f32_16x16x32_bf16 v[48:51], a[24:27], v[196:199], v[48:51]
  ds_read_b128 a[120:123], v222 offset:41216
  v_mul_f32 v184, s39, v184
  v_mfma_f32_16x16x32_bf16 v[52:55], a[24:27], v[200:203], v[52:55]
  v_exp_f32 v178, v178
  v_mfma_f32_16x16x32_bf16 v[56:59], a[28:31], v[196:199], v[56:59]
  ds_read_b128 a[124:127], v223 offset:41216
  v_mul_f32 v185, s39, v185
  v_mfma_f32_16x16x32_bf16 v[60:63], a[28:31], v[200:203], v[60:63]
  buffer_load_dwordx4 v232, s[20:23], s36 offen offset:0 nt lds
  v_mfma_f32_16x16x32_bf16 v[72:75], a[36:39], v[196:199], v[72:75]
  ds_read_b64_tr_b16 a[4:5], v225 offset:16384
  v_mul_f32 v186, s39, v186
  v_mfma_f32_16x16x32_bf16 v[76:79], a[36:39], v[200:203], v[76:79]
  ds_read_b128 a[232:235], v241 offset:2048
  v_mul_f32 v187, s39, v187
  v_mfma_f32_16x16x32_bf16 v[80:83], a[40:43], v[196:199], v[80:83]
  v_exp_f32 v179, v179
  v_mfma_f32_16x16x32_bf16 v[84:87], a[40:43], v[200:203], v[84:87]
  ds_read_b128 a[64:67], v220 offset:32768
  v_mul_f32 v180, s39, v180
  v_mfma_f32_16x16x32_bf16 v[88:91], a[44:47], v[196:199], v[88:91]
  ds_read_b64_tr_b16 a[6:7], v225 offset:24576
  v_mul_f32 v181, s39, v181
  v_mfma_f32_16x16x32_bf16 v[92:95], a[44:47], v[200:203], v[92:95]
  ds_read_b128 a[68:71], v221 offset:32768
  v_mul_f32 v182, s39, v182
  v_mfma_f32_16x16x32_bf16 v[104:107], a[52:55], v[196:199], v[104:107]
  v_exp_f32 v184, v184
  v_mfma_f32_16x16x32_bf16 v[108:111], a[52:55], v[200:203], v[108:111]
  ds_read_b128 a[72:75], v222 offset:32768
  v_mul_f32 v183, s39, v183
  v_mfma_f32_16x16x32_bf16 v[112:115], a[56:59], v[196:199], v[112:115]
  buffer_load_dwordx4 v233, s[20:23], s36 offen offset:1024 nt lds
  v_mfma_f32_16x16x32_bf16 v[116:119], a[56:59], v[200:203], v[116:119]
  ds_read_b128 a[76:79], v223 offset:32768
  v_mul_f32 v188, s39, v188
  v_mfma_f32_16x16x32_bf16 v[120:123], a[60:63], v[196:199], v[120:123]
  ds_read_b128 a[236:239], v241 offset:3072
  v_mul_f32 v189, s39, v189
  v_mfma_f32_16x16x32_bf16 v[124:127], a[60:63], v[200:203], v[124:127]
  v_exp_f32 v185, v185
  v_mfma_f32_16x16x32_bf16 v[0:3], a[0:3], v[196:199], v[0:3]
  ds_read_b128 a[80:83], v220 offset:33024
  v_mul_f32 v190, s39, v190
  v_mfma_f32_16x16x32_bf16 v[4:7], a[0:3], v[200:203], v[4:7]
  ds_read_b64_tr_b16 a[8:9], v226 offset:16384
  v_mul_f32 v191, s39, v191
  v_mfma_f32_16x16x32_bf16 v[128:131], a[0:3], a[224:227], v[128:131]
  ds_read_b128 a[84:87], v221 offset:33024
  v_cvt_pk_bf16_f32 v204, v176, v177
  v_mfma_f32_16x16x32_bf16 v[132:135], a[0:3], a[228:231], v[132:135]
  v_exp_f32 v186, v186
  v_mfma_f32_16x16x32_bf16 v[32:35], a[16:19], v[196:199], v[32:35]
  ds_read_b128 a[88:91], v222 offset:33024
  v_cvt_pk_bf16_f32 v205, v178, v179
  v_mfma_f32_16x16x32_bf16 v[36:39], a[16:19], v[200:203], v[36:39]
  buffer_load_dwordx4 v234, s[20:23], s36 offen offset:2048 nt lds
  v_mfma_f32_16x16x32_bf16 v[136:139], a[16:19], a[224:227], v[136:139]
  ds_read_b128 a[92:95], v223 offset:33024
  v_cvt_pk_bf16_f32 v206, v184, v185
  v_mfma_f32_16x16x32_bf16 v[140:143], a[16:19], a[228:231], v[140:143]
  ds_read_b64_tr_b16 a[10:11], v226 offset:24576
  v_add_f32 v214, v214, v176
  v_mfma_f32_16x16x32_bf16 v[64:67], a[32:35], v[196:199], v[64:67]
  v_exp_f32 v187, v187
  v_mfma_f32_16x16x32_bf16 v[68:71], a[32:35], v[200:203], v[68:71]
  ds_read_b64_tr_b16 a[12:13], v227 offset:16384
  v_cvt_pk_bf16_f32 v207, v186, v187
  v_mfma_f32_16x16x32_bf16 v[144:147], a[32:35], a[224:227], v[144:147]
  ds_read_b64_tr_b16 a[14:15], v227 offset:24576
  v_add_f32 v214, v214, v177
  v_mfma_f32_16x16x32_bf16 v[148:151], a[32:35], a[228:231], v[148:151]
  ds_read_b64_tr_b16 a[20:21], v229 offset:16384
  v_add_f32 v214, v214, v178
  v_mfma_f32_16x16x32_bf16 v[96:99], a[48:51], v[196:199], v[96:99]
  v_exp_f32 v180, v180
  v_mfma_f32_16x16x32_bf16 v[100:103], a[48:51], v[200:203], v[100:103]
  ds_read_b64_tr_b16 a[22:23], v229 offset:24576
  v_add_f32 v214, v214, v179
  v_mfma_f32_16x16x32_bf16 v[152:155], a[48:51], a[224:227], v[152:155]
  buffer_load_dwordx4 v235, s[20:23], s36 offen offset:3072 nt lds
  v_mfma_f32_16x16x32_bf16 v[156:159], a[48:51], a[228:231], v[156:159]
  ds_read_b64_tr_b16 a[24:25], v230 offset:16384
  s_waitcnt lgkmcnt(6)
  s_add_u32 s40, s40, 1
  s_cmp_lt_u32 s40, 7
  s_cbranch_scc1 L_loop_k1q1p1
  v_mfma_f32_16x16x32_bf16 v[192:195], a[96:99], a[192:195], v[250:253]
  ds_read_b64_tr_b16 a[26:27], v230 offset:24576
  v_mfma_f32_16x16x32_bf16 v[192:195], a[100:103], a[196:199], v[192:195]
  v_exp_f32 v181, v181
  v_mfma_f32_16x16x32_bf16 v[192:195], a[104:107], a[200:203], v[192:195]
  ds_read_b64_tr_b16 a[28:29], v231 offset:16384
  v_cvt_pk_bf16_f32 v208, v180, v181
  v_mfma_f32_16x16x32_bf16 v[192:195], a[108:111], a[204:207], v[192:195]
  ds_read_b64_tr_b16 a[30:31], v231 offset:24576
  v_add_f32 v214, v214, v184
  v_mfma_f32_16x16x32_bf16 v[192:195], a[112:115], a[208:211], v[192:195]
  ds_read_b64_tr_b16 a[36:37], v225 offset:16640
  v_add_f32 v214, v214, v185
  v_mfma_f32_16x16x32_bf16 v[192:195], a[116:119], a[212:215], v[192:195]
  ds_read_b64_tr_b16 a[38:39], v225 offset:24832
  v_add_f32 v214, v214, v186
  v_mfma_f32_16x16x32_bf16 v[192:195], a[120:123], a[216:219], v[192:195]
  v_exp_f32 v182, v182
  v_mfma_f32_16x16x32_bf16 v[192:195], a[124:127], a[220:223], v[192:195]
  ds_read_b64_tr_b16 a[40:41], v226 offset:16640
  v_add_f32 v214, v214, v187
  v_mfma_f32_16x16x32_bf16 v[160:163], a[64:67], a[128:131], v[242:245]
  v_mfma_f32_16x16x32_bf16 v[164:167], a[64:67], a[160:163], v[246:249]
  ds_read_b64_tr_b16 a[42:43], v226 offset:24832
  v_add_f32 v215, v215, v180
  v_mfma_f32_16x16x32_bf16 v[160:163], a[68:71], a[132:135], v[160:163]
  v_exp_f32 v183, v183
  v_mfma_f32_16x16x32_bf16 v[164:167], a[68:71], a[164:167], v[164:167]
  ds_read_b64_tr_b16 a[44:45], v227 offset:16640
  v_mul_f32 v192, s39, v192
  v_mfma_f32_16x16x32_bf16 v[160:163], a[72:75], a[136:139], v[160:163]
  ds_read_b64_tr_b16 a[46:47], v227 offset:24832
  v_mul_f32 v193, s39, v193
  v_mfma_f32_16x16x32_bf16 v[164:167], a[72:75], a[168:171], v[164:167]
  v_exp_f32 v192, v192
  v_mfma_f32_16x16x32_bf16 v[160:163], a[76:79], a[140:143], v[160:163]
  ds_read_b64_tr_b16 a[52:53], v229 offset:16640
  v_mul_f32 v194, s39, v194
  v_mfma_f32_16x16x32_bf16 v[164:167], a[76:79], a[172:175], v[164:167]
  v_exp_f32 v193, v193
  v_mfma_f32_16x16x32_bf16 v[160:163], a[80:83], a[144:147], v[160:163]
  ds_read_b64_tr_b16 a[54:55], v229 offset:24832
  v_mul_f32 v195, s39, v195
  v_mfma_f32_16x16x32_bf16 v[164:167], a[80:83], a[176:179], v[164:167]
  ds_read_b64_tr_b16 a[56:57], v230 offset:16640
  v_cvt_pk_bf16_f32 v212, v192, v193
  v_mfma_f32_16x16x32_bf16 v[160:163], a[84:87], a[148:151], v[160:163]
  v_exp_f32 v194, v194
  v_mfma_f32_16x16x32_bf16 v[164:167], a[84:87], a[180:183], v[164:167]
  ds_read_b64_tr_b16 a[58:59], v230 offset:24832
  v_cvt_pk_bf16_f32 v209, v182, v183
  v_mfma_f32_16x16x32_bf16 v[160:163], a[88:91], a[152:155], v[160:163]
  v_exp_f32 v195, v195
  v_mfma_f32_16x16x32_bf16 v[164:167], a[88:91], a[184:187], v[164:167]
  ds_read_b64_tr_b16 a[60:61], v231 offset:16640
  v_cvt_pk_bf16_f32 v213, v194, v195
  v_mfma_f32_16x16x32_bf16 v[160:163], a[92:95], a[156:159], v[160:163]
  v_mfma_f32_16x16x32_bf16 v[164:167], a[92:95], a[188:191], v[164:167]
  ds_write_b64 v240, v[212:213] offset:0
  v_add_f32 v215, v215, v181
  v_mfma_f32_16x16x32_bf16 v[168:171], a[96:99], a[128:131], v[242:245]
  v_exp_f32 v188, v188
  v_mfma_f32_16x16x32_bf16 v[172:175], a[96:99], a[160:163], v[246:249]
  ds_read_b64_tr_b16 a[62:63], v231 offset:24832
  v_add_f32 v215, v215, v182
  v_mfma_f32_16x16x32_bf16 v[168:171], a[100:103], a[132:135], v[168:171]
  ds_read_b64_tr_b16 a[0:1], v224 offset:16384
  v_add_f32 v215, v215, v183
  v_mfma_f32_16x16x32_bf16 v[172:175], a[100:103], a[164:167], v[172:175]
  ds_read_b64_tr_b16 a[2:3], v224 offset:24576
  v_add_f32 v215, v215, v188
  v_mfma_f32_16x16x32_bf16 v[168:171], a[104:107], a[136:139], v[168:171]
  v_exp_f32 v189, v189
  v_mfma_f32_16x16x32_bf16 v[172:175], a[104:107], a[168:171], v[172:175]
  ds_read_b64_tr_b16 a[16:17], v228 offset:16384
  v_cvt_pk_bf16_f32 v210, v188, v189
  v_mfma_f32_16x16x32_bf16 v[168:171], a[108:111], a[140:143], v[168:171]
  ds_read_b64_tr_b16 a[18:19], v228 offset:24576
  v_add_f32 v215, v215, v189
  v_mfma_f32_16x16x32_bf16 v[172:175], a[108:111], a[172:175], v[172:175]
  ds_read_b64_tr_b16 a[32:33], v224 offset:16640
  v_add_f32 v216, v216, v192
  v_mfma_f32_16x16x32_bf16 v[168:171], a[112:115], a[144:147], v[168:171]
  ds_read_b64_tr_b16 a[34:35], v224 offset:24832
  v_add_f32 v216, v216, v193
  v_mfma_f32_16x16x32_bf16 v[172:175], a[112:115], a[176:179], v[172:175]
  ds_read_b64_tr_b16 a[48:49], v228 offset:16640
  v_add_f32 v216, v216, v194
  v_mfma_f32_16x16x32_bf16 v[168:171], a[116:119], a[148:151], v[168:171]
  ds_read_b64_tr_b16 a[50:51], v228 offset:24832
  v_add_f32 v216, v216, v195
  v_mfma_f32_16x16x32_bf16 v[172:175], a[116:119], a[180:183], v[172:175]
  v_mfma_f32_16x16x32_bf16 v[168:171], a[120:123], a[152:155], v[168:171]
  v_exp_f32 v190, v190
  v_mfma_f32_16x16x32_bf16 v[172:175], a[120:123], a[184:187], v[172:175]
  v_mfma_f32_16x16x32_bf16 v[168:171], a[124:127], a[156:159], v[168:171]
  v_exp_f32 v191, v191
  v_mfma_f32_16x16x32_bf16 v[172:175], a[124:127], a[188:191], v[172:175]
  v_cvt_pk_bf16_f32 v211, v190, v191
  v_add_f32 v215, v215, v190
  v_add_f32 v215, v215, v191
  s_waitcnt vmcnt(12) lgkmcnt(0)
  s_barrier
  v_mfma_f32_16x16x32_bf16 v[8:11], a[4:7], v[204:207], v[8:11]
  ds_read_b128 a[96:99], v220 offset:57344
  v_mul_f32 v160, s39, v160
  v_mfma_f32_16x16x32_bf16 v[12:15], a[4:7], v[208:211], v[12:15]
  v_exp_f32 v160, v160
  v_mfma_f32_16x16x32_bf16 v[16:19], a[8:11], v[204:207], v[16:19]
  ds_read_b128 a[100:103], v221 offset:57344
  v_mul_f32 v161, s39, v161
  v_mfma_f32_16x16x32_bf16 v[20:23], a[8:11], v[208:211], v[20:23]
  ds_read_b128 a[104:107], v222 offset:57344
  v_mul_f32 v162, s39, v162
  v_mfma_f32_16x16x32_bf16 v[24:27], a[12:15], v[204:207], v[24:27]
  ds_read_b128 a[108:111], v223 offset:57344
  v_mfma_f32_16x16x32_bf16 v[28:31], a[12:15], v[208:211], v[28:31]
  v_exp_f32 v161, v161
  v_mfma_f32_16x16x32_bf16 v[40:43], a[20:23], v[204:207], v[40:43]
  ds_read_b128 a[112:115], v220 offset:57600
  v_mfma_f32_16x16x32_bf16 v[44:47], a[20:23], v[208:211], v[44:47]
  ds_read_b128 a[116:119], v221 offset:57600
  v_mul_f32 v163, s39, v163
  v_mfma_f32_16x16x32_bf16 v[48:51], a[24:27], v[204:207], v[48:51]
  ds_read_b128 a[120:123], v222 offset:57600
  v_mul_f32 v168, s39, v168
  v_mfma_f32_16x16x32_bf16 v[52:55], a[24:27], v[208:211], v[52:55]
  v_exp_f32 v162, v162
  v_mfma_f32_16x16x32_bf16 v[56:59], a[28:31], v[204:207], v[56:59]
  ds_read_b128 a[124:127], v223 offset:57600
  v_mul_f32 v169, s39, v169
  v_mfma_f32_16x16x32_bf16 v[60:63], a[28:31], v[208:211], v[60:63]
  v_mfma_f32_16x16x32_bf16 v[72:75], a[36:39], v[204:207], v[72:75]
  ds_read_b64_tr_b16 a[4:5], v225 offset:32768
  v_mul_f32 v170, s39, v170
  v_mfma_f32_16x16x32_bf16 v[76:79], a[36:39], v[208:211], v[76:79]
  ds_read_b128 a[224:227], v241 offset:0
  v_mul_f32 v171, s39, v171
  v_mfma_f32_16x16x32_bf16 v[80:83], a[40:43], v[204:207], v[80:83]
  v_exp_f32 v163, v163
  v_mfma_f32_16x16x32_bf16 v[84:87], a[40:43], v[208:211], v[84:87]
  ds_read_b128 a[64:67], v220 offset:49152
  v_mul_f32 v164, s39, v164
  v_mfma_f32_16x16x32_bf16 v[88:91], a[44:47], v[204:207], v[88:91]
  ds_read_b64_tr_b16 a[6:7], v225 offset:40960
  v_mul_f32 v165, s39, v165
  v_mfma_f32_16x16x32_bf16 v[92:95], a[44:47], v[208:211], v[92:95]
  ds_read_b128 a[68:71], v221 offset:49152
  v_mul_f32 v166, s39, v166
  v_mfma_f32_16x16x32_bf16 v[104:107], a[52:55], v[204:207], v[104:107]
  v_exp_f32 v168, v168
  v_mfma_f32_16x16x32_bf16 v[108:111], a[52:55], v[208:211], v[108:111]
  ds_read_b128 a[72:75], v222 offset:49152
  v_mul_f32 v167, s39, v167
  v_mfma_f32_16x16x32_bf16 v[112:115], a[56:59], v[204:207], v[112:115]
  v_mfma_f32_16x16x32_bf16 v[116:119], a[56:59], v[208:211], v[116:119]
  ds_read_b128 a[76:79], v223 offset:49152
  v_mul_f32 v172, s39, v172
  v_mfma_f32_16x16x32_bf16 v[120:123], a[60:63], v[204:207], v[120:123]
  ds_read_b128 a[228:231], v241 offset:1024
  v_mul_f32 v173, s39, v173
  v_mfma_f32_16x16x32_bf16 v[124:127], a[60:63], v[208:211], v[124:127]
  v_exp_f32 v169, v169
  v_mfma_f32_16x16x32_bf16 v[0:3], a[0:3], v[204:207], v[0:3]
  ds_read_b128 a[80:83], v220 offset:49408
  v_mul_f32 v174, s39, v174
  v_mfma_f32_16x16x32_bf16 v[4:7], a[0:3], v[208:211], v[4:7]
  ds_read_b64_tr_b16 a[8:9], v226 offset:32768
  v_mul_f32 v175, s39, v175
  v_mfma_f32_16x16x32_bf16 v[128:131], a[0:3], a[232:235], v[128:131]
  ds_read_b128 a[84:87], v221 offset:49408
  v_cvt_pk_bf16_f32 v196, v160, v161
  v_mfma_f32_16x16x32_bf16 v[132:135], a[0:3], a[236:239], v[132:135]
  v_exp_f32 v170, v170
  v_mfma_f32_16x16x32_bf16 v[32:35], a[16:19], v[204:207], v[32:35]
  ds_read_b128 a[88:91], v222 offset:49408
  v_cvt_pk_bf16_f32 v197, v162, v163
  v_mfma_f32_16x16x32_bf16 v[36:39], a[16:19], v[208:211], v[36:39]
  v_mfma_f32_16x16x32_bf16 v[136:139], a[16:19], a[232:235], v[136:139]
  ds_read_b128 a[92:95], v223 offset:49408
  v_cvt_pk_bf16_f32 v198, v168, v169
  v_mfma_f32_16x16x32_bf16 v[140:143], a[16:19], a[236:239], v[140:143]
  ds_read_b64_tr_b16 a[10:11], v226 offset:40960
  v_add_f32 v214, v214, v160
  v_mfma_f32_16x16x32_bf16 v[64:67], a[32:35], v[204:207], v[64:67]
  v_exp_f32 v171, v171
  v_mfma_f32_16x16x32_bf16 v[68:71], a[32:35], v[208:211], v[68:71]
  ds_read_b64_tr_b16 a[12:13], v227 offset:32768
  v_cvt_pk_bf16_f32 v199, v170, v171
  v_mfma_f32_16x16x32_bf16 v[144:147], a[32:35], a[232:235], v[144:147]
  ds_read_b64_tr_b16 a[14:15], v227 offset:40960
  v_add_f32 v214, v214, v161
  v_mfma_f32_16x16x32_bf16 v[148:151], a[32:35], a[236:239], v[148:151]
  ds_read_b64_tr_b16 a[20:21], v229 offset:32768
  v_add_f32 v214, v214, v162
  v_mfma_f32_16x16x32_bf16 v[96:99], a[48:51], v[204:207], v[96:99]
  v_exp_f32 v164, v164
  v_mfma_f32_16x16x32_bf16 v[100:103], a[48:51], v[208:211], v[100:103]
  ds_read_b64_tr_b16 a[22:23], v229 offset:40960
  v_add_f32 v214, v214, v163
  v_mfma_f32_16x16x32_bf16 v[152:155], a[48:51], a[232:235], v[152:155]
  v_mfma_f32_16x16x32_bf16 v[156:159], a[48:51], a[236:239], v[156:159]
  ds_read_b64_tr_b16 a[24:25], v230 offset:32768
  s_waitcnt lgkmcnt(6)
  v_mfma_f32_16x16x32_bf16 v[192:195], a[96:99], a[192:195], v[250:253]
  ds_read_b64_tr_b16 a[26:27], v230 offset:40960
  v_mfma_f32_16x16x32_bf16 v[192:195], a[100:103], a[196:199], v[192:195]
  v_exp_f32 v165, v165
  v_mfma_f32_16x16x32_bf16 v[192:195], a[104:107], a[200:203], v[192:195]
  ds_read_b64_tr_b16 a[28:29], v231 offset:32768
  v_cvt_pk_bf16_f32 v200, v164, v165
  v_mfma_f32_16x16x32_bf16 v[192:195], a[108:111], a[204:207], v[192:195]
  ds_read_b64_tr_b16 a[30:31], v231 offset:40960
  v_add_f32 v214, v214, v168
  v_mfma_f32_16x16x32_bf16 v[192:195], a[112:115], a[208:211], v[192:195]
  ds_read_b64_tr_b16 a[36:37], v225 offset:33024
  v_add_f32 v214, v214, v169
  v_mfma_f32_16x16x32_bf16 v[192:195], a[116:119], a[212:215], v[192:195]
  ds_read_b64_tr_b16 a[38:39], v225 offset:41216
  v_add_f32 v214, v214, v170
  v_mfma_f32_16x16x32_bf16 v[192:195], a[120:123], a[216:219], v[192:195]
  v_exp_f32 v166, v166
  v_mfma_f32_16x16x32_bf16 v[192:195], a[124:127], a[220:223], v[192:195]
  ds_read_b64_tr_b16 a[40:41], v226 offset:33024
  v_add_f32 v214, v214, v171
  v_mfma_f32_16x16x32_bf16 v[176:179], a[64:67], a[128:131], v[242:245]
  v_mfma_f32_16x16x32_bf16 v[180:183], a[64:67], a[160:163], v[246:249]
  ds_read_b64_tr_b16 a[42:43], v226 offset:41216
  v_add_f32 v215, v215, v164
  v_mfma_f32_16x16x32_bf16 v[176:179], a[68:71], a[132:135], v[176:179]
  v_exp_f32 v167, v167
  v_mfma_f32_16x16x32_bf16 v[180:183], a[68:71], a[164:167], v[180:183]
  ds_read_b64_tr_b16 a[44:45], v227 offset:33024
  v_mul_f32 v192, s39, v192
  v_mfma_f32_16x16x32_bf16 v[176:179], a[72:75], a[136:139], v[176:179]
  ds_read_b64_tr_b16 a[46:47], v227 offset:41216
  v_mul_f32 v193, s39, v193
  v_mfma_f32_16x16x32_bf16 v[180:183], a[72:75], a[168:171], v[180:183]
  v_exp_f32 v192, v192
  v_mfma_f32_16x16x32_bf16 v[176:179], a[76:79], a[140:143], v[176:179]
  ds_read_b64_tr_b16 a[52:53], v229 offset:33024
  v_mul_f32 v194, s39, v194
  v_mfma_f32_16x16x32_bf16 v[180:183], a[76:79], a[172:175], v[180:183]
  v_exp_f32 v193, v193
  v_mfma_f32_16x16x32_bf16 v[176:179], a[80:83], a[144:147], v[176:179]
  ds_read_b64_tr_b16 a[54:55], v229 offset:41216
  v_mul_f32 v195, s39, v195
  v_mfma_f32_16x16x32_bf16 v[180:183], a[80:83], a[176:179], v[180:183]
  ds_read_b64_tr_b16 a[56:57], v230 offset:33024
  v_cvt_pk_bf16_f32 v212, v192, v193
  v_mfma_f32_16x16x32_bf16 v[176:179], a[84:87], a[148:151], v[176:179]
  v_exp_f32 v194, v194
  v_mfma_f32_16x16x32_bf16 v[180:183], a[84:87], a[180:183], v[180:183]
  ds_read_b64_tr_b16 a[58:59], v230 offset:41216
  v_cvt_pk_bf16_f32 v201, v166, v167
  v_mfma_f32_16x16x32_bf16 v[176:179], a[88:91], a[152:155], v[176:179]
  v_exp_f32 v195, v195
  v_mfma_f32_16x16x32_bf16 v[180:183], a[88:91], a[184:187], v[180:183]
  ds_read_b64_tr_b16 a[60:61], v231 offset:33024
  v_cvt_pk_bf16_f32 v213, v194, v195
  v_mfma_f32_16x16x32_bf16 v[176:179], a[92:95], a[156:159], v[176:179]
  v_mfma_f32_16x16x32_bf16 v[180:183], a[92:95], a[188:191], v[180:183]
  ds_write_b64 v240, v[212:213] offset:2048
  v_add_f32 v215, v215, v165
  v_mfma_f32_16x16x32_bf16 v[184:187], a[96:99], a[128:131], v[242:245]
  v_exp_f32 v172, v172
  v_mfma_f32_16x16x32_bf16 v[188:191], a[96:99], a[160:163], v[246:249]
  ds_read_b64_tr_b16 a[62:63], v231 offset:41216
  v_add_f32 v215, v215, v166
  v_mfma_f32_16x16x32_bf16 v[184:187], a[100:103], a[132:135], v[184:187]
  ds_read_b64_tr_b16 a[0:1], v224 offset:32768
  v_add_f32 v215, v215, v167
  v_mfma_f32_16x16x32_bf16 v[188:191], a[100:103], a[164:167], v[188:191]
  ds_read_b64_tr_b16 a[2:3], v224 offset:40960
  v_add_f32 v215, v215, v172
  v_mfma_f32_16x16x32_bf16 v[184:187], a[104:107], a[136:139], v[184:187]
  v_exp_f32 v173, v173
  v_mfma_f32_16x16x32_bf16 v[188:191], a[104:107], a[168:171], v[188:191]
  ds_read_b64_tr_b16 a[16:17], v228 offset:32768
  v_cvt_pk_bf16_f32 v202, v172, v173
  v_mfma_f32_16x16x32_bf16 v[184:187], a[108:111], a[140:143], v[184:187]
  ds_read_b64_tr_b16 a[18:19], v228 offset:40960
  v_add_f32 v215, v215, v173
  v_mfma_f32_16x16x32_bf16 v[188:191], a[108:111], a[172:175], v[188:191]
  ds_read_b64_tr_b16 a[32:33], v224 offset:33024
  v_add_f32 v216, v216, v192
  v_mfma_f32_16x16x32_bf16 v[184:187], a[112:115], a[144:147], v[184:187]
  ds_read_b64_tr_b16 a[34:35], v224 offset:41216
  v_add_f32 v216, v216, v193
  v_mfma_f32_16x16x32_bf16 v[188:191], a[112:115], a[176:179], v[188:191]
  ds_read_b64_tr_b16 a[48:49], v228 offset:33024
  v_add_f32 v216, v216, v194
  v_mfma_f32_16x16x32_bf16 v[184:187], a[116:119], a[148:151], v[184:187]
  ds_read_b64_tr_b16 a[50:51], v228 offset:41216
  v_add_f32 v216, v216, v195
  v_mfma_f32_16x16x32_bf16 v[188:191], a[116:119], a[180:183], v[188:191]
  v_mfma_f32_16x16x32_bf16 v[184:187], a[120:123], a[152:155], v[184:187]
  v_exp_f32 v174, v174
  v_mfma_f32_16x16x32_bf16 v[188:191], a[120:123], a[184:187], v[188:191]
  v_mfma_f32_16x16x32_bf16 v[184:187], a[124:127], a[156:159], v[184:187]
  v_exp_f32 v175, v175
  v_mfma_f32_16x16x32_bf16 v[188:191], a[124:127], a[188:191], v[188:191]
  v_cvt_pk_bf16_f32 v203, v174, v175
  v_add_f32 v215, v215, v174
  v_add_f32 v215, v215, v175
  s_waitcnt vmcnt(4) lgkmcnt(0)
  s_barrier
  v_mfma_f32_16x16x32_bf16 v[8:11], a[4:7], v[196:199], v[8:11]
  v_mul_f32 v176, s39, v176
  v_mfma_f32_16x16x32_bf16 v[12:15], a[4:7], v[200:203], v[12:15]
  ds_read_b64_tr_b16 a[4:5], v225 offset:49152
  v_exp_f32 v176, v176
  v_mfma_f32_16x16x32_bf16 v[16:19], a[8:11], v[196:199], v[16:19]
  ds_read_b64_tr_b16 a[6:7], v225 offset:57344
  v_mul_f32 v177, s39, v177
  v_mfma_f32_16x16x32_bf16 v[20:23], a[8:11], v[200:203], v[20:23]
  ds_read_b64_tr_b16 a[8:9], v226 offset:49152
  v_mul_f32 v178, s39, v178
  v_mfma_f32_16x16x32_bf16 v[24:27], a[12:15], v[196:199], v[24:27]
  ds_read_b64_tr_b16 a[10:11], v226 offset:57344
  v_mfma_f32_16x16x32_bf16 v[28:31], a[12:15], v[200:203], v[28:31]
  ds_read_b64_tr_b16 a[12:13], v227 offset:49152
  v_exp_f32 v177, v177
  v_mfma_f32_16x16x32_bf16 v[40:43], a[20:23], v[196:199], v[40:43]
  ds_read_b64_tr_b16 a[14:15], v227 offset:57344
  v_mfma_f32_16x16x32_bf16 v[44:47], a[20:23], v[200:203], v[44:47]
  ds_read_b64_tr_b16 a[20:21], v229 offset:49152
  v_mul_f32 v179, s39, v179
  v_mfma_f32_16x16x32_bf16 v[48:51], a[24:27], v[196:199], v[48:51]
  ds_read_b64_tr_b16 a[22:23], v229 offset:57344
  v_mul_f32 v184, s39, v184
  v_mfma_f32_16x16x32_bf16 v[52:55], a[24:27], v[200:203], v[52:55]
  ds_read_b64_tr_b16 a[24:25], v230 offset:49152
  v_exp_f32 v178, v178
  v_mfma_f32_16x16x32_bf16 v[56:59], a[28:31], v[196:199], v[56:59]
  ds_read_b64_tr_b16 a[26:27], v230 offset:57344
  v_mul_f32 v185, s39, v185
  v_mfma_f32_16x16x32_bf16 v[60:63], a[28:31], v[200:203], v[60:63]
  ds_read_b64_tr_b16 a[28:29], v231 offset:49152
  v_mfma_f32_16x16x32_bf16 v[72:75], a[36:39], v[196:199], v[72:75]
  ds_read_b64_tr_b16 a[30:31], v231 offset:57344
  v_mul_f32 v186, s39, v186
  v_mfma_f32_16x16x32_bf16 v[76:79], a[36:39], v[200:203], v[76:79]
  ds_read_b128 a[232:235], v241 offset:2048
  v_mul_f32 v187, s39, v187
  v_mfma_f32_16x16x32_bf16 v[80:83], a[40:43], v[196:199], v[80:83]
  ds_read_b64_tr_b16 a[36:37], v225 offset:49408
  v_exp_f32 v179, v179
  v_mfma_f32_16x16x32_bf16 v[84:87], a[40:43], v[200:203], v[84:87]
  ds_read_b64_tr_b16 a[38:39], v225 offset:57600
  v_mul_f32 v180, s39, v180
  v_mfma_f32_16x16x32_bf16 v[88:91], a[44:47], v[196:199], v[88:91]
  ds_read_b64_tr_b16 a[40:41], v226 offset:49408
  v_mul_f32 v181, s39, v181
  v_mfma_f32_16x16x32_bf16 v[92:95], a[44:47], v[200:203], v[92:95]
  ds_read_b64_tr_b16 a[42:43], v226 offset:57600
  v_mul_f32 v182, s39, v182
  v_mfma_f32_16x16x32_bf16 v[104:107], a[52:55], v[196:199], v[104:107]
  ds_read_b64_tr_b16 a[44:45], v227 offset:49408
  v_exp_f32 v184, v184
  v_mfma_f32_16x16x32_bf16 v[108:111], a[52:55], v[200:203], v[108:111]
  ds_read_b64_tr_b16 a[46:47], v227 offset:57600
  v_mul_f32 v183, s39, v183
  v_mfma_f32_16x16x32_bf16 v[112:115], a[56:59], v[196:199], v[112:115]
  ds_read_b64_tr_b16 a[52:53], v229 offset:49408
  v_mfma_f32_16x16x32_bf16 v[116:119], a[56:59], v[200:203], v[116:119]
  ds_read_b64_tr_b16 a[54:55], v229 offset:57600
  v_mul_f32 v188, s39, v188
  v_mfma_f32_16x16x32_bf16 v[120:123], a[60:63], v[196:199], v[120:123]
  ds_read_b128 a[236:239], v241 offset:3072
  v_mul_f32 v189, s39, v189
  v_mfma_f32_16x16x32_bf16 v[124:127], a[60:63], v[200:203], v[124:127]
  ds_read_b64_tr_b16 a[56:57], v230 offset:49408
  v_exp_f32 v185, v185
  v_mfma_f32_16x16x32_bf16 v[0:3], a[0:3], v[196:199], v[0:3]
  ds_read_b64_tr_b16 a[58:59], v230 offset:57600
  v_mul_f32 v190, s39, v190
  v_mfma_f32_16x16x32_bf16 v[4:7], a[0:3], v[200:203], v[4:7]
  ds_read_b64_tr_b16 a[60:61], v231 offset:49408
  v_mul_f32 v191, s39, v191
  v_mfma_f32_16x16x32_bf16 v[128:131], a[0:3], a[224:227], v[128:131]
  ds_read_b64_tr_b16 a[62:63], v231 offset:57600
  v_cvt_pk_bf16_f32 v204, v176, v177
  v_mfma_f32_16x16x32_bf16 v[132:135], a[0:3], a[228:231], v[132:135]
  ds_read_b64_tr_b16 a[0:1], v224 offset:49152
  v_exp_f32 v186, v186
  v_mfma_f32_16x16x32_bf16 v[32:35], a[16:19], v[196:199], v[32:35]
  ds_read_b64_tr_b16 a[2:3], v224 offset:57344
  v_cvt_pk_bf16_f32 v205, v178, v179
  v_mfma_f32_16x16x32_bf16 v[36:39], a[16:19], v[200:203], v[36:39]
  v_mfma_f32_16x16x32_bf16 v[136:139], a[16:19], a[224:227], v[136:139]
  v_cvt_pk_bf16_f32 v206, v184, v185
  v_mfma_f32_16x16x32_bf16 v[140:143], a[16:19], a[228:231], v[140:143]
  ds_read_b64_tr_b16 a[16:17], v228 offset:49152
  v_add_f32 v214, v214, v176
  v_mfma_f32_16x16x32_bf16 v[64:67], a[32:35], v[196:199], v[64:67]
  ds_read_b64_tr_b16 a[18:19], v228 offset:57344
  v_exp_f32 v187, v187
  v_mfma_f32_16x16x32_bf16 v[68:71], a[32:35], v[200:203], v[68:71]
  v_cvt_pk_bf16_f32 v207, v186, v187
  v_mfma_f32_16x16x32_bf16 v[144:147], a[32:35], a[224:227], v[144:147]
  v_add_f32 v214, v214, v177
  v_mfma_f32_16x16x32_bf16 v[148:151], a[32:35], a[228:231], v[148:151]
  ds_read_b64_tr_b16 a[32:33], v224 offset:49408
  v_add_f32 v214, v214, v178
  v_mfma_f32_16x16x32_bf16 v[96:99], a[48:51], v[196:199], v[96:99]
  ds_read_b64_tr_b16 a[34:35], v224 offset:57600
  v_exp_f32 v180, v180
  v_mfma_f32_16x16x32_bf16 v[100:103], a[48:51], v[200:203], v[100:103]
  v_add_f32 v214, v214, v179
  v_mfma_f32_16x16x32_bf16 v[152:155], a[48:51], a[224:227], v[152:155]
  v_mfma_f32_16x16x32_bf16 v[156:159], a[48:51], a[228:231], v[156:159]
  ds_read_b64_tr_b16 a[48:49], v228 offset:49408
  s_waitcnt lgkmcnt(15)
  v_mfma_f32_16x16x32_bf16 v[8:11], a[4:7], v[204:207], v[8:11]
  ds_read_b64_tr_b16 a[50:51], v228 offset:57600
  v_mfma_f32_16x16x32_bf16 v[16:19], a[8:11], v[204:207], v[16:19]
  v_exp_f32 v181, v181
  v_mfma_f32_16x16x32_bf16 v[24:27], a[12:15], v[204:207], v[24:27]
  v_cvt_pk_bf16_f32 v208, v180, v181
  v_mfma_f32_16x16x32_bf16 v[40:43], a[20:23], v[204:207], v[40:43]
  v_exp_f32 v182, v182
  v_mfma_f32_16x16x32_bf16 v[48:51], a[24:27], v[204:207], v[48:51]
  v_exp_f32 v183, v183
  v_mfma_f32_16x16x32_bf16 v[56:59], a[28:31], v[204:207], v[56:59]
  v_cvt_pk_bf16_f32 v209, v182, v183
  v_mfma_f32_16x16x32_bf16 v[72:75], a[36:39], v[204:207], v[72:75]
  v_exp_f32 v188, v188
  v_mfma_f32_16x16x32_bf16 v[80:83], a[40:43], v[204:207], v[80:83]
  v_exp_f32 v189, v189
  s_waitcnt lgkmcnt(15)
  v_mfma_f32_16x16x32_bf16 v[88:91], a[44:47], v[204:207], v[88:91]
  v_cvt_pk_bf16_f32 v210, v188, v189
  s_waitcnt lgkmcnt(13)
  v_mfma_f32_16x16x32_bf16 v[104:107], a[52:55], v[204:207], v[104:107]
  v_exp_f32 v190, v190
  s_waitcnt lgkmcnt(10)
  v_mfma_f32_16x16x32_bf16 v[112:115], a[56:59], v[204:207], v[112:115]
  v_exp_f32 v191, v191
  s_waitcnt lgkmcnt(8)
  v_mfma_f32_16x16x32_bf16 v[120:123], a[60:63], v[204:207], v[120:123]
  v_cvt_pk_bf16_f32 v211, v190, v191
  v_add_f32 v214, v214, v184
  s_waitcnt lgkmcnt(6)
  v_mfma_f32_16x16x32_bf16 v[0:3], a[0:3], v[204:207], v[0:3]
  v_add_f32 v214, v214, v185
  v_add_f32 v214, v214, v186
  s_waitcnt lgkmcnt(4)
  v_mfma_f32_16x16x32_bf16 v[32:35], a[16:19], v[204:207], v[32:35]
  v_add_f32 v214, v214, v187
  v_add_f32 v215, v215, v180
  s_waitcnt lgkmcnt(2)
  v_mfma_f32_16x16x32_bf16 v[64:67], a[32:35], v[204:207], v[64:67]
  v_add_f32 v215, v215, v181
  v_add_f32 v215, v215, v182
  s_waitcnt lgkmcnt(0)
  v_mfma_f32_16x16x32_bf16 v[96:99], a[48:51], v[204:207], v[96:99]
  v_add_f32 v215, v215, v183
  v_add_f32 v215, v215, v188
  v_mfma_f32_16x16x32_bf16 v[12:15], a[4:7], v[208:211], v[12:15]
  v_add_f32 v215, v215, v189
  v_add_f32 v215, v215, v190
  v_mfma_f32_16x16x32_bf16 v[20:23], a[8:11], v[208:211], v[20:23]
  v_add_f32 v215, v215, v191
  v_mfma_f32_16x16x32_bf16 v[28:31], a[12:15], v[208:211], v[28:31]
  v_mbcnt_lo_u32_b32 v250, -1, 0
  v_mbcnt_hi_u32_b32 v250, -1, v250
  v_mov_b32 v247, v214
  v_mov_b32 v248, v215
  v_mov_b32 v249, v216
  v_permlane32_swap_b32 v214, v247
  v_mfma_f32_16x16x32_bf16 v[44:47], a[20:23], v[208:211], v[44:47]
  v_permlane32_swap_b32 v215, v248
  v_permlane32_swap_b32 v216, v249
  v_add_f32 v214, v214, v247
  v_add_f32 v215, v215, v248
  v_add_f32 v216, v216, v249
  v_mov_b32 v247, v214
  v_mfma_f32_16x16x32_bf16 v[52:55], a[24:27], v[208:211], v[52:55]
  v_mov_b32 v248, v215
  v_mov_b32 v249, v216
  v_permlane16_swap_b32 v214, v247
  v_permlane16_swap_b32 v215, v248
  v_permlane16_swap_b32 v216, v249
  v_add_f32 v214, v214, v247
  v_mfma_f32_16x16x32_bf16 v[60:63], a[28:31], v[208:211], v[60:63]
  v_add_f32 v215, v215, v248
  v_add_f32 v216, v216, v249
  v_and_b32 v253, 15, v250
  v_lshrrev_b32 v254, 4, v250
  s_lshr_b32 s48, s16, 1
  s_lshl_b32 s48, s48, 7
  v_mfma_f32_16x16x32_bf16 v[76:79], a[36:39], v[208:211], v[76:79]
  s_and_b32 s49, s16, 1
  s_lshl_b32 s49, s49, 6
  s_add_u32 s48, s48, s49
  s_add_u32 s48, s48, 135168
  v_lshlrev_b32 v242, 2, v253
  v_max3_f32 v244, v214, v215, v216
  v_mfma_f32_16x16x32_bf16 v[84:87], a[40:43], v[208:211], v[84:87]
  v_add_u32 v243, s48, v242
  v_cmp_lt_f32 vcc, s42, v244
  ds_write_b32 v243, v216
  v_rcp_f32 v214, v214
  v_rcp_f32 v215, v215
  s_lshl_b32 s51, s16, 2
  v_mfma_f32_16x16x32_bf16 v[92:95], a[44:47], v[208:211], v[92:95]
  s_add_u32 s51, s51, 135424
  v_mov_b32 v244, s51
  s_cmp_lg_u64 vcc, 0
  s_cselect_b32 s50, 1, 0
  v_mov_b32 v243, s50
  ds_write_b32 v244, v243
  v_mfma_f32_16x16x32_bf16 v[108:111], a[52:55], v[208:211], v[108:111]
  v_and_b32 v246, 1, v254
  v_lshlrev_b32 v246, 1, v246
  v_lshrrev_b32 v247, 1, v254
  v_xor_b32 v248, v246, v247
  s_lshl_b32 s48, s16, 1
  v_xor_b32 v248, s48, v248
  v_mfma_f32_16x16x32_bf16 v[116:119], a[56:59], v[208:211], v[116:119]
  v_xor_b32 v248, v248, v253
  v_lshlrev_b32 v249, 9, v253
  s_lshl_b32 s49, s16, 14
  v_add_u32 v245, s49, v249
  s_waitcnt vmcnt(0) lgkmcnt(0)
  s_barrier
  v_mfma_f32_16x16x32_bf16 v[124:127], a[60:63], v[208:211], v[124:127]
  v_add_u32 v242, 135168, v242
  ds_read_b32 v217, v242
  ds_read_b32 v218, v242 offset:64
  ds_read_b32 v219, v242 offset:128
  ds_read_b32 v212, v242 offset:192
  v_mov_b32 v243, 135424
  v_mfma_f32_16x16x32_bf16 v[4:7], a[0:3], v[208:211], v[4:7]
  ds_read_b128 v[196:199], v243
  v_xor_b32 v244, 0, v248
  v_lshl_add_u32 v160, v244, 4, v245
  v_xor_b32 v244, 4, v248
  v_lshl_add_u32 v161, v244, 4, v245
  v_xor_b32 v244, 8, v248
  v_mfma_f32_16x16x32_bf16 v[128:131], a[0:3], a[232:235], v[128:131]
  v_lshl_add_u32 v162, v244, 4, v245
  v_xor_b32 v244, 12, v248
  v_lshl_add_u32 v163, v244, 4, v245
  v_lshlrev_b32 v246, 2, v246
  v_add_u32 v246, v246, v247
  v_add_u32 v246, s48, v246
  v_mfma_f32_16x16x32_bf16 v[132:135], a[0:3], a[236:239], v[132:135]
  v_xor_b32 v246, v246, v253
  v_lshl_add_u32 v164, v246, 4, v249
  v_add_u32 v164, 65536, v164
  v_and_b32 v251, 31, v250
  v_lshrrev_b32 v252, 5, v250
  v_lshlrev_b32 v245, 9, v252
  v_mfma_f32_16x16x32_bf16 v[36:39], a[16:19], v[208:211], v[36:39]
  v_add_u32 v245, s49, v245
  v_add_u32 v244, 0, v252
  v_xor_b32 v244, v244, v251
  v_lshl_add_u32 v176, v244, 4, v245
  v_add_u32 v244, 2, v252
  v_xor_b32 v244, v244, v251
  v_mfma_f32_16x16x32_bf16 v[136:139], a[16:19], a[232:235], v[136:139]
  v_lshl_add_u32 v177, v244, 4, v245
  v_add_u32 v244, 4, v252
  v_xor_b32 v244, v244, v251
  v_lshl_add_u32 v178, v244, 4, v245
  v_add_u32 v244, 6, v252
  v_xor_b32 v244, v244, v251
  v_mfma_f32_16x16x32_bf16 v[140:143], a[16:19], a[236:239], v[140:143]
  v_lshl_add_u32 v179, v244, 4, v245
  v_add_u32 v244, 8, v252
  v_xor_b32 v244, v244, v251
  v_lshl_add_u32 v180, v244, 4, v245
  v_add_u32 v244, 10, v252
  v_xor_b32 v244, v244, v251
  v_mfma_f32_16x16x32_bf16 v[68:71], a[32:35], v[208:211], v[68:71]
  v_lshl_add_u32 v181, v244, 4, v245
  v_add_u32 v244, 12, v252
  v_xor_b32 v244, v244, v251
  v_lshl_add_u32 v182, v244, 4, v245
  v_add_u32 v244, 14, v252
  v_xor_b32 v244, v244, v251
  v_mfma_f32_16x16x32_bf16 v[144:147], a[32:35], a[232:235], v[144:147]
  v_lshl_add_u32 v183, v244, 4, v245
  v_lshlrev_b32 v249, 4, v250
  v_add_u32 v248, s49, v249
  s_waitcnt lgkmcnt(0)
  v_or_b32 v196, v196, v197
  v_add_f32 v200, v217, v218
  v_mfma_f32_16x16x32_bf16 v[148:151], a[32:35], a[236:239], v[148:151]
  v_or3_b32 v196, v196, v198, v199
  v_add_f32 v201, v219, v212
  v_readfirstlane_b32 s54, v196
  v_rcp_f32 v200, v200
  v_rcp_f32 v201, v201
  v_mfma_f32_16x16x32_bf16 v[100:103], a[48:51], v[208:211], v[100:103]
  v_mfma_f32_16x16x32_bf16 v[152:155], a[48:51], a[232:235], v[152:155]
  v_mfma_f32_16x16x32_bf16 v[156:159], a[48:51], a[236:239], v[156:159]
  s_branch L_epi
L_var_k0q1p0:
  ds_read_b128 a[64:67], v220 offset:16384
  ds_read_b128 a[68:71], v221 offset:16384
  ds_read_b128 a[72:75], v222 offset:16384
  ds_read_b128 a[76:79], v223 offset:16384
  ds_read_b128 a[80:83], v220 offset:16640
  ds_read_b128 a[84:87], v221 offset:16640
  ds_read_b128 a[88:91], v222 offset:16640
  ds_read_b128 a[92:95], v223 offset:16640
  ds_read_b64_tr_b16 a[4:5], v225 offset:0
  ds_read_b128 a[96:99], v220 offset:24576
  ds_read_b128 a[100:103], v221 offset:24576
  ds_read_b128 a[104:107], v222 offset:24576
  ds_read_b64_tr_b16 a[6:7], v225 offset:8192
  ds_read_b128 a[108:111], v223 offset:24576
  ds_read_b128 a[112:115], v220 offset:24832
  ds_read_b128 a[116:119], v221 offset:24832
  ds_read_b128 a[120:123], v222 offset:24832
  ds_read_b64_tr_b16 a[8:9], v226 offset:0
  ds_read_b128 a[124:127], v223 offset:24832
  ds_read_b64_tr_b16 a[10:11], v226 offset:8192
  ds_read_b64_tr_b16 a[12:13], v227 offset:0
  ds_read_b64_tr_b16 a[14:15], v227 offset:8192
  ds_read_b64_tr_b16 a[20:21], v229 offset:0
  ds_read_b64_tr_b16 a[22:23], v229 offset:8192
  ds_read_b64_tr_b16 a[24:25], v230 offset:0
  v_sub_f32 v242, 0, v217
  v_sub_f32 v243, 0, v217
  v_sub_f32 v244, 0, v217
  v_sub_f32 v245, 0, v217
  v_sub_f32 v246, 0, v218
  v_sub_f32 v247, 0, v218
  v_sub_f32 v248, 0, v218
  v_sub_f32 v249, 0, v218
  v_sub_f32 v250, 0, v219
  v_sub_f32 v251, 0, v219
  v_sub_f32 v252, 0, v219
  v_sub_f32 v253, 0, v219
  v_mul_f32 v217, s39, v217
  v_mul_f32 v218, s39, v218
  v_mul_f32 v219, s39, v219
  v_fma_f32 v192, v192, s39, -v219
  v_fma_f32 v193, v193, s39, -v219
  v_fma_f32 v194, v194, s39, -v219
  v_fma_f32 v195, v195, s39, -v219
  v_exp_f32 v192, v192
  v_exp_f32 v193, v193
  v_exp_f32 v194, v194
  v_exp_f32 v195, v195
  s_nop 0
  v_add_f32 v216, v216, v192
  v_add_f32 v216, v216, v193
  v_add_f32 v216, v216, v194
  v_add_f32 v216, v216, v195
  v_cvt_pk_bf16_f32 v212, v192, v193
  v_cvt_pk_bf16_f32 v213, v194, v195
  ds_write_b64 v240, v[212:213] offset:0
  v_fma_f32 v160, v160, s39, -v217
  v_fma_f32 v161, v161, s39, -v217
  v_fma_f32 v162, v162, s39, -v217
  v_fma_f32 v163, v163, s39, -v217
  v_fma_f32 v168, v168, s39, -v217
  v_fma_f32 v169, v169, s39, -v217
  v_fma_f32 v170, v170, s39, -v217
  v_fma_f32 v171, v171, s39, -v217
  v_fma_f32 v164, v164, s39, -v218
  v_fma_f32 v165, v165, s39, -v218
  v_fma_f32 v166, v166, s39, -v218
  v_fma_f32 v167, v167, s39, -v218
  v_fma_f32 v172, v172, s39, -v218
  v_fma_f32 v173, v173, s39, -v218
  v_fma_f32 v174, v174, s39, -v218
  v_fma_f32 v175, v175, s39, -v218
  v_exp_f32 v160, v160
  v_exp_f32 v161, v161
  v_exp_f32 v162, v162
  v_exp_f32 v163, v163
  v_exp_f32 v168, v168
  v_exp_f32 v169, v169
  v_exp_f32 v170, v170
  v_exp_f32 v171, v171
  v_exp_f32 v164, v164
  v_cvt_pk_bf16_f32 v196, v160, v161
  v_cvt_pk_bf16_f32 v197, v162, v163
  v_cvt_pk_bf16_f32 v198, v168, v169
  v_add_f32 v214, v214, v160
  v_cvt_pk_bf16_f32 v199, v170, v171
  v_add_f32 v214, v214, v161
  v_add_f32 v214, v214, v162
  s_waitcnt lgkmcnt(0)
  v_mfma_f32_16x16x32_bf16 v[192:195], a[64:67], a[192:195], v[250:253]
  s_add_u32 s36, s36, 16384
  ds_read_b64_tr_b16 a[26:27], v230 offset:8192
  v_add_f32 v214, v214, v163
  v_mfma_f32_16x16x32_bf16 v[192:195], a[68:71], a[196:199], v[192:195]
  v_exp_f32 v165, v165
  v_mfma_f32_16x16x32_bf16 v[192:195], a[72:75], a[200:203], v[192:195]
  s_add_u32 m0, s38, 49152
  ds_read_b64_tr_b16 a[28:29], v231 offset:0
  v_cvt_pk_bf16_f32 v200, v164, v165
  v_mfma_f32_16x16x32_bf16 v[192:195], a[76:79], a[204:207], v[192:195]
  ds_read_b64_tr_b16 a[30:31], v231 offset:8192
  v_add_f32 v214, v214, v168
  v_mfma_f32_16x16x32_bf16 v[192:195], a[80:83], a[208:211], v[192:195]
  buffer_load_dwordx4 v232, s[20:23], s36 offen offset:0 nt lds
  v_mfma_f32_16x16x32_bf16 v[192:195], a[84:87], a[212:215], v[192:195]
  ds_read_b64_tr_b16 a[36:37], v225 offset:256
  v_add_f32 v214, v214, v169
  v_mfma_f32_16x16x32_bf16 v[192:195], a[88:91], a[216:219], v[192:195]
  v_exp_f32 v166, v166
  v_mfma_f32_16x16x32_bf16 v[192:195], a[92:95], a[220:223], v[192:195]
  buffer_load_dwordx4 v233, s[20:23], s36 offen offset:1024 nt lds
  ds_read_b64_tr_b16 a[38:39], v225 offset:8448
  v_add_f32 v214, v214, v170
  v_mfma_f32_16x16x32_bf16 v[176:179], a[64:67], a[128:131], v[242:245]
  ds_read_b64_tr_b16 a[40:41], v226 offset:256
  v_add_f32 v214, v214, v171
  v_mfma_f32_16x16x32_bf16 v[180:183], a[64:67], a[160:163], v[246:249]
  buffer_load_dwordx4 v234, s[20:23], s36 offen offset:2048 nt lds
  ds_read_b64_tr_b16 a[42:43], v226 offset:8448
  v_add_f32 v215, v215, v164
  v_mfma_f32_16x16x32_bf16 v[176:179], a[68:71], a[132:135], v[176:179]
  v_exp_f32 v167, v167
  v_mfma_f32_16x16x32_bf16 v[180:183], a[68:71], a[164:167], v[180:183]
  buffer_load_dwordx4 v235, s[20:23], s36 offen offset:3072 nt lds
  ds_read_b64_tr_b16 a[44:45], v227 offset:256
  v_mul_f32 v192, s39, v192
  v_mfma_f32_16x16x32_bf16 v[176:179], a[72:75], a[136:139], v[176:179]
  ds_read_b64_tr_b16 a[46:47], v227 offset:8448
  v_mul_f32 v193, s39, v193
  v_mfma_f32_16x16x32_bf16 v[180:183], a[72:75], a[168:171], v[180:183]
  v_exp_f32 v192, v192
  v_mfma_f32_16x16x32_bf16 v[176:179], a[76:79], a[140:143], v[176:179]
  s_add_u32 m0, s38, 98304
  ds_read_b64_tr_b16 a[52:53], v229 offset:256
  v_mul_f32 v194, s39, v194
  v_mfma_f32_16x16x32_bf16 v[180:183], a[76:79], a[172:175], v[180:183]
  v_exp_f32 v193, v193
  v_mfma_f32_16x16x32_bf16 v[176:179], a[80:83], a[144:147], v[176:179]
  buffer_load_dwordx4 v236, s[24:27], s36 offen offset:0 nt lds
  ds_read_b64_tr_b16 a[54:55], v229 offset:8448
  v_mul_f32 v195, s39, v195
  v_mfma_f32_16x16x32_bf16 v[180:183], a[80:83], a[176:179], v[180:183]
  v_mfma_f32_16x16x32_bf16 v[176:179], a[84:87], a[148:151], v[176:179]
  v_exp_f32 v194, v194
  v_mfma_f32_16x16x32_bf16 v[180:183], a[84:87], a[180:183], v[180:183]
  buffer_load_dwordx4 v237, s[24:27], s36 offen offset:1024 nt lds
  ds_read_b64_tr_b16 a[56:57], v230 offset:256
  v_cvt_pk_bf16_f32 v212, v192, v193
  v_mfma_f32_16x16x32_bf16 v[176:179], a[88:91], a[152:155], v[176:179]
  v_exp_f32 v195, v195
  v_mfma_f32_16x16x32_bf16 v[180:183], a[88:91], a[184:187], v[180:183]
  buffer_load_dwordx4 v238, s[24:27], s36 offen offset:2048 nt lds
  ds_read_b64_tr_b16 a[58:59], v230 offset:8448
  v_cvt_pk_bf16_f32 v213, v194, v195
  v_mfma_f32_16x16x32_bf16 v[176:179], a[92:95], a[156:159], v[176:179]
  ds_read_b64_tr_b16 a[60:61], v231 offset:256
  v_cvt_pk_bf16_f32 v201, v166, v167
  v_mfma_f32_16x16x32_bf16 v[180:183], a[92:95], a[188:191], v[180:183]
  buffer_load_dwordx4 v239, s[24:27], s36 offen offset:3072 nt lds
  ds_write_b64 v240, v[212:213] offset:2048
  v_add_f32 v215, v215, v165
  v_mfma_f32_16x16x32_bf16 v[184:187], a[96:99], a[128:131], v[242:245]
  v_exp_f32 v172, v172
  v_mfma_f32_16x16x32_bf16 v[188:191], a[96:99], a[160:163], v[246:249]
  ds_read_b64_tr_b16 a[62:63], v231 offset:8448
  v_add_f32 v215, v215, v166
  v_mfma_f32_16x16x32_bf16 v[184:187], a[100:103], a[132:135], v[184:187]
  s_add_u32 s36, s36, 16384
  ds_read_b64_tr_b16 a[0:1], v224 offset:0
  v_add_f32 v215, v215, v167
  v_mfma_f32_16x16x32_bf16 v[188:191], a[100:103], a[164:167], v[188:191]
  ds_read_b64_tr_b16 a[2:3], v224 offset:8192
  v_add_f32 v215, v215, v172
  v_mfma_f32_16x16x32_bf16 v[184:187], a[104:107], a[136:139], v[184:187]
  s_add_u32 m0, s38, 0
  v_exp_f32 v173, v173
  v_mfma_f32_16x16x32_bf16 v[188:191], a[104:107], a[168:171], v[188:191]
  ds_read_b64_tr_b16 a[16:17], v228 offset:0
  v_cvt_pk_bf16_f32 v202, v172, v173
  v_mfma_f32_16x16x32_bf16 v[184:187], a[108:111], a[140:143], v[184:187]
  buffer_load_dwordx4 v232, s[20:23], s36 offen offset:0 nt lds
  ds_read_b64_tr_b16 a[18:19], v228 offset:8192
  v_add_f32 v215, v215, v173
  v_mfma_f32_16x16x32_bf16 v[188:191], a[108:111], a[172:175], v[188:191]
  ds_read_b64_tr_b16 a[32:33], v224 offset:256
  v_add_f32 v216, v216, v192
  v_mfma_f32_16x16x32_bf16 v[184:187], a[112:115], a[144:147], v[184:187]
  ds_read_b64_tr_b16 a[34:35], v224 offset:8448
  v_add_f32 v216, v216, v193
  v_mfma_f32_16x16x32_bf16 v[188:191], a[112:115], a[176:179], v[188:191]
  buffer_load_dwordx4 v233, s[20:23], s36 offen offset:1024 nt lds
  ds_read_b64_tr_b16 a[48:49], v228 offset:256
  v_add_f32 v216, v216, v194
  v_mfma_f32_16x16x32_bf16 v[184:187], a[116:119], a[148:151], v[184:187]
  ds_read_b64_tr_b16 a[50:51], v228 offset:8448
  v_add_f32 v216, v216, v195
  v_mfma_f32_16x16x32_bf16 v[188:191], a[116:119], a[180:183], v[188:191]
  buffer_load_dwordx4 v234, s[20:23], s36 offen offset:2048 nt lds
  v_exp_f32 v174, v174
  v_mfma_f32_16x16x32_bf16 v[184:187], a[120:123], a[152:155], v[184:187]
  v_mfma_f32_16x16x32_bf16 v[188:191], a[120:123], a[184:187], v[188:191]
  v_exp_f32 v175, v175
  v_mfma_f32_16x16x32_bf16 v[184:187], a[124:127], a[156:159], v[184:187]
  buffer_load_dwordx4 v235, s[20:23], s36 offen offset:3072 nt lds
  v_cvt_pk_bf16_f32 v203, v174, v175
  v_mfma_f32_16x16x32_bf16 v[188:191], a[124:127], a[188:191], v[188:191]
  v_add_f32 v215, v215, v174
  v_add_f32 v215, v215, v175
  s_waitcnt vmcnt(12) lgkmcnt(0)
  s_barrier
  ds_read_b128 a[224:227], v241 offset:0
  v_mfma_f32_16x16x32_bf16 v[8:11], a[4:7], v[196:199], v[8:11]
  ds_read_b128 a[64:67], v220 offset:32768
  v_mul_f32 v176, s39, v176
  v_mfma_f32_16x16x32_bf16 v[12:15], a[4:7], v[200:203], v[12:15]
  s_add_u32 m0, s38, 114688
  v_exp_f32 v176, v176
  v_mfma_f32_16x16x32_bf16 v[16:19], a[8:11], v[196:199], v[16:19]
  ds_read_b128 a[68:71], v221 offset:32768
  v_mul_f32 v177, s39, v177
  v_mfma_f32_16x16x32_bf16 v[20:23], a[8:11], v[200:203], v[20:23]
  ds_read_b128 a[72:75], v222 offset:32768
  v_mfma_f32_16x16x32_bf16 v[24:27], a[12:15], v[196:199], v[24:27]
  buffer_load_dwordx4 v236, s[24:27], s36 offen offset:0 nt lds
  ds_read_b128 a[76:79], v223 offset:32768
  v_mfma_f32_16x16x32_bf16 v[28:31], a[12:15], v[200:203], v[28:31]
  v_exp_f32 v177, v177
  v_mfma_f32_16x16x32_bf16 v[40:43], a[20:23], v[196:199], v[40:43]
  ds_read_b128 a[80:83], v220 offset:33024
  v_mul_f32 v178, s39, v178
  v_mfma_f32_16x16x32_bf16 v[44:47], a[20:23], v[200:203], v[44:47]
  buffer_load_dwordx4 v237, s[24:27], s36 offen offset:1024 nt lds
  v_mfma_f32_16x16x32_bf16 v[48:51], a[24:27], v[196:199], v[48:51]
  ds_read_b128 a[84:87], v221 offset:33024
  v_mul_f32 v179, s39, v179
  v_mfma_f32_16x16x32_bf16 v[52:55], a[24:27], v[200:203], v[52:55]
  v_exp_f32 v178, v178
  v_mfma_f32_16x16x32_bf16 v[56:59], a[28:31], v[196:199], v[56:59]
  buffer_load_dwordx4 v238, s[24:27], s36 offen offset:2048 nt lds
  ds_read_b128 a[88:91], v222 offset:33024
  v_mul_f32 v184, s39, v184
  v_mfma_f32_16x16x32_bf16 v[60:63], a[28:31], v[200:203], v[60:63]
  ds_read_b128 a[92:95], v223 offset:33024
  v_mul_f32 v185, s39, v185
  v_mfma_f32_16x16x32_bf16 v[72:75], a[36:39], v[196:199], v[72:75]
  ds_read_b64_tr_b16 a[4:5], v225 offset:16384
  v_mul_f32 v186, s39, v186
  v_mfma_f32_16x16x32_bf16 v[76:79], a[36:39], v[200:203], v[76:79]
  buffer_load_dwordx4 v239, s[24:27], s36 offen offset:3072 nt lds
  ds_read_b128 a[232:235], v241 offset:2048
  v_mul_f32 v187, s39, v187
  v_mfma_f32_16x16x32_bf16 v[80:83], a[40:43], v[196:199], v[80:83]
  v_exp_f32 v179, v179
  v_mfma_f32_16x16x32_bf16 v[84:87], a[40:43], v[200:203], v[84:87]
  ds_read_b128 a[96:99], v220 offset:40960
  v_mul_f32 v180, s39, v180
  v_mfma_f32_16x16x32_bf16 v[88:91], a[44:47], v[196:199], v[88:91]
  s_add_u32 s36, s36, 16384
  v_mfma_f32_16x16x32_bf16 v[92:95], a[44:47], v[200:203], v[92:95]
  ds_read_b128 a[100:103], v221 offset:40960
  v_mul_f32 v181, s39, v181
  v_mfma_f32_16x16x32_bf16 v[104:107], a[52:55], v[196:199], v[104:107]
  v_exp_f32 v184, v184
  v_mfma_f32_16x16x32_bf16 v[108:111], a[52:55], v[200:203], v[108:111]
  s_add_u32 m0, s38, 16384
  ds_read_b128 a[104:107], v222 offset:40960
  v_mul_f32 v182, s39, v182
  v_mfma_f32_16x16x32_bf16 v[112:115], a[56:59], v[196:199], v[112:115]
  ds_read_b64_tr_b16 a[6:7], v225 offset:24576
  v_mul_f32 v183, s39, v183
  v_mfma_f32_16x16x32_bf16 v[116:119], a[56:59], v[200:203], v[116:119]
  ds_read_b128 a[108:111], v223 offset:40960
  v_mul_f32 v188, s39, v188
  v_mfma_f32_16x16x32_bf16 v[120:123], a[60:63], v[196:199], v[120:123]
  buffer_load_dwordx4 v232, s[20:23], s36 offen offset:0 nt lds
  v_mul_f32 v189, s39, v189
  v_mfma_f32_16x16x32_bf16 v[124:127], a[60:63], v[200:203], v[124:127]
  v_exp_f32 v185, v185
  v_mfma_f32_16x16x32_bf16 v[0:3], a[0:3], v[196:199], v[0:3]
  ds_read_b128 a[112:115], v220 offset:41216
  v_mul_f32 v190, s39, v190
  v_mfma_f32_16x16x32_bf16 v[4:7], a[0:3], v[200:203], v[4:7]
  buffer_load_dwordx4 v233, s[20:23], s36 offen offset:1024 nt lds
  s_waitcnt lgkmcnt(15)
  v_mfma_f32_16x16x32_bf16 v[128:131], a[0:3], a[224:227], v[128:131]
  ds_read_b128 a[116:119], v221 offset:41216
  v_mul_f32 v191, s39, v191
  v_exp_f32 v186, v186
  v_mfma_f32_16x16x32_bf16 v[32:35], a[16:19], v[196:199], v[32:35]
  ds_read_b128 a[120:123], v222 offset:41216
  v_cvt_pk_bf16_f32 v204, v176, v177
  v_mfma_f32_16x16x32_bf16 v[36:39], a[16:19], v[200:203], v[36:39]
  buffer_load_dwordx4 v234, s[20:23], s36 offen offset:2048 nt lds
  ds_read_b64_tr_b16 a[8:9], v226 offset:16384
  v_cvt_pk_bf16_f32 v205, v178, v179
  v_mfma_f32_16x16x32_bf16 v[136:139], a[16:19], a[224:227], v[136:139]
  ds_read_b128 a[124:127], v223 offset:41216
  ds_read_b64_tr_b16 a[10:11], v226 offset:24576
  v_cvt_pk_bf16_f32 v206, v184, v185
  v_add_f32 v214, v214, v176
  v_mfma_f32_16x16x32_bf16 v[64:67], a[32:35], v[196:199], v[64:67]
  v_exp_f32 v187, v187
  v_mfma_f32_16x16x32_bf16 v[68:71], a[32:35], v[200:203], v[68:71]
  buffer_load_dwordx4 v235, s[20:23], s36 offen offset:3072 nt lds
  ds_read_b64_tr_b16 a[12:13], v227 offset:16384
  v_cvt_pk_bf16_f32 v207, v186, v187
  v_mfma_f32_16x16x32_bf16 v[144:147], a[32:35], a[224:227], v[144:147]
  ds_read_b64_tr_b16 a[14:15], v227 offset:24576
  v_mfma_f32_16x16x32_bf16 v[96:99], a[48:51], v[196:199], v[96:99]
  v_exp_f32 v180, v180
  v_mfma_f32_16x16x32_bf16 v[100:103], a[48:51], v[200:203], v[100:103]
  ds_read_b64_tr_b16 a[20:21], v229 offset:16384
  v_add_f32 v214, v214, v177
  v_mfma_f32_16x16x32_bf16 v[152:155], a[48:51], a[224:227], v[152:155]
  s_add_u32 m0, s38, 65536
  ds_read_b64_tr_b16 a[22:23], v229 offset:24576
  ds_read_b64_tr_b16 a[24:25], v230 offset:16384
  v_add_f32 v214, v214, v178
  s_waitcnt lgkmcnt(6)
  s_mov_b32 s40, 0
.p2align 6
L_loop_k0q1p0:
  v_mfma_f32_16x16x32_bf16 v[192:195], a[64:67], a[192:195], v[250:253]
  ds_read_b64_tr_b16 a[26:27], v230 offset:24576
  v_add_f32 v214, v214, v179
  v_mfma_f32_16x16x32_bf16 v[192:195], a[68:71], a[196:199], v[192:195]
  v_exp_f32 v181, v181
  v_mfma_f32_16x16x32_bf16 v[192:195], a[72:75], a[200:203], v[192:195]
  ds_read_b64_tr_b16 a[28:29], v231 offset:16384
  v_cvt_pk_bf16_f32 v208, v180, v181
  v_mfma_f32_16x16x32_bf16 v[192:195], a[76:79], a[204:207], v[192:195]
  ds_read_b64_tr_b16 a[30:31], v231 offset:24576
  v_add_f32 v214, v214, v184
  v_mfma_f32_16x16x32_bf16 v[192:195], a[80:83], a[208:211], v[192:195]
  buffer_load_dwordx4 v236, s[24:27], s36 offen offset:0 nt lds
  v_mfma_f32_16x16x32_bf16 v[192:195], a[84:87], a[212:215], v[192:195]
  ds_read_b64_tr_b16 a[36:37], v225 offset:16640
  v_add_f32 v214, v214, v185
  v_mfma_f32_16x16x32_bf16 v[192:195], a[88:91], a[216:219], v[192:195]
  v_exp_f32 v182, v182
  v_mfma_f32_16x16x32_bf16 v[192:195], a[92:95], a[220:223], v[192:195]
  ds_read_b64_tr_b16 a[38:39], v225 offset:24832
  v_add_f32 v214, v214, v186
  v_mfma_f32_16x16x32_bf16 v[160:163], a[64:67], a[128:131], v[242:245]
  ds_read_b64_tr_b16 a[40:41], v226 offset:16640
  v_add_f32 v214, v214, v187
  v_mfma_f32_16x16x32_bf16 v[164:167], a[64:67], a[160:163], v[246:249]
  ds_read_b64_tr_b16 a[42:43], v226 offset:24832
  v_add_f32 v215, v215, v180
  v_mfma_f32_16x16x32_bf16 v[160:163], a[68:71], a[132:135], v[160:163]
  v_exp_f32 v183, v183
  v_mfma_f32_16x16x32_bf16 v[164:167], a[68:71], a[164:167], v[164:167]
  ds_read_b64_tr_b16 a[44:45], v227 offset:16640
  v_mul_f32 v192, s39, v192
  v_mfma_f32_16x16x32_bf16 v[160:163], a[72:75], a[136:139], v[160:163]
  ds_read_b64_tr_b16 a[46:47], v227 offset:24832
  v_mul_f32 v193, s39, v193
  v_mfma_f32_16x16x32_bf16 v[164:167], a[72:75], a[168:171], v[164:167]
  v_exp_f32 v192, v192
  v_mfma_f32_16x16x32_bf16 v[160:163], a[76:79], a[140:143], v[160:163]
  ds_read_b64_tr_b16 a[52:53], v229 offset:16640
  v_mul_f32 v194, s39, v194
  v_mfma_f32_16x16x32_bf16 v[164:167], a[76:79], a[172:175], v[164:167]
  v_exp_f32 v193, v193
  v_mfma_f32_16x16x32_bf16 v[160:163], a[80:83], a[144:147], v[160:163]
  ds_read_b64_tr_b16 a[54:55], v229 offset:24832
  v_mul_f32 v195, s39, v195
  v_mfma_f32_16x16x32_bf16 v[164:167], a[80:83], a[176:179], v[164:167]
  buffer_load_dwordx4 v237, s[24:27], s36 offen offset:1024 nt lds
  v_mfma_f32_16x16x32_bf16 v[160:163], a[84:87], a[148:151], v[160:163]
  v_exp_f32 v194, v194
  v_mfma_f32_16x16x32_bf16 v[164:167], a[84:87], a[180:183], v[164:167]
  ds_read_b64_tr_b16 a[56:57], v230 offset:16640
  v_cvt_pk_bf16_f32 v212, v192, v193
  v_mfma_f32_16x16x32_bf16 v[160:163], a[88:91], a[152:155], v[160:163]
  v_exp_f32 v195, v195
  v_mfma_f32_16x16x32_bf16 v[164:167], a[88:91], a[184:187], v[164:167]
  ds_read_b64_tr_b16 a[58:59], v230 offset:24832
  v_cvt_pk_bf16_f32 v213, v194, v195
  v_mfma_f32_16x16x32_bf16 v[160:163], a[92:95], a[156:159], v[160:163]
  ds_read_b64_tr_b16 a[60:61], v231 offset:16640
  v_cvt_pk_bf16_f32 v209, v182, v183
  v_mfma_f32_16x16x32_bf16 v[164:167], a[92:95], a[188:191], v[164:167]
  ds_write_b64 v240, v[212:213] offset:0
  v_add_f32 v215, v215, v181
  v_mfma_f32_16x16x32_bf16 v[168:171], a[96:99], a[128:131], v[242:245]
  v_exp_f32 v188, v188
  v_mfma_f32_16x16x32_bf16 v[172:175], a[96:99], a[160:163], v[246:249]
  ds_read_b64_tr_b16 a[62:63], v231 offset:24832
  v_add_f32 v215, v215, v182
  v_mfma_f32_16x16x32_bf16 v[168:171], a[100:103], a[132:135], v[168:171]
  ds_read_b64_tr_b16 a[0:1], v224 offset:16384
  v_add_f32 v215, v215, v183
  v_mfma_f32_16x16x32_bf16 v[172:175], a[100:103], a[164:167], v[172:175]
  ds_read_b64_tr_b16 a[2:3], v224 offset:24576
  v_add_f32 v215, v215, v188
  v_mfma_f32_16x16x32_bf16 v[168:171], a[104:107], a[136:139], v[168:171]
  v_exp_f32 v189, v189
  v_mfma_f32_16x16x32_bf16 v[172:175], a[104:107], a[168:171], v[172:175]
  ds_read_b64_tr_b16 a[16:17], v228 offset:16384
  v_cvt_pk_bf16_f32 v210, v188, v189
  v_mfma_f32_16x16x32_bf16 v[168:171], a[108:111], a[140:143], v[168:171]
  ds_read_b64_tr_b16 a[18:19], v228 offset:24576
  v_add_f32 v215, v215, v189
  v_mfma_f32_16x16x32_bf16 v[172:175], a[108:111], a[172:175], v[172:175]
  ds_read_b64_tr_b16 a[32:33], v224 offset:16640
  v_add_f32 v216, v216, v192
  v_mfma_f32_16x16x32_bf16 v[168:171], a[112:115], a[144:147], v[168:171]
  ds_read_b64_tr_b16 a[34:35], v224 offset:24832
  v_add_f32 v216, v216, v193
  v_mfma_f32_16x16x32_bf16 v[172:175], a[112:115], a[176:179], v[172:175]
  ds_read_b64_tr_b16 a[48:49], v228 offset:16640
  v_add_f32 v216, v216, v194
  v_mfma_f32_16x16x32_bf16 v[168:171], a[116:119], a[148:151], v[168:171]
  ds_read_b64_tr_b16 a[50:51], v228 offset:24832
  v_add_f32 v216, v216, v195
  v_mfma_f32_16x16x32_bf16 v[172:175], a[116:119], a[180:183], v[172:175]
  v_exp_f32 v190, v190
  v_mfma_f32_16x16x32_bf16 v[168:171], a[120:123], a[152:155], v[168:171]
  buffer_load_dwordx4 v238, s[24:27], s36 offen offset:2048 nt lds
  v_mfma_f32_16x16x32_bf16 v[172:175], a[120:123], a[184:187], v[172:175]
  v_exp_f32 v191, v191
  v_mfma_f32_16x16x32_bf16 v[168:171], a[124:127], a[156:159], v[168:171]
  buffer_load_dwordx4 v239, s[24:27], s36 offen offset:3072 nt lds
  v_cvt_pk_bf16_f32 v211, v190, v191
  v_mfma_f32_16x16x32_bf16 v[172:175], a[124:127], a[188:191], v[172:175]
  v_add_f32 v215, v215, v190
  v_add_f32 v215, v215, v191
  s_waitcnt vmcnt(16) lgkmcnt(0)
  s_barrier
  v_mfma_f32_16x16x32_bf16 v[8:11], a[4:7], v[204:207], v[8:11]
  ds_read_b128 a[64:67], v220 offset:49152
  v_mul_f32 v160, s39, v160
  v_mfma_f32_16x16x32_bf16 v[12:15], a[4:7], v[208:211], v[12:15]
  v_exp_f32 v160, v160
  v_mfma_f32_16x16x32_bf16 v[16:19], a[8:11], v[204:207], v[16:19]
  ds_read_b128 a[68:71], v221 offset:49152
  v_mul_f32 v161, s39, v161
  v_mfma_f32_16x16x32_bf16 v[20:23], a[8:11], v[208:211], v[20:23]
  ds_read_b128 a[72:75], v222 offset:49152
  s_add_u32 s36, s36, 16384
  v_mfma_f32_16x16x32_bf16 v[24:27], a[12:15], v[204:207], v[24:27]
  ds_read_b128 a[76:79], v223 offset:49152
  s_add_u32 m0, s38, 32768
  v_mfma_f32_16x16x32_bf16 v[28:31], a[12:15], v[208:211], v[28:31]
  v_exp_f32 v161, v161
  v_mfma_f32_16x16x32_bf16 v[40:43], a[20:23], v[204:207], v[40:43]
  ds_read_b128 a[80:83], v220 offset:49408
  v_mul_f32 v162, s39, v162
  v_mfma_f32_16x16x32_bf16 v[44:47], a[20:23], v[208:211], v[44:47]
  buffer_load_dwordx4 v232, s[20:23], s36 offen offset:0 nt lds
  v_mfma_f32_16x16x32_bf16 v[48:51], a[24:27], v[204:207], v[48:51]
  ds_read_b128 a[84:87], v221 offset:49408
  v_mul_f32 v163, s39, v163
  v_mfma_f32_16x16x32_bf16 v[52:55], a[24:27], v[208:211], v[52:55]
  v_exp_f32 v162, v162
  v_mfma_f32_16x16x32_bf16 v[56:59], a[28:31], v[204:207], v[56:59]
  ds_read_b128 a[88:91], v222 offset:49408
  v_mul_f32 v168, s39, v168
  v_mfma_f32_16x16x32_bf16 v[60:63], a[28:31], v[208:211], v[60:63]
  ds_read_b128 a[92:95], v223 offset:49408
  v_mul_f32 v169, s39, v169
  v_mfma_f32_16x16x32_bf16 v[72:75], a[36:39], v[204:207], v[72:75]
  ds_read_b64_tr_b16 a[4:5], v225 offset:32768
  v_mul_f32 v170, s39, v170
  v_mfma_f32_16x16x32_bf16 v[76:79], a[36:39], v[208:211], v[76:79]
  ds_read_b128 a[224:227], v241 offset:0
  v_mul_f32 v171, s39, v171
  v_mfma_f32_16x16x32_bf16 v[80:83], a[40:43], v[204:207], v[80:83]
  v_exp_f32 v163, v163
  v_mfma_f32_16x16x32_bf16 v[84:87], a[40:43], v[208:211], v[84:87]
  ds_read_b128 a[96:99], v220 offset:57344
  v_mul_f32 v164, s39, v164
  v_mfma_f32_16x16x32_bf16 v[88:91], a[44:47], v[204:207], v[88:91]
  buffer_load_dwordx4 v233, s[20:23], s36 offen offset:1024 nt lds
  v_mfma_f32_16x16x32_bf16 v[92:95], a[44:47], v[208:211], v[92:95]
  ds_read_b128 a[100:103], v221 offset:57344
  v_mul_f32 v165, s39, v165
  v_mfma_f32_16x16x32_bf16 v[104:107], a[52:55], v[204:207], v[104:107]
  v_exp_f32 v168, v168
  v_mfma_f32_16x16x32_bf16 v[108:111], a[52:55], v[208:211], v[108:111]
  ds_read_b128 a[104:107], v222 offset:57344
  v_mul_f32 v166, s39, v166
  v_mfma_f32_16x16x32_bf16 v[112:115], a[56:59], v[204:207], v[112:115]
  ds_read_b64_tr_b16 a[6:7], v225 offset:40960
  v_mul_f32 v167, s39, v167
  v_mfma_f32_16x16x32_bf16 v[116:119], a[56:59], v[208:211], v[116:119]
  ds_read_b128 a[108:111], v223 offset:57344
  v_mul_f32 v172, s39, v172
  v_mfma_f32_16x16x32_bf16 v[120:123], a[60:63], v[204:207], v[120:123]
  v_mul_f32 v173, s39, v173
  v_mfma_f32_16x16x32_bf16 v[124:127], a[60:63], v[208:211], v[124:127]
  v_exp_f32 v169, v169
  v_mfma_f32_16x16x32_bf16 v[0:3], a[0:3], v[204:207], v[0:3]
  ds_read_b128 a[112:115], v220 offset:57600
  v_mul_f32 v174, s39, v174
  v_mfma_f32_16x16x32_bf16 v[4:7], a[0:3], v[208:211], v[4:7]
  buffer_load_dwordx4 v234, s[20:23], s36 offen offset:2048 nt lds
  v_mfma_f32_16x16x32_bf16 v[128:131], a[0:3], a[232:235], v[128:131]
  ds_read_b128 a[116:119], v221 offset:57600
  v_mul_f32 v175, s39, v175
  v_exp_f32 v170, v170
  v_mfma_f32_16x16x32_bf16 v[32:35], a[16:19], v[204:207], v[32:35]
  ds_read_b128 a[120:123], v222 offset:57600
  v_cvt_pk_bf16_f32 v196, v160, v161
  v_mfma_f32_16x16x32_bf16 v[36:39], a[16:19], v[208:211], v[36:39]
  ds_read_b64_tr_b16 a[8:9], v226 offset:32768
  v_cvt_pk_bf16_f32 v197, v162, v163
  v_mfma_f32_16x16x32_bf16 v[136:139], a[16:19], a[232:235], v[136:139]
  ds_read_b128 a[124:127], v223 offset:57600
  ds_read_b64_tr_b16 a[10:11], v226 offset:40960
  v_cvt_pk_bf16_f32 v198, v168, v169
  v_add_f32 v214, v214, v160
  v_mfma_f32_16x16x32_bf16 v[64:67], a[32:35], v[204:207], v[64:67]
  v_exp_f32 v171, v171
  v_mfma_f32_16x16x32_bf16 v[68:71], a[32:35], v[208:211], v[68:71]
  ds_read_b64_tr_b16 a[12:13], v227 offset:32768
  v_cvt_pk_bf16_f32 v199, v170, v171
  v_mfma_f32_16x16x32_bf16 v[144:147], a[32:35], a[232:235], v[144:147]
  buffer_load_dwordx4 v235, s[20:23], s36 offen offset:3072 nt lds
  ds_read_b64_tr_b16 a[14:15], v227 offset:40960
  s_add_u32 m0, s38, 81920
  v_mfma_f32_16x16x32_bf16 v[96:99], a[48:51], v[204:207], v[96:99]
  v_exp_f32 v164, v164
  v_mfma_f32_16x16x32_bf16 v[100:103], a[48:51], v[208:211], v[100:103]
  ds_read_b64_tr_b16 a[20:21], v229 offset:32768
  v_add_f32 v214, v214, v161
  v_mfma_f32_16x16x32_bf16 v[152:155], a[48:51], a[232:235], v[152:155]
  ds_read_b64_tr_b16 a[22:23], v229 offset:40960
  ds_read_b64_tr_b16 a[24:25], v230 offset:32768
  v_add_f32 v214, v214, v162
  s_waitcnt lgkmcnt(6)
  v_mfma_f32_16x16x32_bf16 v[192:195], a[64:67], a[192:195], v[250:253]
  ds_read_b64_tr_b16 a[26:27], v230 offset:40960
  v_add_f32 v214, v214, v163
  v_mfma_f32_16x16x32_bf16 v[192:195], a[68:71], a[196:199], v[192:195]
  v_exp_f32 v165, v165
  v_mfma_f32_16x16x32_bf16 v[192:195], a[72:75], a[200:203], v[192:195]
  ds_read_b64_tr_b16 a[28:29], v231 offset:32768
  v_cvt_pk_bf16_f32 v200, v164, v165
  v_mfma_f32_16x16x32_bf16 v[192:195], a[76:79], a[204:207], v[192:195]
  ds_read_b64_tr_b16 a[30:31], v231 offset:40960
  v_add_f32 v214, v214, v168
  v_mfma_f32_16x16x32_bf16 v[192:195], a[80:83], a[208:211], v[192:195]
  buffer_load_dwordx4 v236, s[24:27], s36 offen offset:0 nt lds
  v_mfma_f32_16x16x32_bf16 v[192:195], a[84:87], a[212:215], v[192:195]
  ds_read_b64_tr_b16 a[36:37], v225 offset:33024
  v_add_f32 v214, v214, v169
  v_mfma_f32_16x16x32_bf16 v[192:195], a[88:91], a[216:219], v[192:195]
  v_exp_f32 v166, v166
  v_mfma_f32_16x16x32_bf16 v[192:195], a[92:95], a[220:223], v[192:195]
  ds_read_b64_tr_b16 a[38:39], v225 offset:41216
  v_add_f32 v214, v214, v170
  v_mfma_f32_16x16x32_bf16 v[176:179], a[64:67], a[128:131], v[242:245]
  ds_read_b64_tr_b16 a[40:41], v226 offset:33024
  v_add_f32 v214, v214, v171
  v_mfma_f32_16x16x32_bf16 v[180:183], a[64:67], a[160:163], v[246:249]
  ds_read_b64_tr_b16 a[42:43], v226 offset:41216
  v_add_f32 v215, v215, v164
  v_mfma_f32_16x16x32_bf16 v[176:179], a[68:71], a[132:135], v[176:179]
  v_exp_f32 v167, v167
  v_mfma_f32_16x16x32_bf16 v[180:183], a[68:71], a[164:167], v[180:183]
  ds_read_b64_tr_b16 a[44:45], v227 offset:33024
  v_mul_f32 v192, s39, v192
  v_mfma_f32_16x16x32_bf16 v[176:179], a[72:75], a[136:139], v[176:179]
  ds_read_b64_tr_b16 a[46:47], v227 offset:41216
  v_mul_f32 v193, s39, v193
  v_mfma_f32_16x16x32_bf16 v[180:183], a[72:75], a[168:171], v[180:183]
  v_exp_f32 v192, v192
  v_mfma_f32_16x16x32_bf16 v[176:179], a[76:79], a[140:143], v[176:179]
  ds_read_b64_tr_b16 a[52:53], v229 offset:33024
  v_mul_f32 v194, s39, v194
  v_mfma_f32_16x16x32_bf16 v[180:183], a[76:79], a[172:175], v[180:183]
  v_exp_f32 v193, v193
  v_mfma_f32_16x16x32_bf16 v[176:179], a[80:83], a[144:147], v[176:179]
  ds_read_b64_tr_b16 a[54:55], v229 offset:41216
  v_mul_f32 v195, s39, v195
  v_mfma_f32_16x16x32_bf16 v[180:183], a[80:83], a[176:179], v[180:183]
  buffer_load_dwordx4 v237, s[24:27], s36 offen offset:1024 nt lds
  v_mfma_f32_16x16x32_bf16 v[176:179], a[84:87], a[148:151], v[176:179]
  v_exp_f32 v194, v194
  v_mfma_f32_16x16x32_bf16 v[180:183], a[84:87], a[180:183], v[180:183]
  ds_read_b64_tr_b16 a[56:57], v230 offset:33024
  v_cvt_pk_bf16_f32 v212, v192, v193
  v_mfma_f32_16x16x32_bf16 v[176:179], a[88:91], a[152:155], v[176:179]
  v_exp_f32 v195, v195
  v_mfma_f32_16x16x32_bf16 v[180:183], a[88:91], a[184:187], v[180:183]
  ds_read_b64_tr_b16 a[58:59], v230 offset:41216
  v_cvt_pk_bf16_f32 v213, v194, v195
  v_mfma_f32_16x16x32_bf16 v[176:179], a[92:95], a[156:159], v[176:179]
  ds_read_b64_tr_b16 a[60:61], v231 offset:33024
  v_cvt_pk_bf16_f32 v201, v166, v167
  v_mfma_f32_16x16x32_bf16 v[180:183], a[92:95], a[188:191], v[180:183]
  ds_write_b64 v240, v[212:213] offset:2048
  v_add_f32 v215, v215, v165
  v_mfma_f32_16x16x32_bf16 v[184:187], a[96:99], a[128:131], v[242:245]
  v_exp_f32 v172, v172
  v_mfma_f32_16x16x32_bf16 v[188:191], a[96:99], a[160:163], v[246:249]
  ds_read_b64_tr_b16 a[62:63], v231 offset:41216
  v_add_f32 v215, v215, v166
  v_mfma_f32_16x16x32_bf16 v[184:187], a[100:103], a[132:135], v[184:187]
  ds_read_b64_tr_b16 a[0:1], v224 offset:32768
  v_add_f32 v215, v215, v167
  v_mfma_f32_16x16x32_bf16 v[188:191], a[100:103], a[164:167], v[188:191]
  ds_read_b64_tr_b16 a[2:3], v224 offset:40960
  v_add_f32 v215, v215, v172
  v_mfma_f32_16x16x32_bf16 v[184:187], a[104:107], a[136:139], v[184:187]
  v_exp_f32 v173, v173
  v_mfma_f32_16x16x32_bf16 v[188:191], a[104:107], a[168:171], v[188:191]
  ds_read_b64_tr_b16 a[16:17], v228 offset:32768
  v_cvt_pk_bf16_f32 v202, v172, v173
  v_mfma_f32_16x16x32_bf16 v[184:187], a[108:111], a[140:143], v[184:187]
  ds_read_b64_tr_b16 a[18:19], v228 offset:40960
  v_add_f32 v215, v215, v173
  v_mfma_f32_16x16x32_bf16 v[188:191], a[108:111], a[172:175], v[188:191]
  ds_read_b64_tr_b16 a[32:33], v224 offset:33024
  v_add_f32 v216, v216, v192
  v_mfma_f32_16x16x32_bf16 v[184:187], a[112:115], a[144:147], v[184:187]
  ds_read_b64_tr_b16 a[34:35], v224 offset:41216
  v_add_f32 v216, v216, v193
  v_mfma_f32_16x16x32_bf16 v[188:191], a[112:115], a[176:179], v[188:191]
  ds_read_b64_tr_b16 a[48:49], v228 offset:33024
  v_add_f32 v216, v216, v194
  v_mfma_f32_16x16x32_bf16 v[184:187], a[116:119], a[148:151], v[184:187]
  ds_read_b64_tr_b16 a[50:51], v228 offset:41216
  v_add_f32 v216, v216, v195
  v_mfma_f32_16x16x32_bf16 v[188:191], a[116:119], a[180:183], v[188:191]
  v_exp_f32 v174, v174
  v_mfma_f32_16x16x32_bf16 v[184:187], a[120:123], a[152:155], v[184:187]
  buffer_load_dwordx4 v238, s[24:27], s36 offen offset:2048 nt lds
  v_mfma_f32_16x16x32_bf16 v[188:191], a[120:123], a[184:187], v[188:191]
  v_exp_f32 v175, v175
  v_mfma_f32_16x16x32_bf16 v[184:187], a[124:127], a[156:159], v[184:187]
  buffer_load_dwordx4 v239, s[24:27], s36 offen offset:3072 nt lds
  v_cvt_pk_bf16_f32 v203, v174, v175
  v_mfma_f32_16x16x32_bf16 v[188:191], a[124:127], a[188:191], v[188:191]
  v_add_f32 v215, v215, v174
  v_add_f32 v215, v215, v175
  s_waitcnt vmcnt(16) lgkmcnt(0)
  s_barrier
  v_mfma_f32_16x16x32_bf16 v[8:11], a[4:7], v[196:199], v[8:11]
  ds_read_b128 a[64:67], v220 offset:0
  v_mul_f32 v176, s39, v176
  v_mfma_f32_16x16x32_bf16 v[12:15], a[4:7], v[200:203], v[12:15]
  v_exp_f32 v176, v176
  v_mfma_f32_16x16x32_bf16 v[16:19], a[8:11], v[196:199], v[16:19]
  ds_read_b128 a[68:71], v221 offset:0
  v_mul_f32 v177, s39, v177
  v_mfma_f32_16x16x32_bf16 v[20:23], a[8:11], v[200:203], v[20:23]
  ds_read_b128 a[72:75], v222 offset:0
  s_add_u32 s36, s36, 16384
  v_mfma_f32_16x16x32_bf16 v[24:27], a[12:15], v[196:199], v[24:27]
  ds_read_b128 a[76:79], v223 offset:0
  s_add_u32 m0, s38, 49152
  v_mfma_f32_16x16x32_bf16 v[28:31], a[12:15], v[200:203], v[28:31]
  v_exp_f32 v177, v177
  v_mfma_f32_16x16x32_bf16 v[40:43], a[20:23], v[196:199], v[40:43]
  ds_read_b128 a[80:83], v220 offset:256
  v_mul_f32 v178, s39, v178
  v_mfma_f32_16x16x32_bf16 v[44:47], a[20:23], v[200:203], v[44:47]
  buffer_load_dwordx4 v232, s[20:23], s36 offen offset:0 nt lds
  v_mfma_f32_16x16x32_bf16 v[48:51], a[24:27], v[196:199], v[48:51]
  ds_read_b128 a[84:87], v221 offset:256
  v_mul_f32 v179, s39, v179
  v_mfma_f32_16x16x32_bf16 v[52:55], a[24:27], v[200:203], v[52:55]
  v_exp_f32 v178, v178
  v_mfma_f32_16x16x32_bf16 v[56:59], a[28:31], v[196:199], v[56:59]
  ds_read_b128 a[88:91], v222 offset:256
  v_mul_f32 v184, s39, v184
  v_mfma_f32_16x16x32_bf16 v[60:63], a[28:31], v[200:203], v[60:63]
  ds_read_b128 a[92:95], v223 offset:256
  v_mul_f32 v185, s39, v185
  v_mfma_f32_16x16x32_bf16 v[72:75], a[36:39], v[196:199], v[72:75]
  ds_read_b64_tr_b16 a[4:5], v225 offset:49152
  v_mul_f32 v186, s39, v186
  v_mfma_f32_16x16x32_bf16 v[76:79], a[36:39], v[200:203], v[76:79]
  ds_read_b128 a[232:235], v241 offset:2048
  v_mul_f32 v187, s39, v187
  v_mfma_f32_16x16x32_bf16 v[80:83], a[40:43], v[196:199], v[80:83]
  v_exp_f32 v179, v179
  v_mfma_f32_16x16x32_bf16 v[84:87], a[40:43], v[200:203], v[84:87]
  ds_read_b128 a[96:99], v220 offset:8192
  v_mul_f32 v180, s39, v180
  v_mfma_f32_16x16x32_bf16 v[88:91], a[44:47], v[196:199], v[88:91]
  buffer_load_dwordx4 v233, s[20:23], s36 offen offset:1024 nt lds
  v_mfma_f32_16x16x32_bf16 v[92:95], a[44:47], v[200:203], v[92:95]
  ds_read_b128 a[100:103], v221 offset:8192
  v_mul_f32 v181, s39, v181
  v_mfma_f32_16x16x32_bf16 v[104:107], a[52:55], v[196:199], v[104:107]
  v_exp_f32 v184, v184
  v_mfma_f32_16x16x32_bf16 v[108:111], a[52:55], v[200:203], v[108:111]
  ds_read_b128 a[104:107], v222 offset:8192
  v_mul_f32 v182, s39, v182
  v_mfma_f32_16x16x32_bf16 v[112:115], a[56:59], v[196:199], v[112:115]
  ds_read_b64_tr_b16 a[6:7], v225 offset:57344
  v_mul_f32 v183, s39, v183
  v_mfma_f32_16x16x32_bf16 v[116:119], a[56:59], v[200:203], v[116:119]
  ds_read_b128 a[108:111], v223 offset:8192
  v_mul_f32 v188, s39, v188
  v_mfma_f32_16x16x32_bf16 v[120:123], a[60:63], v[196:199], v[120:123]
  v_mul_f32 v189, s39, v189
  v_mfma_f32_16x16x32_bf16 v[124:127], a[60:63], v[200:203], v[124:127]
  v_exp_f32 v185, v185
  v_mfma_f32_16x16x32_bf16 v[0:3], a[0:3], v[196:199], v[0:3]
  ds_read_b128 a[112:115], v220 offset:8448
  v_mul_f32 v190, s39, v190
  v_mfma_f32_16x16x32_bf16 v[4:7], a[0:3], v[200:203], v[4:7]
  buffer_load_dwordx4 v234, s[20:23], s36 offen offset:2048 nt lds
  v_mfma_f32_16x16x32_bf16 v[128:131], a[0:3], a[224:227], v[128:131]
  ds_read_b128 a[116:119], v221 offset:8448
  v_mul_f32 v191, s39, v191
  v_exp_f32 v186, v186
  v_mfma_f32_16x16x32_bf16 v[32:35], a[16:19], v[196:199], v[32:35]
  ds_read_b128 a[120:123], v222 offset:8448
  v_cvt_pk_bf16_f32 v204, v176, v177
  v_mfma_f32_16x16x32_bf16 v[36:39], a[16:19], v[200:203], v[36:39]
  ds_read_b64_tr_b16 a[8:9], v226 offset:49152
  v_cvt_pk_bf16_f32 v205, v178, v179
  v_mfma_f32_16x16x32_bf16 v[136:139], a[16:19], a[224:227], v[136:139]
  ds_read_b128 a[124:127], v223 offset:8448
  ds_read_b64_tr_b16 a[10:11], v226 offset:57344
  v_cvt_pk_bf16_f32 v206, v184, v185
  v_add_f32 v214, v214, v176
  v_mfma_f32_16x16x32_bf16 v[64:67], a[32:35], v[196:199], v[64:67]
  v_exp_f32 v187, v187
  v_mfma_f32_16x16x32_bf16 v[68:71], a[32:35], v[200:203], v[68:71]
  ds_read_b64_tr_b16 a[12:13], v227 offset:49152
  v_cvt_pk_bf16_f32 v207, v186, v187
  v_mfma_f32_16x16x32_bf16 v[144:147], a[32:35], a[224:227], v[144:147]
  buffer_load_dwordx4 v235, s[20:23], s36 offen offset:3072 nt lds
  ds_read_b64_tr_b16 a[14:15], v227 offset:57344
  s_add_u32 m0, s38, 98304
  v_mfma_f32_16x16x32_bf16 v[96:99], a[48:51], v[196:199], v[96:99]
  v_exp_f32 v180, v180
  v_mfma_f32_16x16x32_bf16 v[100:103], a[48:51], v[200:203], v[100:103]
  ds_read_b64_tr_b16 a[20:21], v229 offset:49152
  v_add_f32 v214, v214, v177
  v_mfma_f32_16x16x32_bf16 v[152:155], a[48:51], a[224:227], v[152:155]
  ds_read_b64_tr_b16 a[22:23], v229 offset:57344
  ds_read_b64_tr_b16 a[24:25], v230 offset:49152
  v_add_f32 v214, v214, v178
  s_waitcnt lgkmcnt(6)
  v_mfma_f32_16x16x32_bf16 v[192:195], a[64:67], a[192:195], v[250:253]
  ds_read_b64_tr_b16 a[26:27], v230 offset:57344
  v_add_f32 v214, v214, v179
  v_mfma_f32_16x16x32_bf16 v[192:195], a[68:71], a[196:199], v[192:195]
  v_exp_f32 v181, v181
  v_mfma_f32_16x16x32_bf16 v[192:195], a[72:75], a[200:203], v[192:195]
  ds_read_b64_tr_b16 a[28:29], v231 offset:49152
  v_cvt_pk_bf16_f32 v208, v180, v181
  v_mfma_f32_16x16x32_bf16 v[192:195], a[76:79], a[204:207], v[192:195]
  ds_read_b64_tr_b16 a[30:31], v231 offset:57344
  v_add_f32 v214, v214, v184
  v_mfma_f32_16x16x32_bf16 v[192:195], a[80:83], a[208:211], v[192:195]
  buffer_load_dwordx4 v236, s[24:27], s36 offen offset:0 nt lds
  v_mfma_f32_16x16x32_bf16 v[192:195], a[84:87], a[212:215], v[192:195]
  ds_read_b64_tr_b16 a[36:37], v225 offset:49408
  v_add_f32 v214, v214, v185
  v_mfma_f32_16x16x32_bf16 v[192:195], a[88:91], a[216:219], v[192:195]
  v_exp_f32 v182, v182
  v_mfma_f32_16x16x32_bf16 v[192:195], a[92:95], a[220:223], v[192:195]
  ds_read_b64_tr_b16 a[38:39], v225 offset:57600
  v_add_f32 v214, v214, v186
  v_mfma_f32_16x16x32_bf16 v[160:163], a[64:67], a[128:131], v[242:245]
  ds_read_b64_tr_b16 a[40:41], v226 offset:49408
  v_add_f32 v214, v214, v187
  v_mfma_f32_16x16x32_bf16 v[164:167], a[64:67], a[160:163], v[246:249]
  ds_read_b64_tr_b16 a[42:43], v226 offset:57600
  v_add_f32 v215, v215, v180
  v_mfma_f32_16x16x32_bf16 v[160:163], a[68:71], a[132:135], v[160:163]
  v_exp_f32 v183, v183
  v_mfma_f32_16x16x32_bf16 v[164:167], a[68:71], a[164:167], v[164:167]
  ds_read_b64_tr_b16 a[44:45], v227 offset:49408
  v_mul_f32 v192, s39, v192
  v_mfma_f32_16x16x32_bf16 v[160:163], a[72:75], a[136:139], v[160:163]
  ds_read_b64_tr_b16 a[46:47], v227 offset:57600
  v_mul_f32 v193, s39, v193
  v_mfma_f32_16x16x32_bf16 v[164:167], a[72:75], a[168:171], v[164:167]
  v_exp_f32 v192, v192
  v_mfma_f32_16x16x32_bf16 v[160:163], a[76:79], a[140:143], v[160:163]
  ds_read_b64_tr_b16 a[52:53], v229 offset:49408
  v_mul_f32 v194, s39, v194
  v_mfma_f32_16x16x32_bf16 v[164:167], a[76:79], a[172:175], v[164:167]
  v_exp_f32 v193, v193
  v_mfma_f32_16x16x32_bf16 v[160:163], a[80:83], a[144:147], v[160:163]
  ds_read_b64_tr_b16 a[54:55], v229 offset:57600
  v_mul_f32 v195, s39, v195
  v_mfma_f32_16x16x32_bf16 v[164:167], a[80:83], a[176:179], v[164:167]
  buffer_load_dwordx4 v237, s[24:27], s36 offen offset:1024 nt lds
  v_mfma_f32_16x16x32_bf16 v[160:163], a[84:87], a[148:151], v[160:163]
  v_exp_f32 v194, v194
  v_mfma_f32_16x16x32_bf16 v[164:167], a[84:87], a[180:183], v[164:167]
  ds_read_b64_tr_b16 a[56:57], v230 offset:49408
  v_cvt_pk_bf16_f32 v212, v192, v193
  v_mfma_f32_16x16x32_bf16 v[160:163], a[88:91], a[152:155], v[160:163]
  v_exp_f32 v195, v195
  v_mfma_f32_16x16x32_bf16 v[164:167], a[88:91], a[184:187], v[164:167]
  ds_read_b64_tr_b16 a[58:59], v230 offset:57600
  v_cvt_pk_bf16_f32 v213, v194, v195
  v_mfma_f32_16x16x32_bf16 v[160:163], a[92:95], a[156:159], v[160:163]
  ds_read_b64_tr_b16 a[60:61], v231 offset:49408
  v_cvt_pk_bf16_f32 v209, v182, v183
  v_mfma_f32_16x16x32_bf16 v[164:167], a[92:95], a[188:191], v[164:167]
  ds_write_b64 v240, v[212:213] offset:0
  v_add_f32 v215, v215, v181
  v_mfma_f32_16x16x32_bf16 v[168:171], a[96:99], a[128:131], v[242:245]
  v_exp_f32 v188, v188
  v_mfma_f32_16x16x32_bf16 v[172:175], a[96:99], a[160:163], v[246:249]
  ds_read_b64_tr_b16 a[62:63], v231 offset:57600
  v_add_f32 v215, v215, v182
  v_mfma_f32_16x16x32_bf16 v[168:171], a[100:103], a[132:135], v[168:171]
  ds_read_b64_tr_b16 a[0:1], v224 offset:49152
  v_add_f32 v215, v215, v183
  v_mfma_f32_16x16x32_bf16 v[172:175], a[100:103], a[164:167], v[172:175]
  ds_read_b64_tr_b16 a[2:3], v224 offset:57344
  v_add_f32 v215, v215, v188
  v_mfma_f32_16x16x32_bf16 v[168:171], a[104:107], a[136:139], v[168:171]
  v_exp_f32 v189, v189
  v_mfma_f32_16x16x32_bf16 v[172:175], a[104:107], a[168:171], v[172:175]
  ds_read_b64_tr_b16 a[16:17], v228 offset:49152
  v_cvt_pk_bf16_f32 v210, v188, v189
  v_mfma_f32_16x16x32_bf16 v[168:171], a[108:111], a[140:143], v[168:171]
  ds_read_b64_tr_b16 a[18:19], v228 offset:57344
  v_add_f32 v215, v215, v189
  v_mfma_f32_16x16x32_bf16 v[172:175], a[108:111], a[172:175], v[172:175]
  ds_read_b64_tr_b16 a[32:33], v224 offset:49408
  v_add_f32 v216, v216, v192
  v_mfma_f32_16x16x32_bf16 v[168:171], a[112:115], a[144:147], v[168:171]
  ds_read_b64_tr_b16 a[34:35], v224 offset:57600
  v_add_f32 v216, v216, v193
  v_mfma_f32_16x16x32_bf16 v[172:175], a[112:115], a[176:179], v[172:175]
  ds_read_b64_tr_b16 a[48:49], v228 offset:49408
  v_add_f32 v216, v216, v194
  v_mfma_f32_16x16x32_bf16 v[168:171], a[116:119], a[148:151], v[168:171]
  ds_read_b64_tr_b16 a[50:51], v228 offset:57600
  v_add_f32 v216, v216, v195
  v_mfma_f32_16x16x32_bf16 v[172:175], a[116:119], a[180:183], v[172:175]
  v_exp_f32 v190, v190
  v_mfma_f32_16x16x32_bf16 v[168:171], a[120:123], a[152:155], v[168:171]
  buffer_load_dwordx4 v238, s[24:27], s36 offen offset:2048 nt lds
  v_mfma_f32_16x16x32_bf16 v[172:175], a[120:123], a[184:187], v[172:175]
  v_exp_f32 v191, v191
  v_mfma_f32_16x16x32_bf16 v[168:171], a[124:127], a[156:159], v[168:171]
  buffer_load_dwordx4 v239, s[24:27], s36 offen offset:3072 nt lds
  v_cvt_pk_bf16_f32 v211, v190, v191
  v_mfma_f32_16x16x32_bf16 v[172:175], a[124:127], a[188:191], v[172:175]
  v_add_f32 v215, v215, v190
  v_add_f32 v215, v215, v191
  s_waitcnt vmcnt(16) lgkmcnt(0)
  s_barrier
  v_mfma_f32_16x16x32_bf16 v[8:11], a[4:7], v[204:207], v[8:11]
  ds_read_b128 a[64:67], v220 offset:16384
  v_mul_f32 v160, s39, v160
  v_mfma_f32_16x16x32_bf16 v[12:15], a[4:7], v[208:211], v[12:15]
  v_exp_f32 v160, v160
  v_mfma_f32_16x16x32_bf16 v[16:19], a[8:11], v[204:207], v[16:19]
  ds_read_b128 a[68:71], v221 offset:16384
  v_mul_f32 v161, s39, v161
  v_mfma_f32_16x16x32_bf16 v[20:23], a[8:11], v[208:211], v[20:23]
  ds_read_b128 a[72:75], v222 offset:16384
  s_add_u32 s36, s36, 16384
  v_mfma_f32_16x16x32_bf16 v[24:27], a[12:15], v[204:207], v[24:27]
  ds_read_b128 a[76:79], v223 offset:16384
  s_add_u32 m0, s38, 0
  v_mfma_f32_16x16x32_bf16 v[28:31], a[12:15], v[208:211], v[28:31]
  v_exp_f32 v161, v161
  v_mfma_f32_16x16x32_bf16 v[40:43], a[20:23], v[204:207], v[40:43]
  ds_read_b128 a[80:83], v220 offset:16640
  v_mul_f32 v162, s39, v162
  v_mfma_f32_16x16x32_bf16 v[44:47], a[20:23], v[208:211], v[44:47]
  buffer_load_dwordx4 v232, s[20:23], s36 offen offset:0 nt lds
  v_mfma_f32_16x16x32_bf16 v[48:51], a[24:27], v[204:207], v[48:51]
  ds_read_b128 a[84:87], v221 offset:16640
  v_mul_f32 v163, s39, v163
  v_mfma_f32_16x16x32_bf16 v[52:55], a[24:27], v[208:211], v[52:55]
  v_exp_f32 v162, v162
  v_mfma_f32_16x16x32_bf16 v[56:59], a[28:31], v[204:207], v[56:59]
  ds_read_b128 a[88:91], v222 offset:16640
  v_mul_f32 v168, s39, v168
  v_mfma_f32_16x16x32_bf16 v[60:63], a[28:31], v[208:211], v[60:63]
  ds_read_b128 a[92:95], v223 offset:16640
  v_mul_f32 v169, s39, v169
  v_mfma_f32_16x16x32_bf16 v[72:75], a[36:39], v[204:207], v[72:75]
  ds_read_b64_tr_b16 a[4:5], v225 offset:0
  v_mul_f32 v170, s39, v170
  v_mfma_f32_16x16x32_bf16 v[76:79], a[36:39], v[208:211], v[76:79]
  ds_read_b128 a[224:227], v241 offset:0
  v_mul_f32 v171, s39, v171
  v_mfma_f32_16x16x32_bf16 v[80:83], a[40:43], v[204:207], v[80:83]
  v_exp_f32 v163, v163
  v_mfma_f32_16x16x32_bf16 v[84:87], a[40:43], v[208:211], v[84:87]
  ds_read_b128 a[96:99], v220 offset:24576
  v_mul_f32 v164, s39, v164
  v_mfma_f32_16x16x32_bf16 v[88:91], a[44:47], v[204:207], v[88:91]
  buffer_load_dwordx4 v233, s[20:23], s36 offen offset:1024 nt lds
  v_mfma_f32_16x16x32_bf16 v[92:95], a[44:47], v[208:211], v[92:95]
  ds_read_b128 a[100:103], v221 offset:24576
  v_mul_f32 v165, s39, v165
  v_mfma_f32_16x16x32_bf16 v[104:107], a[52:55], v[204:207], v[104:107]
  v_exp_f32 v168, v168
  v_mfma_f32_16x16x32_bf16 v[108:111], a[52:55], v[208:211], v[108:111]
  ds_read_b128 a[104:107], v222 offset:24576
  v_mul_f32 v166, s39, v166
  v_mfma_f32_16x16x32_bf16 v[112:115], a[56:59], v[204:207], v[112:115]
  ds_read_b64_tr_b16 a[6:7], v225 offset:8192
  v_mul_f32 v167, s39, v167
  v_mfma_f32_16x16x32_bf16 v[116:119], a[56:59], v[208:211], v[116:119]
  ds_read_b128 a[108:111], v223 offset:24576
  v_mul_f32 v172, s39, v172
  v_mfma_f32_16x16x32_bf16 v[120:123], a[60:63], v[204:207], v[120:123]
  v_mul_f32 v173, s39, v173
  v_mfma_f32_16x16x32_bf16 v[124:127], a[60:63], v[208:211], v[124:127]
  v_exp_f32 v169, v169
  v_mfma_f32_16x16x32_bf16 v[0:3], a[0:3], v[204:207], v[0:3]
  ds_read_b128 a[112:115], v220 offset:24832
  v_mul_f32 v174, s39, v174
  v_mfma_f32_16x16x32_bf16 v[4:7], a[0:3], v[208:211], v[4:7]
  buffer_load_dwordx4 v234, s[20:23], s36 offen offset:2048 nt lds
  v_mfma_f32_16x16x32_bf16 v[128:131], a[0:3], a[232:235], v[128:131]
  ds_read_b128 a[116:119], v221 offset:24832
  v_mul_f32 v175, s39, v175
  v_exp_f32 v170, v170
  v_mfma_f32_16x16x32_bf16 v[32:35], a[16:19], v[204:207], v[32:35]
  ds_read_b128 a[120:123], v222 offset:24832
  v_cvt_pk_bf16_f32 v196, v160, v161
  v_mfma_f32_16x16x32_bf16 v[36:39], a[16:19], v[208:211], v[36:39]
  ds_read_b64_tr_b16 a[8:9], v226 offset:0
  v_cvt_pk_bf16_f32 v197, v162, v163
  v_mfma_f32_16x16x32_bf16 v[136:139], a[16:19], a[232:235], v[136:139]
  ds_read_b128 a[124:127], v223 offset:24832
  ds_read_b64_tr_b16 a[10:11], v226 offset:8192
  v_cvt_pk_bf16_f32 v198, v168, v169
  v_add_f32 v214, v214, v160
  v_mfma_f32_16x16x32_bf16 v[64:67], a[32:35], v[204:207], v[64:67]
  v_exp_f32 v171, v171
  v_mfma_f32_16x16x32_bf16 v[68:71], a[32:35], v[208:211], v[68:71]
  ds_read_b64_tr_b16 a[12:13], v227 offset:0
  v_cvt_pk_bf16_f32 v199, v170, v171
  v_mfma_f32_16x16x32_bf16 v[144:147], a[32:35], a[232:235], v[144:147]
  buffer_load_dwordx4 v235, s[20:23], s36 offen offset:3072 nt lds
  ds_read_b64_tr_b16 a[14:15], v227 offset:8192
  s_add_u32 m0, s38, 114688
  v_mfma_f32_16x16x32_bf16 v[96:99], a[48:51], v[204:207], v[96:99]
  v_exp_f32 v164, v164
  v_mfma_f32_16x16x32_bf16 v[100:103], a[48:51], v[208:211], v[100:103]
  ds_read_b64_tr_b16 a[20:21], v229 offset:0
  v_add_f32 v214, v214, v161
  v_mfma_f32_16x16x32_bf16 v[152:155], a[48:51], a[232:235], v[152:155]
  ds_read_b64_tr_b16 a[22:23], v229 offset:8192
  ds_read_b64_tr_b16 a[24:25], v230 offset:0
  v_add_f32 v214, v214, v162
  s_waitcnt lgkmcnt(6)
  v_mfma_f32_16x16x32_bf16 v[192:195], a[64:67], a[192:195], v[250:253]
  ds_read_b64_tr_b16 a[26:27], v230 offset:8192
  v_add_f32 v214, v214, v163
  v_mfma_f32_16x16x32_bf16 v[192:195], a[68:71], a[196:199], v[192:195]
  v_exp_f32 v165, v165
  v_mfma_f32_16x16x32_bf16 v[192:195], a[72:75], a[200:203], v[192:195]
  ds_read_b64_tr_b16 a[28:29], v231 offset:0
  v_cvt_pk_bf16_f32 v200, v164, v165
  v_mfma_f32_16x16x32_bf16 v[192:195], a[76:79], a[204:207], v[192:195]
  ds_read_b64_tr_b16 a[30:31], v231 offset:8192
  v_add_f32 v214, v214, v168
  v_mfma_f32_16x16x32_bf16 v[192:195], a[80:83], a[208:211], v[192:195]
  buffer_load_dwordx4 v236, s[24:27], s36 offen offset:0 nt lds
  v_mfma_f32_16x16x32_bf16 v[192:195], a[84:87], a[212:215], v[192:195]
  ds_read_b64_tr_b16 a[36:37], v225 offset:256
  v_add_f32 v214, v214, v169
  v_mfma_f32_16x16x32_bf16 v[192:195], a[88:91], a[216:219], v[192:195]
  v_exp_f32 v166, v166
  v_mfma_f32_16x16x32_bf16 v[192:195], a[92:95], a[220:223], v[192:195]
  ds_read_b64_tr_b16 a[38:39], v225 offset:8448
  v_add_f32 v214, v214, v170
  v_mfma_f32_16x16x32_bf16 v[176:179], a[64:67], a[128:131], v[242:245]
  ds_read_b64_tr_b16 a[40:41], v226 offset:256
  v_add_f32 v214, v214, v171
  v_mfma_f32_16x16x32_bf16 v[180:183], a[64:67], a[160:163], v[246:249]
  ds_read_b64_tr_b16 a[42:43], v226 offset:8448
  v_add_f32 v215, v215, v164
  v_mfma_f32_16x16x32_bf16 v[176:179], a[68:71], a[132:135], v[176:179]
  v_exp_f32 v167, v167
  v_mfma_f32_16x16x32_bf16 v[180:183], a[68:71], a[164:167], v[180:183]
  ds_read_b64_tr_b16 a[44:45], v227 offset:256
  v_mul_f32 v192, s39, v192
  v_mfma_f32_16x16x32_bf16 v[176:179], a[72:75], a[136:139], v[176:179]
  ds_read_b64_tr_b16 a[46:47], v227 offset:8448
  v_mul_f32 v193, s39, v193
  v_mfma_f32_16x16x32_bf16 v[180:183], a[72:75], a[168:171], v[180:183]
  v_exp_f32 v192, v192
  v_mfma_f32_16x16x32_bf16 v[176:179], a[76:79], a[140:143], v[176:179]
  ds_read_b64_tr_b16 a[52:53], v229 offset:256
  v_mul_f32 v194, s39, v194
  v_mfma_f32_16x16x32_bf16 v[180:183], a[76:79], a[172:175], v[180:183]
  v_exp_f32 v193, v193
  v_mfma_f32_16x16x32_bf16 v[176:179], a[80:83], a[144:147], v[176:179]
  ds_read_b64_tr_b16 a[54:55], v229 offset:8448
  v_mul_f32 v195, s39, v195
  v_mfma_f32_16x16x32_bf16 v[180:183], a[80:83], a[176:179], v[180:183]
  buffer_load_dwordx4 v237, s[24:27], s36 offen offset:1024 nt lds
  v_mfma_f32_16x16x32_bf16 v[176:179], a[84:87], a[148:151], v[176:179]
  v_exp_f32 v194, v194
  v_mfma_f32_16x16x32_bf16 v[180:183], a[84:87], a[180:183], v[180:183]
  ds_read_b64_tr_b16 a[56:57], v230 offset:256
  v_cvt_pk_bf16_f32 v212, v192, v193
  v_mfma_f32_16x16x32_bf16 v[176:179], a[88:91], a[152:155], v[176:179]
  v_exp_f32 v195, v195
  v_mfma_f32_16x16x32_bf16 v[180:183], a[88:91], a[184:187], v[180:183]
  ds_read_b64_tr_b16 a[58:59], v230 offset:8448
  v_cvt_pk_bf16_f32 v213, v194, v195
  v_mfma_f32_16x16x32_bf16 v[176:179], a[92:95], a[156:159], v[176:179]
  ds_read_b64_tr_b16 a[60:61], v231 offset:256
  v_cvt_pk_bf16_f32 v201, v166, v167
  v_mfma_f32_16x16x32_bf16 v[180:183], a[92:95], a[188:191], v[180:183]
  ds_write_b64 v240, v[212:213] offset:2048
  v_add_f32 v215, v215, v165
  v_mfma_f32_16x16x32_bf16 v[184:187], a[96:99], a[128:131], v[242:245]
  v_exp_f32 v172, v172
  v_mfma_f32_16x16x32_bf16 v[188:191], a[96:99], a[160:163], v[246:249]
  ds_read_b64_tr_b16 a[62:63], v231 offset:8448
  v_add_f32 v215, v215, v166
  v_mfma_f32_16x16x32_bf16 v[184:187], a[100:103], a[132:135], v[184:187]
  ds_read_b64_tr_b16 a[0:1], v224 offset:0
  v_add_f32 v215, v215, v167
  v_mfma_f32_16x16x32_bf16 v[188:191], a[100:103], a[164:167], v[188:191]
  ds_read_b64_tr_b16 a[2:3], v224 offset:8192
  v_add_f32 v215, v215, v172
  v_mfma_f32_16x16x32_bf16 v[184:187], a[104:107], a[136:139], v[184:187]
  v_exp_f32 v173, v173
  v_mfma_f32_16x16x32_bf16 v[188:191], a[104:107], a[168:171], v[188:191]
  ds_read_b64_tr_b16 a[16:17], v228 offset:0
  v_cvt_pk_bf16_f32 v202, v172, v173
  v_mfma_f32_16x16x32_bf16 v[184:187], a[108:111], a[140:143], v[184:187]
  ds_read_b64_tr_b16 a[18:19], v228 offset:8192
  v_add_f32 v215, v215, v173
  v_mfma_f32_16x16x32_bf16 v[188:191], a[108:111], a[172:175], v[188:191]
  ds_read_b64_tr_b16 a[32:33], v224 offset:256
  v_add_f32 v216, v216, v192
  v_mfma_f32_16x16x32_bf16 v[184:187], a[112:115], a[144:147], v[184:187]
  ds_read_b64_tr_b16 a[34:35], v224 offset:8448
  v_add_f32 v216, v216, v193
  v_mfma_f32_16x16x32_bf16 v[188:191], a[112:115], a[176:179], v[188:191]
  ds_read_b64_tr_b16 a[48:49], v228 offset:256
  v_add_f32 v216, v216, v194
  v_mfma_f32_16x16x32_bf16 v[184:187], a[116:119], a[148:151], v[184:187]
  ds_read_b64_tr_b16 a[50:51], v228 offset:8448
  v_add_f32 v216, v216, v195
  v_mfma_f32_16x16x32_bf16 v[188:191], a[116:119], a[180:183], v[188:191]
  v_exp_f32 v174, v174
  v_mfma_f32_16x16x32_bf16 v[184:187], a[120:123], a[152:155], v[184:187]
  buffer_load_dwordx4 v238, s[24:27], s36 offen offset:2048 nt lds
  v_mfma_f32_16x16x32_bf16 v[188:191], a[120:123], a[184:187], v[188:191]
  v_exp_f32 v175, v175
  v_mfma_f32_16x16x32_bf16 v[184:187], a[124:127], a[156:159], v[184:187]
  buffer_load_dwordx4 v239, s[24:27], s36 offen offset:3072 nt lds
  v_cvt_pk_bf16_f32 v203, v174, v175
  v_mfma_f32_16x16x32_bf16 v[188:191], a[124:127], a[188:191], v[188:191]
  v_add_f32 v215, v215, v174
  v_add_f32 v215, v215, v175
  s_waitcnt vmcnt(16) lgkmcnt(0)
  s_barrier
  v_mfma_f32_16x16x32_bf16 v[8:11], a[4:7], v[196:199], v[8:11]
  ds_read_b128 a[64:67], v220 offset:32768
  v_mul_f32 v176, s39, v176
  v_mfma_f32_16x16x32_bf16 v[12:15], a[4:7], v[200:203], v[12:15]
  v_exp_f32 v176, v176
  v_mfma_f32_16x16x32_bf16 v[16:19], a[8:11], v[196:199], v[16:19]
  ds_read_b128 a[68:71], v221 offset:32768
  v_mul_f32 v177, s39, v177
  v_mfma_f32_16x16x32_bf16 v[20:23], a[8:11], v[200:203], v[20:23]
  ds_read_b128 a[72:75], v222 offset:32768
  s_add_u32 s36, s36, 16384
  v_mfma_f32_16x16x32_bf16 v[24:27], a[12:15], v[196:199], v[24:27]
  ds_read_b128 a[76:79], v223 offset:32768
  s_add_u32 m0, s38, 16384
  v_mfma_f32_16x16x32_bf16 v[28:31], a[12:15], v[200:203], v[28:31]
  v_exp_f32 v177, v177
  v_mfma_f32_16x16x32_bf16 v[40:43], a[20:23], v[196:199], v[40:43]
  ds_read_b128 a[80:83], v220 offset:33024
  v_mul_f32 v178, s39, v178
  v_mfma_f32_16x16x32_bf16 v[44:47], a[20:23], v[200:203], v[44:47]
  buffer_load_dwordx4 v232, s[20:23], s36 offen offset:0 nt lds
  v_mfma_f32_16x16x32_bf16 v[48:51], a[24:27], v[196:199], v[48:51]
  ds_read_b128 a[84:87], v221 offset:33024
  v_mul_f32 v179, s39, v179
  v_mfma_f32_16x16x32_bf16 v[52:55], a[24:27], v[200:203], v[52:55]
  v_exp_f32 v178, v178
  v_mfma_f32_16x16x32_bf16 v[56:59], a[28:31], v[196:199], v[56:59]
  ds_read_b128 a[88:91], v222 offset:33024
  v_mul_f32 v184, s39, v184
  v_mfma_f32_16x16x32_bf16 v[60:63], a[28:31], v[200:203], v[60:63]
  ds_read_b128 a[92:95], v223 offset:33024
  v_mul_f32 v185, s39, v185
  v_mfma_f32_16x16x32_bf16 v[72:75], a[36:39], v[196:199], v[72:75]
  ds_read_b64_tr_b16 a[4:5], v225 offset:16384
  v_mul_f32 v186, s39, v186
  v_mfma_f32_16x16x32_bf16 v[76:79], a[36:39], v[200:203], v[76:79]
  ds_read_b128 a[232:235], v241 offset:2048
  v_mul_f32 v187, s39, v187
  v_mfma_f32_16x16x32_bf16 v[80:83], a[40:43], v[196:199], v[80:83]
  v_exp_f32 v179, v179
  v_mfma_f32_16x16x32_bf16 v[84:87], a[40:43], v[200:203], v[84:87]
  ds_read_b128 a[96:99], v220 offset:40960
  v_mul_f32 v180, s39, v180
  v_mfma_f32_16x16x32_bf16 v[88:91], a[44:47], v[196:199], v[88:91]
  buffer_load_dwordx4 v233, s[20:23], s36 offen offset:1024 nt lds
  v_mfma_f32_16x16x32_bf16 v[92:95], a[44:47], v[200:203], v[92:95]
  ds_read_b128 a[100:103], v221 offset:40960
  v_mul_f32 v181, s39, v181
  v_mfma_f32_16x16x32_bf16 v[104:107], a[52:55], v[196:199], v[104:107]
  v_exp_f32 v184, v184
  v_mfma_f32_16x16x32_bf16 v[108:111], a[52:55], v[200:203], v[108:111]
  ds_read_b128 a[104:107], v222 offset:40960
  v_mul_f32 v182, s39, v182
  v_mfma_f32_16x16x32_bf16 v[112:115], a[56:59], v[196:199], v[112:115]
  ds_read_b64_tr_b16 a[6:7], v225 offset:24576
  v_mul_f32 v183, s39, v183
  v_mfma_f32_16x16x32_bf16 v[116:119], a[56:59], v[200:203], v[116:119]
  ds_read_b128 a[108:111], v223 offset:40960
  v_mul_f32 v188, s39, v188
  v_mfma_f32_16x16x32_bf16 v[120:123], a[60:63], v[196:199], v[120:123]
  v_mul_f32 v189, s39, v189
  v_mfma_f32_16x16x32_bf16 v[124:127], a[60:63], v[200:203], v[124:127]
  v_exp_f32 v185, v185
  v_mfma_f32_16x16x32_bf16 v[0:3], a[0:3], v[196:199], v[0:3]
  ds_read_b128 a[112:115], v220 offset:41216
  v_mul_f32 v190, s39, v190
  v_mfma_f32_16x16x32_bf16 v[4:7], a[0:3], v[200:203], v[4:7]
  buffer_load_dwordx4 v234, s[20:23], s36 offen offset:2048 nt lds
  v_mfma_f32_16x16x32_bf16 v[128:131], a[0:3], a[224:227], v[128:131]
  ds_read_b128 a[116:119], v221 offset:41216
  v_mul_f32 v191, s39, v191
  v_exp_f32 v186, v186
  v_mfma_f32_16x16x32_bf16 v[32:35], a[16:19], v[196:199], v[32:35]
  ds_read_b128 a[120:123], v222 offset:41216
  v_cvt_pk_bf16_f32 v204, v176, v177
  v_mfma_f32_16x16x32_bf16 v[36:39], a[16:19], v[200:203], v[36:39]
  ds_read_b64_tr_b16 a[8:9], v226 offset:16384
  v_cvt_pk_bf16_f32 v205, v178, v179
  v_mfma_f32_16x16x32_bf16 v[136:139], a[16:19], a[224:227], v[136:139]
  ds_read_b128 a[124:127], v223 offset:41216
  ds_read_b64_tr_b16 a[10:11], v226 offset:24576
  v_cvt_pk_bf16_f32 v206, v184, v185
  v_add_f32 v214, v214, v176
  v_mfma_f32_16x16x32_bf16 v[64:67], a[32:35], v[196:199], v[64:67]
  v_exp_f32 v187, v187
  v_mfma_f32_16x16x32_bf16 v[68:71], a[32:35], v[200:203], v[68:71]
  ds_read_b64_tr_b16 a[12:13], v227 offset:16384
  v_cvt_pk_bf16_f32 v207, v186, v187
  v_mfma_f32_16x16x32_bf16 v[144:147], a[32:35], a[224:227], v[144:147]
  buffer_load_dwordx4 v235, s[20:23], s36 offen offset:3072 nt lds
  ds_read_b64_tr_b16 a[14:15], v227 offset:24576
  s_add_u32 m0, s38, 65536
  v_mfma_f32_16x16x32_bf16 v[96:99], a[48:51], v[196:199], v[96:99]
  v_exp_f32 v180, v180
  v_mfma_f32_16x16x32_bf16 v[100:103], a[48:51], v[200:203], v[100:103]
  ds_read_b64_tr_b16 a[20:21], v229 offset:16384
  v_add_f32 v214, v214, v177
  v_mfma_f32_16x16x32_bf16 v[152:155], a[48:51], a[224:227], v[152:155]
  ds_read_b64_tr_b16 a[22:23], v229 offset:24576
  ds_read_b64_tr_b16 a[24:25], v230 offset:16384
  v_add_f32 v214, v214, v178
  s_waitcnt lgkmcnt(6)
  s_add_u32 s40, s40, 1
  s_cmp_lt_u32 s40, 7
  s_cbranch_scc1 L_loop_k0q1p0
  v_mfma_f32_16x16x32_bf16 v[192:195], a[64:67], a[192:195], v[250:253]
  ds_read_b64_tr_b16 a[26:27], v230 offset:24576
  v_add_f32 v214, v214, v179
  v_mfma_f32_16x16x32_bf16 v[192:195], a[68:71], a[196:199], v[192:195]
  v_exp_f32 v181, v181
  v_mfma_f32_16x16x32_bf16 v[192:195], a[72:75], a[200:203], v[192:195]
  ds_read_b64_tr_b16 a[28:29], v231 offset:16384
  v_cvt_pk_bf16_f32 v208, v180, v181
  v_mfma_f32_16x16x32_bf16 v[192:195], a[76:79], a[204:207], v[192:195]
  ds_read_b64_tr_b16 a[30:31], v231 offset:24576
  v_add_f32 v214, v214, v184
  v_mfma_f32_16x16x32_bf16 v[192:195], a[80:83], a[208:211], v[192:195]
  v_mfma_f32_16x16x32_bf16 v[192:195], a[84:87], a[212:215], v[192:195]
  ds_read_b64_tr_b16 a[36:37], v225 offset:16640
  v_add_f32 v214, v214, v185
  v_mfma_f32_16x16x32_bf16 v[192:195], a[88:91], a[216:219], v[192:195]
  v_exp_f32 v182, v182
  v_mfma_f32_16x16x32_bf16 v[192:195], a[92:95], a[220:223], v[192:195]
  ds_read_b64_tr_b16 a[38:39], v225 offset:24832
  v_add_f32 v214, v214, v186
  v_mfma_f32_16x16x32_bf16 v[160:163], a[64:67], a[128:131], v[242:245]
  ds_read_b64_tr_b16 a[40:41], v226 offset:16640
  v_add_f32 v214, v214, v187
  v_mfma_f32_16x16x32_bf16 v[164:167], a[64:67], a[160:163], v[246:249]
  ds_read_b64_tr_b16 a[42:43], v226 offset:24832
  v_add_f32 v215, v215, v180
  v_mfma_f32_16x16x32_bf16 v[160:163], a[68:71], a[132:135], v[160:163]
  v_exp_f32 v183, v183
  v_mfma_f32_16x16x32_bf16 v[164:167], a[68:71], a[164:167], v[164:167]
  ds_read_b64_tr_b16 a[44:45], v227 offset:16640
  v_mul_f32 v192, s39, v192
  v_mfma_f32_16x16x32_bf16 v[160:163], a[72:75], a[136:139], v[160:163]
  ds_read_b64_tr_b16 a[46:47], v227 offset:24832
  v_mul_f32 v193, s39, v193
  v_mfma_f32_16x16x32_bf16 v[164:167], a[72:75], a[168:171], v[164:167]
  v_exp_f32 v192, v192
  v_mfma_f32_16x16x32_bf16 v[160:163], a[76:79], a[140:143], v[160:163]
  ds_read_b64_tr_b16 a[52:53], v229 offset:16640
  v_mul_f32 v194, s39, v194
  v_mfma_f32_16x16x32_bf16 v[164:167], a[76:79], a[172:175], v[164:167]
  v_exp_f32 v193, v193
  v_mfma_f32_16x16x32_bf16 v[160:163], a[80:83], a[144:147], v[160:163]
  ds_read_b64_tr_b16 a[54:55], v229 offset:24832
  v_mul_f32 v195, s39, v195
  v_mfma_f32_16x16x32_bf16 v[164:167], a[80:83], a[176:179], v[164:167]
  v_mfma_f32_16x16x32_bf16 v[160:163], a[84:87], a[148:151], v[160:163]
  v_exp_f32 v194, v194
  v_mfma_f32_16x16x32_bf16 v[164:167], a[84:87], a[180:183], v[164:167]
  ds_read_b64_tr_b16 a[56:57], v230 offset:16640
  v_cvt_pk_bf16_f32 v212, v192, v193
  v_mfma_f32_16x16x32_bf16 v[160:163], a[88:91], a[152:155], v[160:163]
  v_exp_f32 v195, v195
  v_mfma_f32_16x16x32_bf16 v[164:167], a[88:91], a[184:187], v[164:167]
  ds_read_b64_tr_b16 a[58:59], v230 offset:24832
  v_cvt_pk_bf16_f32 v213, v194, v195
  v_mfma_f32_16x16x32_bf16 v[160:163], a[92:95], a[156:159], v[160:163]
  ds_read_b64_tr_b16 a[60:61], v231 offset:16640
  v_cvt_pk_bf16_f32 v209, v182, v183
  v_mfma_f32_16x16x32_bf16 v[164:167], a[92:95], a[188:191], v[164:167]
  ds_write_b64 v240, v[212:213] offset:0
  v_add_f32 v215, v215, v181
  v_mfma_f32_16x16x32_bf16 v[168:171], a[96:99], a[128:131], v[242:245]
  v_exp_f32 v188, v188
  v_mfma_f32_16x16x32_bf16 v[172:175], a[96:99], a[160:163], v[246:249]
  ds_read_b64_tr_b16 a[62:63], v231 offset:24832
  v_add_f32 v215, v215, v182
  v_mfma_f32_16x16x32_bf16 v[168:171], a[100:103], a[132:135], v[168:171]
  ds_read_b64_tr_b16 a[0:1], v224 offset:16384
  v_add_f32 v215, v215, v183
  v_mfma_f32_16x16x32_bf16 v[172:175], a[100:103], a[164:167], v[172:175]
  ds_read_b64_tr_b16 a[2:3], v224 offset:24576
  v_add_f32 v215, v215, v188
  v_mfma_f32_16x16x32_bf16 v[168:171], a[104:107], a[136:139], v[168:171]
  v_exp_f32 v189, v189
  v_mfma_f32_16x16x32_bf16 v[172:175], a[104:107], a[168:171], v[172:175]
  ds_read_b64_tr_b16 a[16:17], v228 offset:16384
  v_cvt_pk_bf16_f32 v210, v188, v189
  v_mfma_f32_16x16x32_bf16 v[168:171], a[108:111], a[140:143], v[168:171]
  ds_read_b64_tr_b16 a[18:19], v228 offset:24576
  v_add_f32 v215, v215, v189
  v_mfma_f32_16x16x32_bf16 v[172:175], a[108:111], a[172:175], v[172:175]
  ds_read_b64_tr_b16 a[32:33], v224 offset:16640
  v_add_f32 v216, v216, v192
  v_mfma_f32_16x16x32_bf16 v[168:171], a[112:115], a[144:147], v[168:171]
  ds_read_b64_tr_b16 a[34:35], v224 offset:24832
  v_add_f32 v216, v216, v193
  v_mfma_f32_16x16x32_bf16 v[172:175], a[112:115], a[176:179], v[172:175]
  ds_read_b64_tr_b16 a[48:49], v228 offset:16640
  v_add_f32 v216, v216, v194
  v_mfma_f32_16x16x32_bf16 v[168:171], a[116:119], a[148:151], v[168:171]
  ds_read_b64_tr_b16 a[50:51], v228 offset:24832
  v_add_f32 v216, v216, v195
  v_mfma_f32_16x16x32_bf16 v[172:175], a[116:119], a[180:183], v[172:175]
  v_exp_f32 v190, v190
  v_mfma_f32_16x16x32_bf16 v[168:171], a[120:123], a[152:155], v[168:171]
  v_mfma_f32_16x16x32_bf16 v[172:175], a[120:123], a[184:187], v[172:175]
  v_exp_f32 v191, v191
  v_mfma_f32_16x16x32_bf16 v[168:171], a[124:127], a[156:159], v[168:171]
  v_cvt_pk_bf16_f32 v211, v190, v191
  v_mfma_f32_16x16x32_bf16 v[172:175], a[124:127], a[188:191], v[172:175]
  v_add_f32 v215, v215, v190
  v_add_f32 v215, v215, v191
  s_waitcnt vmcnt(12) lgkmcnt(0)
  s_barrier
  v_mfma_f32_16x16x32_bf16 v[8:11], a[4:7], v[204:207], v[8:11]
  ds_read_b128 a[64:67], v220 offset:49152
  v_mul_f32 v160, s39, v160
  v_mfma_f32_16x16x32_bf16 v[12:15], a[4:7], v[208:211], v[12:15]
  v_exp_f32 v160, v160
  v_mfma_f32_16x16x32_bf16 v[16:19], a[8:11], v[204:207], v[16:19]
  ds_read_b128 a[68:71], v221 offset:49152
  v_mul_f32 v161, s39, v161
  v_mfma_f32_16x16x32_bf16 v[20:23], a[8:11], v[208:211], v[20:23]
  ds_read_b128 a[72:75], v222 offset:49152
  v_mfma_f32_16x16x32_bf16 v[24:27], a[12:15], v[204:207], v[24:27]
  ds_read_b128 a[76:79], v223 offset:49152
  v_mfma_f32_16x16x32_bf16 v[28:31], a[12:15], v[208:211], v[28:31]
  v_exp_f32 v161, v161
  v_mfma_f32_16x16x32_bf16 v[40:43], a[20:23], v[204:207], v[40:43]
  ds_read_b128 a[80:83], v220 offset:49408
  v_mul_f32 v162, s39, v162
  v_mfma_f32_16x16x32_bf16 v[44:47], a[20:23], v[208:211], v[44:47]
  v_mfma_f32_16x16x32_bf16 v[48:51], a[24:27], v[204:207], v[48:51]
  ds_read_b128 a[84:87], v221 offset:49408
  v_mul_f32 v163, s39, v163
  v_mfma_f32_16x16x32_bf16 v[52:55], a[24:27], v[208:211], v[52:55]
  v_exp_f32 v162, v162
  v_mfma_f32_16x16x32_bf16 v[56:59], a[28:31], v[204:207], v[56:59]
  ds_read_b128 a[88:91], v222 offset:49408
  v_mul_f32 v168, s39, v168
  v_mfma_f32_16x16x32_bf16 v[60:63], a[28:31], v[208:211], v[60:63]
  ds_read_b128 a[92:95], v223 offset:49408
  v_mul_f32 v169, s39, v169
  v_mfma_f32_16x16x32_bf16 v[72:75], a[36:39], v[204:207], v[72:75]
  ds_read_b64_tr_b16 a[4:5], v225 offset:32768
  v_mul_f32 v170, s39, v170
  v_mfma_f32_16x16x32_bf16 v[76:79], a[36:39], v[208:211], v[76:79]
  ds_read_b128 a[224:227], v241 offset:0
  v_mul_f32 v171, s39, v171
  v_mfma_f32_16x16x32_bf16 v[80:83], a[40:43], v[204:207], v[80:83]
  v_exp_f32 v163, v163
  v_mfma_f32_16x16x32_bf16 v[84:87], a[40:43], v[208:211], v[84:87]
  ds_read_b128 a[96:99], v220 offset:57344
  v_mul_f32 v164, s39, v164
  v_mfma_f32_16x16x32_bf16 v[88:91], a[44:47], v[204:207], v[88:91]
  v_mfma_f32_16x16x32_bf16 v[92:95], a[44:47], v[208:211], v[92:95]
  ds_read_b128 a[100:103], v221 offset:57344
  v_mul_f32 v165, s39, v165
  v_mfma_f32_16x16x32_bf16 v[104:107], a[52:55], v[204:207], v[104:107]
  v_exp_f32 v168, v168
  v_mfma_f32_16x16x32_bf16 v[108:111], a[52:55], v[208:211], v[108:111]
  ds_read_b128 a[104:107], v222 offset:57344
  v_mul_f32 v166, s39, v166
  v_mfma_f32_16x16x32_bf16 v[112:115], a[56:59], v[204:207], v[112:115]
  ds_read_b64_tr_b16 a[6:7], v225 offset:40960
  v_mul_f32 v167, s39, v167
  v_mfma_f32_16x16x32_bf16 v[116:119], a[56:59], v[208:211], v[116:119]
  ds_read_b128 a[108:111], v223 offset:57344
  v_mul_f32 v172, s39, v172
  v_mfma_f32_16x16x32_bf16 v[120:123], a[60:63], v[204:207], v[120:123]
  v_mul_f32 v173, s39, v173
  v_mfma_f32_16x16x32_bf16 v[124:127], a[60:63], v[208:211], v[124:127]
  v_exp_f32 v169, v169
  v_mfma_f32_16x16x32_bf16 v[0:3], a[0:3], v[204:207], v[0:3]
  ds_read_b128 a[112:115], v220 offset:57600
  v_mul_f32 v174, s39, v174
  v_mfma_f32_16x16x32_bf16 v[4:7], a[0:3], v[208:211], v[4:7]
  v_mfma_f32_16x16x32_bf16 v[128:131], a[0:3], a[232:235], v[128:131]
  ds_read_b128 a[116:119], v221 offset:57600
  v_mul_f32 v175, s39, v175
  v_exp_f32 v170, v170
  v_mfma_f32_16x16x32_bf16 v[32:35], a[16:19], v[204:207], v[32:35]
  ds_read_b128 a[120:123], v222 offset:57600
  v_cvt_pk_bf16_f32 v196, v160, v161
  v_mfma_f32_16x16x32_bf16 v[36:39], a[16:19], v[208:211], v[36:39]
  ds_read_b64_tr_b16 a[8:9], v226 offset:32768
  v_cvt_pk_bf16_f32 v197, v162, v163
  v_mfma_f32_16x16x32_bf16 v[136:139], a[16:19], a[232:235], v[136:139]
  ds_read_b128 a[124:127], v223 offset:57600
  ds_read_b64_tr_b16 a[10:11], v226 offset:40960
  v_cvt_pk_bf16_f32 v198, v168, v169
  v_add_f32 v214, v214, v160
  v_mfma_f32_16x16x32_bf16 v[64:67], a[32:35], v[204:207], v[64:67]
  v_exp_f32 v171, v171
  v_mfma_f32_16x16x32_bf16 v[68:71], a[32:35], v[208:211], v[68:71]
  ds_read_b64_tr_b16 a[12:13], v227 offset:32768
  v_cvt_pk_bf16_f32 v199, v170, v171
  v_mfma_f32_16x16x32_bf16 v[144:147], a[32:35], a[232:235], v[144:147]
  ds_read_b64_tr_b16 a[14:15], v227 offset:40960
  v_mfma_f32_16x16x32_bf16 v[96:99], a[48:51], v[204:207], v[96:99]
  v_exp_f32 v164, v164
  v_mfma_f32_16x16x32_bf16 v[100:103], a[48:51], v[208:211], v[100:103]
  ds_read_b64_tr_b16 a[20:21], v229 offset:32768
  v_add_f32 v214, v214, v161
  v_mfma_f32_16x16x32_bf16 v[152:155], a[48:51], a[232:235], v[152:155]
  ds_read_b64_tr_b16 a[22:23], v229 offset:40960
  ds_read_b64_tr_b16 a[24:25], v230 offset:32768
  v_add_f32 v214, v214, v162
  s_waitcnt lgkmcnt(6)
  v_mfma_f32_16x16x32_bf16 v[192:195], a[64:67], a[192:195], v[250:253]
  ds_read_b64_tr_b16 a[26:27], v230 offset:40960
  v_add_f32 v214, v214, v163
  v_mfma_f32_16x16x32_bf16 v[192:195], a[68:71], a[196:199], v[192:195]
  v_exp_f32 v165, v165
  v_mfma_f32_16x16x32_bf16 v[192:195], a[72:75], a[200:203], v[192:195]
  ds_read_b64_tr_b16 a[28:29], v231 offset:32768
  v_cvt_pk_bf16_f32 v200, v164, v165
  v_mfma_f32_16x16x32_bf16 v[192:195], a[76:79], a[204:207], v[192:195]
  ds_read_b64_tr_b16 a[30:31], v231 offset:40960
  v_add_f32 v214, v214, v168
  v_mfma_f32_16x16x32_bf16 v[192:195], a[80:83], a[208:211], v[192:195]
  v_mfma_f32_16x16x32_bf16 v[192:195], a[84:87], a[212:215], v[192:195]
  ds_read_b64_tr_b16 a[36:37], v225 offset:33024
  v_add_f32 v214, v214, v169
  v_mfma_f32_16x16x32_bf16 v[192:195], a[88:91], a[216:219], v[192:195]
  v_exp_f32 v166, v166
  v_mfma_f32_16x16x32_bf16 v[192:195], a[92:95], a[220:223], v[192:195]
  ds_read_b64_tr_b16 a[38:39], v225 offset:41216
  v_add_f32 v214, v214, v170
  v_mfma_f32_16x16x32_bf16 v[176:179], a[64:67], a[128:131], v[242:245]
  ds_read_b64_tr_b16 a[40:41], v226 offset:33024
  v_add_f32 v214, v214, v171
  v_mfma_f32_16x16x32_bf16 v[180:183], a[64:67], a[160:163], v[246:249]
  ds_read_b64_tr_b16 a[42:43], v226 offset:41216
  v_add_f32 v215, v215, v164
  v_mfma_f32_16x16x32_bf16 v[176:179], a[68:71], a[132:135], v[176:179]
  v_exp_f32 v167, v167
  v_mfma_f32_16x16x32_bf16 v[180:183], a[68:71], a[164:167], v[180:183]
  ds_read_b64_tr_b16 a[44:45], v227 offset:33024
  v_mul_f32 v192, s39, v192
  v_mfma_f32_16x16x32_bf16 v[176:179], a[72:75], a[136:139], v[176:179]
  ds_read_b64_tr_b16 a[46:47], v227 offset:41216
  v_mul_f32 v193, s39, v193
  v_mfma_f32_16x16x32_bf16 v[180:183], a[72:75], a[168:171], v[180:183]
  v_exp_f32 v192, v192
  v_mfma_f32_16x16x32_bf16 v[176:179], a[76:79], a[140:143], v[176:179]
  ds_read_b64_tr_b16 a[52:53], v229 offset:33024
  v_mul_f32 v194, s39, v194
  v_mfma_f32_16x16x32_bf16 v[180:183], a[76:79], a[172:175], v[180:183]
  v_exp_f32 v193, v193
  v_mfma_f32_16x16x32_bf16 v[176:179], a[80:83], a[144:147], v[176:179]
  ds_read_b64_tr_b16 a[54:55], v229 offset:41216
  v_mul_f32 v195, s39, v195
  v_mfma_f32_16x16x32_bf16 v[180:183], a[80:83], a[176:179], v[180:183]
  v_mfma_f32_16x16x32_bf16 v[176:179], a[84:87], a[148:151], v[176:179]
  v_exp_f32 v194, v194
  v_mfma_f32_16x16x32_bf16 v[180:183], a[84:87], a[180:183], v[180:183]
  ds_read_b64_tr_b16 a[56:57], v230 offset:33024
  v_cvt_pk_bf16_f32 v212, v192, v193
  v_mfma_f32_16x16x32_bf16 v[176:179], a[88:91], a[152:155], v[176:179]
  v_exp_f32 v195, v195
  v_mfma_f32_16x16x32_bf16 v[180:183], a[88:91], a[184:187], v[180:183]
  ds_read_b64_tr_b16 a[58:59], v230 offset:41216
  v_cvt_pk_bf16_f32 v213, v194, v195
  v_mfma_f32_16x16x32_bf16 v[176:179], a[92:95], a[156:159], v[176:179]
  ds_read_b64_tr_b16 a[60:61], v231 offset:33024
  v_cvt_pk_bf16_f32 v201, v166, v167
  v_mfma_f32_16x16x32_bf16 v[180:183], a[92:95], a[188:191], v[180:183]
  ds_write_b64 v240, v[212:213] offset:2048
  v_add_f32 v215, v215, v165
  v_mfma_f32_16x16x32_bf16 v[184:187], a[96:99], a[128:131], v[242:245]
  v_exp_f32 v172, v172
  v_mfma_f32_16x16x32_bf16 v[188:191], a[96:99], a[160:163], v[246:249]
  ds_read_b64_tr_b16 a[62:63], v231 offset:41216
  v_add_f32 v215, v215, v166
  v_mfma_f32_16x16x32_bf16 v[184:187], a[100:103], a[132:135], v[184:187]
  ds_read_b64_tr_b16 a[0:1], v224 offset:32768
  v_add_f32 v215, v215, v167
  v_mfma_f32_16x16x32_bf16 v[188:191], a[100:103], a[164:167], v[188:191]
  ds_read_b64_tr_b16 a[2:3], v224 offset:40960
  v_add_f32 v215, v215, v172
  v_mfma_f32_16x16x32_bf16 v[184:187], a[104:107], a[136:139], v[184:187]
  v_exp_f32 v173, v173
  v_mfma_f32_16x16x32_bf16 v[188:191], a[104:107], a[168:171], v[188:191]
  ds_read_b64_tr_b16 a[16:17], v228 offset:32768
  v_cvt_pk_bf16_f32 v202, v172, v173
  v_mfma_f32_16x16x32_bf16 v[184:187], a[108:111], a[140:143], v[184:187]
  ds_read_b64_tr_b16 a[18:19], v228 offset:40960
  v_add_f32 v215, v215, v173
  v_mfma_f32_16x16x32_bf16 v[188:191], a[108:111], a[172:175], v[188:191]
  ds_read_b64_tr_b16 a[32:33], v224 offset:33024
  v_add_f32 v216, v216, v192
  v_mfma_f32_16x16x32_bf16 v[184:187], a[112:115], a[144:147], v[184:187]
  ds_read_b64_tr_b16 a[34:35], v224 offset:41216
  v_add_f32 v216, v216, v193
  v_mfma_f32_16x16x32_bf16 v[188:191], a[112:115], a[176:179], v[188:191]
  ds_read_b64_tr_b16 a[48:49], v228 offset:33024
  v_add_f32 v216, v216, v194
  v_mfma_f32_16x16x32_bf16 v[184:187], a[116:119], a[148:151], v[184:187]
  ds_read_b64_tr_b16 a[50:51], v228 offset:41216
  v_add_f32 v216, v216, v195
  v_mfma_f32_16x16x32_bf16 v[188:191], a[116:119], a[180:183], v[188:191]
  v_exp_f32 v174, v174
  v_mfma_f32_16x16x32_bf16 v[184:187], a[120:123], a[152:155], v[184:187]
  v_mfma_f32_16x16x32_bf16 v[188:191], a[120:123], a[184:187], v[188:191]
  v_exp_f32 v175, v175
  v_mfma_f32_16x16x32_bf16 v[184:187], a[124:127], a[156:159], v[184:187]
  v_cvt_pk_bf16_f32 v203, v174, v175
  v_mfma_f32_16x16x32_bf16 v[188:191], a[124:127], a[188:191], v[188:191]
  v_add_f32 v215, v215, v174
  v_add_f32 v215, v215, v175
  s_waitcnt vmcnt(4) lgkmcnt(0)
  s_barrier
  v_mfma_f32_16x16x32_bf16 v[8:11], a[4:7], v[196:199], v[8:11]
  v_mul_f32 v176, s39, v176
  v_mfma_f32_16x16x32_bf16 v[12:15], a[4:7], v[200:203], v[12:15]
  ds_read_b64_tr_b16 a[4:5], v225 offset:49152
  v_exp_f32 v176, v176
  v_mfma_f32_16x16x32_bf16 v[16:19], a[8:11], v[196:199], v[16:19]
  ds_read_b64_tr_b16 a[6:7], v225 offset:57344
  v_mul_f32 v177, s39, v177
  v_mfma_f32_16x16x32_bf16 v[20:23], a[8:11], v[200:203], v[20:23]
  ds_read_b64_tr_b16 a[8:9], v226 offset:49152
  v_mfma_f32_16x16x32_bf16 v[24:27], a[12:15], v[196:199], v[24:27]
  ds_read_b64_tr_b16 a[10:11], v226 offset:57344
  v_mfma_f32_16x16x32_bf16 v[28:31], a[12:15], v[200:203], v[28:31]
  ds_read_b64_tr_b16 a[12:13], v227 offset:49152
  v_exp_f32 v177, v177
  v_mfma_f32_16x16x32_bf16 v[40:43], a[20:23], v[196:199], v[40:43]
  ds_read_b64_tr_b16 a[14:15], v227 offset:57344
  v_mul_f32 v178, s39, v178
  v_mfma_f32_16x16x32_bf16 v[44:47], a[20:23], v[200:203], v[44:47]
  ds_read_b64_tr_b16 a[20:21], v229 offset:49152
  v_mfma_f32_16x16x32_bf16 v[48:51], a[24:27], v[196:199], v[48:51]
  ds_read_b64_tr_b16 a[22:23], v229 offset:57344
  v_mul_f32 v179, s39, v179
  v_mfma_f32_16x16x32_bf16 v[52:55], a[24:27], v[200:203], v[52:55]
  ds_read_b64_tr_b16 a[24:25], v230 offset:49152
  v_exp_f32 v178, v178
  v_mfma_f32_16x16x32_bf16 v[56:59], a[28:31], v[196:199], v[56:59]
  ds_read_b64_tr_b16 a[26:27], v230 offset:57344
  v_mul_f32 v184, s39, v184
  v_mfma_f32_16x16x32_bf16 v[60:63], a[28:31], v[200:203], v[60:63]
  ds_read_b64_tr_b16 a[28:29], v231 offset:49152
  v_mul_f32 v185, s39, v185
  v_mfma_f32_16x16x32_bf16 v[72:75], a[36:39], v[196:199], v[72:75]
  ds_read_b64_tr_b16 a[30:31], v231 offset:57344
  v_mul_f32 v186, s39, v186
  v_mfma_f32_16x16x32_bf16 v[76:79], a[36:39], v[200:203], v[76:79]
  ds_read_b128 a[232:235], v241 offset:2048
  v_mul_f32 v187, s39, v187
  v_mfma_f32_16x16x32_bf16 v[80:83], a[40:43], v[196:199], v[80:83]
  ds_read_b64_tr_b16 a[36:37], v225 offset:49408
  v_exp_f32 v179, v179
  v_mfma_f32_16x16x32_bf16 v[84:87], a[40:43], v[200:203], v[84:87]
  ds_read_b64_tr_b16 a[38:39], v225 offset:57600
  v_mul_f32 v180, s39, v180
  v_mfma_f32_16x16x32_bf16 v[88:91], a[44:47], v[196:199], v[88:91]
  ds_read_b64_tr_b16 a[40:41], v226 offset:49408
  v_mfma_f32_16x16x32_bf16 v[92:95], a[44:47], v[200:203], v[92:95]
  ds_read_b64_tr_b16 a[42:43], v226 offset:57600
  v_mul_f32 v181, s39, v181
  v_mfma_f32_16x16x32_bf16 v[104:107], a[52:55], v[196:199], v[104:107]
  ds_read_b64_tr_b16 a[44:45], v227 offset:49408
  v_exp_f32 v184, v184
  v_mfma_f32_16x16x32_bf16 v[108:111], a[52:55], v[200:203], v[108:111]
  ds_read_b64_tr_b16 a[46:47], v227 offset:57600
  v_mul_f32 v182, s39, v182
  v_mfma_f32_16x16x32_bf16 v[112:115], a[56:59], v[196:199], v[112:115]
  ds_read_b64_tr_b16 a[52:53], v229 offset:49408
  v_mul_f32 v183, s39, v183
  v_mfma_f32_16x16x32_bf16 v[116:119], a[56:59], v[200:203], v[116:119]
  ds_read_b64_tr_b16 a[54:55], v229 offset:57600
  v_mul_f32 v188, s39, v188
  v_mfma_f32_16x16x32_bf16 v[120:123], a[60:63], v[196:199], v[120:123]
  ds_read_b64_tr_b16 a[56:57], v230 offset:49408
  v_mul_f32 v189, s39, v189
  v_mfma_f32_16x16x32_bf16 v[124:127], a[60:63], v[200:203], v[124:127]
  ds_read_b64_tr_b16 a[58:59], v230 offset:57600
  v_exp_f32 v185, v185
  v_mfma_f32_16x16x32_bf16 v[0:3], a[0:3], v[196:199], v[0:3]
  ds_read_b64_tr_b16 a[60:61], v231 offset:49408
  v_mul_f32 v190, s39, v190
  v_mfma_f32_16x16x32_bf16 v[4:7], a[0:3], v[200:203], v[4:7]
  ds_read_b64_tr_b16 a[62:63], v231 offset:57600
  v_mfma_f32_16x16x32_bf16 v[128:131], a[0:3], a[224:227], v[128:131]
  ds_read_b64_tr_b16 a[0:1], v224 offset:49152
  v_mul_f32 v191, s39, v191
  v_exp_f32 v186, v186
  v_mfma_f32_16x16x32_bf16 v[32:35], a[16:19], v[196:199], v[32:35]
  ds_read_b64_tr_b16 a[2:3], v224 offset:57344
  v_cvt_pk_bf16_f32 v204, v176, v177
  v_mfma_f32_16x16x32_bf16 v[36:39], a[16:19], v[200:203], v[36:39]
  v_cvt_pk_bf16_f32 v205, v178, v179
  v_mfma_f32_16x16x32_bf16 v[136:139], a[16:19], a[224:227], v[136:139]
  ds_read_b64_tr_b16 a[16:17], v228 offset:49152
  v_cvt_pk_bf16_f32 v206, v184, v185
  v_add_f32 v214, v214, v176
  v_mfma_f32_16x16x32_bf16 v[64:67], a[32:35], v[196:199], v[64:67]
  ds_read_b64_tr_b16 a[18:19], v228 offset:57344
  v_exp_f32 v187, v187
  v_mfma_f32_16x16x32_bf16 v[68:71], a[32:35], v[200:203], v[68:71]
  v_cvt_pk_bf16_f32 v207, v186, v187
  v_mfma_f32_16x16x32_bf16 v[144:147], a[32:35], a[224:227], v[144:147]
  ds_read_b64_tr_b16 a[32:33], v224 offset:49408
  v_mfma_f32_16x16x32_bf16 v[96:99], a[48:51], v[196:199], v[96:99]
  ds_read_b64_tr_b16 a[34:35], v224 offset:57600
  v_exp_f32 v180, v180
  v_mfma_f32_16x16x32_bf16 v[100:103], a[48:51], v[200:203], v[100:103]
  v_add_f32 v214, v214, v177
  v_mfma_f32_16x16x32_bf16 v[152:155], a[48:51], a[224:227], v[152:155]
  ds_read_b64_tr_b16 a[48:49], v228 offset:49408
  v_add_f32 v214, v214, v178
  s_waitcnt lgkmcnt(15)
  v_mfma_f32_16x16x32_bf16 v[8:11], a[4:7], v[204:207], v[8:11]
  ds_read_b64_tr_b16 a[50:51], v228 offset:57600
  v_mfma_f32_16x16x32_bf16 v[16:19], a[8:11], v[204:207], v[16:19]
  v_exp_f32 v181, v181
  v_mfma_f32_16x16x32_bf16 v[24:27], a[12:15], v[204:207], v[24:27]
  v_cvt_pk_bf16_f32 v208, v180, v181
  v_mfma_f32_16x16x32_bf16 v[40:43], a[20:23], v[204:207], v[40:43]
  v_exp_f32 v182, v182
  v_mfma_f32_16x16x32_bf16 v[48:51], a[24:27], v[204:207], v[48:51]
  v_exp_f32 v183, v183
  v_mfma_f32_16x16x32_bf16 v[56:59], a[28:31], v[204:207], v[56:59]
  v_cvt_pk_bf16_f32 v209, v182, v183
  v_mfma_f32_16x16x32_bf16 v[72:75], a[36:39], v[204:207], v[72:75]
  v_exp_f32 v188, v188
  v_mfma_f32_16x16x32_bf16 v[80:83], a[40:43], v[204:207], v[80:83]
  v_exp_f32 v189, v189
  s_waitcnt lgkmcnt(14)
  v_mfma_f32_16x16x32_bf16 v[88:91], a[44:47], v[204:207], v[88:91]
  v_cvt_pk_bf16_f32 v210, v188, v189
  s_waitcnt lgkmcnt(12)
  v_mfma_f32_16x16x32_bf16 v[104:107], a[52:55], v[204:207], v[104:107]
  v_exp_f32 v190, v190
  s_waitcnt lgkmcnt(10)
  v_mfma_f32_16x16x32_bf16 v[112:115], a[56:59], v[204:207], v[112:115]
  v_exp_f32 v191, v191
  s_waitcnt lgkmcnt(8)
  v_mfma_f32_16x16x32_bf16 v[120:123], a[60:63], v[204:207], v[120:123]
  v_cvt_pk_bf16_f32 v211, v190, v191
  v_add_f32 v214, v214, v179
  s_waitcnt lgkmcnt(6)
  v_mfma_f32_16x16x32_bf16 v[0:3], a[0:3], v[204:207], v[0:3]
  v_add_f32 v214, v214, v184
  v_add_f32 v214, v214, v185
  s_waitcnt lgkmcnt(4)
  v_mfma_f32_16x16x32_bf16 v[32:35], a[16:19], v[204:207], v[32:35]
  v_add_f32 v214, v214, v186
  v_add_f32 v214, v214, v187
  s_waitcnt lgkmcnt(2)
  v_mfma_f32_16x16x32_bf16 v[64:67], a[32:35], v[204:207], v[64:67]
  v_add_f32 v215, v215, v180
  v_add_f32 v215, v215, v181
  s_waitcnt lgkmcnt(0)
  v_mfma_f32_16x16x32_bf16 v[96:99], a[48:51], v[204:207], v[96:99]
  v_add_f32 v215, v215, v182
  v_add_f32 v215, v215, v183
  v_mfma_f32_16x16x32_bf16 v[12:15], a[4:7], v[208:211], v[12:15]
  v_add_f32 v215, v215, v188
  v_add_f32 v215, v215, v189
  v_mfma_f32_16x16x32_bf16 v[20:23], a[8:11], v[208:211], v[20:23]
  v_add_f32 v215, v215, v190
  v_add_f32 v215, v215, v191
  v_mfma_f32_16x16x32_bf16 v[28:31], a[12:15], v[208:211], v[28:31]
  v_mbcnt_lo_u32_b32 v250, -1, 0
  v_mbcnt_hi_u32_b32 v250, -1, v250
  v_mov_b32 v247, v214
  v_mov_b32 v248, v215
  v_mov_b32 v249, v216
  v_permlane32_swap_b32 v214, v247
  v_permlane32_swap_b32 v215, v248
  v_mfma_f32_16x16x32_bf16 v[44:47], a[20:23], v[208:211], v[44:47]
  v_permlane32_swap_b32 v216, v249
  v_add_f32 v214, v214, v247
  v_add_f32 v215, v215, v248
  v_add_f32 v216, v216, v249
  v_mov_b32 v247, v214
  v_mov_b32 v248, v215
  v_mov_b32 v249, v216
  v_mfma_f32_16x16x32_bf16 v[52:55], a[24:27], v[208:211], v[52:55]
  v_permlane16_swap_b32 v214, v247
  v_permlane16_swap_b32 v215, v248
  v_permlane16_swap_b32 v216, v249
  v_add_f32 v214, v214, v247
  v_add_f32 v215, v215, v248
  v_add_f32 v216, v216, v249
  v_and_b32 v253, 15, v250
  v_mfma_f32_16x16x32_bf16 v[60:63], a[28:31], v[208:211], v[60:63]
  v_lshrrev_b32 v254, 4, v250
  s_lshr_b32 s48, s16, 1
  s_lshl_b32 s48, s48, 7
  s_and_b32 s49, s16, 1
  s_lshl_b32 s49, s49, 6
  s_add_u32 s48, s48, s49
  s_add_u32 s48, s48, 135168
  v_mfma_f32_16x16x32_bf16 v[76:79], a[36:39], v[208:211], v[76:79]
  v_lshlrev_b32 v242, 2, v253
  v_max3_f32 v244, v214, v215, v216
  v_add_u32 v243, s48, v242
  v_cmp_lt_f32 vcc, s42, v244
  ds_write_b32 v243, v216
  v_rcp_f32 v214, v214
  v_rcp_f32 v215, v215
  v_mfma_f32_16x16x32_bf16 v[84:87], a[40:43], v[208:211], v[84:87]
  s_lshl_b32 s51, s16, 2
  s_add_u32 s51, s51, 135424
  v_mov_b32 v244, s51
  s_cmp_lg_u64 vcc, 0
  s_cselect_b32 s50, 1, 0
  v_mov_b32 v243, s50
  ds_write_b32 v244, v243
  v_mfma_f32_16x16x32_bf16 v[92:95], a[44:47], v[208:211], v[92:95]
  v_and_b32 v246, 1, v254
  v_lshlrev_b32 v246, 1, v246
  v_lshrrev_b32 v247, 1, v254
  v_xor_b32 v248, v246, v247
  s_lshl_b32 s48, s16, 1
  v_xor_b32 v248, s48, v248
  v_xor_b32 v248, v248, v253
  v_mfma_f32_16x16x32_bf16 v[108:111], a[52:55], v[208:211], v[108:111]
  v_lshlrev_b32 v249, 9, v253
  s_lshl_b32 s49, s16, 14
  v_add_u32 v245, s49, v249
  s_waitcnt vmcnt(0) lgkmcnt(0)
  s_barrier
  v_add_u32 v242, 135168, v242
  ds_read_b32 v217, v242
  v_mfma_f32_16x16x32_bf16 v[116:119], a[56:59], v[208:211], v[116:119]
  ds_read_b32 v218, v242 offset:64
  ds_read_b32 v219, v242 offset:128
  ds_read_b32 v212, v242 offset:192
  v_mov_b32 v243, 135424
  ds_read_b128 v[196:199], v243
  v_xor_b32 v244, 0, v248
  v_lshl_add_u32 v160, v244, 4, v245
  v_mfma_f32_16x16x32_bf16 v[124:127], a[60:63], v[208:211], v[124:127]
  v_xor_b32 v244, 4, v248
  v_lshl_add_u32 v161, v244, 4, v245
  v_xor_b32 v244, 8, v248
  v_lshl_add_u32 v162, v244, 4, v245
  v_xor_b32 v244, 12, v248
  v_lshl_add_u32 v163, v244, 4, v245
  v_lshlrev_b32 v246, 2, v246
  v_mfma_f32_16x16x32_bf16 v[4:7], a[0:3], v[208:211], v[4:7]
  v_add_u32 v246, v246, v247
  v_add_u32 v246, s48, v246
  v_xor_b32 v246, v246, v253
  v_lshl_add_u32 v164, v246, 4, v249
  v_add_u32 v164, 65536, v164
  v_and_b32 v251, 31, v250
  v_lshrrev_b32 v252, 5, v250
  v_mfma_f32_16x16x32_bf16 v[128:131], a[0:3], a[232:235], v[128:131]
  v_lshlrev_b32 v245, 9, v252
  v_add_u32 v245, s49, v245
  v_add_u32 v244, 0, v252
  v_xor_b32 v244, v244, v251
  v_lshl_add_u32 v176, v244, 4, v245
  v_add_u32 v244, 2, v252
  v_xor_b32 v244, v244, v251
  v_mfma_f32_16x16x32_bf16 v[36:39], a[16:19], v[208:211], v[36:39]
  v_lshl_add_u32 v177, v244, 4, v245
  v_add_u32 v244, 4, v252
  v_xor_b32 v244, v244, v251
  v_lshl_add_u32 v178, v244, 4, v245
  v_add_u32 v244, 6, v252
  v_xor_b32 v244, v244, v251
  v_lshl_add_u32 v179, v244, 4, v245
  v_mfma_f32_16x16x32_bf16 v[136:139], a[16:19], a[232:235], v[136:139]
  v_add_u32 v244, 8, v252
  v_xor_b32 v244, v244, v251
  v_lshl_add_u32 v180, v244, 4, v245
  v_add_u32 v244, 10, v252
  v_xor_b32 v244, v244, v251
  v_lshl_add_u32 v181, v244, 4, v245
  v_add_u32 v244, 12, v252
  v_mfma_f32_16x16x32_bf16 v[68:71], a[32:35], v[208:211], v[68:71]
  v_xor_b32 v244, v244, v251
  v_lshl_add_u32 v182, v244, 4, v245
  v_add_u32 v244, 14, v252
  v_xor_b32 v244, v244, v251
  v_lshl_add_u32 v183, v244, 4, v245
  v_lshlrev_b32 v249, 4, v250
  v_add_u32 v248, s49, v249
  v_mfma_f32_16x16x32_bf16 v[144:147], a[32:35], a[232:235], v[144:147]
  s_waitcnt lgkmcnt(0)
  v_or_b32 v196, v196, v197
  v_add_f32 v200, v217, v218
  v_or3_b32 v196, v196, v198, v199
  v_add_f32 v201, v219, v212
  v_readfirstlane_b32 s54, v196
  v_rcp_f32 v200, v200
  v_mfma_f32_16x16x32_bf16 v[100:103], a[48:51], v[208:211], v[100:103]
  v_rcp_f32 v201, v201
  v_mfma_f32_16x16x32_bf16 v[152:155], a[48:51], a[232:235], v[152:155]
  s_branch L_epi
L_var_k1q1p0:
  ds_read_b128 a[96:99], v220 offset:24576
  ds_read_b128 a[100:103], v221 offset:24576
  ds_read_b128 a[104:107], v222 offset:24576
  ds_read_b128 a[108:111], v223 offset:24576
  ds_read_b128 a[112:115], v220 offset:24832
  ds_read_b128 a[116:119], v221 offset:24832
  ds_read_b128 a[120:123], v222 offset:24832
  ds_read_b128 a[124:127], v223 offset:24832
  ds_read_b64_tr_b16 a[4:5], v225 offset:0
  ds_read_b128 a[64:67], v220 offset:16384
  ds_read_b64_tr_b16 a[6:7], v225 offset:8192
  ds_read_b128 a[68:71], v221 offset:16384
  ds_read_b128 a[72:75], v222 offset:16384
  ds_read_b128 a[76:79], v223 offset:16384
  ds_read_b128 a[80:83], v220 offset:16640
  ds_read_b64_tr_b16 a[8:9], v226 offset:0
  ds_read_b128 a[84:87], v221 offset:16640
  ds_read_b128 a[88:91], v222 offset:16640
  ds_read_b128 a[92:95], v223 offset:16640
  ds_read_b64_tr_b16 a[10:11], v226 offset:8192
  ds_read_b64_tr_b16 a[12:13], v227 offset:0
  ds_read_b64_tr_b16 a[14:15], v227 offset:8192
  ds_read_b64_tr_b16 a[20:21], v229 offset:0
  ds_read_b64_tr_b16 a[22:23], v229 offset:8192
  ds_read_b64_tr_b16 a[24:25], v230 offset:0
  v_sub_f32 v242, 0, v217
  v_sub_f32 v243, 0, v217
  v_sub_f32 v244, 0, v217
  v_sub_f32 v245, 0, v217
  v_sub_f32 v246, 0, v218
  v_sub_f32 v247, 0, v218
  v_sub_f32 v248, 0, v218
  v_sub_f32 v249, 0, v218
  v_sub_f32 v250, 0, v219
  v_sub_f32 v251, 0, v219
  v_sub_f32 v252, 0, v219
  v_sub_f32 v253, 0, v219
  v_mul_f32 v217, s39, v217
  v_mul_f32 v218, s39, v218
  v_mul_f32 v219, s39, v219
  v_mov_b32 v192, v196
  v_mov_b32 v193, v197
  v_mov_b32 v194, v198
  v_mov_b32 v195, v199
  v_fma_f32 v192, v192, s39, -v219
  v_fma_f32 v193, v193, s39, -v219
  v_fma_f32 v194, v194, s39, -v219
  v_fma_f32 v195, v195, s39, -v219
  v_exp_f32 v192, v192
  v_exp_f32 v193, v193
  v_exp_f32 v194, v194
  v_exp_f32 v195, v195
  s_nop 0
  v_add_f32 v216, v216, v192
  v_add_f32 v216, v216, v193
  v_add_f32 v216, v216, v194
  v_add_f32 v216, v216, v195
  v_cvt_pk_bf16_f32 v212, v192, v193
  v_cvt_pk_bf16_f32 v213, v194, v195
  ds_write_b64 v240, v[212:213] offset:0
  v_fma_f32 v160, v160, s39, -v217
  v_fma_f32 v161, v161, s39, -v217
  v_fma_f32 v162, v162, s39, -v217
  v_fma_f32 v163, v163, s39, -v217
  v_fma_f32 v168, v168, s39, -v217
  v_fma_f32 v169, v169, s39, -v217
  v_fma_f32 v170, v170, s39, -v217
  v_fma_f32 v171, v171, s39, -v217
  v_fma_f32 v164, v164, s39, -v218
  v_fma_f32 v165, v165, s39, -v218
  v_fma_f32 v166, v166, s39, -v218
  v_fma_f32 v167, v167, s39, -v218
  v_fma_f32 v172, v172, s39, -v218
  v_fma_f32 v173, v173, s39, -v218
  v_fma_f32 v174, v174, s39, -v218
  v_fma_f32 v175, v175, s39, -v218
  v_exp_f32 v160, v160
  v_exp_f32 v161, v161
  v_exp_f32 v162, v162
  v_exp_f32 v163, v163
  v_exp_f32 v168, v168
  v_exp_f32 v169, v169
  v_exp_f32 v170, v170
  v_exp_f32 v171, v171
  v_exp_f32 v164, v164
  v_cvt_pk_bf16_f32 v196, v160, v161
  v_cvt_pk_bf16_f32 v197, v162, v163
  v_cvt_pk_bf16_f32 v198, v168, v169
  v_add_f32 v214, v214, v160
  v_cvt_pk_bf16_f32 v199, v170, v171
  v_add_f32 v214, v214, v161
  v_add_f32 v214, v214, v162
  v_add_f32 v214, v214, v163
  s_waitcnt lgkmcnt(0)
  v_mfma_f32_16x16x32_bf16 v[192:195], a[96:99], a[192:195], v[250:253]
  s_add_u32 s36, s36, 16384
  ds_read_b64_tr_b16 a[26:27], v230 offset:8192
  v_mfma_f32_16x16x32_bf16 v[192:195], a[100:103], a[196:199], v[192:195]
  v_exp_f32 v165, v165
  v_mfma_f32_16x16x32_bf16 v[192:195], a[104:107], a[200:203], v[192:195]
  s_add_u32 m0, s38, 49152
  ds_read_b64_tr_b16 a[28:29], v231 offset:0
  v_cvt_pk_bf16_f32 v200, v164, v165
  v_mfma_f32_16x16x32_bf16 v[192:195], a[108:111], a[204:207], v[192:195]
  ds_read_b64_tr_b16 a[30:31], v231 offset:8192
  v_add_f32 v214, v214, v168
  v_mfma_f32_16x16x32_bf16 v[192:195], a[112:115], a[208:211], v[192:195]
  buffer_load_dwordx4 v232, s[20:23], s36 offen offset:0 nt lds
  ds_read_b64_tr_b16 a[36:37], v225 offset:256
  v_add_f32 v214, v214, v169
  v_mfma_f32_16x16x32_bf16 v[192:195], a[116:119], a[212:215], v[192:195]
  ds_read_b64_tr_b16 a[38:39], v225 offset:8448
  v_add_f32 v214, v214, v170
  v_mfma_f32_16x16x32_bf16 v[192:195], a[120:123], a[216:219], v[192:195]
  v_exp_f32 v166, v166
  v_mfma_f32_16x16x32_bf16 v[192:195], a[124:127], a[220:223], v[192:195]
  buffer_load_dwordx4 v233, s[20:23], s36 offen offset:1024 nt lds
  ds_read_b64_tr_b16 a[40:41], v226 offset:256
  v_add_f32 v214, v214, v171
  v_mfma_f32_16x16x32_bf16 v[176:179], a[64:67], a[128:131], v[242:245]
  v_mfma_f32_16x16x32_bf16 v[180:183], a[64:67], a[160:163], v[246:249]
  buffer_load_dwordx4 v234, s[20:23], s36 offen offset:2048 nt lds
  ds_read_b64_tr_b16 a[42:43], v226 offset:8448
  v_add_f32 v215, v215, v164
  v_mfma_f32_16x16x32_bf16 v[176:179], a[68:71], a[132:135], v[176:179]
  v_exp_f32 v167, v167
  v_mfma_f32_16x16x32_bf16 v[180:183], a[68:71], a[164:167], v[180:183]
  buffer_load_dwordx4 v235, s[20:23], s36 offen offset:3072 nt lds
  ds_read_b64_tr_b16 a[44:45], v227 offset:256
  v_mul_f32 v192, s39, v192
  v_mfma_f32_16x16x32_bf16 v[176:179], a[72:75], a[136:139], v[176:179]
  ds_read_b64_tr_b16 a[46:47], v227 offset:8448
  v_mul_f32 v193, s39, v193
  v_mfma_f32_16x16x32_bf16 v[180:183], a[72:75], a[168:171], v[180:183]
  v_exp_f32 v192, v192
  v_mfma_f32_16x16x32_bf16 v[176:179], a[76:79], a[140:143], v[176:179]
  s_add_u32 m0, s38, 98304
  ds_read_b64_tr_b16 a[52:53], v229 offset:256
  v_mul_f32 v194, s39, v194
  v_mfma_f32_16x16x32_bf16 v[180:183], a[76:79], a[172:175], v[180:183]
  v_exp_f32 v193, v193
  v_mfma_f32_16x16x32_bf16 v[176:179], a[80:83], a[144:147], v[176:179]
  buffer_load_dwordx4 v236, s[24:27], s36 offen offset:0 nt lds
  ds_read_b64_tr_b16 a[54:55], v229 offset:8448
  v_mul_f32 v195, s39, v195
  v_mfma_f32_16x16x32_bf16 v[180:183], a[80:83], a[176:179], v[180:183]
  ds_read_b64_tr_b16 a[56:57], v230 offset:256
  v_cvt_pk_bf16_f32 v212, v192, v193
  v_mfma_f32_16x16x32_bf16 v[176:179], a[84:87], a[148:151], v[176:179]
  v_exp_f32 v194, v194
  v_mfma_f32_16x16x32_bf16 v[180:183], a[84:87], a[180:183], v[180:183]
  buffer_load_dwordx4 v237, s[24:27], s36 offen offset:1024 nt lds
  ds_read_b64_tr_b16 a[58:59], v230 offset:8448
  v_cvt_pk_bf16_f32 v201, v166, v167
  v_mfma_f32_16x16x32_bf16 v[176:179], a[88:91], a[152:155], v[176:179]
  v_exp_f32 v195, v195
  v_mfma_f32_16x16x32_bf16 v[180:183], a[88:91], a[184:187], v[180:183]
  buffer_load_dwordx4 v238, s[24:27], s36 offen offset:2048 nt lds
  ds_read_b64_tr_b16 a[60:61], v231 offset:256
  v_cvt_pk_bf16_f32 v213, v194, v195
  v_mfma_f32_16x16x32_bf16 v[176:179], a[92:95], a[156:159], v[176:179]
  v_mfma_f32_16x16x32_bf16 v[180:183], a[92:95], a[188:191], v[180:183]
  buffer_load_dwordx4 v239, s[24:27], s36 offen offset:3072 nt lds
  ds_write_b64 v240, v[212:213] offset:2048
  v_add_f32 v215, v215, v165
  v_mfma_f32_16x16x32_bf16 v[184:187], a[96:99], a[128:131], v[242:245]
  v_exp_f32 v172, v172
  v_mfma_f32_16x16x32_bf16 v[188:191], a[96:99], a[160:163], v[246:249]
  ds_read_b64_tr_b16 a[62:63], v231 offset:8448
  v_add_f32 v215, v215, v166
  v_mfma_f32_16x16x32_bf16 v[184:187], a[100:103], a[132:135], v[184:187]
  s_add_u32 s36, s36, 16384
  ds_read_b64_tr_b16 a[0:1], v224 offset:0
  v_add_f32 v215, v215, v167
  v_mfma_f32_16x16x32_bf16 v[188:191], a[100:103], a[164:167], v[188:191]
  ds_read_b64_tr_b16 a[2:3], v224 offset:8192
  v_add_f32 v215, v215, v172
  v_mfma_f32_16x16x32_bf16 v[184:187], a[104:107], a[136:139], v[184:187]
  s_add_u32 m0, s38, 0
  v_exp_f32 v173, v173
  v_mfma_f32_16x16x32_bf16 v[188:191], a[104:107], a[168:171], v[188:191]
  ds_read_b64_tr_b16 a[16:17], v228 offset:0
  v_cvt_pk_bf16_f32 v202, v172, v173
  v_mfma_f32_16x16x32_bf16 v[184:187], a[108:111], a[140:143], v[184:187]
  buffer_load_dwordx4 v232, s[20:23], s36 offen offset:0 nt lds
  ds_read_b64_tr_b16 a[18:19], v228 offset:8192
  v_add_f32 v215, v215, v173
  v_mfma_f32_16x16x32_bf16 v[188:191], a[108:111], a[172:175], v[188:191]
  ds_read_b64_tr_b16 a[32:33], v224 offset:256
  v_add_f32 v216, v216, v192
  v_mfma_f32_16x16x32_bf16 v[184:187], a[112:115], a[144:147], v[184:187]
  ds_read_b64_tr_b16 a[34:35], v224 offset:8448
  v_add_f32 v216, v216, v193
  v_mfma_f32_16x16x32_bf16 v[188:191], a[112:115], a[176:179], v[188:191]
  buffer_load_dwordx4 v233, s[20:23], s36 offen offset:1024 nt lds
  ds_read_b64_tr_b16 a[48:49], v228 offset:256
  v_add_f32 v216, v216, v194
  v_mfma_f32_16x16x32_bf16 v[184:187], a[116:119], a[148:151], v[184:187]
  ds_read_b64_tr_b16 a[50:51], v228 offset:8448
  v_add_f32 v216, v216, v195
  v_mfma_f32_16x16x32_bf16 v[188:191], a[116:119], a[180:183], v[188:191]
  buffer_load_dwordx4 v234, s[20:23], s36 offen offset:2048 nt lds
  v_mfma_f32_16x16x32_bf16 v[184:187], a[120:123], a[152:155], v[184:187]
  v_exp_f32 v174, v174
  v_mfma_f32_16x16x32_bf16 v[188:191], a[120:123], a[184:187], v[188:191]
  v_mfma_f32_16x16x32_bf16 v[184:187], a[124:127], a[156:159], v[184:187]
  buffer_load_dwordx4 v235, s[20:23], s36 offen offset:3072 nt lds
  v_exp_f32 v175, v175
  v_mfma_f32_16x16x32_bf16 v[188:191], a[124:127], a[188:191], v[188:191]
  v_cvt_pk_bf16_f32 v203, v174, v175
  v_add_f32 v215, v215, v174
  v_add_f32 v215, v215, v175
  s_waitcnt vmcnt(12) lgkmcnt(0)
  s_barrier
  ds_read_b128 a[224:227], v241 offset:0
  v_mfma_f32_16x16x32_bf16 v[8:11], a[4:7], v[196:199], v[8:11]
  ds_read_b128 a[96:99], v220 offset:40960
  v_mul_f32 v176, s39, v176
  v_mfma_f32_16x16x32_bf16 v[12:15], a[4:7], v[200:203], v[12:15]
  s_add_u32 m0, s38, 114688
  v_exp_f32 v176, v176
  v_mfma_f32_16x16x32_bf16 v[16:19], a[8:11], v[196:199], v[16:19]
  ds_read_b128 a[100:103], v221 offset:40960
  v_mul_f32 v177, s39, v177
  v_mfma_f32_16x16x32_bf16 v[20:23], a[8:11], v[200:203], v[20:23]
  ds_read_b128 a[104:107], v222 offset:40960
  v_mul_f32 v178, s39, v178
  v_mfma_f32_16x16x32_bf16 v[24:27], a[12:15], v[196:199], v[24:27]
  buffer_load_dwordx4 v236, s[24:27], s36 offen offset:0 nt lds
  ds_read_b128 a[108:111], v223 offset:40960
  v_mfma_f32_16x16x32_bf16 v[28:31], a[12:15], v[200:203], v[28:31]
  v_exp_f32 v177, v177
  v_mfma_f32_16x16x32_bf16 v[40:43], a[20:23], v[196:199], v[40:43]
  ds_read_b128 a[112:115], v220 offset:41216
  v_mfma_f32_16x16x32_bf16 v[44:47], a[20:23], v[200:203], v[44:47]
  buffer_load_dwordx4 v237, s[24:27], s36 offen offset:1024 nt lds
  ds_read_b128 a[116:119], v221 offset:41216
  v_mul_f32 v179, s39, v179
  v_mfma_f32_16x16x32_bf16 v[48:51], a[24:27], v[196:199], v[48:51]
  ds_read_b128 a[120:123], v222 offset:41216
  v_mul_f32 v184, s39, v184
  v_mfma_f32_16x16x32_bf16 v[52:55], a[24:27], v[200:203], v[52:55]
  v_exp_f32 v178, v178
  v_mfma_f32_16x16x32_bf16 v[56:59], a[28:31], v[196:199], v[56:59]
  buffer_load_dwordx4 v238, s[24:27], s36 offen offset:2048 nt lds
  ds_read_b128 a[124:127], v223 offset:41216
  v_mul_f32 v185, s39, v185
  v_mfma_f32_16x16x32_bf16 v[60:63], a[28:31], v[200:203], v[60:63]
  v_mfma_f32_16x16x32_bf16 v[72:75], a[36:39], v[196:199], v[72:75]
  ds_read_b64_tr_b16 a[4:5], v225 offset:16384
  v_mul_f32 v186, s39, v186
  v_mfma_f32_16x16x32_bf16 v[76:79], a[36:39], v[200:203], v[76:79]
  buffer_load_dwordx4 v239, s[24:27], s36 offen offset:3072 nt lds
  ds_read_b128 a[232:235], v241 offset:2048
  v_mul_f32 v187, s39, v187
  v_mfma_f32_16x16x32_bf16 v[80:83], a[40:43], v[196:199], v[80:83]
  v_exp_f32 v179, v179
  v_mfma_f32_16x16x32_bf16 v[84:87], a[40:43], v[200:203], v[84:87]
  ds_read_b128 a[64:67], v220 offset:32768
  v_mul_f32 v180, s39, v180
  v_mfma_f32_16x16x32_bf16 v[88:91], a[44:47], v[196:199], v[88:91]
  s_add_u32 s36, s36, 16384
  ds_read_b64_tr_b16 a[6:7], v225 offset:24576
  v_mul_f32 v181, s39, v181
  v_mfma_f32_16x16x32_bf16 v[92:95], a[44:47], v[200:203], v[92:95]
  ds_read_b128 a[68:71], v221 offset:32768
  v_mul_f32 v182, s39, v182
  v_mfma_f32_16x16x32_bf16 v[104:107], a[52:55], v[196:199], v[104:107]
  v_exp_f32 v184, v184
  v_mfma_f32_16x16x32_bf16 v[108:111], a[52:55], v[200:203], v[108:111]
  s_add_u32 m0, s38, 16384
  ds_read_b128 a[72:75], v222 offset:32768
  v_mul_f32 v183, s39, v183
  v_mfma_f32_16x16x32_bf16 v[112:115], a[56:59], v[196:199], v[112:115]
  v_mfma_f32_16x16x32_bf16 v[116:119], a[56:59], v[200:203], v[116:119]
  ds_read_b128 a[76:79], v223 offset:32768
  v_mul_f32 v188, s39, v188
  v_mfma_f32_16x16x32_bf16 v[120:123], a[60:63], v[196:199], v[120:123]
  buffer_load_dwordx4 v232, s[20:23], s36 offen offset:0 nt lds
  v_mul_f32 v189, s39, v189
  v_mfma_f32_16x16x32_bf16 v[124:127], a[60:63], v[200:203], v[124:127]
  v_exp_f32 v185, v185
  v_mfma_f32_16x16x32_bf16 v[0:3], a[0:3], v[196:199], v[0:3]
  ds_read_b128 a[80:83], v220 offset:33024
  v_mul_f32 v190, s39, v190
  v_mfma_f32_16x16x32_bf16 v[4:7], a[0:3], v[200:203], v[4:7]
  buffer_load_dwordx4 v233, s[20:23], s36 offen offset:1024 nt lds
  ds_read_b64_tr_b16 a[8:9], v226 offset:16384
  v_mul_f32 v191, s39, v191
  s_waitcnt lgkmcnt(15)
  v_mfma_f32_16x16x32_bf16 v[128:131], a[0:3], a[224:227], v[128:131]
  ds_read_b128 a[84:87], v221 offset:33024
  v_cvt_pk_bf16_f32 v204, v176, v177
  v_exp_f32 v186, v186
  v_mfma_f32_16x16x32_bf16 v[32:35], a[16:19], v[196:199], v[32:35]
  ds_read_b128 a[88:91], v222 offset:33024
  v_cvt_pk_bf16_f32 v205, v178, v179
  v_mfma_f32_16x16x32_bf16 v[36:39], a[16:19], v[200:203], v[36:39]
  buffer_load_dwordx4 v234, s[20:23], s36 offen offset:2048 nt lds
  v_mfma_f32_16x16x32_bf16 v[136:139], a[16:19], a[224:227], v[136:139]
  ds_read_b128 a[92:95], v223 offset:33024
  ds_read_b64_tr_b16 a[10:11], v226 offset:24576
  v_cvt_pk_bf16_f32 v206, v184, v185
  v_add_f32 v214, v214, v176
  v_mfma_f32_16x16x32_bf16 v[64:67], a[32:35], v[196:199], v[64:67]
  v_exp_f32 v187, v187
  v_mfma_f32_16x16x32_bf16 v[68:71], a[32:35], v[200:203], v[68:71]
  buffer_load_dwordx4 v235, s[20:23], s36 offen offset:3072 nt lds
  ds_read_b64_tr_b16 a[12:13], v227 offset:16384
  v_cvt_pk_bf16_f32 v207, v186, v187
  v_mfma_f32_16x16x32_bf16 v[144:147], a[32:35], a[224:227], v[144:147]
  ds_read_b64_tr_b16 a[14:15], v227 offset:24576
  ds_read_b64_tr_b16 a[20:21], v229 offset:16384
  v_add_f32 v214, v214, v177
  v_add_f32 v214, v214, v178
  v_mfma_f32_16x16x32_bf16 v[96:99], a[48:51], v[196:199], v[96:99]
  v_exp_f32 v180, v180
  v_mfma_f32_16x16x32_bf16 v[100:103], a[48:51], v[200:203], v[100:103]
  ds_read_b64_tr_b16 a[22:23], v229 offset:24576
  v_add_f32 v214, v214, v179
  v_mfma_f32_16x16x32_bf16 v[152:155], a[48:51], a[224:227], v[152:155]
  s_add_u32 m0, s38, 65536
  ds_read_b64_tr_b16 a[24:25], v230 offset:16384
  s_waitcnt lgkmcnt(6)
  s_mov_b32 s40, 0
.p2align 6
L_loop_k1q1p0:
  v_mfma_f32_16x16x32_bf16 v[192:195], a[96:99], a[192:195], v[250:253]
  ds_read_b64_tr_b16 a[26:27], v230 offset:24576
  s_add_u32 m0, s38, 65536
  v_mfma_f32_16x16x32_bf16 v[192:195], a[100:103], a[196:199], v[192:195]
  v_exp_f32 v181, v181
  v_mfma_f32_16x16x32_bf16 v[192:195], a[104:107], a[200:203], v[192:195]
  ds_read_b64_tr_b16 a[28:29], v231 offset:16384
  v_cvt_pk_bf16_f32 v208, v180, v181
  v_mfma_f32_16x16x32_bf16 v[192:195], a[108:111], a[204:207], v[192:195]
  ds_read_b64_tr_b16 a[30:31], v231 offset:24576
  v_add_f32 v214, v214, v184
  v_mfma_f32_16x16x32_bf16 v[192:195], a[112:115], a[208:211], v[192:195]
  ds_read_b64_tr_b16 a[36:37], v225 offset:16640
  v_add_f32 v214, v214, v185
  v_mfma_f32_16x16x32_bf16 v[192:195], a[116:119], a[212:215], v[192:195]
  ds_read_b64_tr_b16 a[38:39], v225 offset:24832
  v_add_f32 v214, v214, v186
  v_mfma_f32_16x16x32_bf16 v[192:195], a[120:123], a[216:219], v[192:195]
  v_exp_f32 v182, v182
  v_mfma_f32_16x16x32_bf16 v[192:195], a[124:127], a[220:223], v[192:195]
  ds_read_b64_tr_b16 a[40:41], v226 offset:16640
  v_add_f32 v214, v214, v187
  v_mfma_f32_16x16x32_bf16 v[160:163], a[64:67], a[128:131], v[242:245]
  buffer_load_dwordx4 v236, s[24:27], s36 offen offset:0 nt lds
  v_mfma_f32_16x16x32_bf16 v[164:167], a[64:67], a[160:163], v[246:249]
  ds_read_b64_tr_b16 a[42:43], v226 offset:24832
  v_add_f32 v215, v215, v180
  v_mfma_f32_16x16x32_bf16 v[160:163], a[68:71], a[132:135], v[160:163]
  v_exp_f32 v183, v183
  v_mfma_f32_16x16x32_bf16 v[164:167], a[68:71], a[164:167], v[164:167]
  ds_read_b64_tr_b16 a[44:45], v227 offset:16640
  v_mul_f32 v192, s39, v192
  v_mfma_f32_16x16x32_bf16 v[160:163], a[72:75], a[136:139], v[160:163]
  ds_read_b64_tr_b16 a[46:47], v227 offset:24832
  v_mul_f32 v193, s39, v193
  v_mfma_f32_16x16x32_bf16 v[164:167], a[72:75], a[168:171], v[164:167]
  v_exp_f32 v192, v192
  v_mfma_f32_16x16x32_bf16 v[160:163], a[76:79], a[140:143], v[160:163]
  ds_read_b64_tr_b16 a[52:53], v229 offset:16640
  v_mul_f32 v194, s39, v194
  v_mfma_f32_16x16x32_bf16 v[164:167], a[76:79], a[172:175], v[164:167]
  v_exp_f32 v193, v193
  v_mfma_f32_16x16x32_bf16 v[160:163], a[80:83], a[144:147], v[160:163]
  ds_read_b64_tr_b16 a[54:55], v229 offset:24832
  v_mul_f32 v195, s39, v195
  v_mfma_f32_16x16x32_bf16 v[164:167], a[80:83], a[176:179], v[164:167]
  ds_read_b64_tr_b16 a[56:57], v230 offset:16640
  v_cvt_pk_bf16_f32 v212, v192, v193
  v_mfma_f32_16x16x32_bf16 v[160:163], a[84:87], a[148:151], v[160:163]
  v_exp_f32 v194, v194
  v_mfma_f32_16x16x32_bf16 v[164:167], a[84:87], a[180:183], v[164:167]
  ds_read_b64_tr_b16 a[58:59], v230 offset:24832
  v_cvt_pk_bf16_f32 v209, v182, v183
  v_mfma_f32_16x16x32_bf16 v[160:163], a[88:91], a[152:155], v[160:163]
  v_exp_f32 v195, v195
  v_mfma_f32_16x16x32_bf16 v[164:167], a[88:91], a[184:187], v[164:167]
  ds_read_b64_tr_b16 a[60:61], v231 offset:16640
  v_cvt_pk_bf16_f32 v213, v194, v195
  v_mfma_f32_16x16x32_bf16 v[160:163], a[92:95], a[156:159], v[160:163]
  buffer_load_dwordx4 v237, s[24:27], s36 offen offset:1024 nt lds
  v_mfma_f32_16x16x32_bf16 v[164:167], a[92:95], a[188:191], v[164:167]
  ds_write_b64 v240, v[212:213] offset:0
  v_add_f32 v215, v215, v181
  v_mfma_f32_16x16x32_bf16 v[168:171], a[96:99], a[128:131], v[242:245]
  v_exp_f32 v188, v188
  v_mfma_f32_16x16x32_bf16 v[172:175], a[96:99], a[160:163], v[246:249]
  ds_read_b64_tr_b16 a[62:63], v231 offset:24832
  v_add_f32 v215, v215, v182
  v_mfma_f32_16x16x32_bf16 v[168:171], a[100:103], a[132:135], v[168:171]
  ds_read_b64_tr_b16 a[0:1], v224 offset:16384
  v_add_f32 v215, v215, v183
  v_mfma_f32_16x16x32_bf16 v[172:175], a[100:103], a[164:167], v[172:175]
  ds_read_b64_tr_b16 a[2:3], v224 offset:24576
  v_add_f32 v215, v215, v188
  v_mfma_f32_16x16x32_bf16 v[168:171], a[104:107], a[136:139], v[168:171]
  v_exp_f32 v189, v189
  v_mfma_f32_16x16x32_bf16 v[172:175], a[104:107], a[168:171], v[172:175]
  ds_read_b64_tr_b16 a[16:17], v228 offset:16384
  v_cvt_pk_bf16_f32 v210, v188, v189
  v_mfma_f32_16x16x32_bf16 v[168:171], a[108:111], a[140:143], v[168:171]
  ds_read_b64_tr_b16 a[18:19], v228 offset:24576
  v_add_f32 v215, v215, v189
  v_mfma_f32_16x16x32_bf16 v[172:175], a[108:111], a[172:175], v[172:175]
  ds_read_b64_tr_b16 a[32:33], v224 offset:16640
  v_add_f32 v216, v216, v192
  v_mfma_f32_16x16x32_bf16 v[168:171], a[112:115], a[144:147], v[168:171]
  ds_read_b64_tr_b16 a[34:35], v224 offset:24832
  v_add_f32 v216, v216, v193
  v_mfma_f32_16x16x32_bf16 v[172:175], a[112:115], a[176:179], v[172:175]
  ds_read_b64_tr_b16 a[48:49], v228 offset:16640
  v_add_f32 v216, v216, v194
  v_mfma_f32_16x16x32_bf16 v[168:171], a[116:119], a[148:151], v[168:171]
  ds_read_b64_tr_b16 a[50:51], v228 offset:24832
  v_add_f32 v216, v216, v195
  v_mfma_f32_16x16x32_bf16 v[172:175], a[116:119], a[180:183], v[172:175]
  buffer_load_dwordx4 v238, s[24:27], s36 offen offset:2048 nt lds
  v_mfma_f32_16x16x32_bf16 v[168:171], a[120:123], a[152:155], v[168:171]
  v_exp_f32 v190, v190
  v_mfma_f32_16x16x32_bf16 v[172:175], a[120:123], a[184:187], v[172:175]
  buffer_load_dwordx4 v239, s[24:27], s36 offen offset:3072 nt lds
  v_mfma_f32_16x16x32_bf16 v[168:171], a[124:127], a[156:159], v[168:171]
  v_exp_f32 v191, v191
  v_mfma_f32_16x16x32_bf16 v[172:175], a[124:127], a[188:191], v[172:175]
  v_cvt_pk_bf16_f32 v211, v190, v191
  v_add_f32 v215, v215, v190
  v_add_f32 v215, v215, v191
  s_waitcnt vmcnt(16) lgkmcnt(0)
  s_barrier
  v_mfma_f32_16x16x32_bf16 v[8:11], a[4:7], v[204:207], v[8:11]
  ds_read_b128 a[96:99], v220 offset:57344
  v_mul_f32 v160, s39, v160
  v_mfma_f32_16x16x32_bf16 v[12:15], a[4:7], v[208:211], v[12:15]
  v_exp_f32 v160, v160
  v_mfma_f32_16x16x32_bf16 v[16:19], a[8:11], v[204:207], v[16:19]
  ds_read_b128 a[100:103], v221 offset:57344
  v_mul_f32 v161, s39, v161
  v_mfma_f32_16x16x32_bf16 v[20:23], a[8:11], v[208:211], v[20:23]
  ds_read_b128 a[104:107], v222 offset:57344
  v_mul_f32 v162, s39, v162
  v_mfma_f32_16x16x32_bf16 v[24:27], a[12:15], v[204:207], v[24:27]
  ds_read_b128 a[108:111], v223 offset:57344
  s_add_u32 s36, s36, 16384
  v_mfma_f32_16x16x32_bf16 v[28:31], a[12:15], v[208:211], v[28:31]
  v_exp_f32 v161, v161
  v_mfma_f32_16x16x32_bf16 v[40:43], a[20:23], v[204:207], v[40:43]
  ds_read_b128 a[112:115], v220 offset:57600
  s_add_u32 m0, s38, 32768
  v_mfma_f32_16x16x32_bf16 v[44:47], a[20:23], v[208:211], v[44:47]
  ds_read_b128 a[116:119], v221 offset:57600
  v_mul_f32 v163, s39, v163
  v_mfma_f32_16x16x32_bf16 v[48:51], a[24:27], v[204:207], v[48:51]
  ds_read_b128 a[120:123], v222 offset:57600
  v_mul_f32 v168, s39, v168
  v_mfma_f32_16x16x32_bf16 v[52:55], a[24:27], v[208:211], v[52:55]
  v_exp_f32 v162, v162
  v_mfma_f32_16x16x32_bf16 v[56:59], a[28:31], v[204:207], v[56:59]
  ds_read_b128 a[124:127], v223 offset:57600
  v_mul_f32 v169, s39, v169
  v_mfma_f32_16x16x32_bf16 v[60:63], a[28:31], v[208:211], v[60:63]
  buffer_load_dwordx4 v232, s[20:23], s36 offen offset:0 nt lds
  v_mfma_f32_16x16x32_bf16 v[72:75], a[36:39], v[204:207], v[72:75]
  ds_read_b64_tr_b16 a[4:5], v225 offset:32768
  v_mul_f32 v170, s39, v170
  v_mfma_f32_16x16x32_bf16 v[76:79], a[36:39], v[208:211], v[76:79]
  ds_read_b128 a[224:227], v241 offset:0
  v_mul_f32 v171, s39, v171
  v_mfma_f32_16x16x32_bf16 v[80:83], a[40:43], v[204:207], v[80:83]
  v_exp_f32 v163, v163
  v_mfma_f32_16x16x32_bf16 v[84:87], a[40:43], v[208:211], v[84:87]
  ds_read_b128 a[64:67], v220 offset:49152
  v_mul_f32 v164, s39, v164
  v_mfma_f32_16x16x32_bf16 v[88:91], a[44:47], v[204:207], v[88:91]
  ds_read_b64_tr_b16 a[6:7], v225 offset:40960
  v_mul_f32 v165, s39, v165
  v_mfma_f32_16x16x32_bf16 v[92:95], a[44:47], v[208:211], v[92:95]
  ds_read_b128 a[68:71], v221 offset:49152
  v_mul_f32 v166, s39, v166
  v_mfma_f32_16x16x32_bf16 v[104:107], a[52:55], v[204:207], v[104:107]
  v_exp_f32 v168, v168
  v_mfma_f32_16x16x32_bf16 v[108:111], a[52:55], v[208:211], v[108:111]
  ds_read_b128 a[72:75], v222 offset:49152
  v_mul_f32 v167, s39, v167
  v_mfma_f32_16x16x32_bf16 v[112:115], a[56:59], v[204:207], v[112:115]
  buffer_load_dwordx4 v233, s[20:23], s36 offen offset:1024 nt lds
  v_mfma_f32_16x16x32_bf16 v[116:119], a[56:59], v[208:211], v[116:119]
  ds_read_b128 a[76:79], v223 offset:49152
  v_mul_f32 v172, s39, v172
  v_mfma_f32_16x16x32_bf16 v[120:123], a[60:63], v[204:207], v[120:123]
  v_mul_f32 v173, s39, v173
  v_mfma_f32_16x16x32_bf16 v[124:127], a[60:63], v[208:211], v[124:127]
  v_exp_f32 v169, v169
  v_mfma_f32_16x16x32_bf16 v[0:3], a[0:3], v[204:207], v[0:3]
  ds_read_b128 a[80:83], v220 offset:49408
  v_mul_f32 v174, s39, v174
  v_mfma_f32_16x16x32_bf16 v[4:7], a[0:3], v[208:211], v[4:7]
  ds_read_b64_tr_b16 a[8:9], v226 offset:32768
  v_mul_f32 v175, s39, v175
  v_mfma_f32_16x16x32_bf16 v[128:131], a[0:3], a[232:235], v[128:131]
  ds_read_b128 a[84:87], v221 offset:49408
  v_cvt_pk_bf16_f32 v196, v160, v161
  v_exp_f32 v170, v170
  v_mfma_f32_16x16x32_bf16 v[32:35], a[16:19], v[204:207], v[32:35]
  ds_read_b128 a[88:91], v222 offset:49408
  v_cvt_pk_bf16_f32 v197, v162, v163
  v_mfma_f32_16x16x32_bf16 v[36:39], a[16:19], v[208:211], v[36:39]
  buffer_load_dwordx4 v234, s[20:23], s36 offen offset:2048 nt lds
  v_mfma_f32_16x16x32_bf16 v[136:139], a[16:19], a[232:235], v[136:139]
  ds_read_b128 a[92:95], v223 offset:49408
  ds_read_b64_tr_b16 a[10:11], v226 offset:40960
  v_cvt_pk_bf16_f32 v198, v168, v169
  v_add_f32 v214, v214, v160
  v_mfma_f32_16x16x32_bf16 v[64:67], a[32:35], v[204:207], v[64:67]
  v_exp_f32 v171, v171
  v_mfma_f32_16x16x32_bf16 v[68:71], a[32:35], v[208:211], v[68:71]
  ds_read_b64_tr_b16 a[12:13], v227 offset:32768
  v_cvt_pk_bf16_f32 v199, v170, v171
  v_mfma_f32_16x16x32_bf16 v[144:147], a[32:35], a[232:235], v[144:147]
  ds_read_b64_tr_b16 a[14:15], v227 offset:40960
  ds_read_b64_tr_b16 a[20:21], v229 offset:32768
  v_add_f32 v214, v214, v161
  v_add_f32 v214, v214, v162
  v_mfma_f32_16x16x32_bf16 v[96:99], a[48:51], v[204:207], v[96:99]
  v_exp_f32 v164, v164
  v_mfma_f32_16x16x32_bf16 v[100:103], a[48:51], v[208:211], v[100:103]
  ds_read_b64_tr_b16 a[22:23], v229 offset:40960
  v_add_f32 v214, v214, v163
  v_mfma_f32_16x16x32_bf16 v[152:155], a[48:51], a[232:235], v[152:155]
  buffer_load_dwordx4 v235, s[20:23], s36 offen offset:3072 nt lds
  ds_read_b64_tr_b16 a[24:25], v230 offset:32768
  s_waitcnt lgkmcnt(6)
  v_mfma_f32_16x16x32_bf16 v[192:195], a[96:99], a[192:195], v[250:253]
  ds_read_b64_tr_b16 a[26:27], v230 offset:40960
  s_add_u32 m0, s38, 81920
  v_mfma_f32_16x16x32_bf16 v[192:195], a[100:103], a[196:199], v[192:195]
  v_exp_f32 v165, v165
  v_mfma_f32_16x16x32_bf16 v[192:195], a[104:107], a[200:203], v[192:195]
  ds_read_b64_tr_b16 a[28:29], v231 offset:32768
  v_cvt_pk_bf16_f32 v200, v164, v165
  v_mfma_f32_16x16x32_bf16 v[192:195], a[108:111], a[204:207], v[192:195]
  ds_read_b64_tr_b16 a[30:31], v231 offset:40960
  v_add_f32 v214, v214, v168
  v_mfma_f32_16x16x32_bf16 v[192:195], a[112:115], a[208:211], v[192:195]
  ds_read_b64_tr_b16 a[36:37], v225 offset:33024
  v_add_f32 v214, v214, v169
  v_mfma_f32_16x16x32_bf16 v[192:195], a[116:119], a[212:215], v[192:195]
  ds_read_b64_tr_b16 a[38:39], v225 offset:41216
  v_add_f32 v214, v214, v170
  v_mfma_f32_16x16x32_bf16 v[192:195], a[120:123], a[216:219], v[192:195]
  v_exp_f32 v166, v166
  v_mfma_f32_16x16x32_bf16 v[192:195], a[124:127], a[220:223], v[192:195]
  ds_read_b64_tr_b16 a[40:41], v226 offset:33024
  v_add_f32 v214, v214, v171
  v_mfma_f32_16x16x32_bf16 v[176:179], a[64:67], a[128:131], v[242:245]
  buffer_load_dwordx4 v236, s[24:27], s36 offen offset:0 nt lds
  v_mfma_f32_16x16x32_bf16 v[180:183], a[64:67], a[160:163], v[246:249]
  ds_read_b64_tr_b16 a[42:43], v226 offset:41216
  v_add_f32 v215, v215, v164
  v_mfma_f32_16x16x32_bf16 v[176:179], a[68:71], a[132:135], v[176:179]
  v_exp_f32 v167, v167
  v_mfma_f32_16x16x32_bf16 v[180:183], a[68:71], a[164:167], v[180:183]
  ds_read_b64_tr_b16 a[44:45], v227 offset:33024
  v_mul_f32 v192, s39, v192
  v_mfma_f32_16x16x32_bf16 v[176:179], a[72:75], a[136:139], v[176:179]
  ds_read_b64_tr_b16 a[46:47], v227 offset:41216
  v_mul_f32 v193, s39, v193
  v_mfma_f32_16x16x32_bf16 v[180:183], a[72:75], a[168:171], v[180:183]
  v_exp_f32 v192, v192
  v_mfma_f32_16x16x32_bf16 v[176:179], a[76:79], a[140:143], v[176:179]
  ds_read_b64_tr_b16 a[52:53], v229 offset:33024
  v_mul_f32 v194, s39, v194
  v_mfma_f32_16x16x32_bf16 v[180:183], a[76:79], a[172:175], v[180:183]
  v_exp_f32 v193, v193
  v_mfma_f32_16x16x32_bf16 v[176:179], a[80:83], a[144:147], v[176:179]
  ds_read_b64_tr_b16 a[54:55], v229 offset:41216
  v_mul_f32 v195, s39, v195
  v_mfma_f32_16x16x32_bf16 v[180:183], a[80:83], a[176:179], v[180:183]
  ds_read_b64_tr_b16 a[56:57], v230 offset:33024
  v_cvt_pk_bf16_f32 v212, v192, v193
  v_mfma_f32_16x16x32_bf16 v[176:179], a[84:87], a[148:151], v[176:179]
  v_exp_f32 v194, v194
  v_mfma_f32_16x16x32_bf16 v[180:183], a[84:87], a[180:183], v[180:183]
  ds_read_b64_tr_b16 a[58:59], v230 offset:41216
  v_cvt_pk_bf16_f32 v201, v166, v167
  v_mfma_f32_16x16x32_bf16 v[176:179], a[88:91], a[152:155], v[176:179]
  v_exp_f32 v195, v195
  v_mfma_f32_16x16x32_bf16 v[180:183], a[88:91], a[184:187], v[180:183]
  ds_read_b64_tr_b16 a[60:61], v231 offset:33024
  v_cvt_pk_bf16_f32 v213, v194, v195
  v_mfma_f32_16x16x32_bf16 v[176:179], a[92:95], a[156:159], v[176:179]
  buffer_load_dwordx4 v237, s[24:27], s36 offen offset:1024 nt lds
  v_mfma_f32_16x16x32_bf16 v[180:183], a[92:95], a[188:191], v[180:183]
  ds_write_b64 v240, v[212:213] offset:2048
  v_add_f32 v215, v215, v165
  v_mfma_f32_16x16x32_bf16 v[184:187], a[96:99], a[128:131], v[242:245]
  v_exp_f32 v172, v172
  v_mfma_f32_16x16x32_bf16 v[188:191], a[96:99], a[160:163], v[246:249]
  ds_read_b64_tr_b16 a[62:63], v231 offset:41216
  v_add_f32 v215, v215, v166
  v_mfma_f32_16x16x32_bf16 v[184:187], a[100:103], a[132:135], v[184:187]
  ds_read_b64_tr_b16 a[0:1], v224 offset:32768
  v_add_f32 v215, v215, v167
  v_mfma_f32_16x16x32_bf16 v[188:191], a[100:103], a[164:167], v[188:191]
  ds_read_b64_tr_b16 a[2:3], v224 offset:40960
  v_add_f32 v215, v215, v172
  v_mfma_f32_16x16x32_bf16 v[184:187], a[104:107], a[136:139], v[184:187]
  v_exp_f32 v173, v173
  v_mfma_f32_16x16x32_bf16 v[188:191], a[104:107], a[168:171], v[188:191]
  ds_read_b64_tr_b16 a[16:17], v228 offset:32768
  v_cvt_pk_bf16_f32 v202, v172, v173
  v_mfma_f32_16x16x32_bf16 v[184:187], a[108:111], a[140:143], v[184:187]
  ds_read_b64_tr_b16 a[18:19], v228 offset:40960
  v_add_f32 v215, v215, v173
  v_mfma_f32_16x16x32_bf16 v[188:191], a[108:111], a[172:175], v[188:191]
  ds_read_b64_tr_b16 a[32:33], v224 offset:33024
  v_add_f32 v216, v216, v192
  v_mfma_f32_16x16x32_bf16 v[184:187], a[112:115], a[144:147], v[184:187]
  ds_read_b64_tr_b16 a[34:35], v224 offset:41216
  v_add_f32 v216, v216, v193
  v_mfma_f32_16x16x32_bf16 v[188:191], a[112:115], a[176:179], v[188:191]
  ds_read_b64_tr_b16 a[48:49], v228 offset:33024
  v_add_f32 v216, v216, v194
  v_mfma_f32_16x16x32_bf16 v[184:187], a[116:119], a[148:151], v[184:187]
  ds_read_b64_tr_b16 a[50:51], v228 offset:41216
  v_add_f32 v216, v216, v195
  v_mfma_f32_16x16x32_bf16 v[188:191], a[116:119], a[180:183], v[188:191]
  buffer_load_dwordx4 v238, s[24:27], s36 offen offset:2048 nt lds
  v_mfma_f32_16x16x32_bf16 v[184:187], a[120:123], a[152:155], v[184:187]
  v_exp_f32 v174, v174
  v_mfma_f32_16x16x32_bf16 v[188:191], a[120:123], a[184:187], v[188:191]
  buffer_load_dwordx4 v239, s[24:27], s36 offen offset:3072 nt lds
  v_mfma_f32_16x16x32_bf16 v[184:187], a[124:127], a[156:159], v[184:187]
  v_exp_f32 v175, v175
  v_mfma_f32_16x16x32_bf16 v[188:191], a[124:127], a[188:191], v[188:191]
  v_cvt_pk_bf16_f32 v203, v174, v175
  v_add_f32 v215, v215, v174
  v_add_f32 v215, v215, v175
  s_waitcnt vmcnt(16) lgkmcnt(0)
  s_barrier
  v_mfma_f32_16x16x32_bf16 v[8:11], a[4:7], v[196:199], v[8:11]
  ds_read_b128 a[96:99], v220 offset:8192
  v_mul_f32 v176, s39, v176
  v_mfma_f32_16x16x32_bf16 v[12:15], a[4:7], v[200:203], v[12:15]
  v_exp_f32 v176, v176
  v_mfma_f32_16x16x32_bf16 v[16:19], a[8:11], v[196:199], v[16:19]
  ds_read_b128 a[100:103], v221 offset:8192
  v_mul_f32 v177, s39, v177
  v_mfma_f32_16x16x32_bf16 v[20:23], a[8:11], v[200:203], v[20:23]
  ds_read_b128 a[104:107], v222 offset:8192
  v_mul_f32 v178, s39, v178
  v_mfma_f32_16x16x32_bf16 v[24:27], a[12:15], v[196:199], v[24:27]
  ds_read_b128 a[108:111], v223 offset:8192
  s_add_u32 s36, s36, 16384
  v_mfma_f32_16x16x32_bf16 v[28:31], a[12:15], v[200:203], v[28:31]
  v_exp_f32 v177, v177
  v_mfma_f32_16x16x32_bf16 v[40:43], a[20:23], v[196:199], v[40:43]
  ds_read_b128 a[112:115], v220 offset:8448
  s_add_u32 m0, s38, 49152
  v_mfma_f32_16x16x32_bf16 v[44:47], a[20:23], v[200:203], v[44:47]
  ds_read_b128 a[116:119], v221 offset:8448
  v_mul_f32 v179, s39, v179
  v_mfma_f32_16x16x32_bf16 v[48:51], a[24:27], v[196:199], v[48:51]
  ds_read_b128 a[120:123], v222 offset:8448
  v_mul_f32 v184, s39, v184
  v_mfma_f32_16x16x32_bf16 v[52:55], a[24:27], v[200:203], v[52:55]
  v_exp_f32 v178, v178
  v_mfma_f32_16x16x32_bf16 v[56:59], a[28:31], v[196:199], v[56:59]
  ds_read_b128 a[124:127], v223 offset:8448
  v_mul_f32 v185, s39, v185
  v_mfma_f32_16x16x32_bf16 v[60:63], a[28:31], v[200:203], v[60:63]
  buffer_load_dwordx4 v232, s[20:23], s36 offen offset:0 nt lds
  v_mfma_f32_16x16x32_bf16 v[72:75], a[36:39], v[196:199], v[72:75]
  ds_read_b64_tr_b16 a[4:5], v225 offset:49152
  v_mul_f32 v186, s39, v186
  v_mfma_f32_16x16x32_bf16 v[76:79], a[36:39], v[200:203], v[76:79]
  ds_read_b128 a[232:235], v241 offset:2048
  v_mul_f32 v187, s39, v187
  v_mfma_f32_16x16x32_bf16 v[80:83], a[40:43], v[196:199], v[80:83]
  v_exp_f32 v179, v179
  v_mfma_f32_16x16x32_bf16 v[84:87], a[40:43], v[200:203], v[84:87]
  ds_read_b128 a[64:67], v220 offset:0
  v_mul_f32 v180, s39, v180
  v_mfma_f32_16x16x32_bf16 v[88:91], a[44:47], v[196:199], v[88:91]
  ds_read_b64_tr_b16 a[6:7], v225 offset:57344
  v_mul_f32 v181, s39, v181
  v_mfma_f32_16x16x32_bf16 v[92:95], a[44:47], v[200:203], v[92:95]
  ds_read_b128 a[68:71], v221 offset:0
  v_mul_f32 v182, s39, v182
  v_mfma_f32_16x16x32_bf16 v[104:107], a[52:55], v[196:199], v[104:107]
  v_exp_f32 v184, v184
  v_mfma_f32_16x16x32_bf16 v[108:111], a[52:55], v[200:203], v[108:111]
  ds_read_b128 a[72:75], v222 offset:0
  v_mul_f32 v183, s39, v183
  v_mfma_f32_16x16x32_bf16 v[112:115], a[56:59], v[196:199], v[112:115]
  buffer_load_dwordx4 v233, s[20:23], s36 offen offset:1024 nt lds
  v_mfma_f32_16x16x32_bf16 v[116:119], a[56:59], v[200:203], v[116:119]
  ds_read_b128 a[76:79], v223 offset:0
  v_mul_f32 v188, s39, v188
  v_mfma_f32_16x16x32_bf16 v[120:123], a[60:63], v[196:199], v[120:123]
  v_mul_f32 v189, s39, v189
  v_mfma_f32_16x16x32_bf16 v[124:127], a[60:63], v[200:203], v[124:127]
  v_exp_f32 v185, v185
  v_mfma_f32_16x16x32_bf16 v[0:3], a[0:3], v[196:199], v[0:3]
  ds_read_b128 a[80:83], v220 offset:256
  v_mul_f32 v190, s39, v190
  v_mfma_f32_16x16x32_bf16 v[4:7], a[0:3], v[200:203], v[4:7]
  ds_read_b64_tr_b16 a[8:9], v226 offset:49152
  v_mul_f32 v191, s39, v191
  v_mfma_f32_16x16x32_bf16 v[128:131], a[0:3], a[224:227], v[128:131]
  ds_read_b128 a[84:87], v221 offset:256
  v_cvt_pk_bf16_f32 v204, v176, v177
  v_exp_f32 v186, v186
  v_mfma_f32_16x16x32_bf16 v[32:35], a[16:19], v[196:199], v[32:35]
  ds_read_b128 a[88:91], v222 offset:256
  v_cvt_pk_bf16_f32 v205, v178, v179
  v_mfma_f32_16x16x32_bf16 v[36:39], a[16:19], v[200:203], v[36:39]
  buffer_load_dwordx4 v234, s[20:23], s36 offen offset:2048 nt lds
  v_mfma_f32_16x16x32_bf16 v[136:139], a[16:19], a[224:227], v[136:139]
  ds_read_b128 a[92:95], v223 offset:256
  ds_read_b64_tr_b16 a[10:11], v226 offset:57344
  v_cvt_pk_bf16_f32 v206, v184, v185
  v_add_f32 v214, v214, v176
  v_mfma_f32_16x16x32_bf16 v[64:67], a[32:35], v[196:199], v[64:67]
  v_exp_f32 v187, v187
  v_mfma_f32_16x16x32_bf16 v[68:71], a[32:35], v[200:203], v[68:71]
  ds_read_b64_tr_b16 a[12:13], v227 offset:49152
  v_cvt_pk_bf16_f32 v207, v186, v187
  v_mfma_f32_16x16x32_bf16 v[144:147], a[32:35], a[224:227], v[144:147]
  ds_read_b64_tr_b16 a[14:15], v227 offset:57344
  ds_read_b64_tr_b16 a[20:21], v229 offset:49152
  v_add_f32 v214, v214, v177
  v_add_f32 v214, v214, v178
  v_mfma_f32_16x16x32_bf16 v[96:99], a[48:51], v[196:199], v[96:99]
  v_exp_f32 v180, v180
  v_mfma_f32_16x16x32_bf16 v[100:103], a[48:51], v[200:203], v[100:103]
  ds_read_b64_tr_b16 a[22:23], v229 offset:57344
  v_add_f32 v214, v214, v179
  v_mfma_f32_16x16x32_bf16 v[152:155], a[48:51], a[224:227], v[152:155]
  buffer_load_dwordx4 v235, s[20:23], s36 offen offset:3072 nt lds
  ds_read_b64_tr_b16 a[24:25], v230 offset:49152
  s_waitcnt lgkmcnt(6)
  v_mfma_f32_16x16x32_bf16 v[192:195], a[96:99], a[192:195], v[250:253]
  ds_read_b64_tr_b16 a[26:27], v230 offset:57344
  s_add_u32 m0, s38, 98304
  v_mfma_f32_16x16x32_bf16 v[192:195], a[100:103], a[196:199], v[192:195]
  v_exp_f32 v181, v181
  v_mfma_f32_16x16x32_bf16 v[192:195], a[104:107], a[200:203], v[192:195]
  ds_read_b64_tr_b16 a[28:29], v231 offset:49152
  v_cvt_pk_bf16_f32 v208, v180, v181
  v_mfma_f32_16x16x32_bf16 v[192:195], a[108:111], a[204:207], v[192:195]
  ds_read_b64_tr_b16 a[30:31], v231 offset:57344
  v_add_f32 v214, v214, v184
  v_mfma_f32_16x16x32_bf16 v[192:195], a[112:115], a[208:211], v[192:195]
  ds_read_b64_tr_b16 a[36:37], v225 offset:49408
  v_add_f32 v214, v214, v185
  v_mfma_f32_16x16x32_bf16 v[192:195], a[116:119], a[212:215], v[192:195]
  ds_read_b64_tr_b16 a[38:39], v225 offset:57600
  v_add_f32 v214, v214, v186
  v_mfma_f32_16x16x32_bf16 v[192:195], a[120:123], a[216:219], v[192:195]
  v_exp_f32 v182, v182
  v_mfma_f32_16x16x32_bf16 v[192:195], a[124:127], a[220:223], v[192:195]
  ds_read_b64_tr_b16 a[40:41], v226 offset:49408
  v_add_f32 v214, v214, v187
  v_mfma_f32_16x16x32_bf16 v[160:163], a[64:67], a[128:131], v[242:245]
  buffer_load_dwordx4 v236, s[24:27], s36 offen offset:0 nt lds
  v_mfma_f32_16x16x32_bf16 v[164:167], a[64:67], a[160:163], v[246:249]
  ds_read_b64_tr_b16 a[42:43], v226 offset:57600
  v_add_f32 v215, v215, v180
  v_mfma_f32_16x16x32_bf16 v[160:163], a[68:71], a[132:135], v[160:163]
  v_exp_f32 v183, v183
  v_mfma_f32_16x16x32_bf16 v[164:167], a[68:71], a[164:167], v[164:167]
  ds_read_b64_tr_b16 a[44:45], v227 offset:49408
  v_mul_f32 v192, s39, v192
  v_mfma_f32_16x16x32_bf16 v[160:163], a[72:75], a[136:139], v[160:163]
  ds_read_b64_tr_b16 a[46:47], v227 offset:57600
  v_mul_f32 v193, s39, v193
  v_mfma_f32_16x16x32_bf16 v[164:167], a[72:75], a[168:171], v[164:167]
  v_exp_f32 v192, v192
  v_mfma_f32_16x16x32_bf16 v[160:163], a[76:79], a[140:143], v[160:163]
  ds_read_b64_tr_b16 a[52:53], v229 offset:49408
  v_mul_f32 v194, s39, v194
  v_mfma_f32_16x16x32_bf16 v[164:167], a[76:79], a[172:175], v[164:167]
  v_exp_f32 v193, v193
  v_mfma_f32_16x16x32_bf16 v[160:163], a[80:83], a[144:147], v[160:163]
  ds_read_b64_tr_b16 a[54:55], v229 offset:57600
  v_mul_f32 v195, s39, v195
  v_mfma_f32_16x16x32_bf16 v[164:167], a[80:83], a[176:179], v[164:167]
  ds_read_b64_tr_b16 a[56:57], v230 offset:49408
  v_cvt_pk_bf16_f32 v212, v192, v193
  v_mfma_f32_16x16x32_bf16 v[160:163], a[84:87], a[148:151], v[160:163]
  v_exp_f32 v194, v194
  v_mfma_f32_16x16x32_bf16 v[164:167], a[84:87], a[180:183], v[164:167]
  ds_read_b64_tr_b16 a[58:59], v230 offset:57600
  v_cvt_pk_bf16_f32 v209, v182, v183
  v_mfma_f32_16x16x32_bf16 v[160:163], a[88:91], a[152:155], v[160:163]
  v_exp_f32 v195, v195
  v_mfma_f32_16x16x32_bf16 v[164:167], a[88:91], a[184:187], v[164:167]
  ds_read_b64_tr_b16 a[60:61], v231 offset:49408
  v_cvt_pk_bf16_f32 v213, v194, v195
  v_mfma_f32_16x16x32_bf16 v[160:163], a[92:95], a[156:159], v[160:163]
  buffer_load_dwordx4 v237, s[24:27], s36 offen offset:1024 nt lds
  v_mfma_f32_16x16x32_bf16 v[164:167], a[92:95], a[188:191], v[164:167]
  ds_write_b64 v240, v[212:213] offset:0
  v_add_f32 v215, v215, v181
  v_mfma_f32_16x16x32_bf16 v[168:171], a[96:99], a[128:131], v[242:245]
  v_exp_f32 v188, v188
  v_mfma_f32_16x16x32_bf16 v[172:175], a[96:99], a[160:163], v[246:249]
  ds_read_b64_tr_b16 a[62:63], v231 offset:57600
  v_add_f32 v215, v215, v182
  v_mfma_f32_16x16x32_bf16 v[168:171], a[100:103], a[132:135], v[168:171]
  ds_read_b64_tr_b16 a[0:1], v224 offset:49152
  v_add_f32 v215, v215, v183
  v_mfma_f32_16x16x32_bf16 v[172:175], a[100:103], a[164:167], v[172:175]
  ds_read_b64_tr_b16 a[2:3], v224 offset:57344
  v_add_f32 v215, v215, v188
  v_mfma_f32_16x16x32_bf16 v[168:171], a[104:107], a[136:139], v[168:171]
  v_exp_f32 v189, v189
  v_mfma_f32_16x16x32_bf16 v[172:175], a[104:107], a[168:171], v[172:175]
  ds_read_b64_tr_b16 a[16:17], v228 offset:49152
  v_cvt_pk_bf16_f32 v210, v188, v189
  v_mfma_f32_16x16x32_bf16 v[168:171], a[108:111], a[140:143], v[168:171]
  ds_read_b64_tr_b16 a[18:19], v228 offset:57344
  v_add_f32 v215, v215, v189
  v_mfma_f32_16x16x32_bf16 v[172:175], a[108:111], a[172:175], v[172:175]
  ds_read_b64_tr_b16 a[32:33], v224 offset:49408
  v_add_f32 v216, v216, v192
  v_mfma_f32_16x16x32_bf16 v[168:171], a[112:115], a[144:147], v[168:171]
  ds_read_b64_tr_b16 a[34:35], v224 offset:57600
  v_add_f32 v216, v216, v193
  v_mfma_f32_16x16x32_bf16 v[172:175], a[112:115], a[176:179], v[172:175]
  ds_read_b64_tr_b16 a[48:49], v228 offset:49408
  v_add_f32 v216, v216, v194
  v_mfma_f32_16x16x32_bf16 v[168:171], a[116:119], a[148:151], v[168:171]
  ds_read_b64_tr_b16 a[50:51], v228 offset:57600
  v_add_f32 v216, v216, v195
  v_mfma_f32_16x16x32_bf16 v[172:175], a[116:119], a[180:183], v[172:175]
  buffer_load_dwordx4 v238, s[24:27], s36 offen offset:2048 nt lds
  v_mfma_f32_16x16x32_bf16 v[168:171], a[120:123], a[152:155], v[168:171]
  v_exp_f32 v190, v190
  v_mfma_f32_16x16x32_bf16 v[172:175], a[120:123], a[184:187], v[172:175]
  buffer_load_dwordx4 v239, s[24:27], s36 offen offset:3072 nt lds
  v_mfma_f32_16x16x32_bf16 v[168:171], a[124:127], a[156:159], v[168:171]
  v_exp_f32 v191, v191
  v_mfma_f32_16x16x32_bf16 v[172:175], a[124:127], a[188:191], v[172:175]
  v_cvt_pk_bf16_f32 v211, v190, v191
  v_add_f32 v215, v215, v190
  v_add_f32 v215, v215, v191
  s_waitcnt vmcnt(16) lgkmcnt(0)
  s_barrier
  v_mfma_f32_16x16x32_bf16 v[8:11], a[4:7], v[204:207], v[8:11]
  ds_read_b128 a[96:99], v220 offset:24576
  v_mul_f32 v160, s39, v160
  v_mfma_f32_16x16x32_bf16 v[12:15], a[4:7], v[208:211], v[12:15]
  v_exp_f32 v160, v160
  v_mfma_f32_16x16x32_bf16 v[16:19], a[8:11], v[204:207], v[16:19]
  ds_read_b128 a[100:103], v221 offset:24576
  v_mul_f32 v161, s39, v161
  v_mfma_f32_16x16x32_bf16 v[20:23], a[8:11], v[208:211], v[20:23]
  ds_read_b128 a[104:107], v222 offset:24576
  v_mul_f32 v162, s39, v162
  v_mfma_f32_16x16x32_bf16 v[24:27], a[12:15], v[204:207], v[24:27]
  ds_read_b128 a[108:111], v223 offset:24576
  s_add_u32 s36, s36, 16384
  v_mfma_f32_16x16x32_bf16 v[28:31], a[12:15], v[208:211], v[28:31]
  v_exp_f32 v161, v161
  v_mfma_f32_16x16x32_bf16 v[40:43], a[20:23], v[204:207], v[40:43]
  ds_read_b128 a[112:115], v220 offset:24832
  s_add_u32 m0, s38, 0
  v_mfma_f32_16x16x32_bf16 v[44:47], a[20:23], v[208:211], v[44:47]
  ds_read_b128 a[116:119], v221 offset:24832
  v_mul_f32 v163, s39, v163
  v_mfma_f32_16x16x32_bf16 v[48:51], a[24:27], v[204:207], v[48:51]
  ds_read_b128 a[120:123], v222 offset:24832
  v_mul_f32 v168, s39, v168
  v_mfma_f32_16x16x32_bf16 v[52:55], a[24:27], v[208:211], v[52:55]
  v_exp_f32 v162, v162
  v_mfma_f32_16x16x32_bf16 v[56:59], a[28:31], v[204:207], v[56:59]
  ds_read_b128 a[124:127], v223 offset:24832
  v_mul_f32 v169, s39, v169
  v_mfma_f32_16x16x32_bf16 v[60:63], a[28:31], v[208:211], v[60:63]
  buffer_load_dwordx4 v232, s[20:23], s36 offen offset:0 nt lds
  v_mfma_f32_16x16x32_bf16 v[72:75], a[36:39], v[204:207], v[72:75]
  ds_read_b64_tr_b16 a[4:5], v225 offset:0
  v_mul_f32 v170, s39, v170
  v_mfma_f32_16x16x32_bf16 v[76:79], a[36:39], v[208:211], v[76:79]
  ds_read_b128 a[224:227], v241 offset:0
  v_mul_f32 v171, s39, v171
  v_mfma_f32_16x16x32_bf16 v[80:83], a[40:43], v[204:207], v[80:83]
  v_exp_f32 v163, v163
  v_mfma_f32_16x16x32_bf16 v[84:87], a[40:43], v[208:211], v[84:87]
  ds_read_b128 a[64:67], v220 offset:16384
  v_mul_f32 v164, s39, v164
  v_mfma_f32_16x16x32_bf16 v[88:91], a[44:47], v[204:207], v[88:91]
  ds_read_b64_tr_b16 a[6:7], v225 offset:8192
  v_mul_f32 v165, s39, v165
  v_mfma_f32_16x16x32_bf16 v[92:95], a[44:47], v[208:211], v[92:95]
  ds_read_b128 a[68:71], v221 offset:16384
  v_mul_f32 v166, s39, v166
  v_mfma_f32_16x16x32_bf16 v[104:107], a[52:55], v[204:207], v[104:107]
  v_exp_f32 v168, v168
  v_mfma_f32_16x16x32_bf16 v[108:111], a[52:55], v[208:211], v[108:111]
  ds_read_b128 a[72:75], v222 offset:16384
  v_mul_f32 v167, s39, v167
  v_mfma_f32_16x16x32_bf16 v[112:115], a[56:59], v[204:207], v[112:115]
  buffer_load_dwordx4 v233, s[20:23], s36 offen offset:1024 nt lds
  v_mfma_f32_16x16x32_bf16 v[116:119], a[56:59], v[208:211], v[116:119]
  ds_read_b128 a[76:79], v223 offset:16384
  v_mul_f32 v172, s39, v172
  v_mfma_f32_16x16x32_bf16 v[120:123], a[60:63], v[204:207], v[120:123]
  v_mul_f32 v173, s39, v173
  v_mfma_f32_16x16x32_bf16 v[124:127], a[60:63], v[208:211], v[124:127]
  v_exp_f32 v169, v169
  v_mfma_f32_16x16x32_bf16 v[0:3], a[0:3], v[204:207], v[0:3]
  ds_read_b128 a[80:83], v220 offset:16640
  v_mul_f32 v174, s39, v174
  v_mfma_f32_16x16x32_bf16 v[4:7], a[0:3], v[208:211], v[4:7]
  ds_read_b64_tr_b16 a[8:9], v226 offset:0
  v_mul_f32 v175, s39, v175
  v_mfma_f32_16x16x32_bf16 v[128:131], a[0:3], a[232:235], v[128:131]
  ds_read_b128 a[84:87], v221 offset:16640
  v_cvt_pk_bf16_f32 v196, v160, v161
  v_exp_f32 v170, v170
  v_mfma_f32_16x16x32_bf16 v[32:35], a[16:19], v[204:207], v[32:35]
  ds_read_b128 a[88:91], v222 offset:16640
  v_cvt_pk_bf16_f32 v197, v162, v163
  v_mfma_f32_16x16x32_bf16 v[36:39], a[16:19], v[208:211], v[36:39]
  buffer_load_dwordx4 v234, s[20:23], s36 offen offset:2048 nt lds
  v_mfma_f32_16x16x32_bf16 v[136:139], a[16:19], a[232:235], v[136:139]
  ds_read_b128 a[92:95], v223 offset:16640
  ds_read_b64_tr_b16 a[10:11], v226 offset:8192
  v_cvt_pk_bf16_f32 v198, v168, v169
  v_add_f32 v214, v214, v160
  v_mfma_f32_16x16x32_bf16 v[64:67], a[32:35], v[204:207], v[64:67]
  v_exp_f32 v171, v171
  v_mfma_f32_16x16x32_bf16 v[68:71], a[32:35], v[208:211], v[68:71]
  ds_read_b64_tr_b16 a[12:13], v227 offset:0
  v_cvt_pk_bf16_f32 v199, v170, v171
  v_mfma_f32_16x16x32_bf16 v[144:147], a[32:35], a[232:235], v[144:147]
  ds_read_b64_tr_b16 a[14:15], v227 offset:8192
  ds_read_b64_tr_b16 a[20:21], v229 offset:0
  v_add_f32 v214, v214, v161
  v_add_f32 v214, v214, v162
  v_mfma_f32_16x16x32_bf16 v[96:99], a[48:51], v[204:207], v[96:99]
  v_exp_f32 v164, v164
  v_mfma_f32_16x16x32_bf16 v[100:103], a[48:51], v[208:211], v[100:103]
  ds_read_b64_tr_b16 a[22:23], v229 offset:8192
  v_add_f32 v214, v214, v163
  v_mfma_f32_16x16x32_bf16 v[152:155], a[48:51], a[232:235], v[152:155]
  buffer_load_dwordx4 v235, s[20:23], s36 offen offset:3072 nt lds
  ds_read_b64_tr_b16 a[24:25], v230 offset:0
  s_waitcnt lgkmcnt(6)
  v_mfma_f32_16x16x32_bf16 v[192:195], a[96:99], a[192:195], v[250:253]
  ds_read_b64_tr_b16 a[26:27], v230 offset:8192
  s_add_u32 m0, s38, 114688
  v_mfma_f32_16x16x32_bf16 v[192:195], a[100:103], a[196:199], v[192:195]
  v_exp_f32 v165, v165
  v_mfma_f32_16x16x32_bf16 v[192:195], a[104:107], a[200:203], v[192:195]
  ds_read_b64_tr_b16 a[28:29], v231 offset:0
  v_cvt_pk_bf16_f32 v200, v164, v165
  v_mfma_f32_16x16x32_bf16 v[192:195], a[108:111], a[204:207], v[192:195]
  ds_read_b64_tr_b16 a[30:31], v231 offset:8192
  v_add_f32 v214, v214, v168
  v_mfma_f32_16x16x32_bf16 v[192:195], a[112:115], a[208:211], v[192:195]
  ds_read_b64_tr_b16 a[36:37], v225 offset:256
  v_add_f32 v214, v214, v169
  v_mfma_f32_16x16x32_bf16 v[192:195], a[116:119], a[212:215], v[192:195]
  ds_read_b64_tr_b16 a[38:39], v225 offset:8448
  v_add_f32 v214, v214, v170
  v_mfma_f32_16x16x32_bf16 v[192:195], a[120:123], a[216:219], v[192:195]
  v_exp_f32 v166, v166
  v_mfma_f32_16x16x32_bf16 v[192:195], a[124:127], a[220:223], v[192:195]
  ds_read_b64_tr_b16 a[40:41], v226 offset:256
  v_add_f32 v214, v214, v171
  v_mfma_f32_16x16x32_bf16 v[176:179], a[64:67], a[128:131], v[242:245]
  buffer_load_dwordx4 v236, s[24:27], s36 offen offset:0 nt lds
  v_mfma_f32_16x16x32_bf16 v[180:183], a[64:67], a[160:163], v[246:249]
  ds_read_b64_tr_b16 a[42:43], v226 offset:8448
  v_add_f32 v215, v215, v164
  v_mfma_f32_16x16x32_bf16 v[176:179], a[68:71], a[132:135], v[176:179]
  v_exp_f32 v167, v167
  v_mfma_f32_16x16x32_bf16 v[180:183], a[68:71], a[164:167], v[180:183]
  ds_read_b64_tr_b16 a[44:45], v227 offset:256
  v_mul_f32 v192, s39, v192
  v_mfma_f32_16x16x32_bf16 v[176:179], a[72:75], a[136:139], v[176:179]
  ds_read_b64_tr_b16 a[46:47], v227 offset:8448
  v_mul_f32 v193, s39, v193
  v_mfma_f32_16x16x32_bf16 v[180:183], a[72:75], a[168:171], v[180:183]
  v_exp_f32 v192, v192
  v_mfma_f32_16x16x32_bf16 v[176:179], a[76:79], a[140:143], v[176:179]
  ds_read_b64_tr_b16 a[52:53], v229 offset:256
  v_mul_f32 v194, s39, v194
  v_mfma_f32_16x16x32_bf16 v[180:183], a[76:79], a[172:175], v[180:183]
  v_exp_f32 v193, v193
  v_mfma_f32_16x16x32_bf16 v[176:179], a[80:83], a[144:147], v[176:179]
  ds_read_b64_tr_b16 a[54:55], v229 offset:8448
  v_mul_f32 v195, s39, v195
  v_mfma_f32_16x16x32_bf16 v[180:183], a[80:83], a[176:179], v[180:183]
  ds_read_b64_tr_b16 a[56:57], v230 offset:256
  v_cvt_pk_bf16_f32 v212, v192, v193
  v_mfma_f32_16x16x32_bf16 v[176:179], a[84:87], a[148:151], v[176:179]
  v_exp_f32 v194, v194
  v_mfma_f32_16x16x32_bf16 v[180:183], a[84:87], a[180:183], v[180:183]
  ds_read_b64_tr_b16 a[58:59], v230 offset:8448
  v_cvt_pk_bf16_f32 v201, v166, v167
  v_mfma_f32_16x16x32_bf16 v[176:179], a[88:91], a[152:155], v[176:179]
  v_exp_f32 v195, v195
  v_mfma_f32_16x16x32_bf16 v[180:183], a[88:91], a[184:187], v[180:183]
  ds_read_b64_tr_b16 a[60:61], v231 offset:256
  v_cvt_pk_bf16_f32 v213, v194, v195
  v_mfma_f32_16x16x32_bf16 v[176:179], a[92:95], a[156:159], v[176:179]
  buffer_load_dwordx4 v237, s[24:27], s36 offen offset:1024 nt lds
  v_mfma_f32_16x16x32_bf16 v[180:183], a[92:95], a[188:191], v[180:183]
  ds_write_b64 v240, v[212:213] offset:2048
  v_add_f32 v215, v215, v165
  v_mfma_f32_16x16x32_bf16 v[184:187], a[96:99], a[128:131], v[242:245]
  v_exp_f32 v172, v172
  v_mfma_f32_16x16x32_bf16 v[188:191], a[96:99], a[160:163], v[246:249]
  ds_read_b64_tr_b16 a[62:63], v231 offset:8448
  v_add_f32 v215, v215, v166
  v_mfma_f32_16x16x32_bf16 v[184:187], a[100:103], a[132:135], v[184:187]
  ds_read_b64_tr_b16 a[0:1], v224 offset:0
  v_add_f32 v215, v215, v167
  v_mfma_f32_16x16x32_bf16 v[188:191], a[100:103], a[164:167], v[188:191]
  ds_read_b64_tr_b16 a[2:3], v224 offset:8192
  v_add_f32 v215, v215, v172
  v_mfma_f32_16x16x32_bf16 v[184:187], a[104:107], a[136:139], v[184:187]
  v_exp_f32 v173, v173
  v_mfma_f32_16x16x32_bf16 v[188:191], a[104:107], a[168:171], v[188:191]
  ds_read_b64_tr_b16 a[16:17], v228 offset:0
  v_cvt_pk_bf16_f32 v202, v172, v173
  v_mfma_f32_16x16x32_bf16 v[184:187], a[108:111], a[140:143], v[184:187]
  ds_read_b64_tr_b16 a[18:19], v228 offset:8192
  v_add_f32 v215, v215, v173
  v_mfma_f32_16x16x32_bf16 v[188:191], a[108:111], a[172:175], v[188:191]
  ds_read_b64_tr_b16 a[32:33], v224 offset:256
  v_add_f32 v216, v216, v192
  v_mfma_f32_16x16x32_bf16 v[184:187], a[112:115], a[144:147], v[184:187]
  ds_read_b64_tr_b16 a[34:35], v224 offset:8448
  v_add_f32 v216, v216, v193
  v_mfma_f32_16x16x32_bf16 v[188:191], a[112:115], a[176:179], v[188:191]
  ds_read_b64_tr_b16 a[48:49], v228 offset:256
  v_add_f32 v216, v216, v194
  v_mfma_f32_16x16x32_bf16 v[184:187], a[116:119], a[148:151], v[184:187]
  ds_read_b64_tr_b16 a[50:51], v228 offset:8448
  v_add_f32 v216, v216, v195
  v_mfma_f32_16x16x32_bf16 v[188:191], a[116:119], a[180:183], v[188:191]
  buffer_load_dwordx4 v238, s[24:27], s36 offen offset:2048 nt lds
  v_mfma_f32_16x16x32_bf16 v[184:187], a[120:123], a[152:155], v[184:187]
  v_exp_f32 v174, v174
  v_mfma_f32_16x16x32_bf16 v[188:191], a[120:123], a[184:187], v[188:191]
  buffer_load_dwordx4 v239, s[24:27], s36 offen offset:3072 nt lds
  v_mfma_f32_16x16x32_bf16 v[184:187], a[124:127], a[156:159], v[184:187]
  v_exp_f32 v175, v175
  v_mfma_f32_16x16x32_bf16 v[188:191], a[124:127], a[188:191], v[188:191]
  v_cvt_pk_bf16_f32 v203, v174, v175
  v_add_f32 v215, v215, v174
  v_add_f32 v215, v215, v175
  s_waitcnt vmcnt(16) lgkmcnt(0)
  s_barrier
  v_mfma_f32_16x16x32_bf16 v[8:11], a[4:7], v[196:199], v[8:11]
  ds_read_b128 a[96:99], v220 offset:40960
  v_mul_f32 v176, s39, v176
  v_mfma_f32_16x16x32_bf16 v[12:15], a[4:7], v[200:203], v[12:15]
  v_exp_f32 v176, v176
  v_mfma_f32_16x16x32_bf16 v[16:19], a[8:11], v[196:199], v[16:19]
  ds_read_b128 a[100:103], v221 offset:40960
  v_mul_f32 v177, s39, v177
  v_mfma_f32_16x16x32_bf16 v[20:23], a[8:11], v[200:203], v[20:23]
  ds_read_b128 a[104:107], v222 offset:40960
  v_mul_f32 v178, s39, v178
  v_mfma_f32_16x16x32_bf16 v[24:27], a[12:15], v[196:199], v[24:27]
  ds_read_b128 a[108:111], v223 offset:40960
  s_add_u32 s36, s36, 16384
  v_mfma_f32_16x16x32_bf16 v[28:31], a[12:15], v[200:203], v[28:31]
  v_exp_f32 v177, v177
  v_mfma_f32_16x16x32_bf16 v[40:43], a[20:23], v[196:199], v[40:43]
  ds_read_b128 a[112:115], v220 offset:41216
  s_add_u32 m0, s38, 16384
  v_mfma_f32_16x16x32_bf16 v[44:47], a[20:23], v[200:203], v[44:47]
  ds_read_b128 a[116:119], v221 offset:41216
  v_mul_f32 v179, s39, v179
  v_mfma_f32_16x16x32_bf16 v[48:51], a[24:27], v[196:199], v[48:51]
  ds_read_b128 a[120:123], v222 offset:41216
  v_mul_f32 v184, s39, v184
  v_mfma_f32_16x16x32_bf16 v[52:55], a[24:27], v[200:203], v[52:55]
  v_exp_f32 v178, v178
  v_mfma_f32_16x16x32_bf16 v[56:59], a[28:31], v[196:199], v[56:59]
  ds_read_b128 a[124:127], v223 offset:41216
  v_mul_f32 v185, s39, v185
  v_mfma_f32_16x16x32_bf16 v[60:63], a[28:31], v[200:203], v[60:63]
  buffer_load_dwordx4 v232, s[20:23], s36 offen offset:0 nt lds
  v_mfma_f32_16x16x32_bf16 v[72:75], a[36:39], v[196:199], v[72:75]
  ds_read_b64_tr_b16 a[4:5], v225 offset:16384
  v_mul_f32 v186, s39, v186
  v_mfma_f32_16x16x32_bf16 v[76:79], a[36:39], v[200:203], v[76:79]
  ds_read_b128 a[232:235], v241 offset:2048
  v_mul_f32 v187, s39, v187
  v_mfma_f32_16x16x32_bf16 v[80:83], a[40:43], v[196:199], v[80:83]
  v_exp_f32 v179, v179
  v_mfma_f32_16x16x32_bf16 v[84:87], a[40:43], v[200:203], v[84:87]
  ds_read_b128 a[64:67], v220 offset:32768
  v_mul_f32 v180, s39, v180
  v_mfma_f32_16x16x32_bf16 v[88:91], a[44:47], v[196:199], v[88:91]
  ds_read_b64_tr_b16 a[6:7], v225 offset:24576
  v_mul_f32 v181, s39, v181
  v_mfma_f32_16x16x32_bf16 v[92:95], a[44:47], v[200:203], v[92:95]
  ds_read_b128 a[68:71], v221 offset:32768
  v_mul_f32 v182, s39, v182
  v_mfma_f32_16x16x32_bf16 v[104:107], a[52:55], v[196:199], v[104:107]
  v_exp_f32 v184, v184
  v_mfma_f32_16x16x32_bf16 v[108:111], a[52:55], v[200:203], v[108:111]
  ds_read_b128 a[72:75], v222 offset:32768
  v_mul_f32 v183, s39, v183
  v_mfma_f32_16x16x32_bf16 v[112:115], a[56:59], v[196:199], v[112:115]
  buffer_load_dwordx4 v233, s[20:23], s36 offen offset:1024 nt lds
  v_mfma_f32_16x16x32_bf16 v[116:119], a[56:59], v[200:203], v[116:119]
  ds_read_b128 a[76:79], v223 offset:32768
  v_mul_f32 v188, s39, v188
  v_mfma_f32_16x16x32_bf16 v[120:123], a[60:63], v[196:199], v[120:123]
  v_mul_f32 v189, s39, v189
  v_mfma_f32_16x16x32_bf16 v[124:127], a[60:63], v[200:203], v[124:127]
  v_exp_f32 v185, v185
  v_mfma_f32_16x16x32_bf16 v[0:3], a[0:3], v[196:199], v[0:3]
  ds_read_b128 a[80:83], v220 offset:33024
  v_mul_f32 v190, s39, v190
  v_mfma_f32_16x16x32_bf16 v[4:7], a[0:3], v[200:203], v[4:7]
  ds_read_b64_tr_b16 a[8:9], v226 offset:16384
  v_mul_f32 v191, s39, v191
  v_mfma_f32_16x16x32_bf16 v[128:131], a[0:3], a[224:227], v[128:131]
  ds_read_b128 a[84:87], v221 offset:33024
  v_cvt_pk_bf16_f32 v204, v176, v177
  v_exp_f32 v186, v186
  v_mfma_f32_16x16x32_bf16 v[32:35], a[16:19], v[196:199], v[32:35]
  ds_read_b128 a[88:91], v222 offset:33024
  v_cvt_pk_bf16_f32 v205, v178, v179
  v_mfma_f32_16x16x32_bf16 v[36:39], a[16:19], v[200:203], v[36:39]
  buffer_load_dwordx4 v234, s[20:23], s36 offen offset:2048 nt lds
  v_mfma_f32_16x16x32_bf16 v[136:139], a[16:19], a[224:227], v[136:139]
  ds_read_b128 a[92:95], v223 offset:33024
  ds_read_b64_tr_b16 a[10:11], v226 offset:24576
  v_cvt_pk_bf16_f32 v206, v184, v185
  v_add_f32 v214, v214, v176
  v_mfma_f32_16x16x32_bf16 v[64:67], a[32:35], v[196:199], v[64:67]
  v_exp_f32 v187, v187
  v_mfma_f32_16x16x32_bf16 v[68:71], a[32:35], v[200:203], v[68:71]
  ds_read_b64_tr_b16 a[12:13], v227 offset:16384
  v_cvt_pk_bf16_f32 v207, v186, v187
  v_mfma_f32_16x16x32_bf16 v[144:147], a[32:35], a[224:227], v[144:147]
  ds_read_b64_tr_b16 a[14:15], v227 offset:24576
  ds_read_b64_tr_b16 a[20:21], v229 offset:16384
  v_add_f32 v214, v214, v177
  v_add_f32 v214, v214, v178
  v_mfma_f32_16x16x32_bf16 v[96:99], a[48:51], v[196:199], v[96:99]
  v_exp_f32 v180, v180
  v_mfma_f32_16x16x32_bf16 v[100:103], a[48:51], v[200:203], v[100:103]
  ds_read_b64_tr_b16 a[22:23], v229 offset:24576
  v_add_f32 v214, v214, v179
  v_mfma_f32_16x16x32_bf16 v[152:155], a[48:51], a[224:227], v[152:155]
  buffer_load_dwordx4 v235, s[20:23], s36 offen offset:3072 nt lds
  ds_read_b64_tr_b16 a[24:25], v230 offset:16384
  s_waitcnt lgkmcnt(6)
  s_add_u32 s40, s40, 1
  s_cmp_lt_u32 s40, 7
  s_cbranch_scc1 L_loop_k1q1p0
  v_mfma_f32_16x16x32_bf16 v[192:195], a[96:99], a[192:195], v[250:253]
  ds_read_b64_tr_b16 a[26:27], v230 offset:24576
  v_mfma_f32_16x16x32_bf16 v[192:195], a[100:103], a[196:199], v[192:195]
  v_exp_f32 v181, v181
  v_mfma_f32_16x16x32_bf16 v[192:195], a[104:107], a[200:203], v[192:195]
  ds_read_b64_tr_b16 a[28:29], v231 offset:16384
  v_cvt_pk_bf16_f32 v208, v180, v181
  v_mfma_f32_16x16x32_bf16 v[192:195], a[108:111], a[204:207], v[192:195]
  ds_read_b64_tr_b16 a[30:31], v231 offset:24576
  v_add_f32 v214, v214, v184
  v_mfma_f32_16x16x32_bf16 v[192:195], a[112:115], a[208:211], v[192:195]
  ds_read_b64_tr_b16 a[36:37], v225 offset:16640
  v_add_f32 v214, v214, v185
  v_mfma_f32_16x16x32_bf16 v[192:195], a[116:119], a[212:215], v[192:195]
  ds_read_b64_tr_b16 a[38:39], v225 offset:24832
  v_add_f32 v214, v214, v186
  v_mfma_f32_16x16x32_bf16 v[192:195], a[120:123], a[216:219], v[192:195]
  v_exp_f32 v182, v182
  v_mfma_f32_16x16x32_bf16 v[192:195], a[124:127], a[220:223], v[192:195]
  ds_read_b64_tr_b16 a[40:41], v226 offset:16640
  v_add_f32 v214, v214, v187
  v_mfma_f32_16x16x32_bf16 v[160:163], a[64:67], a[128:131], v[242:245]
  v_mfma_f32_16x16x32_bf16 v[164:167], a[64:67], a[160:163], v[246:249]
  ds_read_b64_tr_b16 a[42:43], v226 offset:24832
  v_add_f32 v215, v215, v180
  v_mfma_f32_16x16x32_bf16 v[160:163], a[68:71], a[132:135], v[160:163]
  v_exp_f32 v183, v183
  v_mfma_f32_16x16x32_bf16 v[164:167], a[68:71], a[164:167], v[164:167]
  ds_read_b64_tr_b16 a[44:45], v227 offset:16640
  v_mul_f32 v192, s39, v192
  v_mfma_f32_16x16x32_bf16 v[160:163], a[72:75], a[136:139], v[160:163]
  ds_read_b64_tr_b16 a[46:47], v227 offset:24832
  v_mul_f32 v193, s39, v193
  v_mfma_f32_16x16x32_bf16 v[164:167], a[72:75], a[168:171], v[164:167]
  v_exp_f32 v192, v192
  v_mfma_f32_16x16x32_bf16 v[160:163], a[76:79], a[140:143], v[160:163]
  ds_read_b64_tr_b16 a[52:53], v229 offset:16640
  v_mul_f32 v194, s39, v194
  v_mfma_f32_16x16x32_bf16 v[164:167], a[76:79], a[172:175], v[164:167]
  v_exp_f32 v193, v193
  v_mfma_f32_16x16x32_bf16 v[160:163], a[80:83], a[144:147], v[160:163]
  ds_read_b64_tr_b16 a[54:55], v229 offset:24832
  v_mul_f32 v195, s39, v195
  v_mfma_f32_16x16x32_bf16 v[164:167], a[80:83], a[176:179], v[164:167]
  ds_read_b64_tr_b16 a[56:57], v230 offset:16640
  v_cvt_pk_bf16_f32 v212, v192, v193
  v_mfma_f32_16x16x32_bf16 v[160:163], a[84:87], a[148:151], v[160:163]
  v_exp_f32 v194, v194
  v_mfma_f32_16x16x32_bf16 v[164:167], a[84:87], a[180:183], v[164:167]
  ds_read_b64_tr_b16 a[58:59], v230 offset:24832
  v_cvt_pk_bf16_f32 v209, v182, v183
  v_mfma_f32_16x16x32_bf16 v[160:163], a[88:91], a[152:155], v[160:163]
  v_exp_f32 v195, v195
  v_mfma_f32_16x16x32_bf16 v[164:167], a[88:91], a[184:187], v[164:167]
  ds_read_b64_tr_b16 a[60:61], v231 offset:16640
  v_cvt_pk_bf16_f32 v213, v194, v195
  v_mfma_f32_16x16x32_bf16 v[160:163], a[92:95], a[156:159], v[160:163]
  v_mfma_f32_16x16x32_bf16 v[164:167], a[92:95], a[188:191], v[164:167]
  ds_write_b64 v240, v[212:213] offset:0
  v_add_f32 v215, v215, v181
  v_mfma_f32_16x16x32_bf16 v[168:171], a[96:99], a[128:131], v[242:245]
  v_exp_f32 v188, v188
  v_mfma_f32_16x16x32_bf16 v[172:175], a[96:99], a[160:163], v[246:249]
  ds_read_b64_tr_b16 a[62:63], v231 offset:24832
  v_add_f32 v215, v215, v182
  v_mfma_f32_16x16x32_bf16 v[168:171], a[100:103], a[132:135], v[168:171]
  ds_read_b64_tr_b16 a[0:1], v224 offset:16384
  v_add_f32 v215, v215, v183
  v_mfma_f32_16x16x32_bf16 v[172:175], a[100:103], a[164:167], v[172:175]
  ds_read_b64_tr_b16 a[2:3], v224 offset:24576
  v_add_f32 v215, v215, v188
  v_mfma_f32_16x16x32_bf16 v[168:171], a[104:107], a[136:139], v[168:171]
  v_exp_f32 v189, v189
  v_mfma_f32_16x16x32_bf16 v[172:175], a[104:107], a[168:171], v[172:175]
  ds_read_b64_tr_b16 a[16:17], v228 offset:16384
  v_cvt_pk_bf16_f32 v210, v188, v189
  v_mfma_f32_16x16x32_bf16 v[168:171], a[108:111], a[140:143], v[168:171]
  ds_read_b64_tr_b16 a[18:19], v228 offset:24576
  v_add_f32 v215, v215, v189
  v_mfma_f32_16x16x32_bf16 v[172:175], a[108:111], a[172:175], v[172:175]
  ds_read_b64_tr_b16 a[32:33], v224 offset:16640
  v_add_f32 v216, v216, v192
  v_mfma_f32_16x16x32_bf16 v[168:171], a[112:115], a[144:147], v[168:171]
  ds_read_b64_tr_b16 a[34:35], v224 offset:24832
  v_add_f32 v216, v216, v193
  v_mfma_f32_16x16x32_bf16 v[172:175], a[112:115], a[176:179], v[172:175]
  ds_read_b64_tr_b16 a[48:49], v228 offset:16640
  v_add_f32 v216, v216, v194
  v_mfma_f32_16x16x32_bf16 v[168:171], a[116:119], a[148:151], v[168:171]
  ds_read_b64_tr_b16 a[50:51], v228 offset:24832
  v_add_f32 v216, v216, v195
  v_mfma_f32_16x16x32_bf16 v[172:175], a[116:119], a[180:183], v[172:175]
  v_mfma_f32_16x16x32_bf16 v[168:171], a[120:123], a[152:155], v[168:171]
  v_exp_f32 v190, v190
  v_mfma_f32_16x16x32_bf16 v[172:175], a[120:123], a[184:187], v[172:175]
  v_mfma_f32_16x16x32_bf16 v[168:171], a[124:127], a[156:159], v[168:171]
  v_exp_f32 v191, v191
  v_mfma_f32_16x16x32_bf16 v[172:175], a[124:127], a[188:191], v[172:175]
  v_cvt_pk_bf16_f32 v211, v190, v191
  v_add_f32 v215, v215, v190
  v_add_f32 v215, v215, v191
  s_waitcnt vmcnt(12) lgkmcnt(0)
  s_barrier
  v_mfma_f32_16x16x32_bf16 v[8:11], a[4:7], v[204:207], v[8:11]
  ds_read_b128 a[96:99], v220 offset:57344
  v_mul_f32 v160, s39, v160
  v_mfma_f32_16x16x32_bf16 v[12:15], a[4:7], v[208:211], v[12:15]
  v_exp_f32 v160, v160
  v_mfma_f32_16x16x32_bf16 v[16:19], a[8:11], v[204:207], v[16:19]
  ds_read_b128 a[100:103], v221 offset:57344
  v_mul_f32 v161, s39, v161
  v_mfma_f32_16x16x32_bf16 v[20:23], a[8:11], v[208:211], v[20:23]
  ds_read_b128 a[104:107], v222 offset:57344
  v_mul_f32 v162, s39, v162
  v_mfma_f32_16x16x32_bf16 v[24:27], a[12:15], v[204:207], v[24:27]
  ds_read_b128 a[108:111], v223 offset:57344
  v_mfma_f32_16x16x32_bf16 v[28:31], a[12:15], v[208:211], v[28:31]
  v_exp_f32 v161, v161
  v_mfma_f32_16x16x32_bf16 v[40:43], a[20:23], v[204:207], v[40:43]
  ds_read_b128 a[112:115], v220 offset:57600
  v_mfma_f32_16x16x32_bf16 v[44:47], a[20:23], v[208:211], v[44:47]
  ds_read_b128 a[116:119], v221 offset:57600
  v_mul_f32 v163, s39, v163
  v_mfma_f32_16x16x32_bf16 v[48:51], a[24:27], v[204:207], v[48:51]
  ds_read_b128 a[120:123], v222 offset:57600
  v_mul_f32 v168, s39, v168
  v_mfma_f32_16x16x32_bf16 v[52:55], a[24:27], v[208:211], v[52:55]
  v_exp_f32 v162, v162
  v_mfma_f32_16x16x32_bf16 v[56:59], a[28:31], v[204:207], v[56:59]
  ds_read_b128 a[124:127], v223 offset:57600
  v_mul_f32 v169, s39, v169
  v_mfma_f32_16x16x32_bf16 v[60:63], a[28:31], v[208:211], v[60:63]
  v_mfma_f32_16x16x32_bf16 v[72:75], a[36:39], v[204:207], v[72:75]
  ds_read_b64_tr_b16 a[4:5], v225 offset:32768
  v_mul_f32 v170, s39, v170
  v_mfma_f32_16x16x32_bf16 v[76:79], a[36:39], v[208:211], v[76:79]
  ds_read_b128 a[224:227], v241 offset:0
  v_mul_f32 v171, s39, v171
  v_mfma_f32_16x16x32_bf16 v[80:83], a[40:43], v[204:207], v[80:83]
  v_exp_f32 v163, v163
  v_mfma_f32_16x16x32_bf16 v[84:87], a[40:43], v[208:211], v[84:87]
  ds_read_b128 a[64:67], v220 offset:49152
  v_mul_f32 v164, s39, v164
  v_mfma_f32_16x16x32_bf16 v[88:91], a[44:47], v[204:207], v[88:91]
  ds_read_b64_tr_b16 a[6:7], v225 offset:40960
  v_mul_f32 v165, s39, v165
  v_mfma_f32_16x16x32_bf16 v[92:95], a[44:47], v[208:211], v[92:95]
  ds_read_b128 a[68:71], v221 offset:49152
  v_mul_f32 v166, s39, v166
  v_mfma_f32_16x16x32_bf16 v[104:107], a[52:55], v[204:207], v[104:107]
  v_exp_f32 v168, v168
  v_mfma_f32_16x16x32_bf16 v[108:111], a[52:55], v[208:211], v[108:111]
  ds_read_b128 a[72:75], v222 offset:49152
  v_mul_f32 v167, s39, v167
  v_mfma_f32_16x16x32_bf16 v[112:115], a[56:59], v[204:207], v[112:115]
  v_mfma_f32_16x16x32_bf16 v[116:119], a[56:59], v[208:211], v[116:119]
  ds_read_b128 a[76:79], v223 offset:49152
  v_mul_f32 v172, s39, v172
  v_mfma_f32_16x16x32_bf16 v[120:123], a[60:63], v[204:207], v[120:123]
  v_mul_f32 v173, s39, v173
  v_mfma_f32_16x16x32_bf16 v[124:127], a[60:63], v[208:211], v[124:127]
  v_exp_f32 v169, v169
  v_mfma_f32_16x16x32_bf16 v[0:3], a[0:3], v[204:207], v[0:3]
  ds_read_b128 a[80:83], v220 offset:49408
  v_mul_f32 v174, s39, v174
  v_mfma_f32_16x16x32_bf16 v[4:7], a[0:3], v[208:211], v[4:7]
  ds_read_b64_tr_b16 a[8:9], v226 offset:32768
  v_mul_f32 v175, s39, v175
  v_mfma_f32_16x16x32_bf16 v[128:131], a[0:3], a[232:235], v[128:131]
  ds_read_b128 a[84:87], v221 offset:49408
  v_cvt_pk_bf16_f32 v196, v160, v161
  v_exp_f32 v170, v170
  v_mfma_f32_16x16x32_bf16 v[32:35], a[16:19], v[204:207], v[32:35]
  ds_read_b128 a[88:91], v222 offset:49408
  v_cvt_pk_bf16_f32 v197, v162, v163
  v_mfma_f32_16x16x32_bf16 v[36:39], a[16:19], v[208:211], v[36:39]
  v_mfma_f32_16x16x32_bf16 v[136:139], a[16:19], a[232:235], v[136:139]
  ds_read_b128 a[92:95], v223 offset:49408
  ds_read_b64_tr_b16 a[10:11], v226 offset:40960
  v_cvt_pk_bf16_f32 v198, v168, v169
  v_add_f32 v214, v214, v160
  v_mfma_f32_16x16x32_bf16 v[64:67], a[32:35], v[204:207], v[64:67]
  v_exp_f32 v171, v171
  v_mfma_f32_16x16x32_bf16 v[68:71], a[32:35], v[208:211], v[68:71]
  ds_read_b64_tr_b16 a[12:13], v227 offset:32768
  v_cvt_pk_bf16_f32 v199, v170, v171
  v_mfma_f32_16x16x32_bf16 v[144:147], a[32:35], a[232:235], v[144:147]
  ds_read_b64_tr_b16 a[14:15], v227 offset:40960
  ds_read_b64_tr_b16 a[20:21], v229 offset:32768
  v_add_f32 v214, v214, v161
  v_add_f32 v214, v214, v162
  v_mfma_f32_16x16x32_bf16 v[96:99], a[48:51], v[204:207], v[96:99]
  v_exp_f32 v164, v164
  v_mfma_f32_16x16x32_bf16 v[100:103], a[48:51], v[208:211], v[100:103]
  ds_read_b64_tr_b16 a[22:23], v229 offset:40960
  v_add_f32 v214, v214, v163
  v_mfma_f32_16x16x32_bf16 v[152:155], a[48:51], a[232:235], v[152:155]
  ds_read_b64_tr_b16 a[24:25], v230 offset:32768
  s_waitcnt lgkmcnt(6)
  v_mfma_f32_16x16x32_bf16 v[192:195], a[96:99], a[192:195], v[250:253]
  ds_read_b64_tr_b16 a[26:27], v230 offset:40960
  v_mfma_f32_16x16x32_bf16 v[192:195], a[100:103], a[196:199], v[192:195]
  v_exp_f32 v165, v165
  v_mfma_f32_16x16x32_bf16 v[192:195], a[104:107], a[200:203], v[192:195]
  ds_read_b64_tr_b16 a[28:29], v231 offset:32768
  v_cvt_pk_bf16_f32 v200, v164, v165
  v_mfma_f32_16x16x32_bf16 v[192:195], a[108:111], a[204:207], v[192:195]
  ds_read_b64_tr_b16 a[30:31], v231 offset:40960
  v_add_f32 v214, v214, v168
  v_mfma_f32_16x16x32_bf16 v[192:195], a[112:115], a[208:211], v[192:195]
  ds_read_b64_tr_b16 a[36:37], v225 offset:33024
  v_add_f32 v214, v214, v169
  v_mfma_f32_16x16x32_bf16 v[192:195], a[116:119], a[212:215], v[192:195]
  ds_read_b64_tr_b16 a[38:39], v225 offset:41216
  v_add_f32 v214, v214, v170
  v_mfma_f32_16x16x32_bf16 v[192:195], a[120:123], a[216:219], v[192:195]
  v_exp_f32 v166, v166
  v_mfma_f32_16x16x32_bf16 v[192:195], a[124:127], a[220:223], v[192:195]
  ds_read_b64_tr_b16 a[40:41], v226 offset:33024
  v_add_f32 v214, v214, v171
  v_mfma_f32_16x16x32_bf16 v[176:179], a[64:67], a[128:131], v[242:245]
  v_mfma_f32_16x16x32_bf16 v[180:183], a[64:67], a[160:163], v[246:249]
  ds_read_b64_tr_b16 a[42:43], v226 offset:41216
  v_add_f32 v215, v215, v164
  v_mfma_f32_16x16x32_bf16 v[176:179], a[68:71], a[132:135], v[176:179]
  v_exp_f32 v167, v167
  v_mfma_f32_16x16x32_bf16 v[180:183], a[68:71], a[164:167], v[180:183]
  ds_read_b64_tr_b16 a[44:45], v227 offset:33024
  v_mul_f32 v192, s39, v192
  v_mfma_f32_16x16x32_bf16 v[176:179], a[72:75], a[136:139], v[176:179]
  ds_read_b64_tr_b16 a[46:47], v227 offset:41216
  v_mul_f32 v193, s39, v193
  v_mfma_f32_16x16x32_bf16 v[180:183], a[72:75], a[168:171], v[180:183]
  v_exp_f32 v192, v192
  v_mfma_f32_16x16x32_bf16 v[176:179], a[76:79], a[140:143], v[176:179]
  ds_read_b64_tr_b16 a[52:53], v229 offset:33024
  v_mul_f32 v194, s39, v194
  v_mfma_f32_16x16x32_bf16 v[180:183], a[76:79], a[172:175], v[180:183]
  v_exp_f32 v193, v193
  v_mfma_f32_16x16x32_bf16 v[176:179], a[80:83], a[144:147], v[176:179]
  ds_read_b64_tr_b16 a[54:55], v229 offset:41216
  v_mul_f32 v195, s39, v195
  v_mfma_f32_16x16x32_bf16 v[180:183], a[80:83], a[176:179], v[180:183]
  ds_read_b64_tr_b16 a[56:57], v230 offset:33024
  v_cvt_pk_bf16_f32 v212, v192, v193
  v_mfma_f32_16x16x32_bf16 v[176:179], a[84:87], a[148:151], v[176:179]
  v_exp_f32 v194, v194
  v_mfma_f32_16x16x32_bf16 v[180:183], a[84:87], a[180:183], v[180:183]
  ds_read_b64_tr_b16 a[58:59], v230 offset:41216
  v_cvt_pk_bf16_f32 v201, v166, v167
  v_mfma_f32_16x16x32_bf16 v[176:179], a[88:91], a[152:155], v[176:179]
  v_exp_f32 v195, v195
  v_mfma_f32_16x16x32_bf16 v[180:183], a[88:91], a[184:187], v[180:183]
  ds_read_b64_tr_b16 a[60:61], v231 offset:33024
  v_cvt_pk_bf16_f32 v213, v194, v195
  v_mfma_f32_16x16x32_bf16 v[176:179], a[92:95], a[156:159], v[176:179]
  v_mfma_f32_16x16x32_bf16 v[180:183], a[92:95], a[188:191], v[180:183]
  ds_write_b64 v240, v[212:213] offset:2048
  v_add_f32 v215, v215, v165
  v_mfma_f32_16x16x32_bf16 v[184:187], a[96:99], a[128:131], v[242:245]
  v_exp_f32 v172, v172
  v_mfma_f32_16x16x32_bf16 v[188:191], a[96:99], a[160:163], v[246:249]
  ds_read_b64_tr_b16 a[62:63], v231 offset:41216
  v_add_f32 v215, v215, v166
  v_mfma_f32_16x16x32_bf16 v[184:187], a[100:103], a[132:135], v[184:187]
  ds_read_b64_tr_b16 a[0:1], v224 offset:32768
  v_add_f32 v215, v215, v167
  v_mfma_f32_16x16x32_bf16 v[188:191], a[100:103], a[164:167], v[188:191]
  ds_read_b64_tr_b16 a[2:3], v224 offset:40960
  v_add_f32 v215, v215, v172
  v_mfma_f32_16x16x32_bf16 v[184:187], a[104:107], a[136:139], v[184:187]
  v_exp_f32 v173, v173
  v_mfma_f32_16x16x32_bf16 v[188:191], a[104:107], a[168:171], v[188:191]
  ds_read_b64_tr_b16 a[16:17], v228 offset:32768
  v_cvt_pk_bf16_f32 v202, v172, v173
  v_mfma_f32_16x16x32_bf16 v[184:187], a[108:111], a[140:143], v[184:187]
  ds_read_b64_tr_b16 a[18:19], v228 offset:40960
  v_add_f32 v215, v215, v173
  v_mfma_f32_16x16x32_bf16 v[188:191], a[108:111], a[172:175], v[188:191]
  ds_read_b64_tr_b16 a[32:33], v224 offset:33024
  v_add_f32 v216, v216, v192
  v_mfma_f32_16x16x32_bf16 v[184:187], a[112:115], a[144:147], v[184:187]
  ds_read_b64_tr_b16 a[34:35], v224 offset:41216
  v_add_f32 v216, v216, v193
  v_mfma_f32_16x16x32_bf16 v[188:191], a[112:115], a[176:179], v[188:191]
  ds_read_b64_tr_b16 a[48:49], v228 offset:33024
  v_add_f32 v216, v216, v194
  v_mfma_f32_16x16x32_bf16 v[184:187], a[116:119], a[148:151], v[184:187]
  ds_read_b64_tr_b16 a[50:51], v228 offset:41216
  v_add_f32 v216, v216, v195
  v_mfma_f32_16x16x32_bf16 v[188:191], a[116:119], a[180:183], v[188:191]
  v_mfma_f32_16x16x32_bf16 v[184:187], a[120:123], a[152:155], v[184:187]
  v_exp_f32 v174, v174
  v_mfma_f32_16x16x32_bf16 v[188:191], a[120:123], a[184:187], v[188:191]
  v_mfma_f32_16x16x32_bf16 v[184:187], a[124:127], a[156:159], v[184:187]
  v_exp_f32 v175, v175
  v_mfma_f32_16x16x32_bf16 v[188:191], a[124:127], a[188:191], v[188:191]
  v_cvt_pk_bf16_f32 v203, v174, v175
  v_add_f32 v215, v215, v174
  v_add_f32 v215, v215, v175
  s_waitcnt vmcnt(4) lgkmcnt(0)
  s_barrier
  v_mfma_f32_16x16x32_bf16 v[8:11], a[4:7], v[196:199], v[8:11]
  v_mul_f32 v176, s39, v176
  v_mfma_f32_16x16x32_bf16 v[12:15], a[4:7], v[200:203], v[12:15]
  ds_read_b64_tr_b16 a[4:5], v225 offset:49152
  v_exp_f32 v176, v176
  v_mfma_f32_16x16x32_bf16 v[16:19], a[8:11], v[196:199], v[16:19]
  ds_read_b64_tr_b16 a[6:7], v225 offset:57344
  v_mul_f32 v177, s39, v177
  v_mfma_f32_16x16x32_bf16 v[20:23], a[8:11], v[200:203], v[20:23]
  ds_read_b64_tr_b16 a[8:9], v226 offset:49152
  v_mul_f32 v178, s39, v178
  v_mfma_f32_16x16x32_bf16 v[24:27], a[12:15], v[196:199], v[24:27]
  ds_read_b64_tr_b16 a[10:11], v226 offset:57344
  v_mfma_f32_16x16x32_bf16 v[28:31], a[12:15], v[200:203], v[28:31]
  ds_read_b64_tr_b16 a[12:13], v227 offset:49152
  v_exp_f32 v177, v177
  v_mfma_f32_16x16x32_bf16 v[40:43], a[20:23], v[196:199], v[40:43]
  ds_read_b64_tr_b16 a[14:15], v227 offset:57344
  v_mfma_f32_16x16x32_bf16 v[44:47], a[20:23], v[200:203], v[44:47]
  ds_read_b64_tr_b16 a[20:21], v229 offset:49152
  v_mul_f32 v179, s39, v179
  v_mfma_f32_16x16x32_bf16 v[48:51], a[24:27], v[196:199], v[48:51]
  ds_read_b64_tr_b16 a[22:23], v229 offset:57344
  v_mul_f32 v184, s39, v184
  v_mfma_f32_16x16x32_bf16 v[52:55], a[24:27], v[200:203], v[52:55]
  ds_read_b64_tr_b16 a[24:25], v230 offset:49152
  v_exp_f32 v178, v178
  v_mfma_f32_16x16x32_bf16 v[56:59], a[28:31], v[196:199], v[56:59]
  ds_read_b64_tr_b16 a[26:27], v230 offset:57344
  v_mul_f32 v185, s39, v185
  v_mfma_f32_16x16x32_bf16 v[60:63], a[28:31], v[200:203], v[60:63]
  ds_read_b64_tr_b16 a[28:29], v231 offset:49152
  v_mfma_f32_16x16x32_bf16 v[72:75], a[36:39], v[196:199], v[72:75]
  ds_read_b64_tr_b16 a[30:31], v231 offset:57344
  v_mul_f32 v186, s39, v186
  v_mfma_f32_16x16x32_bf16 v[76:79], a[36:39], v[200:203], v[76:79]
  ds_read_b128 a[232:235], v241 offset:2048
  v_mul_f32 v187, s39, v187
  v_mfma_f32_16x16x32_bf16 v[80:83], a[40:43], v[196:199], v[80:83]
  ds_read_b64_tr_b16 a[36:37], v225 offset:49408
  v_exp_f32 v179, v179
  v_mfma_f32_16x16x32_bf16 v[84:87], a[40:43], v[200:203], v[84:87]
  ds_read_b64_tr_b16 a[38:39], v225 offset:57600
  v_mul_f32 v180, s39, v180
  v_mfma_f32_16x16x32_bf16 v[88:91], a[44:47], v[196:199], v[88:91]
  ds_read_b64_tr_b16 a[40:41], v226 offset:49408
  v_mul_f32 v181, s39, v181
  v_mfma_f32_16x16x32_bf16 v[92:95], a[44:47], v[200:203], v[92:95]
  ds_read_b64_tr_b16 a[42:43], v226 offset:57600
  v_mul_f32 v182, s39, v182
  v_mfma_f32_16x16x32_bf16 v[104:107], a[52:55], v[196:199], v[104:107]
  ds_read_b64_tr_b16 a[44:45], v227 offset:49408
  v_exp_f32 v184, v184
  v_mfma_f32_16x16x32_bf16 v[108:111], a[52:55], v[200:203], v[108:111]
  ds_read_b64_tr_b16 a[46:47], v227 offset:57600
  v_mul_f32 v183, s39, v183
  v_mfma_f32_16x16x32_bf16 v[112:115], a[56:59], v[196:199], v[112:115]
  ds_read_b64_tr_b16 a[52:53], v229 offset:49408
  v_mfma_f32_16x16x32_bf16 v[116:119], a[56:59], v[200:203], v[116:119]
  ds_read_b64_tr_b16 a[54:55], v229 offset:57600
  v_mul_f32 v188, s39, v188
  v_mfma_f32_16x16x32_bf16 v[120:123], a[60:63], v[196:199], v[120:123]
  ds_read_b64_tr_b16 a[56:57], v230 offset:49408
  v_mul_f32 v189, s39, v189
  v_mfma_f32_16x16x32_bf16 v[124:127], a[60:63], v[200:203], v[124:127]
  ds_read_b64_tr_b16 a[58:59], v230 offset:57600
  v_exp_f32 v185, v185
  v_mfma_f32_16x16x32_bf16 v[0:3], a[0:3], v[196:199], v[0:3]
  ds_read_b64_tr_b16 a[60:61], v231 offset:49408
  v_mul_f32 v190, s39, v190
  v_mfma_f32_16x16x32_bf16 v[4:7], a[0:3], v[200:203], v[4:7]
  ds_read_b64_tr_b16 a[62:63], v231 offset:57600
  v_mul_f32 v191, s39, v191
  v_mfma_f32_16x16x32_bf16 v[128:131], a[0:3], a[224:227], v[128:131]
  ds_read_b64_tr_b16 a[0:1], v224 offset:49152
  v_cvt_pk_bf16_f32 v204, v176, v177
  v_exp_f32 v186, v186
  v_mfma_f32_16x16x32_bf16 v[32:35], a[16:19], v[196:199], v[32:35]
  ds_read_b64_tr_b16 a[2:3], v224 offset:57344
  v_cvt_pk_bf16_f32 v205, v178, v179
  v_mfma_f32_16x16x32_bf16 v[36:39], a[16:19], v[200:203], v[36:39]
  v_mfma_f32_16x16x32_bf16 v[136:139], a[16:19], a[224:227], v[136:139]
  ds_read_b64_tr_b16 a[16:17], v228 offset:49152
  v_cvt_pk_bf16_f32 v206, v184, v185
  v_add_f32 v214, v214, v176
  v_mfma_f32_16x16x32_bf16 v[64:67], a[32:35], v[196:199], v[64:67]
  ds_read_b64_tr_b16 a[18:19], v228 offset:57344
  v_exp_f32 v187, v187
  v_mfma_f32_16x16x32_bf16 v[68:71], a[32:35], v[200:203], v[68:71]
  v_cvt_pk_bf16_f32 v207, v186, v187
  v_mfma_f32_16x16x32_bf16 v[144:147], a[32:35], a[224:227], v[144:147]
  ds_read_b64_tr_b16 a[32:33], v224 offset:49408
  v_add_f32 v214, v214, v177
  v_add_f32 v214, v214, v178
  v_mfma_f32_16x16x32_bf16 v[96:99], a[48:51], v[196:199], v[96:99]
  ds_read_b64_tr_b16 a[34:35], v224 offset:57600
  v_exp_f32 v180, v180
  v_mfma_f32_16x16x32_bf16 v[100:103], a[48:51], v[200:203], v[100:103]
  v_add_f32 v214, v214, v179
  v_mfma_f32_16x16x32_bf16 v[152:155], a[48:51], a[224:227], v[152:155]
  ds_read_b64_tr_b16 a[48:49], v228 offset:49408
  s_waitcnt lgkmcnt(15)
  v_mfma_f32_16x16x32_bf16 v[8:11], a[4:7], v[204:207], v[8:11]
  ds_read_b64_tr_b16 a[50:51], v228 offset:57600
  v_mfma_f32_16x16x32_bf16 v[16:19], a[8:11], v[204:207], v[16:19]
  v_exp_f32 v181, v181
  v_mfma_f32_16x16x32_bf16 v[24:27], a[12:15], v[204:207], v[24:27]
  v_cvt_pk_bf16_f32 v208, v180, v181
  v_mfma_f32_16x16x32_bf16 v[40:43], a[20:23], v[204:207], v[40:43]
  v_exp_f32 v182, v182
  v_mfma_f32_16x16x32_bf16 v[48:51], a[24:27], v[204:207], v[48:51]
  v_exp_f32 v183, v183
  v_mfma_f32_16x16x32_bf16 v[56:59], a[28:31], v[204:207], v[56:59]
  v_cvt_pk_bf16_f32 v209, v182, v183
  v_mfma_f32_16x16x32_bf16 v[72:75], a[36:39], v[204:207], v[72:75]
  v_exp_f32 v188, v188
  v_mfma_f32_16x16x32_bf16 v[80:83], a[40:43], v[204:207], v[80:83]
  v_exp_f32 v189, v189
  s_waitcnt lgkmcnt(14)
  v_mfma_f32_16x16x32_bf16 v[88:91], a[44:47], v[204:207], v[88:91]
  v_cvt_pk_bf16_f32 v210, v188, v189
  s_waitcnt lgkmcnt(12)
  v_mfma_f32_16x16x32_bf16 v[104:107], a[52:55], v[204:207], v[104:107]
  v_exp_f32 v190, v190
  s_waitcnt lgkmcnt(10)
  v_mfma_f32_16x16x32_bf16 v[112:115], a[56:59], v[204:207], v[112:115]
  v_exp_f32 v191, v191
  s_waitcnt lgkmcnt(8)
  v_mfma_f32_16x16x32_bf16 v[120:123], a[60:63], v[204:207], v[120:123]
  v_cvt_pk_bf16_f32 v211, v190, v191
  v_add_f32 v214, v214, v184
  s_waitcnt lgkmcnt(6)
  v_mfma_f32_16x16x32_bf16 v[0:3], a[0:3], v[204:207], v[0:3]
  v_add_f32 v214, v214, v185
  v_add_f32 v214, v214, v186
  s_waitcnt lgkmcnt(4)
  v_mfma_f32_16x16x32_bf16 v[32:35], a[16:19], v[204:207], v[32:35]
  v_add_f32 v214, v214, v187
  v_add_f32 v215, v215, v180
  s_waitcnt lgkmcnt(2)
  v_mfma_f32_16x16x32_bf16 v[64:67], a[32:35], v[204:207], v[64:67]
  v_add_f32 v215, v215, v181
  v_add_f32 v215, v215, v182
  s_waitcnt lgkmcnt(0)
  v_mfma_f32_16x16x32_bf16 v[96:99], a[48:51], v[204:207], v[96:99]
  v_add_f32 v215, v215, v183
  v_add_f32 v215, v215, v188
  v_mfma_f32_16x16x32_bf16 v[12:15], a[4:7], v[208:211], v[12:15]
  v_add_f32 v215, v215, v189
  v_add_f32 v215, v215, v190
  v_mfma_f32_16x16x32_bf16 v[20:23], a[8:11], v[208:211], v[20:23]
  v_add_f32 v215, v215, v191
  v_mfma_f32_16x16x32_bf16 v[28:31], a[12:15], v[208:211], v[28:31]
  v_mbcnt_lo_u32_b32 v250, -1, 0
  v_mbcnt_hi_u32_b32 v250, -1, v250
  v_mov_b32 v247, v214
  v_mov_b32 v248, v215
  v_mov_b32 v249, v216
  v_permlane32_swap_b32 v214, v247
  v_permlane32_swap_b32 v215, v248
  v_mfma_f32_16x16x32_bf16 v[44:47], a[20:23], v[208:211], v[44:47]
  v_permlane32_swap_b32 v216, v249
  v_add_f32 v214, v214, v247
  v_add_f32 v215, v215, v248
  v_add_f32 v216, v216, v249
  v_mov_b32 v247, v214
  v_mov_b32 v248, v215
  v_mov_b32 v249, v216
  v_mfma_f32_16x16x32_bf16 v[52:55], a[24:27], v[208:211], v[52:55]
  v_permlane16_swap_b32 v214, v247
  v_permlane16_swap_b32 v215, v248
  v_permlane16_swap_b32 v216, v249
  v_add_f32 v214, v214, v247
  v_add_f32 v215, v215, v248
  v_add_f32 v216, v216, v249
  v_and_b32 v253, 15, v250
  v_mfma_f32_16x16x32_bf16 v[60:63], a[28:31], v[208:211], v[60:63]
  v_lshrrev_b32 v254, 4, v250
  s_lshr_b32 s48, s16, 1
  s_lshl_b32 s48, s48, 7
  s_and_b32 s49, s16, 1
  s_lshl_b32 s49, s49, 6
  s_add_u32 s48, s48, s49
  s_add_u32 s48, s48, 135168
  v_mfma_f32_16x16x32_bf16 v[76:79], a[36:39], v[208:211], v[76:79]
  v_lshlrev_b32 v242, 2, v253
  v_max3_f32 v244, v214, v215, v216
  v_add_u32 v243, s48, v242
  v_cmp_lt_f32 vcc, s42, v244
  ds_write_b32 v243, v216
  v_rcp_f32 v214, v214
  v_rcp_f32 v215, v215
  v_mfma_f32_16x16x32_bf16 v[84:87], a[40:43], v[208:211], v[84:87]
  s_lshl_b32 s51, s16, 2
  s_add_u32 s51, s51, 135424
  v_mov_b32 v244, s51
  s_cmp_lg_u64 vcc, 0
  s_cselect_b32 s50, 1, 0
  v_mov_b32 v243, s50
  ds_write_b32 v244, v243
  v_mfma_f32_16x16x32_bf16 v[92:95], a[44:47], v[208:211], v[92:95]
  v_and_b32 v246, 1, v254
  v_lshlrev_b32 v246, 1, v246
  v_lshrrev_b32 v247, 1, v254
  v_xor_b32 v248, v246, v247
  s_lshl_b32 s48, s16, 1
  v_xor_b32 v248, s48, v248
  v_xor_b32 v248, v248, v253
  v_mfma_f32_16x16x32_bf16 v[108:111], a[52:55], v[208:211], v[108:111]
  v_lshlrev_b32 v249, 9, v253
  s_lshl_b32 s49, s16, 14
  v_add_u32 v245, s49, v249
  s_waitcnt vmcnt(0) lgkmcnt(0)
  s_barrier
  v_add_u32 v242, 135168, v242
  ds_read_b32 v217, v242
  v_mfma_f32_16x16x32_bf16 v[116:119], a[56:59], v[208:211], v[116:119]
  ds_read_b32 v218, v242 offset:64
  ds_read_b32 v219, v242 offset:128
  ds_read_b32 v212, v242 offset:192
  v_mov_b32 v243, 135424
  ds_read_b128 v[196:199], v243
  v_xor_b32 v244, 0, v248
  v_lshl_add_u32 v160, v244, 4, v245
  v_mfma_f32_16x16x32_bf16 v[124:127], a[60:63], v[208:211], v[124:127]
  v_xor_b32 v244, 4, v248
  v_lshl_add_u32 v161, v244, 4, v245
  v_xor_b32 v244, 8, v248
  v_lshl_add_u32 v162, v244, 4, v245
  v_xor_b32 v244, 12, v248
  v_lshl_add_u32 v163, v244, 4, v245
  v_lshlrev_b32 v246, 2, v246
  v_mfma_f32_16x16x32_bf16 v[4:7], a[0:3], v[208:211], v[4:7]
  v_add_u32 v246, v246, v247
  v_add_u32 v246, s48, v246
  v_xor_b32 v246, v246, v253
  v_lshl_add_u32 v164, v246, 4, v249
  v_add_u32 v164, 65536, v164
  v_and_b32 v251, 31, v250
  v_lshrrev_b32 v252, 5, v250
  v_mfma_f32_16x16x32_bf16 v[128:131], a[0:3], a[232:235], v[128:131]
  v_lshlrev_b32 v245, 9, v252
  v_add_u32 v245, s49, v245
  v_add_u32 v244, 0, v252
  v_xor_b32 v244, v244, v251
  v_lshl_add_u32 v176, v244, 4, v245
  v_add_u32 v244, 2, v252
  v_xor_b32 v244, v244, v251
  v_mfma_f32_16x16x32_bf16 v[36:39], a[16:19], v[208:211], v[36:39]
  v_lshl_add_u32 v177, v244, 4, v245
  v_add_u32 v244, 4, v252
  v_xor_b32 v244, v244, v251
  v_lshl_add_u32 v178, v244, 4, v245
  v_add_u32 v244, 6, v252
  v_xor_b32 v244, v244, v251
  v_lshl_add_u32 v179, v244, 4, v245
  v_mfma_f32_16x16x32_bf16 v[136:139], a[16:19], a[232:235], v[136:139]
  v_add_u32 v244, 8, v252
  v_xor_b32 v244, v244, v251
  v_lshl_add_u32 v180, v244, 4, v245
  v_add_u32 v244, 10, v252
  v_xor_b32 v244, v244, v251
  v_lshl_add_u32 v181, v244, 4, v245
  v_add_u32 v244, 12, v252
  v_mfma_f32_16x16x32_bf16 v[68:71], a[32:35], v[208:211], v[68:71]
  v_xor_b32 v244, v244, v251
  v_lshl_add_u32 v182, v244, 4, v245
  v_add_u32 v244, 14, v252
  v_xor_b32 v244, v244, v251
  v_lshl_add_u32 v183, v244, 4, v245
  v_lshlrev_b32 v249, 4, v250
  v_add_u32 v248, s49, v249
  v_mfma_f32_16x16x32_bf16 v[144:147], a[32:35], a[232:235], v[144:147]
  s_waitcnt lgkmcnt(0)
  v_or_b32 v196, v196, v197
  v_add_f32 v200, v217, v218
  v_or3_b32 v196, v196, v198, v199
  v_add_f32 v201, v219, v212
  v_readfirstlane_b32 s54, v196
  v_rcp_f32 v200, v200
  v_mfma_f32_16x16x32_bf16 v[100:103], a[48:51], v[208:211], v[100:103]
  v_rcp_f32 v201, v201
  v_mfma_f32_16x16x32_bf16 v[152:155], a[48:51], a[232:235], v[152:155]
  s_branch L_epi
L_var_k0q0p0:
  ds_read_b128 a[64:67], v220 offset:16384
  ds_read_b128 a[68:71], v221 offset:16384
  ds_read_b128 a[72:75], v222 offset:16384
  ds_read_b128 a[76:79], v223 offset:16384
  ds_read_b128 a[80:83], v220 offset:16640
  ds_read_b128 a[84:87], v221 offset:16640
  ds_read_b128 a[88:91], v222 offset:16640
  ds_read_b128 a[92:95], v223 offset:16640
  ds_read_b64_tr_b16 a[4:5], v225 offset:0
  ds_read_b128 a[96:99], v220 offset:24576
  ds_read_b128 a[100:103], v221 offset:24576
  ds_read_b128 a[104:107], v222 offset:24576
  ds_read_b64_tr_b16 a[6:7], v225 offset:8192
  ds_read_b128 a[108:111], v223 offset:24576
  ds_read_b128 a[112:115], v220 offset:24832
  ds_read_b128 a[116:119], v221 offset:24832
  ds_read_b128 a[120:123], v222 offset:24832
  ds_read_b64_tr_b16 a[8:9], v226 offset:0
  ds_read_b128 a[124:127], v223 offset:24832
  ds_read_b64_tr_b16 a[10:11], v226 offset:8192
  ds_read_b64_tr_b16 a[12:13], v227 offset:0
  ds_read_b64_tr_b16 a[14:15], v227 offset:8192
  ds_read_b64_tr_b16 a[20:21], v229 offset:0
  ds_read_b64_tr_b16 a[22:23], v229 offset:8192
  ds_read_b64_tr_b16 a[24:25], v230 offset:0
  v_sub_f32 v242, 0, v217
  v_sub_f32 v243, 0, v217
  v_sub_f32 v244, 0, v217
  v_sub_f32 v245, 0, v217
  v_sub_f32 v246, 0, v218
  v_sub_f32 v247, 0, v218
  v_sub_f32 v248, 0, v218
  v_sub_f32 v249, 0, v218
  v_sub_f32 v250, 0, v219
  v_sub_f32 v251, 0, v219
  v_sub_f32 v252, 0, v219
  v_sub_f32 v253, 0, v219
  v_mul_f32 v217, s39, v217
  v_mul_f32 v218, s39, v218
  v_mul_f32 v219, s39, v219
  v_fma_f32 v160, v160, s39, -v217
  v_fma_f32 v161, v161, s39, -v217
  v_fma_f32 v162, v162, s39, -v217
  v_fma_f32 v163, v163, s39, -v217
  v_fma_f32 v168, v168, s39, -v217
  v_fma_f32 v169, v169, s39, -v217
  v_fma_f32 v170, v170, s39, -v217
  v_fma_f32 v171, v171, s39, -v217
  v_fma_f32 v164, v164, s39, -v218
  v_fma_f32 v165, v165, s39, -v218
  v_fma_f32 v166, v166, s39, -v218
  v_fma_f32 v167, v167, s39, -v218
  v_fma_f32 v172, v172, s39, -v218
  v_fma_f32 v173, v173, s39, -v218
  v_fma_f32 v174, v174, s39, -v218
  v_fma_f32 v175, v175, s39, -v218
  v_exp_f32 v160, v160
  v_exp_f32 v161, v161
  v_exp_f32 v162, v162
  v_exp_f32 v163, v163
  v_exp_f32 v168, v168
  v_exp_f32 v169, v169
  v_exp_f32 v170, v170
  v_exp_f32 v171, v171
  v_exp_f32 v164, v164
  v_cvt_pk_bf16_f32 v196, v160, v161
  v_cvt_pk_bf16_f32 v197, v162, v163
  v_cvt_pk_bf16_f32 v198, v168, v169
  v_add_f32 v214, v214, v160
  v_cvt_pk_bf16_f32 v199, v170, v171
  v_add_f32 v214, v214, v161
  v_add_f32 v214, v214, v162
  s_waitcnt lgkmcnt(0)
  ds_read_b64_tr_b16 a[26:27], v230 offset:8192
  ds_read_b64_tr_b16 a[28:29], v231 offset:0
  ds_read_b64_tr_b16 a[30:31], v231 offset:8192
  ds_read_b64_tr_b16 a[36:37], v225 offset:256
  ds_read_b64_tr_b16 a[38:39], v225 offset:8448
  v_add_f32 v214, v214, v163
  v_exp_f32 v165, v165
  s_nop 0
  v_cvt_pk_bf16_f32 v200, v164, v165
  v_add_f32 v214, v214, v168
  v_add_f32 v214, v214, v169
  v_exp_f32 v166, v166
  v_add_f32 v214, v214, v170
  v_mfma_f32_16x16x32_bf16 v[176:179], a[64:67], a[128:131], v[242:245]
  s_add_u32 s36, s36, 16384
  ds_read_b64_tr_b16 a[40:41], v226 offset:256
  v_add_f32 v214, v214, v171
  v_mfma_f32_16x16x32_bf16 v[180:183], a[64:67], a[160:163], v[246:249]
  s_add_u32 m0, s38, 49152
  ds_read_b64_tr_b16 a[42:43], v226 offset:8448
  v_add_f32 v215, v215, v164
  v_mfma_f32_16x16x32_bf16 v[176:179], a[68:71], a[132:135], v[176:179]
  v_exp_f32 v167, v167
  v_mfma_f32_16x16x32_bf16 v[180:183], a[68:71], a[164:167], v[180:183]
  buffer_load_dwordx4 v232, s[20:23], s36 offen offset:0 nt lds
  ds_read_b64_tr_b16 a[44:45], v227 offset:256
  v_mfma_f32_16x16x32_bf16 v[176:179], a[72:75], a[136:139], v[176:179]
  ds_read_b64_tr_b16 a[46:47], v227 offset:8448
  v_mfma_f32_16x16x32_bf16 v[180:183], a[72:75], a[168:171], v[180:183]
  buffer_load_dwordx4 v233, s[20:23], s36 offen offset:1024 nt lds
  v_mfma_f32_16x16x32_bf16 v[176:179], a[76:79], a[140:143], v[176:179]
  ds_read_b64_tr_b16 a[52:53], v229 offset:256
  v_mfma_f32_16x16x32_bf16 v[180:183], a[76:79], a[172:175], v[180:183]
  buffer_load_dwordx4 v234, s[20:23], s36 offen offset:2048 nt lds
  v_mfma_f32_16x16x32_bf16 v[176:179], a[80:83], a[144:147], v[176:179]
  ds_read_b64_tr_b16 a[54:55], v229 offset:8448
  v_mfma_f32_16x16x32_bf16 v[180:183], a[80:83], a[176:179], v[180:183]
  buffer_load_dwordx4 v235, s[20:23], s36 offen offset:3072 nt lds
  v_mfma_f32_16x16x32_bf16 v[176:179], a[84:87], a[148:151], v[176:179]
  v_mfma_f32_16x16x32_bf16 v[180:183], a[84:87], a[180:183], v[180:183]
  s_add_u32 m0, s38, 98304
  ds_read_b64_tr_b16 a[56:57], v230 offset:256
  v_mfma_f32_16x16x32_bf16 v[176:179], a[88:91], a[152:155], v[176:179]
  v_mfma_f32_16x16x32_bf16 v[180:183], a[88:91], a[184:187], v[180:183]
  buffer_load_dwordx4 v236, s[24:27], s36 offen offset:0 nt lds
  ds_read_b64_tr_b16 a[58:59], v230 offset:8448
  v_mfma_f32_16x16x32_bf16 v[176:179], a[92:95], a[156:159], v[176:179]
  ds_read_b64_tr_b16 a[60:61], v231 offset:256
  v_cvt_pk_bf16_f32 v201, v166, v167
  v_mfma_f32_16x16x32_bf16 v[180:183], a[92:95], a[188:191], v[180:183]
  buffer_load_dwordx4 v237, s[24:27], s36 offen offset:1024 nt lds
  v_add_f32 v215, v215, v165
  v_mfma_f32_16x16x32_bf16 v[184:187], a[96:99], a[128:131], v[242:245]
  v_exp_f32 v172, v172
  v_mfma_f32_16x16x32_bf16 v[188:191], a[96:99], a[160:163], v[246:249]
  buffer_load_dwordx4 v238, s[24:27], s36 offen offset:2048 nt lds
  ds_read_b64_tr_b16 a[62:63], v231 offset:8448
  v_add_f32 v215, v215, v166
  v_mfma_f32_16x16x32_bf16 v[184:187], a[100:103], a[132:135], v[184:187]
  ds_read_b64_tr_b16 a[0:1], v224 offset:0
  v_add_f32 v215, v215, v167
  v_mfma_f32_16x16x32_bf16 v[188:191], a[100:103], a[164:167], v[188:191]
  buffer_load_dwordx4 v239, s[24:27], s36 offen offset:3072 nt lds
  ds_read_b64_tr_b16 a[2:3], v224 offset:8192
  v_add_f32 v215, v215, v172
  v_mfma_f32_16x16x32_bf16 v[184:187], a[104:107], a[136:139], v[184:187]
  v_exp_f32 v173, v173
  v_mfma_f32_16x16x32_bf16 v[188:191], a[104:107], a[168:171], v[188:191]
  s_add_u32 s36, s36, 16384
  ds_read_b64_tr_b16 a[16:17], v228 offset:0
  v_cvt_pk_bf16_f32 v202, v172, v173
  v_mfma_f32_16x16x32_bf16 v[184:187], a[108:111], a[140:143], v[184:187]
  ds_read_b64_tr_b16 a[18:19], v228 offset:8192
  v_add_f32 v215, v215, v173
  v_mfma_f32_16x16x32_bf16 v[188:191], a[108:111], a[172:175], v[188:191]
  s_add_u32 m0, s38, 0
  ds_read_b64_tr_b16 a[32:33], v224 offset:256
  v_mfma_f32_16x16x32_bf16 v[184:187], a[112:115], a[144:147], v[184:187]
  ds_read_b64_tr_b16 a[34:35], v224 offset:8448
  v_mfma_f32_16x16x32_bf16 v[188:191], a[112:115], a[176:179], v[188:191]
  buffer_load_dwordx4 v232, s[20:23], s36 offen offset:0 nt lds
  ds_read_b64_tr_b16 a[48:49], v228 offset:256
  v_mfma_f32_16x16x32_bf16 v[184:187], a[116:119], a[148:151], v[184:187]
  ds_read_b64_tr_b16 a[50:51], v228 offset:8448
  v_mfma_f32_16x16x32_bf16 v[188:191], a[116:119], a[180:183], v[188:191]
  buffer_load_dwordx4 v233, s[20:23], s36 offen offset:1024 nt lds
  v_exp_f32 v174, v174
  v_mfma_f32_16x16x32_bf16 v[184:187], a[120:123], a[152:155], v[184:187]
  v_mfma_f32_16x16x32_bf16 v[188:191], a[120:123], a[184:187], v[188:191]
  buffer_load_dwordx4 v234, s[20:23], s36 offen offset:2048 nt lds
  v_exp_f32 v175, v175
  v_mfma_f32_16x16x32_bf16 v[184:187], a[124:127], a[156:159], v[184:187]
  v_cvt_pk_bf16_f32 v203, v174, v175
  v_mfma_f32_16x16x32_bf16 v[188:191], a[124:127], a[188:191], v[188:191]
  buffer_load_dwordx4 v235, s[20:23], s36 offen offset:3072 nt lds
  v_add_f32 v215, v215, v174
  v_add_f32 v215, v215, v175
  s_waitcnt vmcnt(12) lgkmcnt(0)
  s_barrier
  ds_read_b128 a[224:227], v241 offset:0
  v_mfma_f32_16x16x32_bf16 v[8:11], a[4:7], v[196:199], v[8:11]
  ds_read_b128 a[64:67], v220 offset:32768
  v_mul_f32 v176, s39, v176
  v_mfma_f32_16x16x32_bf16 v[12:15], a[4:7], v[200:203], v[12:15]
  s_add_u32 m0, s38, 114688
  v_exp_f32 v176, v176
  v_mfma_f32_16x16x32_bf16 v[16:19], a[8:11], v[196:199], v[16:19]
  ds_read_b128 a[68:71], v221 offset:32768
  v_mul_f32 v177, s39, v177
  v_mfma_f32_16x16x32_bf16 v[20:23], a[8:11], v[200:203], v[20:23]
  ds_read_b128 a[72:75], v222 offset:32768
  v_mfma_f32_16x16x32_bf16 v[24:27], a[12:15], v[196:199], v[24:27]
  buffer_load_dwordx4 v236, s[24:27], s36 offen offset:0 nt lds
  ds_read_b128 a[76:79], v223 offset:32768
  v_mfma_f32_16x16x32_bf16 v[28:31], a[12:15], v[200:203], v[28:31]
  v_exp_f32 v177, v177
  v_mfma_f32_16x16x32_bf16 v[40:43], a[20:23], v[196:199], v[40:43]
  ds_read_b128 a[80:83], v220 offset:33024
  v_mul_f32 v178, s39, v178
  v_mfma_f32_16x16x32_bf16 v[44:47], a[20:23], v[200:203], v[44:47]
  buffer_load_dwordx4 v237, s[24:27], s36 offen offset:1024 nt lds
  v_mfma_f32_16x16x32_bf16 v[48:51], a[24:27], v[196:199], v[48:51]
  ds_read_b128 a[84:87], v221 offset:33024
  v_mul_f32 v179, s39, v179
  v_mfma_f32_16x16x32_bf16 v[52:55], a[24:27], v[200:203], v[52:55]
  v_exp_f32 v178, v178
  v_mfma_f32_16x16x32_bf16 v[56:59], a[28:31], v[196:199], v[56:59]
  buffer_load_dwordx4 v238, s[24:27], s36 offen offset:2048 nt lds
  ds_read_b128 a[88:91], v222 offset:33024
  v_mul_f32 v184, s39, v184
  v_mfma_f32_16x16x32_bf16 v[60:63], a[28:31], v[200:203], v[60:63]
  ds_read_b128 a[92:95], v223 offset:33024
  v_mul_f32 v185, s39, v185
  v_mfma_f32_16x16x32_bf16 v[72:75], a[36:39], v[196:199], v[72:75]
  ds_read_b64_tr_b16 a[4:5], v225 offset:16384
  v_mul_f32 v186, s39, v186
  v_mfma_f32_16x16x32_bf16 v[76:79], a[36:39], v[200:203], v[76:79]
  buffer_load_dwordx4 v239, s[24:27], s36 offen offset:3072 nt lds
  ds_read_b128 a[232:235], v241 offset:2048
  v_mul_f32 v187, s39, v187
  v_mfma_f32_16x16x32_bf16 v[80:83], a[40:43], v[196:199], v[80:83]
  v_exp_f32 v179, v179
  v_mfma_f32_16x16x32_bf16 v[84:87], a[40:43], v[200:203], v[84:87]
  ds_read_b128 a[96:99], v220 offset:40960
  v_mul_f32 v180, s39, v180
  v_mfma_f32_16x16x32_bf16 v[88:91], a[44:47], v[196:199], v[88:91]
  s_add_u32 s36, s36, 16384
  v_mfma_f32_16x16x32_bf16 v[92:95], a[44:47], v[200:203], v[92:95]
  ds_read_b128 a[100:103], v221 offset:40960
  v_mul_f32 v181, s39, v181
  v_mfma_f32_16x16x32_bf16 v[104:107], a[52:55], v[196:199], v[104:107]
  v_exp_f32 v184, v184
  v_mfma_f32_16x16x32_bf16 v[108:111], a[52:55], v[200:203], v[108:111]
  s_add_u32 m0, s38, 16384
  ds_read_b128 a[104:107], v222 offset:40960
  v_mul_f32 v182, s39, v182
  v_mfma_f32_16x16x32_bf16 v[112:115], a[56:59], v[196:199], v[112:115]
  ds_read_b64_tr_b16 a[6:7], v225 offset:24576
  v_mul_f32 v183, s39, v183
  v_mfma_f32_16x16x32_bf16 v[116:119], a[56:59], v[200:203], v[116:119]
  ds_read_b128 a[108:111], v223 offset:40960
  v_mul_f32 v188, s39, v188
  v_mfma_f32_16x16x32_bf16 v[120:123], a[60:63], v[196:199], v[120:123]
  buffer_load_dwordx4 v232, s[20:23], s36 offen offset:0 nt lds
  v_mul_f32 v189, s39, v189
  v_mfma_f32_16x16x32_bf16 v[124:127], a[60:63], v[200:203], v[124:127]
  v_exp_f32 v185, v185
  v_mfma_f32_16x16x32_bf16 v[0:3], a[0:3], v[196:199], v[0:3]
  ds_read_b128 a[112:115], v220 offset:41216
  v_mul_f32 v190, s39, v190
  v_mfma_f32_16x16x32_bf16 v[4:7], a[0:3], v[200:203], v[4:7]
  buffer_load_dwordx4 v233, s[20:23], s36 offen offset:1024 nt lds
  s_waitcnt lgkmcnt(15)
  v_mfma_f32_16x16x32_bf16 v[128:131], a[0:3], a[224:227], v[128:131]
  ds_read_b128 a[116:119], v221 offset:41216
  v_mul_f32 v191, s39, v191
  v_exp_f32 v186, v186
  v_mfma_f32_16x16x32_bf16 v[32:35], a[16:19], v[196:199], v[32:35]
  ds_read_b128 a[120:123], v222 offset:41216
  v_cvt_pk_bf16_f32 v204, v176, v177
  v_mfma_f32_16x16x32_bf16 v[36:39], a[16:19], v[200:203], v[36:39]
  buffer_load_dwordx4 v234, s[20:23], s36 offen offset:2048 nt lds
  ds_read_b64_tr_b16 a[8:9], v226 offset:16384
  v_cvt_pk_bf16_f32 v205, v178, v179
  v_mfma_f32_16x16x32_bf16 v[136:139], a[16:19], a[224:227], v[136:139]
  ds_read_b128 a[124:127], v223 offset:41216
  ds_read_b64_tr_b16 a[10:11], v226 offset:24576
  v_cvt_pk_bf16_f32 v206, v184, v185
  v_add_f32 v214, v214, v176
  v_mfma_f32_16x16x32_bf16 v[64:67], a[32:35], v[196:199], v[64:67]
  v_exp_f32 v187, v187
  v_mfma_f32_16x16x32_bf16 v[68:71], a[32:35], v[200:203], v[68:71]
  buffer_load_dwordx4 v235, s[20:23], s36 offen offset:3072 nt lds
  ds_read_b64_tr_b16 a[12:13], v227 offset:16384
  v_cvt_pk_bf16_f32 v207, v186, v187
  v_mfma_f32_16x16x32_bf16 v[144:147], a[32:35], a[224:227], v[144:147]
  ds_read_b64_tr_b16 a[14:15], v227 offset:24576
  v_mfma_f32_16x16x32_bf16 v[96:99], a[48:51], v[196:199], v[96:99]
  v_exp_f32 v180, v180
  v_mfma_f32_16x16x32_bf16 v[100:103], a[48:51], v[200:203], v[100:103]
  ds_read_b64_tr_b16 a[20:21], v229 offset:16384
  v_add_f32 v214, v214, v177
  v_mfma_f32_16x16x32_bf16 v[152:155], a[48:51], a[224:227], v[152:155]
  s_add_u32 m0, s38, 65536
  ds_read_b64_tr_b16 a[22:23], v229 offset:24576
  ds_read_b64_tr_b16 a[24:25], v230 offset:16384
  v_add_f32 v214, v214, v178
  s_waitcnt lgkmcnt(6)
  s_mov_b32 s40, 0
.p2align 6
L_loop_k0q0p0:
  ds_read_b64_tr_b16 a[26:27], v230 offset:24576
  ds_read_b64_tr_b16 a[28:29], v231 offset:16384
  ds_read_b64_tr_b16 a[30:31], v231 offset:24576
  buffer_load_dwordx4 v236, s[24:27], s36 offen offset:0 nt lds
  ds_read_b64_tr_b16 a[36:37], v225 offset:16640
  ds_read_b64_tr_b16 a[38:39], v225 offset:24832
  v_add_f32 v214, v214, v179
  v_exp_f32 v181, v181
  s_nop 0
  v_cvt_pk_bf16_f32 v208, v180, v181
  v_add_f32 v214, v214, v184
  v_add_f32 v214, v214, v185
  v_exp_f32 v182, v182
  v_add_f32 v214, v214, v186
  v_mfma_f32_16x16x32_bf16 v[160:163], a[64:67], a[128:131], v[242:245]
  ds_read_b64_tr_b16 a[40:41], v226 offset:16640
  v_add_f32 v214, v214, v187
  v_mfma_f32_16x16x32_bf16 v[164:167], a[64:67], a[160:163], v[246:249]
  ds_read_b64_tr_b16 a[42:43], v226 offset:24832
  v_add_f32 v215, v215, v180
  v_mfma_f32_16x16x32_bf16 v[160:163], a[68:71], a[132:135], v[160:163]
  v_exp_f32 v183, v183
  v_mfma_f32_16x16x32_bf16 v[164:167], a[68:71], a[164:167], v[164:167]
  ds_read_b64_tr_b16 a[44:45], v227 offset:16640
  v_mfma_f32_16x16x32_bf16 v[160:163], a[72:75], a[136:139], v[160:163]
  ds_read_b64_tr_b16 a[46:47], v227 offset:24832
  v_mfma_f32_16x16x32_bf16 v[164:167], a[72:75], a[168:171], v[164:167]
  v_mfma_f32_16x16x32_bf16 v[160:163], a[76:79], a[140:143], v[160:163]
  ds_read_b64_tr_b16 a[52:53], v229 offset:16640
  v_mfma_f32_16x16x32_bf16 v[164:167], a[76:79], a[172:175], v[164:167]
  v_mfma_f32_16x16x32_bf16 v[160:163], a[80:83], a[144:147], v[160:163]
  ds_read_b64_tr_b16 a[54:55], v229 offset:24832
  v_mfma_f32_16x16x32_bf16 v[164:167], a[80:83], a[176:179], v[164:167]
  buffer_load_dwordx4 v237, s[24:27], s36 offen offset:1024 nt lds
  v_mfma_f32_16x16x32_bf16 v[160:163], a[84:87], a[148:151], v[160:163]
  v_mfma_f32_16x16x32_bf16 v[164:167], a[84:87], a[180:183], v[164:167]
  ds_read_b64_tr_b16 a[56:57], v230 offset:16640
  v_mfma_f32_16x16x32_bf16 v[160:163], a[88:91], a[152:155], v[160:163]
  v_mfma_f32_16x16x32_bf16 v[164:167], a[88:91], a[184:187], v[164:167]
  ds_read_b64_tr_b16 a[58:59], v230 offset:24832
  v_mfma_f32_16x16x32_bf16 v[160:163], a[92:95], a[156:159], v[160:163]
  ds_read_b64_tr_b16 a[60:61], v231 offset:16640
  v_cvt_pk_bf16_f32 v209, v182, v183
  v_mfma_f32_16x16x32_bf16 v[164:167], a[92:95], a[188:191], v[164:167]
  v_add_f32 v215, v215, v181
  v_mfma_f32_16x16x32_bf16 v[168:171], a[96:99], a[128:131], v[242:245]
  v_exp_f32 v188, v188
  v_mfma_f32_16x16x32_bf16 v[172:175], a[96:99], a[160:163], v[246:249]
  ds_read_b64_tr_b16 a[62:63], v231 offset:24832
  v_add_f32 v215, v215, v182
  v_mfma_f32_16x16x32_bf16 v[168:171], a[100:103], a[132:135], v[168:171]
  ds_read_b64_tr_b16 a[0:1], v224 offset:16384
  v_add_f32 v215, v215, v183
  v_mfma_f32_16x16x32_bf16 v[172:175], a[100:103], a[164:167], v[172:175]
  ds_read_b64_tr_b16 a[2:3], v224 offset:24576
  v_add_f32 v215, v215, v188
  v_mfma_f32_16x16x32_bf16 v[168:171], a[104:107], a[136:139], v[168:171]
  v_exp_f32 v189, v189
  v_mfma_f32_16x16x32_bf16 v[172:175], a[104:107], a[168:171], v[172:175]
  ds_read_b64_tr_b16 a[16:17], v228 offset:16384
  v_cvt_pk_bf16_f32 v210, v188, v189
  v_mfma_f32_16x16x32_bf16 v[168:171], a[108:111], a[140:143], v[168:171]
  ds_read_b64_tr_b16 a[18:19], v228 offset:24576
  v_add_f32 v215, v215, v189
  v_mfma_f32_16x16x32_bf16 v[172:175], a[108:111], a[172:175], v[172:175]
  ds_read_b64_tr_b16 a[32:33], v224 offset:16640
  v_mfma_f32_16x16x32_bf16 v[168:171], a[112:115], a[144:147], v[168:171]
  ds_read_b64_tr_b16 a[34:35], v224 offset:24832
  v_mfma_f32_16x16x32_bf16 v[172:175], a[112:115], a[176:179], v[172:175]
  ds_read_b64_tr_b16 a[48:49], v228 offset:16640
  v_mfma_f32_16x16x32_bf16 v[168:171], a[116:119], a[148:151], v[168:171]
  ds_read_b64_tr_b16 a[50:51], v228 offset:24832
  v_mfma_f32_16x16x32_bf16 v[172:175], a[116:119], a[180:183], v[172:175]
  v_exp_f32 v190, v190
  v_mfma_f32_16x16x32_bf16 v[168:171], a[120:123], a[152:155], v[168:171]
  buffer_load_dwordx4 v238, s[24:27], s36 offen offset:2048 nt lds
  v_mfma_f32_16x16x32_bf16 v[172:175], a[120:123], a[184:187], v[172:175]
  v_exp_f32 v191, v191
  v_mfma_f32_16x16x32_bf16 v[168:171], a[124:127], a[156:159], v[168:171]
  buffer_load_dwordx4 v239, s[24:27], s36 offen offset:3072 nt lds
  v_cvt_pk_bf16_f32 v211, v190, v191
  v_mfma_f32_16x16x32_bf16 v[172:175], a[124:127], a[188:191], v[172:175]
  v_add_f32 v215, v215, v190
  v_add_f32 v215, v215, v191
  s_waitcnt vmcnt(16) lgkmcnt(0)
  s_barrier
  v_mfma_f32_16x16x32_bf16 v[8:11], a[4:7], v[204:207], v[8:11]
  ds_read_b128 a[64:67], v220 offset:49152
  v_mul_f32 v160, s39, v160
  v_mfma_f32_16x16x32_bf16 v[12:15], a[4:7], v[208:211], v[12:15]
  v_exp_f32 v160, v160
  v_mfma_f32_16x16x32_bf16 v[16:19], a[8:11], v[204:207], v[16:19]
  ds_read_b128 a[68:71], v221 offset:49152
  v_mul_f32 v161, s39, v161
  v_mfma_f32_16x16x32_bf16 v[20:23], a[8:11], v[208:211], v[20:23]
  ds_read_b128 a[72:75], v222 offset:49152
  s_add_u32 s36, s36, 16384
  v_mfma_f32_16x16x32_bf16 v[24:27], a[12:15], v[204:207], v[24:27]
  ds_read_b128 a[76:79], v223 offset:49152
  s_add_u32 m0, s38, 32768
  v_mfma_f32_16x16x32_bf16 v[28:31], a[12:15], v[208:211], v[28:31]
  v_exp_f32 v161, v161
  v_mfma_f32_16x16x32_bf16 v[40:43], a[20:23], v[204:207], v[40:43]
  ds_read_b128 a[80:83], v220 offset:49408
  v_mul_f32 v162, s39, v162
  v_mfma_f32_16x16x32_bf16 v[44:47], a[20:23], v[208:211], v[44:47]
  buffer_load_dwordx4 v232, s[20:23], s36 offen offset:0 nt lds
  v_mfma_f32_16x16x32_bf16 v[48:51], a[24:27], v[204:207], v[48:51]
  ds_read_b128 a[84:87], v221 offset:49408
  v_mul_f32 v163, s39, v163
  v_mfma_f32_16x16x32_bf16 v[52:55], a[24:27], v[208:211], v[52:55]
  v_exp_f32 v162, v162
  v_mfma_f32_16x16x32_bf16 v[56:59], a[28:31], v[204:207], v[56:59]
  ds_read_b128 a[88:91], v222 offset:49408
  v_mul_f32 v168, s39, v168
  v_mfma_f32_16x16x32_bf16 v[60:63], a[28:31], v[208:211], v[60:63]
  ds_read_b128 a[92:95], v223 offset:49408
  v_mul_f32 v169, s39, v169
  v_mfma_f32_16x16x32_bf16 v[72:75], a[36:39], v[204:207], v[72:75]
  ds_read_b64_tr_b16 a[4:5], v225 offset:32768
  v_mul_f32 v170, s39, v170
  v_mfma_f32_16x16x32_bf16 v[76:79], a[36:39], v[208:211], v[76:79]
  ds_read_b128 a[224:227], v241 offset:0
  v_mul_f32 v171, s39, v171
  v_mfma_f32_16x16x32_bf16 v[80:83], a[40:43], v[204:207], v[80:83]
  v_exp_f32 v163, v163
  v_mfma_f32_16x16x32_bf16 v[84:87], a[40:43], v[208:211], v[84:87]
  ds_read_b128 a[96:99], v220 offset:57344
  v_mul_f32 v164, s39, v164
  v_mfma_f32_16x16x32_bf16 v[88:91], a[44:47], v[204:207], v[88:91]
  buffer_load_dwordx4 v233, s[20:23], s36 offen offset:1024 nt lds
  v_mfma_f32_16x16x32_bf16 v[92:95], a[44:47], v[208:211], v[92:95]
  ds_read_b128 a[100:103], v221 offset:57344
  v_mul_f32 v165, s39, v165
  v_mfma_f32_16x16x32_bf16 v[104:107], a[52:55], v[204:207], v[104:107]
  v_exp_f32 v168, v168
  v_mfma_f32_16x16x32_bf16 v[108:111], a[52:55], v[208:211], v[108:111]
  ds_read_b128 a[104:107], v222 offset:57344
  v_mul_f32 v166, s39, v166
  v_mfma_f32_16x16x32_bf16 v[112:115], a[56:59], v[204:207], v[112:115]
  ds_read_b64_tr_b16 a[6:7], v225 offset:40960
  v_mul_f32 v167, s39, v167
  v_mfma_f32_16x16x32_bf16 v[116:119], a[56:59], v[208:211], v[116:119]
  ds_read_b128 a[108:111], v223 offset:57344
  v_mul_f32 v172, s39, v172
  v_mfma_f32_16x16x32_bf16 v[120:123], a[60:63], v[204:207], v[120:123]
  v_mul_f32 v173, s39, v173
  v_mfma_f32_16x16x32_bf16 v[124:127], a[60:63], v[208:211], v[124:127]
  v_exp_f32 v169, v169
  v_mfma_f32_16x16x32_bf16 v[0:3], a[0:3], v[204:207], v[0:3]
  ds_read_b128 a[112:115], v220 offset:57600
  v_mul_f32 v174, s39, v174
  v_mfma_f32_16x16x32_bf16 v[4:7], a[0:3], v[208:211], v[4:7]
  buffer_load_dwordx4 v234, s[20:23], s36 offen offset:2048 nt lds
  v_mfma_f32_16x16x32_bf16 v[128:131], a[0:3], a[232:235], v[128:131]
  ds_read_b128 a[116:119], v221 offset:57600
  v_mul_f32 v175, s39, v175
  v_exp_f32 v170, v170
  v_mfma_f32_16x16x32_bf16 v[32:35], a[16:19], v[204:207], v[32:35]
  ds_read_b128 a[120:123], v222 offset:57600
  v_cvt_pk_bf16_f32 v196, v160, v161
  v_mfma_f32_16x16x32_bf16 v[36:39], a[16:19], v[208:211], v[36:39]
  ds_read_b64_tr_b16 a[8:9], v226 offset:32768
  v_cvt_pk_bf16_f32 v197, v162, v163
  v_mfma_f32_16x16x32_bf16 v[136:139], a[16:19], a[232:235], v[136:139]
  ds_read_b128 a[124:127], v223 offset:57600
  ds_read_b64_tr_b16 a[10:11], v226 offset:40960
  v_cvt_pk_bf16_f32 v198, v168, v169
  v_add_f32 v214, v214, v160
  v_mfma_f32_16x16x32_bf16 v[64:67], a[32:35], v[204:207], v[64:67]
  v_exp_f32 v171, v171
  v_mfma_f32_16x16x32_bf16 v[68:71], a[32:35], v[208:211], v[68:71]
  ds_read_b64_tr_b16 a[12:13], v227 offset:32768
  v_cvt_pk_bf16_f32 v199, v170, v171
  v_mfma_f32_16x16x32_bf16 v[144:147], a[32:35], a[232:235], v[144:147]
  buffer_load_dwordx4 v235, s[20:23], s36 offen offset:3072 nt lds
  ds_read_b64_tr_b16 a[14:15], v227 offset:40960
  s_add_u32 m0, s38, 81920
  v_mfma_f32_16x16x32_bf16 v[96:99], a[48:51], v[204:207], v[96:99]
  v_exp_f32 v164, v164
  v_mfma_f32_16x16x32_bf16 v[100:103], a[48:51], v[208:211], v[100:103]
  ds_read_b64_tr_b16 a[20:21], v229 offset:32768
  v_add_f32 v214, v214, v161
  v_mfma_f32_16x16x32_bf16 v[152:155], a[48:51], a[232:235], v[152:155]
  ds_read_b64_tr_b16 a[22:23], v229 offset:40960
  ds_read_b64_tr_b16 a[24:25], v230 offset:32768
  v_add_f32 v214, v214, v162
  s_waitcnt lgkmcnt(6)
  ds_read_b64_tr_b16 a[26:27], v230 offset:40960
  ds_read_b64_tr_b16 a[28:29], v231 offset:32768
  ds_read_b64_tr_b16 a[30:31], v231 offset:40960
  buffer_load_dwordx4 v236, s[24:27], s36 offen offset:0 nt lds
  ds_read_b64_tr_b16 a[36:37], v225 offset:33024
  ds_read_b64_tr_b16 a[38:39], v225 offset:41216
  v_add_f32 v214, v214, v163
  v_exp_f32 v165, v165
  s_nop 0
  v_cvt_pk_bf16_f32 v200, v164, v165
  v_add_f32 v214, v214, v168
  v_add_f32 v214, v214, v169
  v_exp_f32 v166, v166
  v_add_f32 v214, v214, v170
  v_mfma_f32_16x16x32_bf16 v[176:179], a[64:67], a[128:131], v[242:245]
  ds_read_b64_tr_b16 a[40:41], v226 offset:33024
  v_add_f32 v214, v214, v171
  v_mfma_f32_16x16x32_bf16 v[180:183], a[64:67], a[160:163], v[246:249]
  ds_read_b64_tr_b16 a[42:43], v226 offset:41216
  v_add_f32 v215, v215, v164
  v_mfma_f32_16x16x32_bf16 v[176:179], a[68:71], a[132:135], v[176:179]
  v_exp_f32 v167, v167
  v_mfma_f32_16x16x32_bf16 v[180:183], a[68:71], a[164:167], v[180:183]
  ds_read_b64_tr_b16 a[44:45], v227 offset:33024
  v_mfma_f32_16x16x32_bf16 v[176:179], a[72:75], a[136:139], v[176:179]
  ds_read_b64_tr_b16 a[46:47], v227 offset:41216
  v_mfma_f32_16x16x32_bf16 v[180:183], a[72:75], a[168:171], v[180:183]
  v_mfma_f32_16x16x32_bf16 v[176:179], a[76:79], a[140:143], v[176:179]
  ds_read_b64_tr_b16 a[52:53], v229 offset:33024
  v_mfma_f32_16x16x32_bf16 v[180:183], a[76:79], a[172:175], v[180:183]
  v_mfma_f32_16x16x32_bf16 v[176:179], a[80:83], a[144:147], v[176:179]
  ds_read_b64_tr_b16 a[54:55], v229 offset:41216
  v_mfma_f32_16x16x32_bf16 v[180:183], a[80:83], a[176:179], v[180:183]
  buffer_load_dwordx4 v237, s[24:27], s36 offen offset:1024 nt lds
  v_mfma_f32_16x16x32_bf16 v[176:179], a[84:87], a[148:151], v[176:179]
  v_mfma_f32_16x16x32_bf16 v[180:183], a[84:87], a[180:183], v[180:183]
  ds_read_b64_tr_b16 a[56:57], v230 offset:33024
  v_mfma_f32_16x16x32_bf16 v[176:179], a[88:91], a[152:155], v[176:179]
  v_mfma_f32_16x16x32_bf16 v[180:183], a[88:91], a[184:187], v[180:183]
  ds_read_b64_tr_b16 a[58:59], v230 offset:41216
  v_mfma_f32_16x16x32_bf16 v[176:179], a[92:95], a[156:159], v[176:179]
  ds_read_b64_tr_b16 a[60:61], v231 offset:33024
  v_cvt_pk_bf16_f32 v201, v166, v167
  v_mfma_f32_16x16x32_bf16 v[180:183], a[92:95], a[188:191], v[180:183]
  v_add_f32 v215, v215, v165
  v_mfma_f32_16x16x32_bf16 v[184:187], a[96:99], a[128:131], v[242:245]
  v_exp_f32 v172, v172
  v_mfma_f32_16x16x32_bf16 v[188:191], a[96:99], a[160:163], v[246:249]
  ds_read_b64_tr_b16 a[62:63], v231 offset:41216
  v_add_f32 v215, v215, v166
  v_mfma_f32_16x16x32_bf16 v[184:187], a[100:103], a[132:135], v[184:187]
  ds_read_b64_tr_b16 a[0:1], v224 offset:32768
  v_add_f32 v215, v215, v167
  v_mfma_f32_16x16x32_bf16 v[188:191], a[100:103], a[164:167], v[188:191]
  ds_read_b64_tr_b16 a[2:3], v224 offset:40960
  v_add_f32 v215, v215, v172
  v_mfma_f32_16x16x32_bf16 v[184:187], a[104:107], a[136:139], v[184:187]
  v_exp_f32 v173, v173
  v_mfma_f32_16x16x32_bf16 v[188:191], a[104:107], a[168:171], v[188:191]
  ds_read_b64_tr_b16 a[16:17], v228 offset:32768
  v_cvt_pk_bf16_f32 v202, v172, v173
  v_mfma_f32_16x16x32_bf16 v[184:187], a[108:111], a[140:143], v[184:187]
  ds_read_b64_tr_b16 a[18:19], v228 offset:40960
  v_add_f32 v215, v215, v173
  v_mfma_f32_16x16x32_bf16 v[188:191], a[108:111], a[172:175], v[188:191]
  ds_read_b64_tr_b16 a[32:33], v224 offset:33024
  v_mfma_f32_16x16x32_bf16 v[184:187], a[112:115], a[144:147], v[184:187]
  ds_read_b64_tr_b16 a[34:35], v224 offset:41216
  v_mfma_f32_16x16x32_bf16 v[188:191], a[112:115], a[176:179], v[188:191]
  ds_read_b64_tr_b16 a[48:49], v228 offset:33024
  v_mfma_f32_16x16x32_bf16 v[184:187], a[116:119], a[148:151], v[184:187]
  ds_read_b64_tr_b16 a[50:51], v228 offset:41216
  v_mfma_f32_16x16x32_bf16 v[188:191], a[116:119], a[180:183], v[188:191]
  v_exp_f32 v174, v174
  v_mfma_f32_16x16x32_bf16 v[184:187], a[120:123], a[152:155], v[184:187]
  buffer_load_dwordx4 v238, s[24:27], s36 offen offset:2048 nt lds
  v_mfma_f32_16x16x32_bf16 v[188:191], a[120:123], a[184:187], v[188:191]
  v_exp_f32 v175, v175
  v_mfma_f32_16x16x32_bf16 v[184:187], a[124:127], a[156:159], v[184:187]
  buffer_load_dwordx4 v239, s[24:27], s36 offen offset:3072 nt lds
  v_cvt_pk_bf16_f32 v203, v174, v175
  v_mfma_f32_16x16x32_bf16 v[188:191], a[124:127], a[188:191], v[188:191]
  v_add_f32 v215, v215, v174
  v_add_f32 v215, v215, v175
  s_waitcnt vmcnt(16) lgkmcnt(0)
  s_barrier
  v_mfma_f32_16x16x32_bf16 v[8:11], a[4:7], v[196:199], v[8:11]
  ds_read_b128 a[64:67], v220 offset:0
  v_mul_f32 v176, s39, v176
  v_mfma_f32_16x16x32_bf16 v[12:15], a[4:7], v[200:203], v[12:15]
  v_exp_f32 v176, v176
  v_mfma_f32_16x16x32_bf16 v[16:19], a[8:11], v[196:199], v[16:19]
  ds_read_b128 a[68:71], v221 offset:0
  v_mul_f32 v177, s39, v177
  v_mfma_f32_16x16x32_bf16 v[20:23], a[8:11], v[200:203], v[20:23]
  ds_read_b128 a[72:75], v222 offset:0
  s_add_u32 s36, s36, 16384
  v_mfma_f32_16x16x32_bf16 v[24:27], a[12:15], v[196:199], v[24:27]
  ds_read_b128 a[76:79], v223 offset:0
  s_add_u32 m0, s38, 49152
  v_mfma_f32_16x16x32_bf16 v[28:31], a[12:15], v[200:203], v[28:31]
  v_exp_f32 v177, v177
  v_mfma_f32_16x16x32_bf16 v[40:43], a[20:23], v[196:199], v[40:43]
  ds_read_b128 a[80:83], v220 offset:256
  v_mul_f32 v178, s39, v178
  v_mfma_f32_16x16x32_bf16 v[44:47], a[20:23], v[200:203], v[44:47]
  buffer_load_dwordx4 v232, s[20:23], s36 offen offset:0 nt lds
  v_mfma_f32_16x16x32_bf16 v[48:51], a[24:27], v[196:199], v[48:51]
  ds_read_b128 a[84:87], v221 offset:256
  v_mul_f32 v179, s39, v179
  v_mfma_f32_16x16x32_bf16 v[52:55], a[24:27], v[200:203], v[52:55]
  v_exp_f32 v178, v178
  v_mfma_f32_16x16x32_bf16 v[56:59], a[28:31], v[196:199], v[56:59]
  ds_read_b128 a[88:91], v222 offset:256
  v_mul_f32 v184, s39, v184
  v_mfma_f32_16x16x32_bf16 v[60:63], a[28:31], v[200:203], v[60:63]
  ds_read_b128 a[92:95], v223 offset:256
  v_mul_f32 v185, s39, v185
  v_mfma_f32_16x16x32_bf16 v[72:75], a[36:39], v[196:199], v[72:75]
  ds_read_b64_tr_b16 a[4:5], v225 offset:49152
  v_mul_f32 v186, s39, v186
  v_mfma_f32_16x16x32_bf16 v[76:79], a[36:39], v[200:203], v[76:79]
  ds_read_b128 a[232:235], v241 offset:2048
  v_mul_f32 v187, s39, v187
  v_mfma_f32_16x16x32_bf16 v[80:83], a[40:43], v[196:199], v[80:83]
  v_exp_f32 v179, v179
  v_mfma_f32_16x16x32_bf16 v[84:87], a[40:43], v[200:203], v[84:87]
  ds_read_b128 a[96:99], v220 offset:8192
  v_mul_f32 v180, s39, v180
  v_mfma_f32_16x16x32_bf16 v[88:91], a[44:47], v[196:199], v[88:91]
  buffer_load_dwordx4 v233, s[20:23], s36 offen offset:1024 nt lds
  v_mfma_f32_16x16x32_bf16 v[92:95], a[44:47], v[200:203], v[92:95]
  ds_read_b128 a[100:103], v221 offset:8192
  v_mul_f32 v181, s39, v181
  v_mfma_f32_16x16x32_bf16 v[104:107], a[52:55], v[196:199], v[104:107]
  v_exp_f32 v184, v184
  v_mfma_f32_16x16x32_bf16 v[108:111], a[52:55], v[200:203], v[108:111]
  ds_read_b128 a[104:107], v222 offset:8192
  v_mul_f32 v182, s39, v182
  v_mfma_f32_16x16x32_bf16 v[112:115], a[56:59], v[196:199], v[112:115]
  ds_read_b64_tr_b16 a[6:7], v225 offset:57344
  v_mul_f32 v183, s39, v183
  v_mfma_f32_16x16x32_bf16 v[116:119], a[56:59], v[200:203], v[116:119]
  ds_read_b128 a[108:111], v223 offset:8192
  v_mul_f32 v188, s39, v188
  v_mfma_f32_16x16x32_bf16 v[120:123], a[60:63], v[196:199], v[120:123]
  v_mul_f32 v189, s39, v189
  v_mfma_f32_16x16x32_bf16 v[124:127], a[60:63], v[200:203], v[124:127]
  v_exp_f32 v185, v185
  v_mfma_f32_16x16x32_bf16 v[0:3], a[0:3], v[196:199], v[0:3]
  ds_read_b128 a[112:115], v220 offset:8448
  v_mul_f32 v190, s39, v190
  v_mfma_f32_16x16x32_bf16 v[4:7], a[0:3], v[200:203], v[4:7]
  buffer_load_dwordx4 v234, s[20:23], s36 offen offset:2048 nt lds
  v_mfma_f32_16x16x32_bf16 v[128:131], a[0:3], a[224:227], v[128:131]
  ds_read_b128 a[116:119], v221 offset:8448
  v_mul_f32 v191, s39, v191
  v_exp_f32 v186, v186
  v_mfma_f32_16x16x32_bf16 v[32:35], a[16:19], v[196:199], v[32:35]
  ds_read_b128 a[120:123], v222 offset:8448
  v_cvt_pk_bf16_f32 v204, v176, v177
  v_mfma_f32_16x16x32_bf16 v[36:39], a[16:19], v[200:203], v[36:39]
  ds_read_b64_tr_b16 a[8:9], v226 offset:49152
  v_cvt_pk_bf16_f32 v205, v178, v179
  v_mfma_f32_16x16x32_bf16 v[136:139], a[16:19], a[224:227], v[136:139]
  ds_read_b128 a[124:127], v223 offset:8448
  ds_read_b64_tr_b16 a[10:11], v226 offset:57344
  v_cvt_pk_bf16_f32 v206, v184, v185
  v_add_f32 v214, v214, v176
  v_mfma_f32_16x16x32_bf16 v[64:67], a[32:35], v[196:199], v[64:67]
  v_exp_f32 v187, v187
  v_mfma_f32_16x16x32_bf16 v[68:71], a[32:35], v[200:203], v[68:71]
  ds_read_b64_tr_b16 a[12:13], v227 offset:49152
  v_cvt_pk_bf16_f32 v207, v186, v187
  v_mfma_f32_16x16x32_bf16 v[144:147], a[32:35], a[224:227], v[144:147]
  buffer_load_dwordx4 v235, s[20:23], s36 offen offset:3072 nt lds
  ds_read_b64_tr_b16 a[14:15], v227 offset:57344
  s_add_u32 m0, s38, 98304
  v_mfma_f32_16x16x32_bf16 v[96:99], a[48:51], v[196:199], v[96:99]
  v_exp_f32 v180, v180
  v_mfma_f32_16x16x32_bf16 v[100:103], a[48:51], v[200:203], v[100:103]
  ds_read_b64_tr_b16 a[20:21], v229 offset:49152
  v_add_f32 v214, v214, v177
  v_mfma_f32_16x16x32_bf16 v[152:155], a[48:51], a[224:227], v[152:155]
  ds_read_b64_tr_b16 a[22:23], v229 offset:57344
  ds_read_b64_tr_b16 a[24:25], v230 offset:49152
  v_add_f32 v214, v214, v178
  s_waitcnt lgkmcnt(6)
  ds_read_b64_tr_b16 a[26:27], v230 offset:57344
  ds_read_b64_tr_b16 a[28:29], v231 offset:49152
  ds_read_b64_tr_b16 a[30:31], v231 offset:57344
  buffer_load_dwordx4 v236, s[24:27], s36 offen offset:0 nt lds
  ds_read_b64_tr_b16 a[36:37], v225 offset:49408
  ds_read_b64_tr_b16 a[38:39], v225 offset:57600
  v_add_f32 v214, v214, v179
  v_exp_f32 v181, v181
  s_nop 0
  v_cvt_pk_bf16_f32 v208, v180, v181
  v_add_f32 v214, v214, v184
  v_add_f32 v214, v214, v185
  v_exp_f32 v182, v182
  v_add_f32 v214, v214, v186
  v_mfma_f32_16x16x32_bf16 v[160:163], a[64:67], a[128:131], v[242:245]
  ds_read_b64_tr_b16 a[40:41], v226 offset:49408
  v_add_f32 v214, v214, v187
  v_mfma_f32_16x16x32_bf16 v[164:167], a[64:67], a[160:163], v[246:249]
  ds_read_b64_tr_b16 a[42:43], v226 offset:57600
  v_add_f32 v215, v215, v180
  v_mfma_f32_16x16x32_bf16 v[160:163], a[68:71], a[132:135], v[160:163]
  v_exp_f32 v183, v183
  v_mfma_f32_16x16x32_bf16 v[164:167], a[68:71], a[164:167], v[164:167]
  ds_read_b64_tr_b16 a[44:45], v227 offset:49408
  v_mfma_f32_16x16x32_bf16 v[160:163], a[72:75], a[136:139], v[160:163]
  ds_read_b64_tr_b16 a[46:47], v227 offset:57600
  v_mfma_f32_16x16x32_bf16 v[164:167], a[72:75], a[168:171], v[164:167]
  v_mfma_f32_16x16x32_bf16 v[160:163], a[76:79], a[140:143], v[160:163]
  ds_read_b64_tr_b16 a[52:53], v229 offset:49408
  v_mfma_f32_16x16x32_bf16 v[164:167], a[76:79], a[172:175], v[164:167]
  v_mfma_f32_16x16x32_bf16 v[160:163], a[80:83], a[144:147], v[160:163]
  ds_read_b64_tr_b16 a[54:55], v229 offset:57600
  v_mfma_f32_16x16x32_bf16 v[164:167], a[80:83], a[176:179], v[164:167]
  buffer_load_dwordx4 v237, s[24:27], s36 offen offset:1024 nt lds
  v_mfma_f32_16x16x32_bf16 v[160:163], a[84:87], a[148:151], v[160:163]
  v_mfma_f32_16x16x32_bf16 v[164:167], a[84:87], a[180:183], v[164:167]
  ds_read_b64_tr_b16 a[56:57], v230 offset:49408
  v_mfma_f32_16x16x32_bf16 v[160:163], a[88:91], a[152:155], v[160:163]
  v_mfma_f32_16x16x32_bf16 v[164:167], a[88:91], a[184:187], v[164:167]
  ds_read_b64_tr_b16 a[58:59], v230 offset:57600
  v_mfma_f32_16x16x32_bf16 v[160:163], a[92:95], a[156:159], v[160:163]
  ds_read_b64_tr_b16 a[60:61], v231 offset:49408
  v_cvt_pk_bf16_f32 v209, v182, v183
  v_mfma_f32_16x16x32_bf16 v[164:167], a[92:95], a[188:191], v[164:167]
  v_add_f32 v215, v215, v181
  v_mfma_f32_16x16x32_bf16 v[168:171], a[96:99], a[128:131], v[242:245]
  v_exp_f32 v188, v188
  v_mfma_f32_16x16x32_bf16 v[172:175], a[96:99], a[160:163], v[246:249]
  ds_read_b64_tr_b16 a[62:63], v231 offset:57600
  v_add_f32 v215, v215, v182
  v_mfma_f32_16x16x32_bf16 v[168:171], a[100:103], a[132:135], v[168:171]
  ds_read_b64_tr_b16 a[0:1], v224 offset:49152
  v_add_f32 v215, v215, v183
  v_mfma_f32_16x16x32_bf16 v[172:175], a[100:103], a[164:167], v[172:175]
  ds_read_b64_tr_b16 a[2:3], v224 offset:57344
  v_add_f32 v215, v215, v188
  v_mfma_f32_16x16x32_bf16 v[168:171], a[104:107], a[136:139], v[168:171]
  v_exp_f32 v189, v189
  v_mfma_f32_16x16x32_bf16 v[172:175], a[104:107], a[168:171], v[172:175]
  ds_read_b64_tr_b16 a[16:17], v228 offset:49152
  v_cvt_pk_bf16_f32 v210, v188, v189
  v_mfma_f32_16x16x32_bf16 v[168:171], a[108:111], a[140:143], v[168:171]
  ds_read_b64_tr_b16 a[18:19], v228 offset:57344
  v_add_f32 v215, v215, v189
  v_mfma_f32_16x16x32_bf16 v[172:175], a[108:111], a[172:175], v[172:175]
  ds_read_b64_tr_b16 a[32:33], v224 offset:49408
  v_mfma_f32_16x16x32_bf16 v[168:171], a[112:115], a[144:147], v[168:171]
  ds_read_b64_tr_b16 a[34:35], v224 offset:57600
  v_mfma_f32_16x16x32_bf16 v[172:175], a[112:115], a[176:179], v[172:175]
  ds_read_b64_tr_b16 a[48:49], v228 offset:49408
  v_mfma_f32_16x16x32_bf16 v[168:171], a[116:119], a[148:151], v[168:171]
  ds_read_b64_tr_b16 a[50:51], v228 offset:57600
  v_mfma_f32_16x16x32_bf16 v[172:175], a[116:119], a[180:183], v[172:175]
  v_exp_f32 v190, v190
  v_mfma_f32_16x16x32_bf16 v[168:171], a[120:123], a[152:155], v[168:171]
  buffer_load_dwordx4 v238, s[24:27], s36 offen offset:2048 nt lds
  v_mfma_f32_16x16x32_bf16 v[172:175], a[120:123], a[184:187], v[172:175]
  v_exp_f32 v191, v191
  v_mfma_f32_16x16x32_bf16 v[168:171], a[124:127], a[156:159], v[168:171]
  buffer_load_dwordx4 v239, s[24:27], s36 offen offset:3072 nt lds
  v_cvt_pk_bf16_f32 v211, v190, v191
  v_mfma_f32_16x16x32_bf16 v[172:175], a[124:127], a[188:191], v[172:175]
  v_add_f32 v215, v215, v190
  v_add_f32 v215, v215, v191
  s_waitcnt vmcnt(16) lgkmcnt(0)
  s_barrier
  v_mfma_f32_16x16x32_bf16 v[8:11], a[4:7], v[204:207], v[8:11]
  ds_read_b128 a[64:67], v220 offset:16384
  v_mul_f32 v160, s39, v160
  v_mfma_f32_16x16x32_bf16 v[12:15], a[4:7], v[208:211], v[12:15]
  v_exp_f32 v160, v160
  v_mfma_f32_16x16x32_bf16 v[16:19], a[8:11], v[204:207], v[16:19]
  ds_read_b128 a[68:71], v221 offset:16384
  v_mul_f32 v161, s39, v161
  v_mfma_f32_16x16x32_bf16 v[20:23], a[8:11], v[208:211], v[20:23]
  ds_read_b128 a[72:75], v222 offset:16384
  s_add_u32 s36, s36, 16384
  v_mfma_f32_16x16x32_bf16 v[24:27], a[12:15], v[204:207], v[24:27]
  ds_read_b128 a[76:79], v223 offset:16384
  s_add_u32 m0, s38, 0
  v_mfma_f32_16x16x32_bf16 v[28:31], a[12:15], v[208:211], v[28:31]
  v_exp_f32 v161, v161
  v_mfma_f32_16x16x32_bf16 v[40:43], a[20:23], v[204:207], v[40:43]
  ds_read_b128 a[80:83], v220 offset:16640
  v_mul_f32 v162, s39, v162
  v_mfma_f32_16x16x32_bf16 v[44:47], a[20:23], v[208:211], v[44:47]
  buffer_load_dwordx4 v232, s[20:23], s36 offen offset:0 nt lds
  v_mfma_f32_16x16x32_bf16 v[48:51], a[24:27], v[204:207], v[48:51]
  ds_read_b128 a[84:87], v221 offset:16640
  v_mul_f32 v163, s39, v163
  v_mfma_f32_16x16x32_bf16 v[52:55], a[24:27], v[208:211], v[52:55]
  v_exp_f32 v162, v162
  v_mfma_f32_16x16x32_bf16 v[56:59], a[28:31], v[204:207], v[56:59]
  ds_read_b128 a[88:91], v222 offset:16640
  v_mul_f32 v168, s39, v168
  v_mfma_f32_16x16x32_bf16 v[60:63], a[28:31], v[208:211], v[60:63]
  ds_read_b128 a[92:95], v223 offset:16640
  v_mul_f32 v169, s39, v169
  v_mfma_f32_16x16x32_bf16 v[72:75], a[36:39], v[204:207], v[72:75]
  ds_read_b64_tr_b16 a[4:5], v225 offset:0
  v_mul_f32 v170, s39, v170
  v_mfma_f32_16x16x32_bf16 v[76:79], a[36:39], v[208:211], v[76:79]
  ds_read_b128 a[224:227], v241 offset:0
  v_mul_f32 v171, s39, v171
  v_mfma_f32_16x16x32_bf16 v[80:83], a[40:43], v[204:207], v[80:83]
  v_exp_f32 v163, v163
  v_mfma_f32_16x16x32_bf16 v[84:87], a[40:43], v[208:211], v[84:87]
  ds_read_b128 a[96:99], v220 offset:24576
  v_mul_f32 v164, s39, v164
  v_mfma_f32_16x16x32_bf16 v[88:91], a[44:47], v[204:207], v[88:91]
  buffer_load_dwordx4 v233, s[20:23], s36 offen offset:1024 nt lds
  v_mfma_f32_16x16x32_bf16 v[92:95], a[44:47], v[208:211], v[92:95]
  ds_read_b128 a[100:103], v221 offset:24576
  v_mul_f32 v165, s39, v165
  v_mfma_f32_16x16x32_bf16 v[104:107], a[52:55], v[204:207], v[104:107]
  v_exp_f32 v168, v168
  v_mfma_f32_16x16x32_bf16 v[108:111], a[52:55], v[208:211], v[108:111]
  ds_read_b128 a[104:107], v222 offset:24576
  v_mul_f32 v166, s39, v166
  v_mfma_f32_16x16x32_bf16 v[112:115], a[56:59], v[204:207], v[112:115]
  ds_read_b64_tr_b16 a[6:7], v225 offset:8192
  v_mul_f32 v167, s39, v167
  v_mfma_f32_16x16x32_bf16 v[116:119], a[56:59], v[208:211], v[116:119]
  ds_read_b128 a[108:111], v223 offset:24576
  v_mul_f32 v172, s39, v172
  v_mfma_f32_16x16x32_bf16 v[120:123], a[60:63], v[204:207], v[120:123]
  v_mul_f32 v173, s39, v173
  v_mfma_f32_16x16x32_bf16 v[124:127], a[60:63], v[208:211], v[124:127]
  v_exp_f32 v169, v169
  v_mfma_f32_16x16x32_bf16 v[0:3], a[0:3], v[204:207], v[0:3]
  ds_read_b128 a[112:115], v220 offset:24832
  v_mul_f32 v174, s39, v174
  v_mfma_f32_16x16x32_bf16 v[4:7], a[0:3], v[208:211], v[4:7]
  buffer_load_dwordx4 v234, s[20:23], s36 offen offset:2048 nt lds
  v_mfma_f32_16x16x32_bf16 v[128:131], a[0:3], a[232:235], v[128:131]
  ds_read_b128 a[116:119], v221 offset:24832
  v_mul_f32 v175, s39, v175
  v_exp_f32 v170, v170
  v_mfma_f32_16x16x32_bf16 v[32:35], a[16:19], v[204:207], v[32:35]
  ds_read_b128 a[120:123], v222 offset:24832
  v_cvt_pk_bf16_f32 v196, v160, v161
  v_mfma_f32_16x16x32_bf16 v[36:39], a[16:19], v[208:211], v[36:39]
  ds_read_b64_tr_b16 a[8:9], v226 offset:0
  v_cvt_pk_bf16_f32 v197, v162, v163
  v_mfma_f32_16x16x32_bf16 v[136:139], a[16:19], a[232:235], v[136:139]
  ds_read_b128 a[124:127], v223 offset:24832
  ds_read_b64_tr_b16 a[10:11], v226 offset:8192
  v_cvt_pk_bf16_f32 v198, v168, v169
  v_add_f32 v214, v214, v160
  v_mfma_f32_16x16x32_bf16 v[64:67], a[32:35], v[204:207], v[64:67]
  v_exp_f32 v171, v171
  v_mfma_f32_16x16x32_bf16 v[68:71], a[32:35], v[208:211], v[68:71]
  ds_read_b64_tr_b16 a[12:13], v227 offset:0
  v_cvt_pk_bf16_f32 v199, v170, v171
  v_mfma_f32_16x16x32_bf16 v[144:147], a[32:35], a[232:235], v[144:147]
  buffer_load_dwordx4 v235, s[20:23], s36 offen offset:3072 nt lds
  ds_read_b64_tr_b16 a[14:15], v227 offset:8192
  s_add_u32 m0, s38, 114688
  v_mfma_f32_16x16x32_bf16 v[96:99], a[48:51], v[204:207], v[96:99]
  v_exp_f32 v164, v164
  v_mfma_f32_16x16x32_bf16 v[100:103], a[48:51], v[208:211], v[100:103]
  ds_read_b64_tr_b16 a[20:21], v229 offset:0
  v_add_f32 v214, v214, v161
  v_mfma_f32_16x16x32_bf16 v[152:155], a[48:51], a[232:235], v[152:155]
  ds_read_b64_tr_b16 a[22:23], v229 offset:8192
  ds_read_b64_tr_b16 a[24:25], v230 offset:0
  v_add_f32 v214, v214, v162
  s_waitcnt lgkmcnt(6)
  ds_read_b64_tr_b16 a[26:27], v230 offset:8192
  ds_read_b64_tr_b16 a[28:29], v231 offset:0
  ds_read_b64_tr_b16 a[30:31], v231 offset:8192
  buffer_load_dwordx4 v236, s[24:27], s36 offen offset:0 nt lds
  ds_read_b64_tr_b16 a[36:37], v225 offset:256
  ds_read_b64_tr_b16 a[38:39], v225 offset:8448
  v_add_f32 v214, v214, v163
  v_exp_f32 v165, v165
  s_nop 0
  v_cvt_pk_bf16_f32 v200, v164, v165
  v_add_f32 v214, v214, v168
  v_add_f32 v214, v214, v169
  v_exp_f32 v166, v166
  v_add_f32 v214, v214, v170
  v_mfma_f32_16x16x32_bf16 v[176:179], a[64:67], a[128:131], v[242:245]
  ds_read_b64_tr_b16 a[40:41], v226 offset:256
  v_add_f32 v214, v214, v171
  v_mfma_f32_16x16x32_bf16 v[180:183], a[64:67], a[160:163], v[246:249]
  ds_read_b64_tr_b16 a[42:43], v226 offset:8448
  v_add_f32 v215, v215, v164
  v_mfma_f32_16x16x32_bf16 v[176:179], a[68:71], a[132:135], v[176:179]
  v_exp_f32 v167, v167
  v_mfma_f32_16x16x32_bf16 v[180:183], a[68:71], a[164:167], v[180:183]
  ds_read_b64_tr_b16 a[44:45], v227 offset:256
  v_mfma_f32_16x16x32_bf16 v[176:179], a[72:75], a[136:139], v[176:179]
  ds_read_b64_tr_b16 a[46:47], v227 offset:8448
  v_mfma_f32_16x16x32_bf16 v[180:183], a[72:75], a[168:171], v[180:183]
  v_mfma_f32_16x16x32_bf16 v[176:179], a[76:79], a[140:143], v[176:179]
  ds_read_b64_tr_b16 a[52:53], v229 offset:256
  v_mfma_f32_16x16x32_bf16 v[180:183], a[76:79], a[172:175], v[180:183]
  v_mfma_f32_16x16x32_bf16 v[176:179], a[80:83], a[144:147], v[176:179]
  ds_read_b64_tr_b16 a[54:55], v229 offset:8448
  v_mfma_f32_16x16x32_bf16 v[180:183], a[80:83], a[176:179], v[180:183]
  buffer_load_dwordx4 v237, s[24:27], s36 offen offset:1024 nt lds
  v_mfma_f32_16x16x32_bf16 v[176:179], a[84:87], a[148:151], v[176:179]
  v_mfma_f32_16x16x32_bf16 v[180:183], a[84:87], a[180:183], v[180:183]
  ds_read_b64_tr_b16 a[56:57], v230 offset:256
  v_mfma_f32_16x16x32_bf16 v[176:179], a[88:91], a[152:155], v[176:179]
  v_mfma_f32_16x16x32_bf16 v[180:183], a[88:91], a[184:187], v[180:183]
  ds_read_b64_tr_b16 a[58:59], v230 offset:8448
  v_mfma_f32_16x16x32_bf16 v[176:179], a[92:95], a[156:159], v[176:179]
  ds_read_b64_tr_b16 a[60:61], v231 offset:256
  v_cvt_pk_bf16_f32 v201, v166, v167
  v_mfma_f32_16x16x32_bf16 v[180:183], a[92:95], a[188:191], v[180:183]
  v_add_f32 v215, v215, v165
  v_mfma_f32_16x16x32_bf16 v[184:187], a[96:99], a[128:131], v[242:245]
  v_exp_f32 v172, v172
  v_mfma_f32_16x16x32_bf16 v[188:191], a[96:99], a[160:163], v[246:249]
  ds_read_b64_tr_b16 a[62:63], v231 offset:8448
  v_add_f32 v215, v215, v166
  v_mfma_f32_16x16x32_bf16 v[184:187], a[100:103], a[132:135], v[184:187]
  ds_read_b64_tr_b16 a[0:1], v224 offset:0
  v_add_f32 v215, v215, v167
  v_mfma_f32_16x16x32_bf16 v[188:191], a[100:103], a[164:167], v[188:191]
  ds_read_b64_tr_b16 a[2:3], v224 offset:8192
  v_add_f32 v215, v215, v172
  v_mfma_f32_16x16x32_bf16 v[184:187], a[104:107], a[136:139], v[184:187]
  v_exp_f32 v173, v173
  v_mfma_f32_16x16x32_bf16 v[188:191], a[104:107], a[168:171], v[188:191]
  ds_read_b64_tr_b16 a[16:17], v228 offset:0
  v_cvt_pk_bf16_f32 v202, v172, v173
  v_mfma_f32_16x16x32_bf16 v[184:187], a[108:111], a[140:143], v[184:187]
  ds_read_b64_tr_b16 a[18:19], v228 offset:8192
  v_add_f32 v215, v215, v173
  v_mfma_f32_16x16x32_bf16 v[188:191], a[108:111], a[172:175], v[188:191]
  ds_read_b64_tr_b16 a[32:33], v224 offset:256
  v_mfma_f32_16x16x32_bf16 v[184:187], a[112:115], a[144:147], v[184:187]
  ds_read_b64_tr_b16 a[34:35], v224 offset:8448
  v_mfma_f32_16x16x32_bf16 v[188:191], a[112:115], a[176:179], v[188:191]
  ds_read_b64_tr_b16 a[48:49], v228 offset:256
  v_mfma_f32_16x16x32_bf16 v[184:187], a[116:119], a[148:151], v[184:187]
  ds_read_b64_tr_b16 a[50:51], v228 offset:8448
  v_mfma_f32_16x16x32_bf16 v[188:191], a[116:119], a[180:183], v[188:191]
  v_exp_f32 v174, v174
  v_mfma_f32_16x16x32_bf16 v[184:187], a[120:123], a[152:155], v[184:187]
  buffer_load_dwordx4 v238, s[24:27], s36 offen offset:2048 nt lds
  v_mfma_f32_16x16x32_bf16 v[188:191], a[120:123], a[184:187], v[188:191]
  v_exp_f32 v175, v175
  v_mfma_f32_16x16x32_bf16 v[184:187], a[124:127], a[156:159], v[184:187]
  buffer_load_dwordx4 v239, s[24:27], s36 offen offset:3072 nt lds
  v_cvt_pk_bf16_f32 v203, v174, v175
  v_mfma_f32_16x16x32_bf16 v[188:191], a[124:127], a[188:191], v[188:191]
  v_add_f32 v215, v215, v174
  v_add_f32 v215, v215, v175
  s_waitcnt vmcnt(16) lgkmcnt(0)
  s_barrier
  v_mfma_f32_16x16x32_bf16 v[8:11], a[4:7], v[196:199], v[8:11]
  ds_read_b128 a[64:67], v220 offset:32768
  v_mul_f32 v176, s39, v176
  v_mfma_f32_16x16x32_bf16 v[12:15], a[4:7], v[200:203], v[12:15]
  v_exp_f32 v176, v176
  v_mfma_f32_16x16x32_bf16 v[16:19], a[8:11], v[196:199], v[16:19]
  ds_read_b128 a[68:71], v221 offset:32768
  v_mul_f32 v177, s39, v177
  v_mfma_f32_16x16x32_bf16 v[20:23], a[8:11], v[200:203], v[20:23]
  ds_read_b128 a[72:75], v222 offset:32768
  s_add_u32 s36, s36, 16384
  v_mfma_f32_16x16x32_bf16 v[24:27], a[12:15], v[196:199], v[24:27]
  ds_read_b128 a[76:79], v223 offset:32768
  s_add_u32 m0, s38, 16384
  v_mfma_f32_16x16x32_bf16 v[28:31], a[12:15], v[200:203], v[28:31]
  v_exp_f32 v177, v177
  v_mfma_f32_16x16x32_bf16 v[40:43], a[20:23], v[196:199], v[40:43]
  ds_read_b128 a[80:83], v220 offset:33024
  v_mul_f32 v178, s39, v178
  v_mfma_f32_16x16x32_bf16 v[44:47], a[20:23], v[200:203], v[44:47]
  buffer_load_dwordx4 v232, s[20:23], s36 offen offset:0 nt lds
  v_mfma_f32_16x16x32_bf16 v[48:51], a[24:27], v[196:199], v[48:51]
  ds_read_b128 a[84:87], v221 offset:33024
  v_mul_f32 v179, s39, v179
  v_mfma_f32_16x16x32_bf16 v[52:55], a[24:27], v[200:203], v[52:55]
  v_exp_f32 v178, v178
  v_mfma_f32_16x16x32_bf16 v[56:59], a[28:31], v[196:199], v[56:59]
  ds_read_b128 a[88:91], v222 offset:33024
  v_mul_f32 v184, s39, v184
  v_mfma_f32_16x16x32_bf16 v[60:63], a[28:31], v[200:203], v[60:63]
  ds_read_b128 a[92:95], v223 offset:33024
  v_mul_f32 v185, s39, v185
  v_mfma_f32_16x16x32_bf16 v[72:75], a[36:39], v[196:199], v[72:75]
  ds_read_b64_tr_b16 a[4:5], v225 offset:16384
  v_mul_f32 v186, s39, v186
  v_mfma_f32_16x16x32_bf16 v[76:79], a[36:39], v[200:203], v[76:79]
  ds_read_b128 a[232:235], v241 offset:2048
  v_mul_f32 v187, s39, v187
  v_mfma_f32_16x16x32_bf16 v[80:83], a[40:43], v[196:199], v[80:83]
  v_exp_f32 v179, v179
  v_mfma_f32_16x16x32_bf16 v[84:87], a[40:43], v[200:203], v[84:87]
  ds_read_b128 a[96:99], v220 offset:40960
  v_mul_f32 v180, s39, v180
  v_mfma_f32_16x16x32_bf16 v[88:91], a[44:47], v[196:199], v[88:91]
  buffer_load_dwordx4 v233, s[20:23], s36 offen offset:1024 nt lds
  v_mfma_f32_16x16x32_bf16 v[92:95], a[44:47], v[200:203], v[92:95]
  ds_read_b128 a[100:103], v221 offset:40960
  v_mul_f32 v181, s39, v181
  v_mfma_f32_16x16x32_bf16 v[104:107], a[52:55], v[196:199], v[104:107]
  v_exp_f32 v184, v184
  v_mfma_f32_16x16x32_bf16 v[108:111], a[52:55], v[200:203], v[108:111]
  ds_read_b128 a[104:107], v222 offset:40960
  v_mul_f32 v182, s39, v182
  v_mfma_f32_16x16x32_bf16 v[112:115], a[56:59], v[196:199], v[112:115]
  ds_read_b64_tr_b16 a[6:7], v225 offset:24576
  v_mul_f32 v183, s39, v183
  v_mfma_f32_16x16x32_bf16 v[116:119], a[56:59], v[200:203], v[116:119]
  ds_read_b128 a[108:111], v223 offset:40960
  v_mul_f32 v188, s39, v188
  v_mfma_f32_16x16x32_bf16 v[120:123], a[60:63], v[196:199], v[120:123]
  v_mul_f32 v189, s39, v189
  v_mfma_f32_16x16x32_bf16 v[124:127], a[60:63], v[200:203], v[124:127]
  v_exp_f32 v185, v185
  v_mfma_f32_16x16x32_bf16 v[0:3], a[0:3], v[196:199], v[0:3]
  ds_read_b128 a[112:115], v220 offset:41216
  v_mul_f32 v190, s39, v190
  v_mfma_f32_16x16x32_bf16 v[4:7], a[0:3], v[200:203], v[4:7]
  buffer_load_dwordx4 v234, s[20:23], s36 offen offset:2048 nt lds
  v_mfma_f32_16x16x32_bf16 v[128:131], a[0:3], a[224:227], v[128:131]
  ds_read_b128 a[116:119], v221 offset:41216
  v_mul_f32 v191, s39, v191
  v_exp_f32 v186, v186
  v_mfma_f32_16x16x32_bf16 v[32:35], a[16:19], v[196:199], v[32:35]
  ds_read_b128 a[120:123], v222 offset:41216
  v_cvt_pk_bf16_f32 v204, v176, v177
  v_mfma_f32_16x16x32_bf16 v[36:39], a[16:19], v[200:203], v[36:39]
  ds_read_b64_tr_b16 a[8:9], v226 offset:16384
  v_cvt_pk_bf16_f32 v205, v178, v179
  v_mfma_f32_16x16x32_bf16 v[136:139], a[16:19], a[224:227], v[136:139]
  ds_read_b128 a[124:127], v223 offset:41216
  ds_read_b64_tr_b16 a[10:11], v226 offset:24576
  v_cvt_pk_bf16_f32 v206, v184, v185
  v_add_f32 v214, v214, v176
  v_mfma_f32_16x16x32_bf16 v[64:67], a[32:35], v[196:199], v[64:67]
  v_exp_f32 v187, v187
  v_mfma_f32_16x16x32_bf16 v[68:71], a[32:35], v[200:203], v[68:71]
  ds_read_b64_tr_b16 a[12:13], v227 offset:16384
  v_cvt_pk_bf16_f32 v207, v186, v187
  v_mfma_f32_16x16x32_bf16 v[144:147], a[32:35], a[224:227], v[144:147]
  buffer_load_dwordx4 v235, s[20:23], s36 offen offset:3072 nt lds
  ds_read_b64_tr_b16 a[14:15], v227 offset:24576
  s_add_u32 m0, s38, 65536
  v_mfma_f32_16x16x32_bf16 v[96:99], a[48:51], v[196:199], v[96:99]
  v_exp_f32 v180, v180
  v_mfma_f32_16x16x32_bf16 v[100:103], a[48:51], v[200:203], v[100:103]
  ds_read_b64_tr_b16 a[20:21], v229 offset:16384
  v_add_f32 v214, v214, v177
  v_mfma_f32_16x16x32_bf16 v[152:155], a[48:51], a[224:227], v[152:155]
  ds_read_b64_tr_b16 a[22:23], v229 offset:24576
  ds_read_b64_tr_b16 a[24:25], v230 offset:16384
  v_add_f32 v214, v214, v178
  s_waitcnt lgkmcnt(6)
  s_add_u32 s40, s40, 1
  s_cmp_lt_u32 s40, 7
  s_cbranch_scc1 L_loop_k0q0p0
  ds_read_b64_tr_b16 a[26:27], v230 offset:24576
  ds_read_b64_tr_b16 a[28:29], v231 offset:16384
  ds_read_b64_tr_b16 a[30:31], v231 offset:24576
  ds_read_b64_tr_b16 a[36:37], v225 offset:16640
  ds_read_b64_tr_b16 a[38:39], v225 offset:24832
  v_add_f32 v214, v214, v179
  v_exp_f32 v181, v181
  s_nop 0
  v_cvt_pk_bf16_f32 v208, v180, v181
  v_add_f32 v214, v214, v184
  v_add_f32 v214, v214, v185
  v_exp_f32 v182, v182
  v_add_f32 v214, v214, v186
  v_mfma_f32_16x16x32_bf16 v[160:163], a[64:67], a[128:131], v[242:245]
  ds_read_b64_tr_b16 a[40:41], v226 offset:16640
  v_add_f32 v214, v214, v187
  v_mfma_f32_16x16x32_bf16 v[164:167], a[64:67], a[160:163], v[246:249]
  ds_read_b64_tr_b16 a[42:43], v226 offset:24832
  v_add_f32 v215, v215, v180
  v_mfma_f32_16x16x32_bf16 v[160:163], a[68:71], a[132:135], v[160:163]
  v_exp_f32 v183, v183
  v_mfma_f32_16x16x32_bf16 v[164:167], a[68:71], a[164:167], v[164:167]
  ds_read_b64_tr_b16 a[44:45], v227 offset:16640
  v_mfma_f32_16x16x32_bf16 v[160:163], a[72:75], a[136:139], v[160:163]
  ds_read_b64_tr_b16 a[46:47], v227 offset:24832
  v_mfma_f32_16x16x32_bf16 v[164:167], a[72:75], a[168:171], v[164:167]
  v_mfma_f32_16x16x32_bf16 v[160:163], a[76:79], a[140:143], v[160:163]
  ds_read_b64_tr_b16 a[52:53], v229 offset:16640
  v_mfma_f32_16x16x32_bf16 v[164:167], a[76:79], a[172:175], v[164:167]
  v_mfma_f32_16x16x32_bf16 v[160:163], a[80:83], a[144:147], v[160:163]
  ds_read_b64_tr_b16 a[54:55], v229 offset:24832
  v_mfma_f32_16x16x32_bf16 v[164:167], a[80:83], a[176:179], v[164:167]
  v_mfma_f32_16x16x32_bf16 v[160:163], a[84:87], a[148:151], v[160:163]
  v_mfma_f32_16x16x32_bf16 v[164:167], a[84:87], a[180:183], v[164:167]
  ds_read_b64_tr_b16 a[56:57], v230 offset:16640
  v_mfma_f32_16x16x32_bf16 v[160:163], a[88:91], a[152:155], v[160:163]
  v_mfma_f32_16x16x32_bf16 v[164:167], a[88:91], a[184:187], v[164:167]
  ds_read_b64_tr_b16 a[58:59], v230 offset:24832
  v_mfma_f32_16x16x32_bf16 v[160:163], a[92:95], a[156:159], v[160:163]
  ds_read_b64_tr_b16 a[60:61], v231 offset:16640
  v_cvt_pk_bf16_f32 v209, v182, v183
  v_mfma_f32_16x16x32_bf16 v[164:167], a[92:95], a[188:191], v[164:167]
  v_add_f32 v215, v215, v181
  v_mfma_f32_16x16x32_bf16 v[168:171], a[96:99], a[128:131], v[242:245]
  v_exp_f32 v188, v188
  v_mfma_f32_16x16x32_bf16 v[172:175], a[96:99], a[160:163], v[246:249]
  ds_read_b64_tr_b16 a[62:63], v231 offset:24832
  v_add_f32 v215, v215, v182
  v_mfma_f32_16x16x32_bf16 v[168:171], a[100:103], a[132:135], v[168:171]
  ds_read_b64_tr_b16 a[0:1], v224 offset:16384
  v_add_f32 v215, v215, v183
  v_mfma_f32_16x16x32_bf16 v[172:175], a[100:103], a[164:167], v[172:175]
  ds_read_b64_tr_b16 a[2:3], v224 offset:24576
  v_add_f32 v215, v215, v188
  v_mfma_f32_16x16x32_bf16 v[168:171], a[104:107], a[136:139], v[168:171]
  v_exp_f32 v189, v189
  v_mfma_f32_16x16x32_bf16 v[172:175], a[104:107], a[168:171], v[172:175]
  ds_read_b64_tr_b16 a[16:17], v228 offset:16384
  v_cvt_pk_bf16_f32 v210, v188, v189
  v_mfma_f32_16x16x32_bf16 v[168:171], a[108:111], a[140:143], v[168:171]
  ds_read_b64_tr_b16 a[18:19], v228 offset:24576
  v_add_f32 v215, v215, v189
  v_mfma_f32_16x16x32_bf16 v[172:175], a[108:111], a[172:175], v[172:175]
  ds_read_b64_tr_b16 a[32:33], v224 offset:16640
  v_mfma_f32_16x16x32_bf16 v[168:171], a[112:115], a[144:147], v[168:171]
  ds_read_b64_tr_b16 a[34:35], v224 offset:24832
  v_mfma_f32_16x16x32_bf16 v[172:175], a[112:115], a[176:179], v[172:175]
  ds_read_b64_tr_b16 a[48:49], v228 offset:16640
  v_mfma_f32_16x16x32_bf16 v[168:171], a[116:119], a[148:151], v[168:171]
  ds_read_b64_tr_b16 a[50:51], v228 offset:24832
  v_mfma_f32_16x16x32_bf16 v[172:175], a[116:119], a[180:183], v[172:175]
  v_exp_f32 v190, v190
  v_mfma_f32_16x16x32_bf16 v[168:171], a[120:123], a[152:155], v[168:171]
  v_mfma_f32_16x16x32_bf16 v[172:175], a[120:123], a[184:187], v[172:175]
  v_exp_f32 v191, v191
  v_mfma_f32_16x16x32_bf16 v[168:171], a[124:127], a[156:159], v[168:171]
  v_cvt_pk_bf16_f32 v211, v190, v191
  v_mfma_f32_16x16x32_bf16 v[172:175], a[124:127], a[188:191], v[172:175]
  v_add_f32 v215, v215, v190
  v_add_f32 v215, v215, v191
  s_waitcnt vmcnt(12) lgkmcnt(0)
  s_barrier
  v_mfma_f32_16x16x32_bf16 v[8:11], a[4:7], v[204:207], v[8:11]
  ds_read_b128 a[64:67], v220 offset:49152
  v_mul_f32 v160, s39, v160
  v_mfma_f32_16x16x32_bf16 v[12:15], a[4:7], v[208:211], v[12:15]
  v_exp_f32 v160, v160
  v_mfma_f32_16x16x32_bf16 v[16:19], a[8:11], v[204:207], v[16:19]
  ds_read_b128 a[68:71], v221 offset:49152
  v_mul_f32 v161, s39, v161
  v_mfma_f32_16x16x32_bf16 v[20:23], a[8:11], v[208:211], v[20:23]
  ds_read_b128 a[72:75], v222 offset:49152
  v_mfma_f32_16x16x32_bf16 v[24:27], a[12:15], v[204:207], v[24:27]
  ds_read_b128 a[76:79], v223 offset:49152
  v_mfma_f32_16x16x32_bf16 v[28:31], a[12:15], v[208:211], v[28:31]
  v_exp_f32 v161, v161
  v_mfma_f32_16x16x32_bf16 v[40:43], a[20:23], v[204:207], v[40:43]
  ds_read_b128 a[80:83], v220 offset:49408
  v_mul_f32 v162, s39, v162
  v_mfma_f32_16x16x32_bf16 v[44:47], a[20:23], v[208:211], v[44:47]
  v_mfma_f32_16x16x32_bf16 v[48:51], a[24:27], v[204:207], v[48:51]
  ds_read_b128 a[84:87], v221 offset:49408
  v_mul_f32 v163, s39, v163
  v_mfma_f32_16x16x32_bf16 v[52:55], a[24:27], v[208:211], v[52:55]
  v_exp_f32 v162, v162
  v_mfma_f32_16x16x32_bf16 v[56:59], a[28:31], v[204:207], v[56:59]
  ds_read_b128 a[88:91], v222 offset:49408
  v_mul_f32 v168, s39, v168
  v_mfma_f32_16x16x32_bf16 v[60:63], a[28:31], v[208:211], v[60:63]
  ds_read_b128 a[92:95], v223 offset:49408
  v_mul_f32 v169, s39, v169
  v_mfma_f32_16x16x32_bf16 v[72:75], a[36:39], v[204:207], v[72:75]
  ds_read_b64_tr_b16 a[4:5], v225 offset:32768
  v_mul_f32 v170, s39, v170
  v_mfma_f32_16x16x32_bf16 v[76:79], a[36:39], v[208:211], v[76:79]
  ds_read_b128 a[224:227], v241 offset:0
  v_mul_f32 v171, s39, v171
  v_mfma_f32_16x16x32_bf16 v[80:83], a[40:43], v[204:207], v[80:83]
  v_exp_f32 v163, v163
  v_mfma_f32_16x16x32_bf16 v[84:87], a[40:43], v[208:211], v[84:87]
  ds_read_b128 a[96:99], v220 offset:57344
  v_mul_f32 v164, s39, v164
  v_mfma_f32_16x16x32_bf16 v[88:91], a[44:47], v[204:207], v[88:91]
  v_mfma_f32_16x16x32_bf16 v[92:95], a[44:47], v[208:211], v[92:95]
  ds_read_b128 a[100:103], v221 offset:57344
  v_mul_f32 v165, s39, v165
  v_mfma_f32_16x16x32_bf16 v[104:107], a[52:55], v[204:207], v[104:107]
  v_exp_f32 v168, v168
  v_mfma_f32_16x16x32_bf16 v[108:111], a[52:55], v[208:211], v[108:111]
  ds_read_b128 a[104:107], v222 offset:57344
  v_mul_f32 v166, s39, v166
  v_mfma_f32_16x16x32_bf16 v[112:115], a[56:59], v[204:207], v[112:115]
  ds_read_b64_tr_b16 a[6:7], v225 offset:40960
  v_mul_f32 v167, s39, v167
  v_mfma_f32_16x16x32_bf16 v[116:119], a[56:59], v[208:211], v[116:119]
  ds_read_b128 a[108:111], v223 offset:57344
  v_mul_f32 v172, s39, v172
  v_mfma_f32_16x16x32_bf16 v[120:123], a[60:63], v[204:207], v[120:123]
  v_mul_f32 v173, s39, v173
  v_mfma_f32_16x16x32_bf16 v[124:127], a[60:63], v[208:211], v[124:127]
  v_exp_f32 v169, v169
  v_mfma_f32_16x16x32_bf16 v[0:3], a[0:3], v[204:207], v[0:3]
  ds_read_b128 a[112:115], v220 offset:57600
  v_mul_f32 v174, s39, v174
  v_mfma_f32_16x16x32_bf16 v[4:7], a[0:3], v[208:211], v[4:7]
  v_mfma_f32_16x16x32_bf16 v[128:131], a[0:3], a[232:235], v[128:131]
  ds_read_b128 a[116:119], v221 offset:57600
  v_mul_f32 v175, s39, v175
  v_exp_f32 v170, v170
  v_mfma_f32_16x16x32_bf16 v[32:35], a[16:19], v[204:207], v[32:35]
  ds_read_b128 a[120:123], v222 offset:57600
  v_cvt_pk_bf16_f32 v196, v160, v161
  v_mfma_f32_16x16x32_bf16 v[36:39], a[16:19], v[208:211], v[36:39]
  ds_read_b64_tr_b16 a[8:9], v226 offset:32768
  v_cvt_pk_bf16_f32 v197, v162, v163
  v_mfma_f32_16x16x32_bf16 v[136:139], a[16:19], a[232:235], v[136:139]
  ds_read_b128 a[124:127], v223 offset:57600
  ds_read_b64_tr_b16 a[10:11], v226 offset:40960
  v_cvt_pk_bf16_f32 v198, v168, v169
  v_add_f32 v214, v214, v160
  v_mfma_f32_16x16x32_bf16 v[64:67], a[32:35], v[204:207], v[64:67]
  v_exp_f32 v171, v171
  v_mfma_f32_16x16x32_bf16 v[68:71], a[32:35], v[208:211], v[68:71]
  ds_read_b64_tr_b16 a[12:13], v227 offset:32768
  v_cvt_pk_bf16_f32 v199, v170, v171
  v_mfma_f32_16x16x32_bf16 v[144:147], a[32:35], a[232:235], v[144:147]
  ds_read_b64_tr_b16 a[14:15], v227 offset:40960
  v_mfma_f32_16x16x32_bf16 v[96:99], a[48:51], v[204:207], v[96:99]
  v_exp_f32 v164, v164
  v_mfma_f32_16x16x32_bf16 v[100:103], a[48:51], v[208:211], v[100:103]
  ds_read_b64_tr_b16 a[20:21], v229 offset:32768
  v_add_f32 v214, v214, v161
  v_mfma_f32_16x16x32_bf16 v[152:155], a[48:51], a[232:235], v[152:155]
  ds_read_b64_tr_b16 a[22:23], v229 offset:40960
  ds_read_b64_tr_b16 a[24:25], v230 offset:32768
  v_add_f32 v214, v214, v162
  s_waitcnt lgkmcnt(6)
  ds_read_b64_tr_b16 a[26:27], v230 offset:40960
  ds_read_b64_tr_b16 a[28:29], v231 offset:32768
  ds_read_b64_tr_b16 a[30:31], v231 offset:40960
  ds_read_b64_tr_b16 a[36:37], v225 offset:33024
  ds_read_b64_tr_b16 a[38:39], v225 offset:41216
  v_add_f32 v214, v214, v163
  v_exp_f32 v165, v165
  s_nop 0
  v_cvt_pk_bf16_f32 v200, v164, v165
  v_add_f32 v214, v214, v168
  v_add_f32 v214, v214, v169
  v_exp_f32 v166, v166
  v_add_f32 v214, v214, v170
  v_mfma_f32_16x16x32_bf16 v[176:179], a[64:67], a[128:131], v[242:245]
  ds_read_b64_tr_b16 a[40:41], v226 offset:33024
  v_add_f32 v214, v214, v171
  v_mfma_f32_16x16x32_bf16 v[180:183], a[64:67], a[160:163], v[246:249]
  ds_read_b64_tr_b16 a[42:43], v226 offset:41216
  v_add_f32 v215, v215, v164
  v_mfma_f32_16x16x32_bf16 v[176:179], a[68:71], a[132:135], v[176:179]
  v_exp_f32 v167, v167
  v_mfma_f32_16x16x32_bf16 v[180:183], a[68:71], a[164:167], v[180:183]
  ds_read_b64_tr_b16 a[44:45], v227 offset:33024
  v_mfma_f32_16x16x32_bf16 v[176:179], a[72:75], a[136:139], v[176:179]
  ds_read_b64_tr_b16 a[46:47], v227 offset:41216
  v_mfma_f32_16x16x32_bf16 v[180:183], a[72:75], a[168:171], v[180:183]
  v_mfma_f32_16x16x32_bf16 v[176:179], a[76:79], a[140:143], v[176:179]
  ds_read_b64_tr_b16 a[52:53], v229 offset:33024
  v_mfma_f32_16x16x32_bf16 v[180:183], a[76:79], a[172:175], v[180:183]
  v_mfma_f32_16x16x32_bf16 v[176:179], a[80:83], a[144:147], v[176:179]
  ds_read_b64_tr_b16 a[54:55], v229 offset:41216
  v_mfma_f32_16x16x32_bf16 v[180:183], a[80:83], a[176:179], v[180:183]
  v_mfma_f32_16x16x32_bf16 v[176:179], a[84:87], a[148:151], v[176:179]
  v_mfma_f32_16x16x32_bf16 v[180:183], a[84:87], a[180:183], v[180:183]
  ds_read_b64_tr_b16 a[56:57], v230 offset:33024
  v_mfma_f32_16x16x32_bf16 v[176:179], a[88:91], a[152:155], v[176:179]
  v_mfma_f32_16x16x32_bf16 v[180:183], a[88:91], a[184:187], v[180:183]
  ds_read_b64_tr_b16 a[58:59], v230 offset:41216
  v_mfma_f32_16x16x32_bf16 v[176:179], a[92:95], a[156:159], v[176:179]
  ds_read_b64_tr_b16 a[60:61], v231 offset:33024
  v_cvt_pk_bf16_f32 v201, v166, v167
  v_mfma_f32_16x16x32_bf16 v[180:183], a[92:95], a[188:191], v[180:183]
  v_add_f32 v215, v215, v165
  v_mfma_f32_16x16x32_bf16 v[184:187], a[96:99], a[128:131], v[242:245]
  v_exp_f32 v172, v172
  v_mfma_f32_16x16x32_bf16 v[188:191], a[96:99], a[160:163], v[246:249]
  ds_read_b64_tr_b16 a[62:63], v231 offset:41216
  v_add_f32 v215, v215, v166
  v_mfma_f32_16x16x32_bf16 v[184:187], a[100:103], a[132:135], v[184:187]
  ds_read_b64_tr_b16 a[0:1], v224 offset:32768
  v_add_f32 v215, v215, v167
  v_mfma_f32_16x16x32_bf16 v[188:191], a[100:103], a[164:167], v[188:191]
  ds_read_b64_tr_b16 a[2:3], v224 offset:40960
  v_add_f32 v215, v215, v172
  v_mfma_f32_16x16x32_bf16 v[184:187], a[104:107], a[136:139], v[184:187]
  v_exp_f32 v173, v173
  v_mfma_f32_16x16x32_bf16 v[188:191], a[104:107], a[168:171], v[188:191]
  ds_read_b64_tr_b16 a[16:17], v228 offset:32768
  v_cvt_pk_bf16_f32 v202, v172, v173
  v_mfma_f32_16x16x32_bf16 v[184:187], a[108:111], a[140:143], v[184:187]
  ds_read_b64_tr_b16 a[18:19], v228 offset:40960
  v_add_f32 v215, v215, v173
  v_mfma_f32_16x16x32_bf16 v[188:191], a[108:111], a[172:175], v[188:191]
  ds_read_b64_tr_b16 a[32:33], v224 offset:33024
  v_mfma_f32_16x16x32_bf16 v[184:187], a[112:115], a[144:147], v[184:187]
  ds_read_b64_tr_b16 a[34:35], v224 offset:41216
  v_mfma_f32_16x16x32_bf16 v[188:191], a[112:115], a[176:179], v[188:191]
  ds_read_b64_tr_b16 a[48:49], v228 offset:33024
  v_mfma_f32_16x16x32_bf16 v[184:187], a[116:119], a[148:151], v[184:187]
  ds_read_b64_tr_b16 a[50:51], v228 offset:41216
  v_mfma_f32_16x16x32_bf16 v[188:191], a[116:119], a[180:183], v[188:191]
  v_exp_f32 v174, v174
  v_mfma_f32_16x16x32_bf16 v[184:187], a[120:123], a[152:155], v[184:187]
  v_mfma_f32_16x16x32_bf16 v[188:191], a[120:123], a[184:187], v[188:191]
  v_exp_f32 v175, v175
  v_mfma_f32_16x16x32_bf16 v[184:187], a[124:127], a[156:159], v[184:187]
  v_cvt_pk_bf16_f32 v203, v174, v175
  v_mfma_f32_16x16x32_bf16 v[188:191], a[124:127], a[188:191], v[188:191]
  v_add_f32 v215, v215, v174
  v_add_f32 v215, v215, v175
  s_waitcnt vmcnt(4) lgkmcnt(0)
  s_barrier
  v_mfma_f32_16x16x32_bf16 v[8:11], a[4:7], v[196:199], v[8:11]
  v_mul_f32 v176, s39, v176
  v_mfma_f32_16x16x32_bf16 v[12:15], a[4:7], v[200:203], v[12:15]
  ds_read_b64_tr_b16 a[4:5], v225 offset:49152
  v_exp_f32 v176, v176
  v_mfma_f32_16x16x32_bf16 v[16:19], a[8:11], v[196:199], v[16:19]
  ds_read_b64_tr_b16 a[6:7], v225 offset:57344
  v_mul_f32 v177, s39, v177
  v_mfma_f32_16x16x32_bf16 v[20:23], a[8:11], v[200:203], v[20:23]
  ds_read_b64_tr_b16 a[8:9], v226 offset:49152
  v_mfma_f32_16x16x32_bf16 v[24:27], a[12:15], v[196:199], v[24:27]
  ds_read_b64_tr_b16 a[10:11], v226 offset:57344
  v_mfma_f32_16x16x32_bf16 v[28:31], a[12:15], v[200:203], v[28:31]
  ds_read_b64_tr_b16 a[12:13], v227 offset:49152
  v_exp_f32 v177, v177
  v_mfma_f32_16x16x32_bf16 v[40:43], a[20:23], v[196:199], v[40:43]
  ds_read_b64_tr_b16 a[14:15], v227 offset:57344
  v_mul_f32 v178, s39, v178
  v_mfma_f32_16x16x32_bf16 v[44:47], a[20:23], v[200:203], v[44:47]
  ds_read_b64_tr_b16 a[20:21], v229 offset:49152
  v_mfma_f32_16x16x32_bf16 v[48:51], a[24:27], v[196:199], v[48:51]
  ds_read_b64_tr_b16 a[22:23], v229 offset:57344
  v_mul_f32 v179, s39, v179
  v_mfma_f32_16x16x32_bf16 v[52:55], a[24:27], v[200:203], v[52:55]
  ds_read_b64_tr_b16 a[24:25], v230 offset:49152
  v_exp_f32 v178, v178
  v_mfma_f32_16x16x32_bf16 v[56:59], a[28:31], v[196:199], v[56:59]
  ds_read_b64_tr_b16 a[26:27], v230 offset:57344
  v_mul_f32 v184, s39, v184
  v_mfma_f32_16x16x32_bf16 v[60:63], a[28:31], v[200:203], v[60:63]
  ds_read_b64_tr_b16 a[28:29], v231 offset:49152
  v_mul_f32 v185, s39, v185
  v_mfma_f32_16x16x32_bf16 v[72:75], a[36:39], v[196:199], v[72:75]
  ds_read_b64_tr_b16 a[30:31], v231 offset:57344
  v_mul_f32 v186, s39, v186
  v_mfma_f32_16x16x32_bf16 v[76:79], a[36:39], v[200:203], v[76:79]
  ds_read_b128 a[232:235], v241 offset:2048
  v_mul_f32 v187, s39, v187
  v_mfma_f32_16x16x32_bf16 v[80:83], a[40:43], v[196:199], v[80:83]
  ds_read_b64_tr_b16 a[36:37], v225 offset:49408
  v_exp_f32 v179, v179
  v_mfma_f32_16x16x32_bf16 v[84:87], a[40:43], v[200:203], v[84:87]
  ds_read_b64_tr_b16 a[38:39], v225 offset:57600
  v_mul_f32 v180, s39, v180
  v_mfma_f32_16x16x32_bf16 v[88:91], a[44:47], v[196:199], v[88:91]
  ds_read_b64_tr_b16 a[40:41], v226 offset:49408
  v_mfma_f32_16x16x32_bf16 v[92:95], a[44:47], v[200:203], v[92:95]
  ds_read_b64_tr_b16 a[42:43], v226 offset:57600
  v_mul_f32 v181, s39, v181
  v_mfma_f32_16x16x32_bf16 v[104:107], a[52:55], v[196:199], v[104:107]
  ds_read_b64_tr_b16 a[44:45], v227 offset:49408
  v_exp_f32 v184, v184
  v_mfma_f32_16x16x32_bf16 v[108:111], a[52:55], v[200:203], v[108:111]
  ds_read_b64_tr_b16 a[46:47], v227 offset:57600
  v_mul_f32 v182, s39, v182
  v_mfma_f32_16x16x32_bf16 v[112:115], a[56:59], v[196:199], v[112:115]
  ds_read_b64_tr_b16 a[52:53], v229 offset:49408
  v_mul_f32 v183, s39, v183
  v_mfma_f32_16x16x32_bf16 v[116:119], a[56:59], v[200:203], v[116:119]
  ds_read_b64_tr_b16 a[54:55], v229 offset:57600
  v_mul_f32 v188, s39, v188
  v_mfma_f32_16x16x32_bf16 v[120:123], a[60:63], v[196:199], v[120:123]
  ds_read_b64_tr_b16 a[56:57], v230 offset:49408
  v_mul_f32 v189, s39, v189
  v_mfma_f32_16x16x32_bf16 v[124:127], a[60:63], v[200:203], v[124:127]
  ds_read_b64_tr_b16 a[58:59], v230 offset:57600
  v_exp_f32 v185, v185
  v_mfma_f32_16x16x32_bf16 v[0:3], a[0:3], v[196:199], v[0:3]
  ds_read_b64_tr_b16 a[60:61], v231 offset:49408
  v_mul_f32 v190, s39, v190
  v_mfma_f32_16x16x32_bf16 v[4:7], a[0:3], v[200:203], v[4:7]
  ds_read_b64_tr_b16 a[62:63], v231 offset:57600
  v_mfma_f32_16x16x32_bf16 v[128:131], a[0:3], a[224:227], v[128:131]
  ds_read_b64_tr_b16 a[0:1], v224 offset:49152
  v_mul_f32 v191, s39, v191
  v_exp_f32 v186, v186
  v_mfma_f32_16x16x32_bf16 v[32:35], a[16:19], v[196:199], v[32:35]
  ds_read_b64_tr_b16 a[2:3], v224 offset:57344
  v_cvt_pk_bf16_f32 v204, v176, v177
  v_mfma_f32_16x16x32_bf16 v[36:39], a[16:19], v[200:203], v[36:39]
  v_cvt_pk_bf16_f32 v205, v178, v179
  v_mfma_f32_16x16x32_bf16 v[136:139], a[16:19], a[224:227], v[136:139]
  ds_read_b64_tr_b16 a[16:17], v228 offset:49152
  v_cvt_pk_bf16_f32 v206, v184, v185
  v_add_f32 v214, v214, v176
  v_mfma_f32_16x16x32_bf16 v[64:67], a[32:35], v[196:199], v[64:67]
  ds_read_b64_tr_b16 a[18:19], v228 offset:57344
  v_exp_f32 v187, v187
  v_mfma_f32_16x16x32_bf16 v[68:71], a[32:35], v[200:203], v[68:71]
  v_cvt_pk_bf16_f32 v207, v186, v187
  v_mfma_f32_16x16x32_bf16 v[144:147], a[32:35], a[224:227], v[144:147]
  ds_read_b64_tr_b16 a[32:33], v224 offset:49408
  v_mfma_f32_16x16x32_bf16 v[96:99], a[48:51], v[196:199], v[96:99]
  ds_read_b64_tr_b16 a[34:35], v224 offset:57600
  v_exp_f32 v180, v180
  v_mfma_f32_16x16x32_bf16 v[100:103], a[48:51], v[200:203], v[100:103]
  v_add_f32 v214, v214, v177
  v_mfma_f32_16x16x32_bf16 v[152:155], a[48:51], a[224:227], v[152:155]
  ds_read_b64_tr_b16 a[48:49], v228 offset:49408
  v_add_f32 v214, v214, v178
  s_waitcnt lgkmcnt(15)
  v_mfma_f32_16x16x32_bf16 v[8:11], a[4:7], v[204:207], v[8:11]
  ds_read_b64_tr_b16 a[50:51], v228 offset:57600
  v_mfma_f32_16x16x32_bf16 v[16:19], a[8:11], v[204:207], v[16:19]
  v_exp_f32 v181, v181
  v_mfma_f32_16x16x32_bf16 v[24:27], a[12:15], v[204:207], v[24:27]
  v_cvt_pk_bf16_f32 v208, v180, v181
  v_mfma_f32_16x16x32_bf16 v[40:43], a[20:23], v[204:207], v[40:43]
  v_exp_f32 v182, v182
  v_mfma_f32_16x16x32_bf16 v[48:51], a[24:27], v[204:207], v[48:51]
  v_exp_f32 v183, v183
  v_mfma_f32_16x16x32_bf16 v[56:59], a[28:31], v[204:207], v[56:59]
  v_cvt_pk_bf16_f32 v209, v182, v183
  v_mfma_f32_16x16x32_bf16 v[72:75], a[36:39], v[204:207], v[72:75]
  v_exp_f32 v188, v188
  v_mfma_f32_16x16x32_bf16 v[80:83], a[40:43], v[204:207], v[80:83]
  v_exp_f32 v189, v189
  s_waitcnt lgkmcnt(14)
  v_mfma_f32_16x16x32_bf16 v[88:91], a[44:47], v[204:207], v[88:91]
  v_cvt_pk_bf16_f32 v210, v188, v189
  s_waitcnt lgkmcnt(12)
  v_mfma_f32_16x16x32_bf16 v[104:107], a[52:55], v[204:207], v[104:107]
  v_exp_f32 v190, v190
  s_waitcnt lgkmcnt(10)
  v_mfma_f32_16x16x32_bf16 v[112:115], a[56:59], v[204:207], v[112:115]
  v_exp_f32 v191, v191
  s_waitcnt lgkmcnt(8)
  v_mfma_f32_16x16x32_bf16 v[120:123], a[60:63], v[204:207], v[120:123]
  v_cvt_pk_bf16_f32 v211, v190, v191
  v_add_f32 v214, v214, v179
  s_waitcnt lgkmcnt(6)
  v_mfma_f32_16x16x32_bf16 v[0:3], a[0:3], v[204:207], v[0:3]
  v_add_f32 v214, v214, v184
  v_add_f32 v214, v214, v185
  s_waitcnt lgkmcnt(4)
  v_mfma_f32_16x16x32_bf16 v[32:35], a[16:19], v[204:207], v[32:35]
  v_add_f32 v214, v214, v186
  v_add_f32 v214, v214, v187
  s_waitcnt lgkmcnt(2)
  v_mfma_f32_16x16x32_bf16 v[64:67], a[32:35], v[204:207], v[64:67]
  v_add_f32 v215, v215, v180
  v_add_f32 v215, v215, v181
  s_waitcnt lgkmcnt(0)
  v_mfma_f32_16x16x32_bf16 v[96:99], a[48:51], v[204:207], v[96:99]
  v_add_f32 v215, v215, v182
  v_add_f32 v215, v215, v183
  v_mfma_f32_16x16x32_bf16 v[12:15], a[4:7], v[208:211], v[12:15]
  v_add_f32 v215, v215, v188
  v_add_f32 v215, v215, v189
  v_mfma_f32_16x16x32_bf16 v[20:23], a[8:11], v[208:211], v[20:23]
  v_add_f32 v215, v215, v190
  v_add_f32 v215, v215, v191
  v_mfma_f32_16x16x32_bf16 v[28:31], a[12:15], v[208:211], v[28:31]
  v_mbcnt_lo_u32_b32 v250, -1, 0
  v_mbcnt_hi_u32_b32 v250, -1, v250
  v_mov_b32 v247, v214
  v_mov_b32 v248, v215
  v_mov_b32 v249, v216
  v_permlane32_swap_b32 v214, v247
  v_permlane32_swap_b32 v215, v248
  v_mfma_f32_16x16x32_bf16 v[44:47], a[20:23], v[208:211], v[44:47]
  v_permlane32_swap_b32 v216, v249
  v_add_f32 v214, v214, v247
  v_add_f32 v215, v215, v248
  v_add_f32 v216, v216, v249
  v_mov_b32 v247, v214
  v_mov_b32 v248, v215
  v_mov_b32 v249, v216
  v_mfma_f32_16x16x32_bf16 v[52:55], a[24:27], v[208:211], v[52:55]
  v_permlane16_swap_b32 v214, v247
  v_permlane16_swap_b32 v215, v248
  v_permlane16_swap_b32 v216, v249
  v_add_f32 v214, v214, v247
  v_add_f32 v215, v215, v248
  v_add_f32 v216, v216, v249
  v_and_b32 v253, 15, v250
  v_mfma_f32_16x16x32_bf16 v[60:63], a[28:31], v[208:211], v[60:63]
  v_lshrrev_b32 v254, 4, v250
  s_lshr_b32 s48, s16, 1
  s_lshl_b32 s48, s48, 7
  s_and_b32 s49, s16, 1
  s_lshl_b32 s49, s49, 6
  s_add_u32 s48, s48, s49
  s_add_u32 s48, s48, 135168
  v_mfma_f32_16x16x32_bf16 v[76:79], a[36:39], v[208:211], v[76:79]
  v_lshlrev_b32 v242, 2, v253
  v_max3_f32 v244, v214, v215, v216
  v_add_u32 v243, s48, v242
  v_cmp_lt_f32 vcc, s42, v244
  ds_write_b32 v243, v216
  v_rcp_f32 v214, v214
  v_rcp_f32 v215, v215
  v_mfma_f32_16x16x32_bf16 v[84:87], a[40:43], v[208:211], v[84:87]
  s_lshl_b32 s51, s16, 2
  s_add_u32 s51, s51, 135424
  v_mov_b32 v244, s51
  s_cmp_lg_u64 vcc, 0
  s_cselect_b32 s50, 1, 0
  v_mov_b32 v243, s50
  ds_write_b32 v244, v243
  v_mfma_f32_16x16x32_bf16 v[92:95], a[44:47], v[208:211], v[92:95]
  v_and_b32 v246, 1, v254
  v_lshlrev_b32 v246, 1, v246
  v_lshrrev_b32 v247, 1, v254
  v_xor_b32 v248, v246, v247
  s_lshl_b32 s48, s16, 1
  v_xor_b32 v248, s48, v248
  v_xor_b32 v248, v248, v253
  v_mfma_f32_16x16x32_bf16 v[108:111], a[52:55], v[208:211], v[108:111]
  v_lshlrev_b32 v249, 9, v253
  s_lshl_b32 s49, s16, 14
  v_add_u32 v245, s49, v249
  s_waitcnt vmcnt(0) lgkmcnt(0)
  s_barrier
  v_add_u32 v242, 135168, v242
  ds_read_b32 v217, v242
  v_mfma_f32_16x16x32_bf16 v[116:119], a[56:59], v[208:211], v[116:119]
  ds_read_b32 v218, v242 offset:64
  ds_read_b32 v219, v242 offset:128
  ds_read_b32 v212, v242 offset:192
  v_mov_b32 v243, 135424
  ds_read_b128 v[196:199], v243
  v_xor_b32 v244, 0, v248
  v_lshl_add_u32 v160, v244, 4, v245
  v_mfma_f32_16x16x32_bf16 v[124:127], a[60:63], v[208:211], v[124:127]
  v_xor_b32 v244, 4, v248
  v_lshl_add_u32 v161, v244, 4, v245
  v_xor_b32 v244, 8, v248
  v_lshl_add_u32 v162, v244, 4, v245
  v_xor_b32 v244, 12, v248
  v_lshl_add_u32 v163, v244, 4, v245
  v_lshlrev_b32 v246, 2, v246
  v_mfma_f32_16x16x32_bf16 v[4:7], a[0:3], v[208:211], v[4:7]
  v_add_u32 v246, v246, v247
  v_add_u32 v246, s48, v246
  v_xor_b32 v246, v246, v253
  v_lshl_add_u32 v164, v246, 4, v249
  v_add_u32 v164, 65536, v164
  v_and_b32 v251, 31, v250
  v_lshrrev_b32 v252, 5, v250
  v_mfma_f32_16x16x32_bf16 v[128:131], a[0:3], a[232:235], v[128:131]
  v_lshlrev_b32 v245, 9, v252
  v_add_u32 v245, s49, v245
  v_add_u32 v244, 0, v252
  v_xor_b32 v244, v244, v251
  v_lshl_add_u32 v176, v244, 4, v245
  v_add_u32 v244, 2, v252
  v_xor_b32 v244, v244, v251
  v_mfma_f32_16x16x32_bf16 v[36:39], a[16:19], v[208:211], v[36:39]
  v_lshl_add_u32 v177, v244, 4, v245
  v_add_u32 v244, 4, v252
  v_xor_b32 v244, v244, v251
  v_lshl_add_u32 v178, v244, 4, v245
  v_add_u32 v244, 6, v252
  v_xor_b32 v244, v244, v251
  v_lshl_add_u32 v179, v244, 4, v245
  v_mfma_f32_16x16x32_bf16 v[136:139], a[16:19], a[232:235], v[136:139]
  v_add_u32 v244, 8, v252
  v_xor_b32 v244, v244, v251
  v_lshl_add_u32 v180, v244, 4, v245
  v_add_u32 v244, 10, v252
  v_xor_b32 v244, v244, v251
  v_lshl_add_u32 v181, v244, 4, v245
  v_add_u32 v244, 12, v252
  v_mfma_f32_16x16x32_bf16 v[68:71], a[32:35], v[208:211], v[68:71]
  v_xor_b32 v244, v244, v251
  v_lshl_add_u32 v182, v244, 4, v245
  v_add_u32 v244, 14, v252
  v_xor_b32 v244, v244, v251
  v_lshl_add_u32 v183, v244, 4, v245
  v_lshlrev_b32 v249, 4, v250
  v_add_u32 v248, s49, v249
  v_mfma_f32_16x16x32_bf16 v[144:147], a[32:35], a[232:235], v[144:147]
  s_waitcnt lgkmcnt(0)
  v_or_b32 v196, v196, v197
  v_add_f32 v200, v217, v218
  v_or3_b32 v196, v196, v198, v199
  v_add_f32 v201, v219, v212
  v_readfirstlane_b32 s54, v196
  v_rcp_f32 v200, v200
  v_mfma_f32_16x16x32_bf16 v[100:103], a[48:51], v[208:211], v[100:103]
  v_rcp_f32 v201, v201
  v_mfma_f32_16x16x32_bf16 v[152:155], a[48:51], a[232:235], v[152:155]
L_epi:
  s_cmp_lg_u32 s41, 0
  s_cbranch_scc1 L_final
  s_cmp_lg_u32 s54, 0
  s_cbranch_scc1 L_maxpass
L_final:
  s_nop 3
  v_pk_mul_f32 v[16:17], v[16:17], v[214:215] op_sel_hi:[1,0]
  v_pk_mul_f32 v[18:19], v[18:19], v[214:215] op_sel_hi:[1,0]
  v_pk_mul_f32 v[24:25], v[24:25], v[214:215] op_sel_hi:[1,0]
  v_pk_mul_f32 v[26:27], v[26:27], v[214:215] op_sel_hi:[1,0]
  v_cvt_pk_bf16_f32 v16, v16, v17
  v_cvt_pk_bf16_f32 v17, v18, v19
  v_cvt_pk_bf16_f32 v18, v24, v25
  v_cvt_pk_bf16_f32 v19, v26, v27
  v_pk_mul_f32 v[48:49], v[48:49], v[214:215] op_sel_hi:[1,0]
  v_pk_mul_f32 v[50:51], v[50:51], v[214:215] op_sel_hi:[1,0]
  v_pk_mul_f32 v[56:57], v[56:57], v[214:215] op_sel_hi:[1,0]
  v_pk_mul_f32 v[58:59], v[58:59], v[214:215] op_sel_hi:[1,0]
  v_cvt_pk_bf16_f32 v48, v48, v49
  v_cvt_pk_bf16_f32 v49, v50, v51
  v_cvt_pk_bf16_f32 v50, v56, v57
  v_cvt_pk_bf16_f32 v51, v58, v59
  v_permlane16_swap_b32 v16, v18
  v_permlane16_swap_b32 v17, v19
  ds_write_b128 v161, v[16:19] offset:0
  v_pk_mul_f32 v[80:81], v[80:81], v[214:215] op_sel_hi:[1,0]
  v_pk_mul_f32 v[82:83], v[82:83], v[214:215] op_sel_hi:[1,0]
  v_pk_mul_f32 v[88:89], v[88:89], v[214:215] op_sel_hi:[1,0]
  v_pk_mul_f32 v[90:91], v[90:91], v[214:215] op_sel_hi:[1,0]
  v_cvt_pk_bf16_f32 v80, v80, v81
  v_cvt_pk_bf16_f32 v81, v82, v83
  v_cvt_pk_bf16_f32 v82, v88, v89
  v_cvt_pk_bf16_f32 v83, v90, v91
  v_permlane16_swap_b32 v48, v50
  v_permlane16_swap_b32 v49, v51
  ds_write_b128 v163, v[48:51] offset:0
  v_pk_mul_f32 v[112:113], v[112:113], v[214:215] op_sel_hi:[1,0]
  v_pk_mul_f32 v[114:115], v[114:115], v[214:215] op_sel_hi:[1,0]
  v_pk_mul_f32 v[120:121], v[120:121], v[214:215] op_sel_hi:[1,0]
  v_pk_mul_f32 v[122:123], v[122:123], v[214:215] op_sel_hi:[1,0]
  v_cvt_pk_bf16_f32 v112, v112, v113
  v_cvt_pk_bf16_f32 v113, v114, v115
  v_cvt_pk_bf16_f32 v114, v120, v121
  v_cvt_pk_bf16_f32 v115, v122, v123
  v_permlane16_swap_b32 v80, v82
  v_permlane16_swap_b32 v81, v83
  ds_write_b128 v161, v[80:83] offset:256
  v_pk_mul_f32 v[0:1], v[0:1], v[214:215] op_sel_hi:[1,0]
  v_pk_mul_f32 v[2:3], v[2:3], v[214:215] op_sel_hi:[1,0]
  v_pk_mul_f32 v[8:9], v[8:9], v[214:215] op_sel_hi:[1,0]
  v_pk_mul_f32 v[10:11], v[10:11], v[214:215] op_sel_hi:[1,0]
  v_cvt_pk_bf16_f32 v0, v0, v1
  v_cvt_pk_bf16_f32 v1, v2, v3
  v_cvt_pk_bf16_f32 v2, v8, v9
  v_cvt_pk_bf16_f32 v3, v10, v11
  v_permlane16_swap_b32 v112, v114
  v_permlane16_swap_b32 v113, v115
  ds_write_b128 v163, v[112:115] offset:256
  v_pk_mul_f32 v[32:33], v[32:33], v[214:215] op_sel_hi:[1,0]
  v_pk_mul_f32 v[34:35], v[34:35], v[214:215] op_sel_hi:[1,0]
  v_pk_mul_f32 v[40:41], v[40:41], v[214:215] op_sel_hi:[1,0]
  v_pk_mul_f32 v[42:43], v[42:43], v[214:215] op_sel_hi:[1,0]
  v_cvt_pk_bf16_f32 v32, v32, v33
  v_cvt_pk_bf16_f32 v33, v34, v35
  v_cvt_pk_bf16_f32 v34, v40, v41
  v_cvt_pk_bf16_f32 v35, v42, v43
  v_permlane16_swap_b32 v0, v2
  v_permlane16_swap_b32 v1, v3
  ds_write_b128 v160, v[0:3] offset:0
  v_pk_mul_f32 v[64:65], v[64:65], v[214:215] op_sel_hi:[1,0]
  v_pk_mul_f32 v[66:67], v[66:67], v[214:215] op_sel_hi:[1,0]
  v_pk_mul_f32 v[72:73], v[72:73], v[214:215] op_sel_hi:[1,0]
  v_pk_mul_f32 v[74:75], v[74:75], v[214:215] op_sel_hi:[1,0]
  v_cvt_pk_bf16_f32 v64, v64, v65
  v_cvt_pk_bf16_f32 v65, v66, v67
  v_cvt_pk_bf16_f32 v66, v72, v73
  v_cvt_pk_bf16_f32 v67, v74, v75
  v_permlane16_swap_b32 v32, v34
  v_permlane16_swap_b32 v33, v35
  ds_write_b128 v162, v[32:35] offset:0
  v_pk_mul_f32 v[96:97], v[96:97], v[214:215] op_sel_hi:[1,0]
  v_pk_mul_f32 v[98:99], v[98:99], v[214:215] op_sel_hi:[1,0]
  v_pk_mul_f32 v[104:105], v[104:105], v[214:215] op_sel_hi:[1,0]
  v_pk_mul_f32 v[106:107], v[106:107], v[214:215] op_sel_hi:[1,0]
  v_cvt_pk_bf16_f32 v96, v96, v97
  v_cvt_pk_bf16_f32 v97, v98, v99
  v_cvt_pk_bf16_f32 v98, v104, v105
  v_cvt_pk_bf16_f32 v99, v106, v107
  v_permlane16_swap_b32 v64, v66
  v_permlane16_swap_b32 v65, v67
  ds_write_b128 v160, v[64:67] offset:256
  v_pk_mul_f32 v[20:21], v[20:21], v[214:215] op_sel:[0,1] op_sel_hi:[1,1]
  v_pk_mul_f32 v[22:23], v[22:23], v[214:215] op_sel:[0,1] op_sel_hi:[1,1]
  v_pk_mul_f32 v[28:29], v[28:29], v[214:215] op_sel:[0,1] op_sel_hi:[1,1]
  v_pk_mul_f32 v[30:31], v[30:31], v[214:215] op_sel:[0,1] op_sel_hi:[1,1]
  v_cvt_pk_bf16_f32 v20, v20, v21
  v_cvt_pk_bf16_f32 v21, v22, v23
  v_cvt_pk_bf16_f32 v22, v28, v29
  v_cvt_pk_bf16_f32 v23, v30, v31
  v_permlane16_swap_b32 v96, v98
  v_permlane16_swap_b32 v97, v99
  ds_write_b128 v162, v[96:99] offset:256
  s_waitcnt lgkmcnt(0)
  ds_read_b128 a[64:67], v248 offset:0
  ds_read_b128 a[68:71], v248 offset:1024
  ds_read_b128 a[72:75], v248 offset:2048
  ds_read_b128 a[76:79], v248 offset:3072
  ds_read_b128 a[80:83], v248 offset:4096
  ds_read_b128 a[84:87], v248 offset:5120
  ds_read_b128 a[88:91], v248 offset:6144
  ds_read_b128 a[92:95], v248 offset:7168
  v_pk_mul_f32 v[52:53], v[52:53], v[214:215] op_sel:[0,1] op_sel_hi:[1,1]
  v_pk_mul_f32 v[54:55], v[54:55], v[214:215] op_sel:[0,1] op_sel_hi:[1,1]
  v_pk_mul_f32 v[60:61], v[60:61], v[214:215] op_sel:[0,1] op_sel_hi:[1,1]
  v_pk_mul_f32 v[62:63], v[62:63], v[214:215] op_sel:[0,1] op_sel_hi:[1,1]
  v_cvt_pk_bf16_f32 v52, v52, v53
  v_cvt_pk_bf16_f32 v53, v54, v55
  v_cvt_pk_bf16_f32 v54, v60, v61
  v_cvt_pk_bf16_f32 v55, v62, v63
  v_permlane16_swap_b32 v20, v22
  v_permlane16_swap_b32 v21, v23
  ds_write_b128 v161, v[20:23] offset:8192
  v_pk_mul_f32 v[84:85], v[84:85], v[214:215] op_sel:[0,1] op_sel_hi:[1,1]
  v_pk_mul_f32 v[86:87], v[86:87], v[214:215] op_sel:[0,1] op_sel_hi:[1,1]
  v_pk_mul_f32 v[92:93], v[92:93], v[214:215] op_sel:[0,1] op_sel_hi:[1,1]
  v_pk_mul_f32 v[94:95], v[94:95], v[214:215] op_sel:[0,1] op_sel_hi:[1,1]
  v_cvt_pk_bf16_f32 v84, v84, v85
  v_cvt_pk_bf16_f32 v85, v86, v87
  v_cvt_pk_bf16_f32 v86, v92, v93
  v_cvt_pk_bf16_f32 v87, v94, v95
  v_permlane16_swap_b32 v52, v54
  v_permlane16_swap_b32 v53, v55
  ds_write_b128 v163, v[52:55] offset:8192
  s_waitcnt lgkmcnt(9)
  s_mov_b32 s48, 0
  buffer_store_dwordx4 a[64:67], v176, s[32:35], s48 offen offset:0 nt
  v_pk_mul_f32 v[116:117], v[116:117], v[214:215] op_sel:[0,1] op_sel_hi:[1,1]
  v_pk_mul_f32 v[118:119], v[118:119], v[214:215] op_sel:[0,1] op_sel_hi:[1,1]
  v_pk_mul_f32 v[124:125], v[124:125], v[214:215] op_sel:[0,1] op_sel_hi:[1,1]
  v_pk_mul_f32 v[126:127], v[126:127], v[214:215] op_sel:[0,1] op_sel_hi:[1,1]
  v_cvt_pk_bf16_f32 v116, v116, v117
  v_cvt_pk_bf16_f32 v117, v118, v119
  v_cvt_pk_bf16_f32 v118, v124, v125
  v_cvt_pk_bf16_f32 v119, v126, v127
  v_permlane16_swap_b32 v84, v86
  v_permlane16_swap_b32 v85, v87
  ds_write_b128 v161, v[84:87] offset:8448
  s_waitcnt lgkmcnt(9)
  buffer_store_dwordx4 a[68:71], v177, s[32:35], s48 offen offset:1024 nt
  v_pk_mul_f32 v[4:5], v[4:5], v[214:215] op_sel:[0,1] op_sel_hi:[1,1]
  v_pk_mul_f32 v[6:7], v[6:7], v[214:215] op_sel:[0,1] op_sel_hi:[1,1]
  v_pk_mul_f32 v[12:13], v[12:13], v[214:215] op_sel:[0,1] op_sel_hi:[1,1]
  v_pk_mul_f32 v[14:15], v[14:15], v[214:215] op_sel:[0,1] op_sel_hi:[1,1]
  v_cvt_pk_bf16_f32 v4, v4, v5
  v_cvt_pk_bf16_f32 v5, v6, v7
  v_cvt_pk_bf16_f32 v6, v12, v13
  v_cvt_pk_bf16_f32 v7, v14, v15
  v_permlane16_swap_b32 v116, v118
  v_permlane16_swap_b32 v117, v119
  ds_write_b128 v163, v[116:119] offset:8448
  s_waitcnt lgkmcnt(9)
  buffer_store_dwordx4 a[72:75], v178, s[32:35], s48 offen offset:2048 nt
  v_pk_mul_f32 v[36:37], v[36:37], v[214:215] op_sel:[0,1] op_sel_hi:[1,1]
  v_pk_mul_f32 v[38:39], v[38:39], v[214:215] op_sel:[0,1] op_sel_hi:[1,1]
  v_pk_mul_f32 v[44:45], v[44:45], v[214:215] op_sel:[0,1] op_sel_hi:[1,1]
  v_pk_mul_f32 v[46:47], v[46:47], v[214:215] op_sel:[0,1] op_sel_hi:[1,1]
  v_cvt_pk_bf16_f32 v36, v36, v37
  v_cvt_pk_bf16_f32 v37, v38, v39
  v_cvt_pk_bf16_f32 v38, v44, v45
  v_cvt_pk_bf16_f32 v39, v46, v47
  v_permlane16_swap_b32 v4, v6
  v_permlane16_swap_b32 v5, v7
  ds_write_b128 v160, v[4:7] offset:8192
  s_waitcnt lgkmcnt(9)
  buffer_store_dwordx4 a[76:79], v179, s[32:35], s48 offen offset:3072 nt
  v_pk_mul_f32 v[68:69], v[68:69], v[214:215] op_sel:[0,1] op_sel_hi:[1,1]
  v_pk_mul_f32 v[70:71], v[70:71], v[214:215] op_sel:[0,1] op_sel_hi:[1,1]
  v_pk_mul_f32 v[76:77], v[76:77], v[214:215] op_sel:[0,1] op_sel_hi:[1,1]
  v_pk_mul_f32 v[78:79], v[78:79], v[214:215] op_sel:[0,1] op_sel_hi:[1,1]
  v_cvt_pk_bf16_f32 v68, v68, v69
  v_cvt_pk_bf16_f32 v69, v70, v71
  v_cvt_pk_bf16_f32 v70, v76, v77
  v_cvt_pk_bf16_f32 v71, v78, v79
  v_permlane16_swap_b32 v36, v38
  v_permlane16_swap_b32 v37, v39
  ds_write_b128 v162, v[36:39] offset:8192
  s_waitcnt lgkmcnt(9)
  s_mov_b32 s48, 4096
  buffer_store_dwordx4 a[80:83], v180, s[32:35], s48 offen offset:0 nt
  v_pk_mul_f32 v[100:101], v[100:101], v[214:215] op_sel:[0,1] op_sel_hi:[1,1]
  v_pk_mul_f32 v[102:103], v[102:103], v[214:215] op_sel:[0,1] op_sel_hi:[1,1]
  v_pk_mul_f32 v[108:109], v[108:109], v[214:215] op_sel:[0,1] op_sel_hi:[1,1]
  v_pk_mul_f32 v[110:111], v[110:111], v[214:215] op_sel:[0,1] op_sel_hi:[1,1]
  v_cvt_pk_bf16_f32 v100, v100, v101
  v_cvt_pk_bf16_f32 v101, v102, v103
  v_cvt_pk_bf16_f32 v102, v108, v109
  v_cvt_pk_bf16_f32 v103, v110, v111
  v_permlane16_swap_b32 v68, v70
  v_permlane16_swap_b32 v69, v71
  ds_write_b128 v160, v[68:71] offset:8448
  s_waitcnt lgkmcnt(9)
  buffer_store_dwordx4 a[84:87], v181, s[32:35], s48 offen offset:1024 nt
  s_waitcnt lgkmcnt(8)
  buffer_store_dwordx4 a[88:91], v182, s[32:35], s48 offen offset:2048 nt
  s_waitcnt lgkmcnt(7)
  buffer_store_dwordx4 a[92:95], v183, s[32:35], s48 offen offset:3072 nt
  v_pk_mul_f32 v[128:129], v[128:129], v[200:201] op_sel_hi:[1,0]
  v_pk_mul_f32 v[130:131], v[130:131], v[200:201] op_sel_hi:[1,0]
  v_pk_mul_f32 v[136:137], v[136:137], v[200:201] op_sel_hi:[1,0]
  v_pk_mul_f32 v[138:139], v[138:139], v[200:201] op_sel_hi:[1,0]
  v_cvt_pk_bf16_f32 v128, v128, v129
  v_cvt_pk_bf16_f32 v129, v130, v131
  v_cvt_pk_bf16_f32 v130, v136, v137
  v_cvt_pk_bf16_f32 v131, v138, v139
  v_permlane16_swap_b32 v100, v102
  v_permlane16_swap_b32 v101, v103
  ds_write_b128 v162, v[100:103] offset:8448
  s_waitcnt lgkmcnt(0)
  ds_read_b128 a[96:99], v248 offset:8192
  ds_read_b128 a[100:103], v248 offset:9216
  ds_read_b128 a[104:107], v248 offset:10240
  ds_read_b128 a[108:111], v248 offset:11264
  ds_read_b128 a[112:115], v248 offset:12288
  ds_read_b128 a[116:119], v248 offset:13312
  ds_read_b128 a[120:123], v248 offset:14336
  ds_read_b128 a[124:127], v248 offset:15360
  v_pk_mul_f32 v[144:145], v[144:145], v[200:201] op_sel_hi:[1,0]
  v_pk_mul_f32 v[146:147], v[146:147], v[200:201] op_sel_hi:[1,0]
  v_pk_mul_f32 v[152:153], v[152:153], v[200:201] op_sel_hi:[1,0]
  v_pk_mul_f32 v[154:155], v[154:155], v[200:201] op_sel_hi:[1,0]
  v_cvt_pk_bf16_f32 v144, v144, v145
  v_cvt_pk_bf16_f32 v145, v146, v147
  v_cvt_pk_bf16_f32 v146, v152, v153
  v_cvt_pk_bf16_f32 v147, v154, v155
  v_permlane16_swap_b32 v128, v130
  v_permlane16_swap_b32 v129, v131
  ds_write_b128 v164, v[128:131] offset:0
  s_waitcnt lgkmcnt(8)
  s_mov_b32 s48, 8192
  buffer_store_dwordx4 a[96:99], v176, s[32:35], s48 offen offset:0 nt
  s_waitcnt lgkmcnt(7)
  buffer_store_dwordx4 a[100:103], v177, s[32:35], s48 offen offset:1024 nt
  v_pk_mul_f32 v[132:133], v[132:133], v[200:201] op_sel:[0,1] op_sel_hi:[1,1]
  v_pk_mul_f32 v[134:135], v[134:135], v[200:201] op_sel:[0,1] op_sel_hi:[1,1]
  v_pk_mul_f32 v[140:141], v[140:141], v[200:201] op_sel:[0,1] op_sel_hi:[1,1]
  v_pk_mul_f32 v[142:143], v[142:143], v[200:201] op_sel:[0,1] op_sel_hi:[1,1]
  v_cvt_pk_bf16_f32 v132, v132, v133
  v_cvt_pk_bf16_f32 v133, v134, v135
  v_cvt_pk_bf16_f32 v134, v140, v141
  v_cvt_pk_bf16_f32 v135, v142, v143
  v_permlane16_swap_b32 v144, v146
  v_permlane16_swap_b32 v145, v147
  ds_write_b128 v164, v[144:147] offset:256
  s_waitcnt lgkmcnt(7)
  buffer_store_dwordx4 a[104:107], v178, s[32:35], s48 offen offset:2048 nt
  s_waitcnt lgkmcnt(6)
  buffer_store_dwordx4 a[108:111], v179, s[32:35], s48 offen offset:3072 nt
  v_pk_mul_f32 v[148:149], v[148:149], v[200:201] op_sel:[0,1] op_sel_hi:[1,1]
  v_pk_mul_f32 v[150:151], v[150:151], v[200:201] op_sel:[0,1] op_sel_hi:[1,1]
  v_pk_mul_f32 v[156:157], v[156:157], v[200:201] op_sel:[0,1] op_sel_hi:[1,1]
  v_pk_mul_f32 v[158:159], v[158:159], v[200:201] op_sel:[0,1] op_sel_hi:[1,1]
  v_cvt_pk_bf16_f32 v148, v148, v149
  v_cvt_pk_bf16_f32 v149, v150, v151
  v_cvt_pk_bf16_f32 v150, v156, v157
  v_cvt_pk_bf16_f32 v151, v158, v159
  v_permlane16_swap_b32 v132, v134
  v_permlane16_swap_b32 v133, v135
  ds_write_b128 v164, v[132:135] offset:8192
  s_waitcnt lgkmcnt(6)
  s_mov_b32 s48, 12288
  buffer_store_dwordx4 a[112:115], v180, s[32:35], s48 offen offset:0 nt
  s_waitcnt lgkmcnt(5)
  buffer_store_dwordx4 a[116:119], v181, s[32:35], s48 offen offset:1024 nt
  s_nop 1
  v_permlane16_swap_b32 v148, v150
  v_permlane16_swap_b32 v149, v151
  ds_write_b128 v164, v[148:151] offset:8448
  s_waitcnt lgkmcnt(5)
  buffer_store_dwordx4 a[120:123], v182, s[32:35], s48 offen offset:2048 nt
  s_waitcnt lgkmcnt(4)
  buffer_store_dwordx4 a[124:127], v183, s[32:35], s48 offen offset:3072 nt
  v_add_u32 v243, s38, v249
  v_add_u32 v243, 65536, v243
  s_waitcnt lgkmcnt(0)
  s_barrier
  ds_read_b128 v[64:67], v243 offset:0
  ds_read_b128 v[68:71], v243 offset:1024
  ds_read_b128 v[72:75], v243 offset:2048
  ds_read_b128 v[76:79], v243 offset:3072
  s_mov_b32 s48, 65536
  s_waitcnt lgkmcnt(3)
  buffer_store_dwordx4 v[64:67], v232, s[32:35], s48 offen offset:0 nt
  s_waitcnt lgkmcnt(2)
  buffer_store_dwordx4 v[68:71], v233, s[32:35], s48 offen offset:1024 nt
  s_waitcnt lgkmcnt(1)
  buffer_store_dwordx4 v[72:75], v234, s[32:35], s48 offen offset:2048 nt
  s_waitcnt lgkmcnt(0)
  buffer_store_dwordx4 v[76:79], v235, s[32:35], s48 offen offset:3072 nt
  s_endpgm
L_maxpass:
  s_mov_b32 s41, 1
  v_mov_b32 v217, 0xff800000
  v_mov_b32 v218, 0xff800000
  v_mov_b32 v219, 0xff800000
  s_mov_b32 s36, 0
L_maxloop:
  s_barrier
  s_add_u32 m0, s38, 0
  s_nop 0
  buffer_load_dwordx4 v232, s[20:23], s36 offen offset:0 nt lds
  buffer_load_dwordx4 v233, s[20:23], s36 offen offset:1024 nt lds
  buffer_load_dwordx4 v234, s[20:23], s36 offen offset:2048 nt lds
  buffer_load_dwordx4 v235, s[20:23], s36 offen offset:3072 nt lds
  s_waitcnt vmcnt(0)
  s_barrier
  ds_read_b128 a[64:67], v220 offset:0
  ds_read_b128 a[68:71], v221 offset:0
  ds_read_b128 a[72:75], v222 offset:0
  ds_read_b128 a[76:79], v223 offset:0
  ds_read_b128 a[80:83], v220 offset:256
  ds_read_b128 a[84:87], v221 offset:256
  ds_read_b128 a[88:91], v222 offset:256
  ds_read_b128 a[92:95], v223 offset:256
  ds_read_b128 a[96:99], v220 offset:8192
  ds_read_b128 a[100:103], v221 offset:8192
  ds_read_b128 a[104:107], v222 offset:8192
  ds_read_b128 a[108:111], v223 offset:8192
  ds_read_b128 a[112:115], v220 offset:8448
  ds_read_b128 a[116:119], v221 offset:8448
  ds_read_b128 a[120:123], v222 offset:8448
  ds_read_b128 a[124:127], v223 offset:8448
  s_waitcnt lgkmcnt(0)
  v_mfma_f32_16x16x32_bf16 v[160:163], a[64:67], a[128:131], 0
  v_mfma_f32_16x16x32_bf16 v[164:167], a[64:67], a[160:163], 0
  v_mfma_f32_16x16x32_bf16 v[192:195], a[64:67], a[192:195], 0
  v_mfma_f32_16x16x32_bf16 v[160:163], a[68:71], a[132:135], v[160:163]
  v_mfma_f32_16x16x32_bf16 v[164:167], a[68:71], a[164:167], v[164:167]
  v_mfma_f32_16x16x32_bf16 v[192:195], a[68:71], a[196:199], v[192:195]
  v_mfma_f32_16x16x32_bf16 v[160:163], a[72:75], a[136:139], v[160:163]
  v_mfma_f32_16x16x32_bf16 v[164:167], a[72:75], a[168:171], v[164:167]
  v_mfma_f32_16x16x32_bf16 v[192:195], a[72:75], a[200:203], v[192:195]
  v_mfma_f32_16x16x32_bf16 v[160:163], a[76:79], a[140:143], v[160:163]
  v_mfma_f32_16x16x32_bf16 v[164:167], a[76:79], a[172:175], v[164:167]
  v_mfma_f32_16x16x32_bf16 v[192:195], a[76:79], a[204:207], v[192:195]
  v_mfma_f32_16x16x32_bf16 v[160:163], a[80:83], a[144:147], v[160:163]
  v_mfma_f32_16x16x32_bf16 v[164:167], a[80:83], a[176:179], v[164:167]
  v_mfma_f32_16x16x32_bf16 v[192:195], a[80:83], a[208:211], v[192:195]
  v_mfma_f32_16x16x32_bf16 v[160:163], a[84:87], a[148:151], v[160:163]
  v_mfma_f32_16x16x32_bf16 v[164:167], a[84:87], a[180:183], v[164:167]
  v_mfma_f32_16x16x32_bf16 v[192:195], a[84:87], a[212:215], v[192:195]
  v_mfma_f32_16x16x32_bf16 v[160:163], a[88:91], a[152:155], v[160:163]
  v_mfma_f32_16x16x32_bf16 v[164:167], a[88:91], a[184:187], v[164:167]
  v_mfma_f32_16x16x32_bf16 v[192:195], a[88:91], a[216:219], v[192:195]
  v_mfma_f32_16x16x32_bf16 v[160:163], a[92:95], a[156:159], v[160:163]
  v_mfma_f32_16x16x32_bf16 v[164:167], a[92:95], a[188:191], v[164:167]
  v_mfma_f32_16x16x32_bf16 v[192:195], a[92:95], a[220:223], v[192:195]
  v_mfma_f32_16x16x32_bf16 v[168:171], a[96:99], a[128:131], 0
  v_mfma_f32_16x16x32_bf16 v[172:175], a[96:99], a[160:163], 0
  v_mfma_f32_16x16x32_bf16 v[196:199], a[96:99], a[192:195], 0
  v_mfma_f32_16x16x32_bf16 v[168:171], a[100:103], a[132:135], v[168:171]
  v_mfma_f32_16x16x32_bf16 v[172:175], a[100:103], a[164:167], v[172:175]
  v_mfma_f32_16x16x32_bf16 v[196:199], a[100:103], a[196:199], v[196:199]
  v_mfma_f32_16x16x32_bf16 v[168:171], a[104:107], a[136:139], v[168:171]
  v_mfma_f32_16x16x32_bf16 v[172:175], a[104:107], a[168:171], v[172:175]
  v_mfma_f32_16x16x32_bf16 v[196:199], a[104:107], a[200:203], v[196:199]
  v_mfma_f32_16x16x32_bf16 v[168:171], a[108:111], a[140:143], v[168:171]
  v_mfma_f32_16x16x32_bf16 v[172:175], a[108:111], a[172:175], v[172:175]
  v_mfma_f32_16x16x32_bf16 v[196:199], a[108:111], a[204:207], v[196:199]
  v_mfma_f32_16x16x32_bf16 v[168:171], a[112:115], a[144:147], v[168:171]
  v_mfma_f32_16x16x32_bf16 v[172:175], a[112:115], a[176:179], v[172:175]
  v_mfma_f32_16x16x32_bf16 v[196:199], a[112:115], a[208:211], v[196:199]
  v_mfma_f32_16x16x32_bf16 v[168:171], a[116:119], a[148:151], v[168:171]
  v_mfma_f32_16x16x32_bf16 v[172:175], a[116:119], a[180:183], v[172:175]
  v_mfma_f32_16x16x32_bf16 v[196:199], a[116:119], a[212:215], v[196:199]
  v_mfma_f32_16x16x32_bf16 v[168:171], a[120:123], a[152:155], v[168:171]
  v_mfma_f32_16x16x32_bf16 v[172:175], a[120:123], a[184:187], v[172:175]
  v_mfma_f32_16x16x32_bf16 v[196:199], a[120:123], a[216:219], v[196:199]
  v_mfma_f32_16x16x32_bf16 v[168:171], a[124:127], a[156:159], v[168:171]
  v_mfma_f32_16x16x32_bf16 v[172:175], a[124:127], a[188:191], v[172:175]
  v_mfma_f32_16x16x32_bf16 v[196:199], a[124:127], a[220:223], v[196:199]
  s_nop 7
  s_nop 1
  v_max3_f32 v217, v217, v160, v161
  v_max3_f32 v217, v217, v162, v163
  v_max3_f32 v217, v217, v168, v169
  v_max3_f32 v217, v217, v170, v171
  v_max3_f32 v218, v218, v164, v165
  v_max3_f32 v218, v218, v166, v167
  v_max3_f32 v218, v218, v172, v173
  v_max3_f32 v218, v218, v174, v175
  v_max3_f32 v219, v219, v192, v193
  v_max3_f32 v219, v219, v194, v195
  v_max3_f32 v219, v219, v196, v197
  v_max3_f32 v219, v219, v198, v199
  s_add_u32 s36, s36, 16384
  s_cmp_lt_u32 s36, 524288
  s_cbranch_scc1 L_maxloop
  v_mov_b32 v249, v217
  s_nop 1
  v_permlane32_swap_b32 v217, v249
  s_nop 1
  v_max_f32 v217, v217, v249
  v_mov_b32 v249, v217
  s_nop 1
  v_permlane16_swap_b32 v217, v249
  s_nop 1
  v_max_f32 v217, v217, v249
  v_mov_b32 v249, v218
  s_nop 1
  v_permlane32_swap_b32 v218, v249
  s_nop 1
  v_max_f32 v218, v218, v249
  v_mov_b32 v249, v218
  s_nop 1
  v_permlane16_swap_b32 v218, v249
  s_nop 1
  v_max_f32 v218, v218, v249
  v_mov_b32 v249, v219
  s_nop 1
  v_permlane32_swap_b32 v219, v249
  s_nop 1
  v_max_f32 v219, v219, v249
  v_mov_b32 v249, v219
  s_nop 1
  v_permlane16_swap_b32 v219, v249
  s_nop 1
  v_max_f32 v219, v219, v249
  s_barrier
  s_branch L_restart
L_done:
  s_endpgm
.section .rodata,"a"
.p2align 6
.amdhsa_kernel standalone__mha_softmax__near_ridge_kernel
  .amdhsa_next_free_vgpr 512
  .amdhsa_next_free_sgpr 102
  .amdhsa_accum_offset 256
  .amdhsa_group_segment_fixed_size 0
  .amdhsa_kernarg_size 48
  .amdhsa_user_sgpr_count 2
  .amdhsa_user_sgpr_kernarg_segment_ptr 1
  .amdhsa_system_sgpr_workgroup_id_x 1
.end_amdhsa_kernel
```
